```python
import torch

def _softmax(x, axis=-1):
    return torch.softmax(x, dim=axis)
def _gelu(x):
    return torch.nn.functional.gelu(x, approximate="tanh")
def _silu(x):
    return torch.nn.functional.silu(x)
def _sigmoid(x):
    return torch.sigmoid(x)
def _layernorm(x, axis=-1, eps=1e-5):
    m = x.mean(dim=axis, keepdim=True)
    v = x.var(dim=axis, keepdim=True, unbiased=False)
    return (x - m) / torch.sqrt(v + eps)
def _scatter_add(tgt, idx, src, axis=0):
    return tgt.clone().index_add_(axis, idx, src)
def _segment_sum(src, seg, n):
    out = torch.zeros((n,) + src.shape[1:], dtype=src.dtype)
    return out.index_add_(0, seg, src)
def _pad(x, pw):
    flat = tuple(v for pair in reversed(pw) for v in pair)
    return torch.nn.functional.pad(x, flat)

kernel_name = 'parallel_sum__sliding_block__glu_gated_bilinear__prompt'

def setup_inputs():

    _w = (lambda a: (lambda t: t.to(torch.bfloat16) if t.is_floating_point() else t)(torch.as_tensor(a)))
    def _A_setup():
        B, S, D = 1, 2048, 448
        return {
            "x": _w((lambda *s: torch.randn(*s, dtype=torch.bfloat16) * 0.05)(B, S, D)),
            "wqkv": _w((lambda *s: torch.randn(*s, dtype=torch.bfloat16) * 0.05)(D, 3 * D)),
            "wo": _w((lambda *s: torch.randn(*s, dtype=torch.bfloat16) * 0.05)(D, D)),
        }
    _A_in = _A_setup()

    def _B_setup():
        B, S, D, F = 1, 2048, 448, 1792
        return {
            "x": _w((lambda *s: torch.randn(*s, dtype=torch.bfloat16) * 0.05)(B, S, D)),
            "w_gate": _w((lambda *s: torch.randn(*s, dtype=torch.bfloat16) * 0.8)(D, F) * (D ** -0.5)),
            "w_up": _w((lambda *s: torch.randn(*s, dtype=torch.bfloat16) * 0.8)(D, F) * (D ** -0.5)),
            "w_down": _w((lambda *s: torch.randn(*s, dtype=torch.bfloat16) * 0.8)(F, D) * (F ** -0.5)),
        }
    _B_in = _B_setup()

    return {
        "A_x": _A_in["x"],
        "A_wqkv": _A_in["wqkv"],
        "A_wo": _A_in["wo"],
        "B_x": _B_in["x"],
        "B_w_gate": _B_in["w_gate"],
        "B_w_up": _B_in["w_up"],
        "B_w_down": _B_in["w_down"],
    }

def reference(A_x, A_wqkv, A_wo, B_x, B_w_gate, B_w_up, B_w_down):
    def _A_ref(x, wqkv, wo):
        B, S, D = x.shape
        H = 16; Dh = D // H; W = 256
        qkv = (lambda x, *d: x.permute(*d))((x @ wqkv).reshape(B, S, 3, H, Dh), 2, 0, 3, 1, 4)
        q, k, v = qkv[0], qkv[1], qkv[2]
        scores = torch.einsum("bhqd,bhkd->bhqk", q, k) * (Dh ** -0.5)
        idx = torch.arange(S)
        mask = (idx[:, None] - idx[None, :] >= 0) & (idx[:, None] - idx[None, :] < W)
        scores = torch.where(mask[None, None], scores, -1e9)
        p = _softmax(scores, axis=-1)
        o = torch.einsum("bhqk,bhkd->bhqd", p, v)
        return (lambda x, *d: x.permute(*d))(o, 0, 2, 1, 3).reshape(B, S, D) @ wo

    def _B_ref(x, w_gate, w_up, w_down):
        g = torch.einsum("bsd,df->bsf", x, w_gate)
        u = torch.einsum("bsd,df->bsf", x, w_up)
        h = g * u
        return torch.einsum("bsf,fd->bsd", h, w_down)

    x = A_x
    xn = _layernorm(x, axis=-1)
    return x + _A_ref(xn, A_wqkv, A_wo) + _B_ref(xn, B_w_gate, B_w_up, B_w_down)
```

```asm
; @launch grid=(256,1,1) block=(256,1,1) lds=163840
.amdgcn_target "amdgcn-amd-amdhsa--gfx950"
.text
.globl parallel_sum__sliding_block__glu_gated_bilinear__prompt_kernel
.p2align 8
.type parallel_sum__sliding_block__glu_gated_bilinear__prompt_kernel,@function
parallel_sum__sliding_block__glu_gated_bilinear__prompt_kernel:
  s_cmp_ge_u32 s2, 256
  s_cbranch_scc1 L_END
  s_load_dwordx2 s[8:9], s[0:1], 0
  s_load_dwordx2 s[12:13], s[0:1], 8
  v_lshrrev_b32 v3, 6, v0
  v_and_b32 v1, 63, v0
  v_readfirstlane_b32 s3, v3
  v_lshlrev_b32 v2, 4, v1
  s_and_b32 s92, s2, 7
  s_lshr_b32 s6, s2, 3
  s_getpc_b64 s[96:97]
L_PFBASE:
  s_lshl_b32 s76, s2, 2
  s_add_u32 s76, s76, s3
  s_mul_i32 s76, s76, 324
  s_add_u32 s76, s76, L_TABLE-L_PFBASE
  s_add_u32 s80, s96, s76
  s_addc_u32 s81, s97, 0
  v_min_u32 v11, 48, v1
  v_lshlrev_b32 v11, 2, v11
  global_load_dword v252, v11, s[80:81]
  global_load_dword v11, v11, s[80:81] offset:128
  s_and_b32 s76, s6, 3
  s_cmp_eq_u32 s76, s3
  s_cbranch_scc0 L1
  s_lshl_b32 s76, s76, 13
  v_lshlrev_b32 v90, 7, v1
  v_add_u32 v90, s76, v90
  v_min_u32 v90, L_CEND-L_PFBASE, v90
  global_load_dword v252, v90, s[96:97]
L1:
  s_and_b32 s76, s92, 1
  s_lshl_b32 s76, s76, 3
  s_and_b32 s77, s6, 7
  s_add_u32 s93, s76, s77
  s_lshr_b32 s76, s92, 1
  s_lshl_b32 s76, s76, 2
  s_lshr_b32 s77, s6, 3
  s_add_u32 s94, s76, s77
  v_lshrrev_b32 v254, 3, v1
  v_lshrrev_b32 v85, 4, v1
  v_and_b32 v86, 7, v1
  v_xor_b32 v87, v86, v85
  v_mul_u32_u24 v88, 896, v254
  v_lshl_add_u32 v112, v87, 4, v88
  v_xor_b32 v113, 64, v112
  v_add_u32 v115, 18432, v113
  v_add_u32 v113, 6144, v113
  v_add_u32 v114, 12288, v112
  s_lshl_b32 s95, s93, 2
  s_add_u32 s95, s95, s3
  s_mul_i32 s82, s95, 28672
  s_lshl_b32 s84, s3, 12
  v_and_b32 v255, 1, v85
  v_lshlrev_b32 v255, 2, v255
  v_xor_b32 v255, v255, v86
  v_lshlrev_b32 v255, 4, v255
  s_movk_i32 s78, 2688
  v_mad_u32_u24 v116, v254, s78, v255
  v_add_u32 v117, 20480, v116
  v_add_u32 v4, v88, v255
  v_add_u32 v5, 6144, v4
  s_mul_i32 s83, s3, 43008
  s_lshl_b32 s76, s94, 7
  s_add_u32 s83, s83, s76
  s_lshl_b32 s85, s3, 11
  s_add_u32 s85, s85, 98304
  s_lshl_b32 s79, s93, 4
  s_add_u32 s79, s79, s94
  s_lshl_b32 s79, s79, 2
  s_add_u32 s79, s79, s3
  s_mul_i32 s88, s79, 1792
  v_cmp_gt_u32 vcc, 56, v1
  v_mov_b32 v89, 0x10000000
  s_lshr_b32 s4, s3, 1
  s_and_b32 s5, s3, 1
  v_cndmask_b32 v89, v89, v2, vcc
  s_and_b32 s76, s6, 7
  s_cmp_ge_u32 s76, 3
  s_addc_u32 s77, s76, 0
  s_lshl_b32 s77, s77, 3
  s_add_u32 s78, s3, 1
  s_bitcmp0_b32 s78, 1
  s_cselect_b32 s77, 72, s77
  s_load_dwordx2 s[96:97], s[0:1], s77
  s_mov_b32 s78, 1605628
  s_cmp_eq_u32 s76, 0
  s_cselect_b32 s78, 1835004, s78
  s_cmp_eq_u32 s76, 6
  s_cselect_b32 s78, 1835004, s78
  s_cmp_eq_u32 s76, 1
  s_cselect_b32 s78, 1204220, s78
  s_cmp_eq_u32 s76, 2
  s_cselect_b32 s78, 401404, s78
  s_cmp_eq_u32 s76, 7
  s_cselect_b32 s78, 0, s78
  s_lshl_b32 s76, s76, 21
  s_cmp_eq_u32 s3, 0
  s_cselect_b32 s78, s76, s78
  s_cmp_eq_u32 s3, 1
  s_cselect_b32 s78, 0, s78
  s_cmp_eq_u32 s3, 3
  s_cselect_b32 s78, 15204224, s78
  v_mov_b32 v227, s78
  s_mov_b32 s10, 1835008
  s_mov_b32 s11, 0x20000
  s_mov_b32 s14, 1204224
  s_mov_b32 s15, 0x20000
  s_mov_b32 s26, 16252928
  s_mov_b32 s27, 0x20000
  s_mov_b32 s42, 256
  s_mov_b32 s43, 0x20000
  s_mov_b32 s34, 401408
  s_mov_b32 s35, 0x20000
  s_mov_b32 s22, 1605632
  s_mov_b32 s23, 0x20000
  s_mov_b32 s19, 0x20000
  s_mov_b32 s39, 0x20000
  s_sub_u32 s76, s94, 12
  s_cmp_lt_u32 s76, 3
  s_cselect_b32 s86, 1, 0
  s_cselect_b32 s18, s14, s22
  s_lshl_b32 s76, s94, 1
  s_add_u32 s76, s76, s4
  s_cmp_ge_u32 s76, 29
  s_cselect_b32 s18, 0, s18
  s_mul_i32 s90, s95, 16128
  s_lshl_b32 s77, s94, 7
  s_add_u32 s90, s90, s77
  s_add_u32 s90, s90, 172032
  v_min_u32 v224, 5, v1
  v_mul_u32_u24 v224, 2688, v224
  v_lshlrev_b32 v8, 28, v1
  v_and_b32 v84, 31, v1
  v_lshrrev_b32 v85, 5, v1
  v_bfe_u32 v86, v1, 1, 3
  v_xor_b32 v86, v86, v85
  v_lshlrev_b32 v87, 7, v84
  v_add_u32 v87, s84, v87
  v_xor_b32 v88, 0, v86
  v_lshl_add_u32 v12, v88, 4, v87
  v_xor_b32 v16, 4096, v12
  v_xor_b32 v88, 2, v86
  v_lshl_add_u32 v13, v88, 4, v87
  v_xor_b32 v17, 4096, v13
  v_xor_b32 v88, 4, v86
  v_lshl_add_u32 v14, v88, 4, v87
  v_xor_b32 v18, 4096, v14
  v_xor_b32 v88, 6, v86
  v_lshl_add_u32 v15, v88, 4, v87
  v_xor_b32 v19, 4096, v15
  v_bfe_u32 v86, v1, 2, 2
  v_lshl_add_u32 v87, v85, 3, v86
  v_and_b32 v88, 3, v1
  v_lshlrev_b32 v88, 3, v88
  v_lshl_add_u32 v87, v87, 7, v88
  v_add_u32 v22, 98304, v87
  v_and_b32 v86, 2, v86
  v_bfe_u32 v26, v1, 4, 1
  v_xor_b32 v23, v86, v26
  s_lshl_b32 s76, s5, 1
  v_xor_b32 v225, s76, v23
  v_lshl_add_u32 v20, v225, 5, v22
  v_lshrrev_b32 v225, 2, v1
  v_xor_b32 v225, v225, v26
  v_and_b32 v225, 1, v225
  v_and_or_b32 v225, v1, 3, v225
  v_cmp_eq_u32 vcc, 0, v225
  v_mov_b32 v226, 0x3f803f80
  v_add_u32 v10, 147456, v2
  v_cndmask_b32 v28, 0, v226, vcc
  v_cndmask_b32 v29, 0, v226, vcc
  v_cndmask_b32 v30, 0, v226, vcc
  v_cndmask_b32 v31, 0, v226, vcc
  s_waitcnt lgkmcnt(0)
  global_load_dword v252, v227, s[96:97]
  s_add_u32 m0, s84, 0
  s_nop 0
  buffer_load_dwordx4 v112, s[8:11], s82 offen offset:0 lds
  buffer_load_dwordx4 v113, s[8:11], s82 offen offset:1024 lds
  s_add_u32 m0, s84, 0
  s_nop 0
  buffer_load_dwordx4 v114, s[8:11], s82 offen offset:2048 lds
  buffer_load_dwordx4 v115, s[8:11], s82 offen offset:3072 lds
  s_add_u32 m0, s85, 0
  s_nop 0
  buffer_load_dwordx4 v116, s[12:15], s83 offen lds
  buffer_load_dwordx4 v117, s[12:15], s83 offen offset:1024 lds
  s_load_dwordx2 s[32:33], s[0:1], 16
  s_load_dwordx4 s[92:95], s[0:1], 32
  s_load_dwordx4 s[28:31], s[0:1], 48
  s_load_dwordx2 s[40:41], s[0:1], 64
  s_load_dwordx2 s[24:25], s[0:1], 72
  s_load_dwordx16 s[44:59], s[80:81], 0
  s_load_dwordx16 s[60:75], s[80:81], 64
  buffer_load_dwordx4 v[232:235], v89, s[8:11], s88 offen offset:0
  buffer_load_dwordx4 v[236:239], v89, s[8:11], s88 offen offset:896
  buffer_load_dword v252, v224, s[12:15], s90 offen
  s_add_u32 m0, s84, 16384
  s_add_u32 s82, s82, 128
  buffer_load_dwordx4 v112, s[8:11], s82 offen offset:0 lds
  buffer_load_dwordx4 v113, s[8:11], s82 offen offset:1024 lds
  s_add_u32 m0, s84, 16384
  s_nop 0
  buffer_load_dwordx4 v114, s[8:11], s82 offen offset:2048 lds
  buffer_load_dwordx4 v115, s[8:11], s82 offen offset:3072 lds
  s_add_u32 m0, s85, 8192
  s_add_u32 s83, s83, 172032
  buffer_load_dwordx4 v116, s[12:15], s83 offen lds
  buffer_load_dwordx4 v117, s[12:15], s83 offen offset:1024 lds
  s_waitcnt lgkmcnt(0)
  s_waitcnt vmcnt(9)
  s_barrier
  ds_read_b128 a[0:3], v12 offset:0
  ds_read_b128 a[112:115], v16 offset:0
  ds_read_b64_tr_b16 v[44:45], v20 offset:0
  ds_read_b64_tr_b16 v[46:47], v20 offset:512
  ds_read_b128 a[4:7], v13 offset:0
  ds_read_b128 a[116:119], v17 offset:0
  ds_read_b64_tr_b16 v[36:37], v20 offset:2048
  ds_read_b64_tr_b16 v[38:39], v20 offset:2560
  s_waitcnt lgkmcnt(4)
  v_mfma_f32_32x32x16_bf16 v[192:207], v[44:47], a[0:3], 0
  ds_read_b128 a[8:11], v14 offset:0
  ds_read_b128 a[120:123], v18 offset:0
  v_mfma_f32_32x32x16_bf16 v[208:223], v[44:47], a[112:115], 0
  ds_read_b64_tr_b16 v[40:41], v20 offset:4096
  ds_read_b64_tr_b16 v[42:43], v20 offset:4608
  s_add_u32 m0, s84, 32768
  s_add_u32 s82, s82, 128
  buffer_load_dwordx4 v112, s[8:11], s82 offen offset:0 lds
  buffer_load_dwordx4 v113, s[8:11], s82 offen offset:1024 lds
  s_add_u32 m0, s84, 32768
  s_nop 0
  buffer_load_dwordx4 v114, s[8:11], s82 offen offset:2048 lds
  buffer_load_dwordx4 v115, s[8:11], s82 offen offset:3072 lds
  s_or_b32 s79, s6, s3
  s_cmp_lg_u32 s79, 0
  s_cbranch_scc1 L4
  s_memrealtime s[98:99]
  s_waitcnt lgkmcnt(0)
  s_and_b32 s79, s98, 0x3fff
  s_lshl_b32 s90, s98, 2
  s_and_b32 s90, s90, 0x3fff0000
  s_or_b32 s79, s79, s90
  s_or_b32 s79, s79, 1
  s_lshr_b64 s[90:91], s[98:99], 28
  s_or_b32 s90, s90, 0x80000000
  v_mov_b32 v128, s79
  v_mov_b32 v129, s90
  v_mov_b32 v130, 0
  v_mov_b32 v131, 0
  v_lshlrev_b32 v132, 8, v1
  buffer_atomic_cmpswap_x2 v[128:131], v132, s[40:43], 0 offen sc1
L4:
  s_mov_b32 s30, 1605632
  s_mov_b32 s31, 0x20000
  s_cmp_eq_u32 s4, 0
  s_cselect_b64 s[20:21], s[92:93], s[94:95]
  v_mfma_f32_16x16x32_bf16 v[48:51], v[28:31], v[44:47], 0
  s_cmp_eq_u32 s86, 1
  s_cselect_b64 s[16:17], s[12:13], s[20:21]
  s_waitcnt lgkmcnt(4)
  v_mfma_f32_32x32x16_bf16 v[192:207], v[36:39], a[4:7], v[192:207]
  ds_read_b128 a[12:15], v15 offset:0
  ds_read_b128 a[124:127], v19 offset:0
  v_mfma_f32_32x32x16_bf16 v[208:223], v[36:39], a[116:119], v[208:223]
  ds_read_b64_tr_b16 v[44:45], v20 offset:6144
  ds_read_b64_tr_b16 v[46:47], v20 offset:6656
  s_add_u32 m0, s85, 16384
  s_add_u32 s83, s83, 172032
  buffer_load_dwordx4 v116, s[12:15], s83 offen lds
  buffer_load_dwordx4 v117, s[12:15], s83 offen offset:1024 lds
  s_bitcmp0_b32 s6, 0
  s_cselect_b64 s[36:37], s[92:93], s[94:95]
  s_lshr_b32 s76, s6, 1
  s_andn2_b32 s76, s86, s76
  s_cselect_b64 s[36:37], s[12:13], s[36:37]
  s_cselect_b32 s38, s14, s22
  v_mfma_f32_16x16x32_bf16 v[48:51], v[28:31], v[36:39], v[48:51]
  s_waitcnt vmcnt(6)
  s_barrier
  s_waitcnt lgkmcnt(4)
  v_mfma_f32_32x32x16_bf16 v[192:207], v[40:43], a[8:11], v[192:207]
  ds_read_b128 a[16:19], v12 offset:16384
  ds_read_b128 a[128:131], v16 offset:16384
  v_mfma_f32_32x32x16_bf16 v[208:223], v[40:43], a[120:123], v[208:223]
  ds_read_b64_tr_b16 v[36:37], v20 offset:8192
  ds_read_b64_tr_b16 v[38:39], v20 offset:8704
  s_add_u32 m0, s84, 49152
  s_add_u32 s82, s82, 128
  buffer_load_dwordx4 v112, s[8:11], s82 offen offset:0 lds
  buffer_load_dwordx4 v113, s[8:11], s82 offen offset:1024 lds
  v_readlane_b32 s94, v11, 23
  s_lshr_b32 s93, s59, 3
  s_lshl_b32 s76, s4, 5
  v_xor_b32 v84, s76, v255
  s_movk_i32 s76, 3584
  v_mad_u32_u24 v21, v254, s94, v84
  v_readlane_b32 s88, v11, 46
  v_readlane_b32 s89, v11, 23
  v_min_u32 v230, 13, v1
  s_nop 0
  v_mul_lo_u32 v231, s89, v230
  s_nop 0
  buffer_load_dword v252, v231, s[16:19], s88 offen
  v_mfma_f32_16x16x32_bf16 v[48:51], v[28:31], v[40:43], v[48:51]
  s_waitcnt lgkmcnt(4)
  v_mfma_f32_32x32x16_bf16 v[192:207], v[44:47], a[12:15], v[192:207]
  ds_read_b128 a[20:23], v13 offset:16384
  ds_read_b128 a[132:135], v17 offset:16384
  v_mfma_f32_32x32x16_bf16 v[208:223], v[44:47], a[124:127], v[208:223]
  ds_read_b64_tr_b16 v[40:41], v20 offset:10240
  ds_read_b64_tr_b16 v[42:43], v20 offset:10752
  s_add_u32 m0, s84, 49152
  s_nop 0
  buffer_load_dwordx4 v114, s[8:11], s82 offen offset:2048 lds
  buffer_load_dwordx4 v115, s[8:11], s82 offen offset:3072 lds
  v_mad_u32_u24 v9, v254, s76, v84
  s_lshr_b32 s76, s46, 1
  s_sub_u32 s76, s76, 1024
  v_add_u32 v90, s76, v21
  v_mfma_f32_16x16x32_bf16 v[48:51], v[28:31], v[44:47], v[48:51]
  v_add_u32 v91, 27648, v9
  v_min_u32 v253, 55, v1
  s_waitcnt lgkmcnt(4)
  v_mfma_f32_32x32x16_bf16 v[192:207], v[36:39], a[16:19], v[192:207]
  ds_read_b128 a[24:27], v14 offset:16384
  ds_read_b128 a[136:139], v18 offset:16384
  v_mfma_f32_32x32x16_bf16 v[208:223], v[36:39], a[128:131], v[208:223]
  ds_read_b64_tr_b16 v[44:45], v20 offset:12288
  ds_read_b64_tr_b16 v[46:47], v20 offset:12800
  s_add_u32 m0, s85, 24576
  s_add_u32 s83, s83, 172032
  buffer_load_dwordx4 v116, s[12:15], s83 offen lds
  buffer_load_dwordx4 v117, s[12:15], s83 offen offset:1024 lds
  v_mul_lo_u32 v253, s93, v253
  v_mad_u32_u24 v254, v254, s93, v255
  s_mul_i32 s76, s4, 14336
  s_add_u32 s76, s76, 4294934528
  v_mfma_f32_16x16x32_bf16 v[48:51], v[28:31], v[36:39], v[48:51]
  v_add_u32 v255, s76, v20
  s_mov_b32 s76, 0x3f803f80
  s_waitcnt lgkmcnt(4)
  v_mfma_f32_32x32x16_bf16 v[192:207], v[40:43], a[20:23], v[192:207]
  ds_read_b128 a[28:31], v15 offset:16384
  ds_read_b128 a[140:143], v19 offset:16384
  v_mfma_f32_32x32x16_bf16 v[208:223], v[40:43], a[132:135], v[208:223]
  ds_read_b64_tr_b16 v[36:37], v20 offset:14336
  ds_read_b64_tr_b16 v[38:39], v20 offset:14848
  v_dot2_f32_bf16 v84, v232, s76, 0
  v_dot2_f32_bf16 v85, v236, s76, 0
  v_dot2_f32_bf16 v86, v232, v232, 0
  v_dot2_f32_bf16 v87, v236, v236, 0
  v_mfma_f32_16x16x32_bf16 v[48:51], v[28:31], v[40:43], v[48:51]
  v_dot2_f32_bf16 v84, v233, s76, v84
  v_dot2_f32_bf16 v85, v237, s76, v85
  s_waitcnt vmcnt(7)
  s_barrier
  s_waitcnt lgkmcnt(4)
  v_mfma_f32_32x32x16_bf16 v[192:207], v[44:47], a[24:27], v[192:207]
  ds_read_b128 a[32:35], v12 offset:32768
  ds_read_b128 a[144:147], v16 offset:32768
  v_mfma_f32_32x32x16_bf16 v[208:223], v[44:47], a[136:139], v[208:223]
  ds_read_b64_tr_b16 v[40:41], v20 offset:16384
  ds_read_b64_tr_b16 v[42:43], v20 offset:16896
  s_add_u32 m0, s84, 0
  s_add_u32 s82, s82, 128
  buffer_load_dwordx4 v112, s[8:11], s82 offen offset:0 lds
  buffer_load_dwordx4 v113, s[8:11], s82 offen offset:1024 lds
  v_dot2_f32_bf16 v86, v233, v233, v86
  v_dot2_f32_bf16 v87, v237, v237, v87
  v_dot2_f32_bf16 v84, v234, s76, v84
  v_dot2_f32_bf16 v85, v238, s76, v85
  v_mfma_f32_16x16x32_bf16 v[48:51], v[28:31], v[44:47], v[48:51]
  v_dot2_f32_bf16 v86, v234, v234, v86
  v_dot2_f32_bf16 v87, v238, v238, v87
  s_waitcnt lgkmcnt(4)
  v_mfma_f32_32x32x16_bf16 v[192:207], v[36:39], a[28:31], v[192:207]
  ds_read_b128 a[36:39], v13 offset:32768
  ds_read_b128 a[148:151], v17 offset:32768
  v_mfma_f32_32x32x16_bf16 v[208:223], v[36:39], a[140:143], v[208:223]
  ds_read_b64_tr_b16 v[44:45], v20 offset:18432
  ds_read_b64_tr_b16 v[46:47], v20 offset:18944
  s_add_u32 m0, s84, 0
  s_nop 0
  buffer_load_dwordx4 v114, s[8:11], s82 offen offset:2048 lds
  buffer_load_dwordx4 v115, s[8:11], s82 offen offset:3072 lds
  v_dot2_f32_bf16 v84, v235, s76, v84
  v_dot2_f32_bf16 v85, v239, s76, v85
  v_dot2_f32_bf16 v86, v235, v235, v86
  v_dot2_f32_bf16 v87, v239, v239, v87
  v_and_b32 v224, 31, v1
  v_mfma_f32_16x16x32_bf16 v[48:51], v[28:31], v[36:39], v[48:51]
  v_lshlrev_b32 v248, 27, v224
  v_lshrrev_b32 v225, 5, v1
  s_waitcnt lgkmcnt(4)
  v_mfma_f32_32x32x16_bf16 v[192:207], v[40:43], a[32:35], v[192:207]
  ds_read_b128 a[40:43], v14 offset:32768
  ds_read_b128 a[152:155], v18 offset:32768
  v_mfma_f32_32x32x16_bf16 v[208:223], v[40:43], a[144:147], v[208:223]
  ds_read_b64_tr_b16 v[36:37], v20 offset:20480
  ds_read_b64_tr_b16 v[38:39], v20 offset:20992
  s_add_u32 m0, s85, 32768
  s_add_u32 s83, s83, 172032
  buffer_load_dwordx4 v116, s[12:15], s83 offen lds
  buffer_load_dwordx4 v117, s[12:15], s83 offen offset:1024 lds
  v_permlane32_swap_b32 v84, v85
  v_permlane32_swap_b32 v86, v87
  v_add_f32 v84, v84, v85
  v_add_f32 v86, v86, v87
  v_mfma_f32_16x16x32_bf16 v[48:51], v[28:31], v[40:43], v[48:51]
  v_lshl_add_u32 v248, v225, 3, v248
  v_mov_b32 v249, 0
  s_waitcnt lgkmcnt(4)
  v_mfma_f32_32x32x16_bf16 v[192:207], v[44:47], a[36:39], v[192:207]
  ds_read_b128 a[44:47], v15 offset:32768
  ds_read_b128 a[156:159], v19 offset:32768
  v_mfma_f32_32x32x16_bf16 v[208:223], v[44:47], a[148:151], v[208:223]
  ds_read_b64_tr_b16 v[40:41], v20 offset:22528
  ds_read_b64_tr_b16 v[42:43], v20 offset:23040
  v_permlane16_swap_b32 v84, v86
  v_add_f32 v84, v84, v86
  v_readlane_b32 s92, v11, 5
  s_mov_b32 s77, 0xffff
  v_mfma_f32_16x16x32_bf16 v[48:51], v[28:31], v[44:47], v[48:51]
  v_add_f32_dpp v84, v84, v84 row_ror:8 row_mask:0xf bank_mask:0xf
  s_nop 1
  s_waitcnt vmcnt(6)
  s_barrier
  s_waitcnt lgkmcnt(4)
  v_mfma_f32_32x32x16_bf16 v[192:207], v[36:39], a[40:43], v[192:207]
  ds_read_b128 a[48:51], v12 offset:49152
  ds_read_b128 a[160:163], v16 offset:49152
  v_mfma_f32_32x32x16_bf16 v[208:223], v[36:39], a[152:155], v[208:223]
  ds_read_b64_tr_b16 v[44:45], v20 offset:24576
  ds_read_b64_tr_b16 v[46:47], v20 offset:25088
  s_add_u32 m0, s84, 16384
  s_add_u32 s82, s82, 128
  buffer_load_dwordx4 v112, s[8:11], s82 offen offset:0 lds
  buffer_load_dwordx4 v113, s[8:11], s82 offen offset:1024 lds
  v_add_f32_dpp v84, v84, v84 row_ror:4 row_mask:0xf bank_mask:0xf
  v_readlane_b32 s95, v11, 17
  v_readlane_b32 s96, v11, 20
  v_add_f32_dpp v84, v84, v84 row_ror:2 row_mask:0xf bank_mask:0xf
  v_readlane_b32 s97, v11, 21
  v_mov_b32 v77, 0
  v_mfma_f32_16x16x32_bf16 v[48:51], v[28:31], v[36:39], v[48:51]
  v_add_f32_dpp v84, v84, v84 row_ror:1 row_mask:0xf bank_mask:0xf
  buffer_load_dwordx2 v[6:7], v249, s[40:43], 0 offen sc1
  s_waitcnt lgkmcnt(4)
  v_mfma_f32_32x32x16_bf16 v[192:207], v[40:43], a[44:47], v[192:207]
  ds_read_b128 a[52:55], v13 offset:49152
  ds_read_b128 a[164:167], v17 offset:49152
  v_mfma_f32_32x32x16_bf16 v[208:223], v[40:43], a[156:159], v[208:223]
  ds_read_b64_tr_b16 v[36:37], v20 offset:26624
  ds_read_b64_tr_b16 v[38:39], v20 offset:27136
  s_add_u32 m0, s84, 16384
  s_nop 0
  buffer_load_dwordx4 v114, s[8:11], s82 offen offset:2048 lds
  buffer_load_dwordx4 v115, s[8:11], s82 offen offset:3072 lds
  v_mov_b32 v86, v84
  v_mov_b32 v78, 0
  v_mov_b32 v79, 0
  v_permlane16_swap_b32 v84, v86
  v_mfma_f32_16x16x32_bf16 v[48:51], v[28:31], v[40:43], v[48:51]
  v_mul_f32 v85, 0x3b124925, v84
  v_mul_f32 v86, 0x3b124925, v86
  s_waitcnt lgkmcnt(4)
  v_mfma_f32_32x32x16_bf16 v[192:207], v[44:47], a[48:51], v[192:207]
  ds_read_b128 a[56:59], v14 offset:49152
  ds_read_b128 a[168:171], v18 offset:49152
  v_mfma_f32_32x32x16_bf16 v[208:223], v[44:47], a[160:163], v[208:223]
  ds_read_b64_tr_b16 v[40:41], v20 offset:28672
  ds_read_b64_tr_b16 v[42:43], v20 offset:29184
  s_add_u32 m0, s85, 40960
  s_add_u32 s83, s83, 172032
  buffer_load_dwordx4 v116, s[12:15], s83 offen lds
  buffer_load_dwordx4 v117, s[12:15], s83 offen offset:1024 lds
  v_fmac_f32 v84, 0xc3e00000, v85
  v_fmamk_f32 v84, v84, 0x3b124925, v85
  v_fma_f32 v86, -v84, v84, v86
  v_max_f32 v86, 0, v86
  v_mfma_f32_16x16x32_bf16 v[48:51], v[28:31], v[44:47], v[48:51]
  v_cvt_pk_bf16_f32 v84, v84, v86
  v_and_b32 v86, 0xffff0000, v84
  s_waitcnt lgkmcnt(4)
  v_mfma_f32_32x32x16_bf16 v[192:207], v[36:39], a[52:55], v[192:207]
  ds_read_b128 a[60:63], v15 offset:49152
  ds_read_b128 a[172:175], v19 offset:49152
  v_mfma_f32_32x32x16_bf16 v[208:223], v[36:39], a[164:167], v[208:223]
  ds_read_b64_tr_b16 v[44:45], v20 offset:30720
  ds_read_b64_tr_b16 v[46:47], v20 offset:31232
  v_add_f32 v86, 0x3727c5ac, v86
  v_cvt_pk_bf16_f32 v86, v86, v86
  v_lshlrev_b32 v86, 16, v86
  v_sqrt_f32 v86, v86
  v_mfma_f32_16x16x32_bf16 v[48:51], v[28:31], v[36:39], v[48:51]
  v_mov_b32 v53, 0
  v_cvt_pk_bf16_f32 v86, v86, v86
  s_waitcnt vmcnt(7)
  s_barrier
  s_waitcnt lgkmcnt(4)
  v_mfma_f32_32x32x16_bf16 v[192:207], v[40:43], a[56:59], v[192:207]
  ds_read_b128 a[64:67], v12 offset:0
  ds_read_b128 a[176:179], v16 offset:0
  v_mfma_f32_32x32x16_bf16 v[208:223], v[40:43], a[168:171], v[208:223]
  ds_read_b64_tr_b16 v[36:37], v20 offset:32768
  ds_read_b64_tr_b16 v[38:39], v20 offset:33280
  s_add_u32 m0, s84, 32768
  s_add_u32 s82, s82, 128
  buffer_load_dwordx4 v112, s[8:11], s82 offen offset:0 lds
  buffer_load_dwordx4 v113, s[8:11], s82 offen offset:1024 lds
  s_add_u32 m0, s84, 32768
  s_nop 0
  buffer_load_dwordx4 v114, s[8:11], s82 offen offset:2048 lds
  buffer_load_dwordx4 v115, s[8:11], s82 offen offset:3072 lds
  v_bfi_b32 v250, s77, v84, v86
  s_lshl_b32 s76, s5, 1
  s_add_u32 s77, s76, s4
  v_xor_b32 v84, s77, v23
  v_lshl_add_u32 v85, v26, 13, v22
  v_mfma_f32_16x16x32_bf16 v[48:51], v[28:31], v[40:43], v[48:51]
  v_lshl_add_u32 v24, v84, 5, v85
  v_xor_b32 v25, 32, v24
  s_waitcnt lgkmcnt(4)
  v_mfma_f32_32x32x16_bf16 v[192:207], v[44:47], a[60:63], v[192:207]
  ds_read_b128 a[68:71], v13 offset:0
  ds_read_b128 a[180:183], v17 offset:0
  v_mfma_f32_32x32x16_bf16 v[208:223], v[44:47], a[172:175], v[208:223]
  ds_read_b64_tr_b16 v[40:41], v20 offset:34816
  ds_read_b64_tr_b16 v[42:43], v20 offset:35328
  s_add_u32 m0, s85, 49152
  s_add_u32 s83, s83, 172032
  buffer_load_dwordx4 v116, s[12:15], s83 offen lds
  buffer_load_dwordx4 v117, s[12:15], s83 offen offset:1024 lds
  s_lshl_b32 s77, s4, 1
  s_xor_b32 s77, s77, s5
  v_xor_b32 v84, s77, v23
  s_lshl_b32 s78, s5, 13
  v_mfma_f32_16x16x32_bf16 v[48:51], v[28:31], v[44:47], v[48:51]
  v_add_u32 v85, s78, v22
  v_lshl_add_u32 v84, v84, 5, v85
  s_waitcnt lgkmcnt(4)
  v_mfma_f32_32x32x16_bf16 v[192:207], v[36:39], a[64:67], v[192:207]
  ds_read_b128 a[72:75], v14 offset:0
  ds_read_b128 a[184:187], v18 offset:0
  v_mfma_f32_32x32x16_bf16 v[208:223], v[36:39], a[176:179], v[208:223]
  ds_read_b64_tr_b16 v[44:45], v20 offset:36864
  ds_read_b64_tr_b16 v[46:47], v20 offset:37376
  s_add_u32 m0, s84, 98304
  s_nop 0
  buffer_load_dwordx4 v21, s[16:19], s44 offen lds
  buffer_load_dwordx4 v90, s[16:19], s44 offen offset:1024 lds
  v_xor_b32 v85, 64, v84
  v_lshlrev_b32 v86, 9, v225
  v_sub_u32 v86, v22, v86
  v_lshl_add_u32 v86, v23, 5, v86
  v_add_u32 v108, s84, v86
  v_xor_b32 v109, 64, v108
  s_bitcmp1_b32 s6, 2
  s_cbranch_scc0 L5
  buffer_load_dword v252, v253, s[36:39], s58 offen
L5:
  s_bitcmp1_b32 s6, 2
  s_cbranch_scc1 L6
  s_mul_i32 s79, s3, 7168
  s_add_u32 m0, s79, 65536
  s_nop 0
  buffer_load_dwordx4 v254, s[36:39], s58 offen lds
  s_add_u32 m0, s79, 66560
  s_add_u32 s58, s58, s59
  buffer_load_dwordx4 v254, s[36:39], s58 offen lds
  s_add_u32 m0, s79, 67584
  s_add_u32 s58, s58, s59
  buffer_load_dwordx4 v254, s[36:39], s58 offen lds
L6:
  v_mfma_f32_16x16x32_bf16 v[48:51], v[28:31], v[36:39], v[48:51]
  s_waitcnt lgkmcnt(4)
  v_mfma_f32_32x32x16_bf16 v[192:207], v[40:43], a[68:71], v[192:207]
  ds_read_b128 a[76:79], v15 offset:0
  ds_read_b128 a[188:191], v19 offset:0
  v_mfma_f32_32x32x16_bf16 v[208:223], v[40:43], a[180:183], v[208:223]
  ds_read_b64_tr_b16 v[36:37], v20 offset:38912
  ds_read_b64_tr_b16 v[38:39], v20 offset:39424
  s_add_u32 m0, s84, 100352
  s_add_u32 s44, s44, s46
  buffer_load_dwordx4 v21, s[16:19], s44 offen lds
  buffer_load_dwordx4 v90, s[16:19], s44 offen offset:1024 lds
  v_subrev_u32 v86, 98304, v86
  v_add_u32 v104, s73, v86
  v_xor_b32 v105, 64, v104
  v_add_u32 v106, s74, v86
  v_xor_b32 v107, 64, v106
  s_cmp_eq_u32 s86, 1
  s_cselect_b64 vcc, -1, 0
  s_bitcmp1_b32 s6, 2
  s_cbranch_scc1 L7
  s_mul_i32 s79, s3, 7168
  s_add_u32 m0, s79, 68608
  s_add_u32 s58, s58, s59
  buffer_load_dwordx4 v254, s[36:39], s58 offen lds
  s_add_u32 m0, s79, 69632
  s_add_u32 s58, s58, s59
  buffer_load_dwordx4 v254, s[36:39], s58 offen lds
  s_add_u32 m0, s79, 70656
  s_add_u32 s58, s58, s59
  buffer_load_dwordx4 v254, s[36:39], s58 offen lds
  s_add_u32 m0, s79, 71680
  s_add_u32 s58, s58, s59
  buffer_load_dwordx4 v254, s[36:39], s58 offen lds
L7:
  v_mfma_f32_16x16x32_bf16 v[48:51], v[28:31], v[40:43], v[48:51]
  s_waitcnt vmcnt(10)
  s_barrier
  s_waitcnt lgkmcnt(4)
  v_mfma_f32_32x32x16_bf16 v[192:207], v[44:47], a[72:75], v[192:207]
  ds_read_b128 a[80:83], v12 offset:16384
  ds_read_b128 a[192:195], v16 offset:16384
  v_mfma_f32_32x32x16_bf16 v[208:223], v[44:47], a[184:187], v[208:223]
  ds_read_b64_tr_b16 v[40:41], v20 offset:40960
  ds_read_b64_tr_b16 v[42:43], v20 offset:41472
  s_add_u32 m0, s84, 114688
  s_add_u32 s44, s44, s47
  buffer_load_dwordx4 v21, s[16:19], s44 offen lds
  buffer_load_dwordx4 v90, s[16:19], s44 offen offset:1024 lds
  v_cndmask_b32 v22, v24, v84, vcc
  v_cndmask_b32 v23, v25, v85, vcc
  v_lshlrev_b32 v84, 10, v225
  v_lshl_add_u32 v84, v224, 4, v84
  v_mfma_f32_16x16x32_bf16 v[48:51], v[28:31], v[44:47], v[48:51]
  v_mul_u32_u24 v85, 57088, v26
  v_add_u32 v245, v84, v85
  s_waitcnt lgkmcnt(4)
  v_mfma_f32_32x32x16_bf16 v[192:207], v[36:39], a[76:79], v[192:207]
  ds_read_b128 a[84:87], v13 offset:16384
  ds_read_b128 a[196:199], v17 offset:16384
  v_mfma_f32_32x32x16_bf16 v[208:223], v[36:39], a[188:191], v[208:223]
  ds_read_b64_tr_b16 v[44:45], v20 offset:43008
  ds_read_b64_tr_b16 v[46:47], v20 offset:43520
  s_add_u32 m0, s84, 116736
  s_add_u32 s44, s44, s46
  buffer_load_dwordx4 v21, s[16:19], s44 offen lds
  buffer_load_dwordx4 v90, s[16:19], s44 offen offset:1024 lds
  v_cndmask_b32 v244, v245, v84, vcc
  v_lshlrev_b32 v246, 3, v224
  s_lshl_b32 s76, s5, 8
  v_add_u32 v246, s76, v246
  v_xor_b32 v247, 256, v246
  v_lshrrev_b32 v84, 4, v1
  v_readfirstlane_b32 s80, v6
  v_readfirstlane_b32 s81, v7
  s_nop 0
  s_min_u32 s90, s80, s81
  v_mfma_f32_16x16x32_bf16 v[48:51], v[28:31], v[36:39], v[48:51]
  s_cmp_lg_u32 s90, 0
  s_cbranch_scc0 SPIN3
OK2:
  v_mov_b32 v251, v6
  buffer_store_dwordx2 v[250:251], v248, s[24:27], s92 offen sc1
  s_waitcnt lgkmcnt(4)
  v_mfma_f32_32x32x16_bf16 v[192:207], v[40:43], a[80:83], v[192:207]
  ds_read_b128 a[88:91], v14 offset:16384
  ds_read_b128 a[200:203], v18 offset:16384
  v_mfma_f32_32x32x16_bf16 v[208:223], v[40:43], a[192:195], v[208:223]
  ds_read_b64_tr_b16 v[36:37], v20 offset:45056
  ds_read_b64_tr_b16 v[38:39], v20 offset:45568
  v_min_u32 v84, 2, v84
  v_sub_u32 v84, s95, v84
  v_max_i32 v84, 0, v84
  v_and_b32 v85, 15, v1
  v_mfma_f32_16x16x32_bf16 v[48:51], v[28:31], v[40:43], v[48:51]
  v_lshlrev_b32 v84, 7, v84
  v_lshl_add_u32 v26, v85, 3, v84
  s_waitcnt lgkmcnt(4)
  v_mfma_f32_32x32x16_bf16 v[192:207], v[44:47], a[84:87], v[192:207]
  ds_read_b128 a[92:95], v15 offset:16384
  ds_read_b128 a[204:207], v19 offset:16384
  v_mfma_f32_32x32x16_bf16 v[208:223], v[44:47], a[196:199], v[208:223]
  ds_read_b64_tr_b16 v[40:41], v20 offset:47104
  ds_read_b64_tr_b16 v[42:43], v20 offset:47616
  v_min_u32 v85, 11, v85
  v_lshl_add_u32 v27, v85, 3, v84
  v_add_u32 v27, 2048, v27
  v_lshlrev_b32 v110, 6, v225
  v_xor_b32 v110, v110, v2
  v_mfma_f32_16x16x32_bf16 v[48:51], v[28:31], v[44:47], v[48:51]
  v_xor_b32 v111, 128, v110
  s_lshl_b32 s76, s3, 11
  s_waitcnt vmcnt(5)
  s_barrier
  s_waitcnt lgkmcnt(4)
  v_mfma_f32_32x32x16_bf16 v[192:207], v[36:39], a[88:91], v[192:207]
  ds_read_b128 a[96:99], v12 offset:32768
  ds_read_b128 a[208:211], v16 offset:32768
  v_mfma_f32_32x32x16_bf16 v[208:223], v[36:39], a[200:203], v[208:223]
  ds_read_b64_tr_b16 v[44:45], v20 offset:49152
  ds_read_b64_tr_b16 v[46:47], v20 offset:49664
  v_add_u32 v92, s76, v2
  v_bfe_u32 v84, v1, 4, 1
  v_and_b32 v85, 3, v1
  v_lshl_add_u32 v84, v84, 2, v85
  v_add_u32 v84, s96, v84
  v_bfe_u32 v85, v84, 1, 2
  s_bitcmp1_b32 s6, 2
  s_cbranch_scc1 L8
  ds_read_b64_tr_b16 v[128:129], v255 offset:0
  ds_read_b64_tr_b16 v[130:131], v255 offset:512
  ds_read_b64_tr_b16 v[132:133], v255 offset:2048
  ds_read_b64_tr_b16 v[134:135], v255 offset:2560
  ds_read_b64_tr_b16 v[136:137], v255 offset:4096
  ds_read_b64_tr_b16 v[138:139], v255 offset:4608
  ds_read_b64_tr_b16 v[140:141], v255 offset:6144
L8:
  v_mfma_f32_16x16x32_bf16 v[48:51], v[28:31], v[36:39], v[48:51]
  s_waitcnt lgkmcnt(4)
  v_mfma_f32_32x32x16_bf16 v[192:207], v[40:43], a[92:95], v[192:207]
  ds_read_b128 a[100:103], v13 offset:32768
  ds_read_b128 a[212:215], v17 offset:32768
  v_mfma_f32_32x32x16_bf16 v[208:223], v[40:43], a[204:207], v[208:223]
  ds_read_b64_tr_b16 v[36:37], v20 offset:51200
  ds_read_b64_tr_b16 v[38:39], v20 offset:51712
  v_and_b32 v84, 1, v84
  v_bfe_u32 v87, v1, 2, 2
  v_xor_b32 v88, v225, v85
  v_lshl_add_u32 v87, v88, 2, v87
  v_lshlrev_b32 v85, 9, v85
  v_lshl_add_u32 v85, v87, 4, v85
  s_bitcmp1_b32 s6, 2
  s_cbranch_scc1 L9
  ds_read_b64_tr_b16 v[142:143], v255 offset:6656
  ds_read_b64_tr_b16 v[144:145], v255 offset:8192
  ds_read_b64_tr_b16 v[146:147], v255 offset:8704
  ds_read_b64_tr_b16 v[148:149], v255 offset:10240
  ds_read_b64_tr_b16 v[150:151], v255 offset:10752
  ds_read_b64_tr_b16 v[152:153], v255 offset:12288
  ds_read_b64_tr_b16 v[154:155], v255 offset:12800
L9:
  v_mfma_f32_16x16x32_bf16 v[48:51], v[28:31], v[40:43], v[48:51]
  s_waitcnt lgkmcnt(4)
  v_mfma_f32_32x32x16_bf16 v[192:207], v[44:47], a[96:99], v[192:207]
  ds_read_b128 a[104:107], v14 offset:32768
  ds_read_b128 a[216:219], v18 offset:32768
  v_mfma_f32_32x32x16_bf16 v[208:223], v[44:47], a[208:211], v[208:223]
  ds_read_b64_tr_b16 v[40:41], v20 offset:53248
  ds_read_b64_tr_b16 v[42:43], v20 offset:53760
  v_lshl_add_u32 v85, v84, 3, v85
  s_add_u32 s76, s76, 24576
  v_add_u32 v93, s76, v85
  v_xor_b32 v94, 128, v93
  v_lshl_add_u32 v95, v224, 4, s97
  v_and_b32 v84, 1, v1
  s_cmp_eq_u32 s3, 3
  s_cbranch_scc1 L10
  v_min_u32 v253, 24, v1
  v_lshlrev_b32 v253, 7, v253
  s_cmp_eq_u32 s3, 2
  s_cbranch_scc1 L11
  s_lshl_b32 s79, s2, 1
  s_add_u32 s79, s79, s3
  s_mul_i32 s79, s79, 3136
  s_and_b32 s79, s79, 0xffffff80
  buffer_load_dword v252, v253, s[28:31], s79 offen
  s_branch L10
L11:
  s_mul_i32 s79, s2, 1664
  v_min_u32 v253, 1536, v253
  buffer_load_dword v252, v253, s[32:35], s79 offen
L10:
  s_bitcmp1_b32 s6, 2
  s_cbranch_scc1 L12
  s_waitcnt lgkmcnt(4)
  v_mfma_f32_16x16x32_bf16 v[156:159], v[28:31], v[128:131], 0
  v_mfma_f32_16x16x32_bf16 v[156:159], v[28:31], v[132:135], v[156:159]
  v_mfma_f32_16x16x32_bf16 v[156:159], v[28:31], v[136:139], v[156:159]
  v_mfma_f32_16x16x32_bf16 v[156:159], v[28:31], v[140:143], v[156:159]
  v_mfma_f32_16x16x32_bf16 v[156:159], v[28:31], v[144:147], v[156:159]
  v_mfma_f32_16x16x32_bf16 v[156:159], v[28:31], v[148:151], v[156:159]
  v_mfma_f32_16x16x32_bf16 v[156:159], v[28:31], v[152:155], v[156:159]
L12:
  v_mfma_f32_16x16x32_bf16 v[48:51], v[28:31], v[44:47], v[48:51]
  s_waitcnt lgkmcnt(4)
  v_mfma_f32_32x32x16_bf16 v[192:207], v[36:39], a[100:103], v[192:207]
  ds_read_b128 a[108:111], v15 offset:32768
  ds_read_b128 a[220:223], v19 offset:32768
  v_mfma_f32_32x32x16_bf16 v[208:223], v[36:39], a[212:215], v[208:223]
  ds_read_b64_tr_b16 v[44:45], v20 offset:55296
  ds_read_b64_tr_b16 v[46:47], v20 offset:55808
  v_lshlrev_b32 v84, 3, v84
  v_bfe_u32 v85, v1, 1, 2
  v_lshl_add_u32 v228, v85, 5, v84
  v_min_u32 v86, 2, v85
  v_lshl_add_u32 v226, v86, 5, v84
  v_mfma_f32_16x16x32_bf16 v[48:51], v[28:31], v[36:39], v[48:51]
  s_lshl_b32 s76, s3, 6
  s_sub_u32 s76, 384, s76
  s_waitcnt lgkmcnt(4)
  v_mfma_f32_32x32x16_bf16 v[192:207], v[40:43], a[104:107], v[192:207]
  v_mfma_f32_32x32x16_bf16 v[208:223], v[40:43], a[216:219], v[208:223]
  v_cmp_eq_u32 vcc, 3, v85
  v_add_u32 v84, s76, v84
  v_mov_b32 v55, 0
  v_cndmask_b32 v227, v228, v84, vcc
  v_mov_b32 v57, 0
  v_mov_b32 v59, 0
  s_bitcmp1_b32 s6, 2
  s_cbranch_scc1 L13
  v_readlane_b32 s58, v11, 4
  v_lshrrev_b32 v160, 5, v1
  v_lshl_add_u32 v160, v160, 27, v2
  v_mov_b32 v163, v6
  v_cvt_pk_bf16_f32 v164, v156, v156
  v_lshlrev_b32 v164, 16, v164
  v_sub_f32 v165, v156, v164
  v_cvt_pk_bf16_f32 v162, v164, v165
  buffer_store_dwordx2 v[162:163], v160, s[24:27], s58 offen sc1
L13:
  v_mfma_f32_16x16x32_bf16 v[48:51], v[28:31], v[40:43], v[48:51]
  s_waitcnt vmcnt(5) lgkmcnt(0)
  s_barrier
  v_mfma_f32_32x32x16_bf16 v[192:207], v[44:47], a[108:111], v[192:207]
  ds_read_b64_tr_b16 v[32:33], v22 offset:0
  ds_read_b64_tr_b16 v[34:35], v22 offset:512
  v_mfma_f32_32x32x16_bf16 v[208:223], v[44:47], a[220:223], v[208:223]
  ds_read_b64_tr_b16 v[36:37], v23 offset:0
  ds_read_b64_tr_b16 v[38:39], v23 offset:512
  s_add_u32 m0, s84, 131072
  s_add_u32 s44, s44, s47
  buffer_load_dwordx4 v21, s[16:19], s44 offen lds
  buffer_load_dwordx4 v90, s[16:19], s44 offen offset:1024 lds
  v_mfma_f32_16x16x32_bf16 v[48:51], v[28:31], v[44:47], v[48:51]
  s_waitcnt lgkmcnt(0)
  v_mfma_f32_32x32x16_bf16 v[128:143], v[32:35], a[0:3], 0
  ds_read_b64_tr_b16 v[40:41], v22 offset:2048
  ds_read_b64_tr_b16 v[42:43], v22 offset:2560
  v_mov_b32 v12, v226
  v_mov_b32 v13, v227
  v_mov_b32 v14, v228
  s_nop 0
  v_mul_f32 v86, 0.5, v48
  v_mfma_f32_32x32x16_bf16 v[144:159], v[32:35], a[112:115], 0
  ds_read_b64_tr_b16 v[44:45], v23 offset:2048
  ds_read_b64_tr_b16 v[46:47], v23 offset:2560
  v_mfma_f32_32x32x16_bf16 v[160:175], v[36:39], a[0:3], 0
  s_add_u32 m0, s84, 133120
  s_add_u32 s44, s44, s46
  buffer_load_dwordx4 v21, s[16:19], s44 offen lds
  buffer_load_dwordx4 v90, s[16:19], s44 offen offset:1024 lds
  v_mfma_f32_32x32x16_bf16 v[176:191], v[36:39], a[112:115], 0
  v_readlane_b32 s67, v11, 27
  s_add_u32 m0, s73, 0
  s_add_u32 s79, s67, 14336
  buffer_load_dwordx4 v4, s[28:31], s79 offen lds
  buffer_load_dwordx4 v5, s[28:31], s79 offen offset:1024 lds
  s_waitcnt lgkmcnt(0)
  v_mfma_f32_32x32x16_bf16 v[128:143], v[40:43], a[4:7], v[128:143]
  ds_read_b64_tr_b16 v[32:33], v22 offset:4096
  ds_read_b64_tr_b16 v[34:35], v22 offset:4608
  v_cvt_pk_bf16_f32 v84, v86, v86
  v_mfma_f32_32x32x16_bf16 v[144:159], v[40:43], a[116:119], v[144:159]
  ds_read_b64_tr_b16 v[36:37], v23 offset:4096
  ds_read_b64_tr_b16 v[38:39], v23 offset:4608
  v_mfma_f32_32x32x16_bf16 v[160:175], v[44:47], a[4:7], v[160:175]
  s_add_u32 m0, s84, 147456
  s_add_u32 s44, s44, s47
  buffer_load_dwordx4 v21, s[16:19], s44 offen lds
  buffer_load_dwordx4 v90, s[16:19], s44 offen offset:1024 lds
  v_mfma_f32_32x32x16_bf16 v[176:191], v[44:47], a[116:119], v[176:191]
  v_lshlrev_b32 v84, 16, v84
  v_sub_f32 v85, v86, v84
  v_cvt_pk_bf16_f32 v76, v84, v85
  v_readlane_b32 s92, v11, 6
  s_waitcnt lgkmcnt(0)
  v_mfma_f32_32x32x16_bf16 v[128:143], v[32:35], a[8:11], v[128:143]
  ds_read_b64_tr_b16 v[40:41], v22 offset:6144
  ds_read_b64_tr_b16 v[42:43], v22 offset:6656
  s_add_u32 m0, s73, 2048
  s_add_u32 s79, s67, 28672
  buffer_load_dwordx4 v4, s[28:31], s79 offen lds
  buffer_load_dwordx4 v5, s[28:31], s79 offen offset:1024 lds
  v_mfma_f32_32x32x16_bf16 v[144:159], v[32:35], a[120:123], v[144:159]
  ds_read_b64_tr_b16 v[44:45], v23 offset:6144
  ds_read_b64_tr_b16 v[46:47], v23 offset:6656
  v_mfma_f32_32x32x16_bf16 v[160:175], v[36:39], a[8:11], v[160:175]
  s_add_u32 m0, s84, 149504
  s_add_u32 s44, s44, s46
  buffer_load_dwordx4 v21, s[16:19], s44 offen lds
  buffer_load_dwordx4 v90, s[16:19], s44 offen offset:1024 lds
  v_mfma_f32_32x32x16_bf16 v[176:191], v[36:39], a[120:123], v[176:191]
  s_waitcnt vmcnt(13) lgkmcnt(0)
  s_barrier
  v_mfma_f32_32x32x16_bf16 v[128:143], v[40:43], a[12:15], v[128:143]
  ds_read_b64_tr_b16 v[32:33], v22 offset:16384
  ds_read_b64_tr_b16 v[34:35], v22 offset:16896
  buffer_load_dwordx2 v[232:233], v246, s[24:27], s92 offen sc1
  v_mfma_f32_32x32x16_bf16 v[144:159], v[40:43], a[124:127], v[144:159]
  ds_read_b64_tr_b16 v[36:37], v23 offset:16384
  ds_read_b64_tr_b16 v[38:39], v23 offset:16896
  v_mfma_f32_32x32x16_bf16 v[160:175], v[44:47], a[12:15], v[160:175]
  s_add_u32 m0, s84, 98304
  s_add_u32 s44, s44, s47
  buffer_load_dwordx4 v21, s[16:19], s44 offen lds
  buffer_load_dwordx4 v90, s[16:19], s44 offen offset:1024 lds
  v_mfma_f32_32x32x16_bf16 v[176:191], v[44:47], a[124:127], v[176:191]
  buffer_load_dwordx2 v[234:235], v247, s[24:27], s92 offen sc1
  s_waitcnt lgkmcnt(0)
  v_mfma_f32_32x32x16_bf16 v[128:143], v[32:35], a[16:19], v[128:143]
  ds_read_b64_tr_b16 v[40:41], v22 offset:18432
  ds_read_b64_tr_b16 v[42:43], v22 offset:18944
  v_mfma_f32_32x32x16_bf16 v[144:159], v[32:35], a[128:131], v[144:159]
  ds_read_b64_tr_b16 v[44:45], v23 offset:18432
  ds_read_b64_tr_b16 v[46:47], v23 offset:18944
  v_mfma_f32_32x32x16_bf16 v[160:175], v[36:39], a[16:19], v[160:175]
  s_add_u32 m0, s73, 4096
  s_add_u32 s79, s67, 43008
  buffer_load_dwordx4 v4, s[28:31], s79 offen lds
  buffer_load_dwordx4 v5, s[28:31], s79 offen offset:1024 lds
  v_mfma_f32_32x32x16_bf16 v[176:191], v[36:39], a[128:131], v[176:191]
  s_waitcnt lgkmcnt(0)
  v_mfma_f32_32x32x16_bf16 v[128:143], v[40:43], a[20:23], v[128:143]
  ds_read_b64_tr_b16 v[32:33], v22 offset:20480
  ds_read_b64_tr_b16 v[34:35], v22 offset:20992
  v_mfma_f32_32x32x16_bf16 v[144:159], v[40:43], a[132:135], v[144:159]
  ds_read_b64_tr_b16 v[36:37], v23 offset:20480
  ds_read_b64_tr_b16 v[38:39], v23 offset:20992
  v_mfma_f32_32x32x16_bf16 v[160:175], v[44:47], a[20:23], v[160:175]
  s_add_u32 m0, s84, 100352
  s_add_u32 s44, s44, s46
  buffer_load_dwordx4 v21, s[16:19], s44 offen lds
  buffer_load_dwordx4 v90, s[16:19], s44 offen offset:1024 lds
  v_mfma_f32_32x32x16_bf16 v[176:191], v[44:47], a[132:135], v[176:191]
  buffer_load_dwordx4 v[60:63], v244, s[24:27], s60 offen sc1
  s_waitcnt lgkmcnt(0)
  v_mfma_f32_32x32x16_bf16 v[128:143], v[32:35], a[24:27], v[128:143]
  ds_read_b64_tr_b16 v[40:41], v22 offset:22528
  ds_read_b64_tr_b16 v[42:43], v22 offset:23040
  v_mfma_f32_32x32x16_bf16 v[144:159], v[32:35], a[136:139], v[144:159]
  ds_read_b64_tr_b16 v[44:45], v23 offset:22528
  ds_read_b64_tr_b16 v[46:47], v23 offset:23040
  v_readlane_b32 s67, v11, 28
  s_add_u32 m0, s73, 6144
  s_add_u32 s79, s67, 0
  buffer_load_dwordx4 v4, s[28:31], s79 offen lds
  buffer_load_dwordx4 v5, s[28:31], s79 offen offset:1024 lds
  v_mfma_f32_32x32x16_bf16 v[160:175], v[36:39], a[24:27], v[160:175]
  buffer_load_dwordx4 v[64:67], v244, s[24:27], s61 offen sc1
  v_mfma_f32_32x32x16_bf16 v[176:191], v[36:39], a[136:139], v[176:191]
  s_waitcnt vmcnt(20) lgkmcnt(0)
  s_barrier
  v_mfma_f32_32x32x16_bf16 v[128:143], v[40:43], a[28:31], v[128:143]
  ds_read_b64_tr_b16 v[32:33], v22 offset:32768
  ds_read_b64_tr_b16 v[34:35], v22 offset:33280
  v_mfma_f32_32x32x16_bf16 v[144:159], v[40:43], a[140:143], v[144:159]
  ds_read_b64_tr_b16 v[36:37], v23 offset:32768
  ds_read_b64_tr_b16 v[38:39], v23 offset:33280
  v_mfma_f32_32x32x16_bf16 v[160:175], v[44:47], a[28:31], v[160:175]
  s_add_u32 m0, s84, 114688
  s_add_u32 s44, s44, s47
  buffer_load_dwordx4 v21, s[16:19], s44 offen lds
  buffer_load_dwordx4 v90, s[16:19], s44 offen offset:1024 lds
  v_mfma_f32_32x32x16_bf16 v[176:191], v[44:47], a[140:143], v[176:191]
  s_waitcnt lgkmcnt(0)
  v_mfma_f32_32x32x16_bf16 v[128:143], v[32:35], a[32:35], v[128:143]
  ds_read_b64_tr_b16 v[40:41], v22 offset:34816
  ds_read_b64_tr_b16 v[42:43], v22 offset:35328
  v_mfma_f32_32x32x16_bf16 v[144:159], v[32:35], a[144:147], v[144:159]
  ds_read_b64_tr_b16 v[44:45], v23 offset:34816
  ds_read_b64_tr_b16 v[46:47], v23 offset:35328
  v_mfma_f32_32x32x16_bf16 v[160:175], v[36:39], a[32:35], v[160:175]
  s_add_u32 m0, s73, 8192
  s_add_u32 s79, s67, 14336
  buffer_load_dwordx4 v4, s[28:31], s79 offen lds
  buffer_load_dwordx4 v5, s[28:31], s79 offen offset:1024 lds
  v_mfma_f32_32x32x16_bf16 v[176:191], v[36:39], a[144:147], v[176:191]
  buffer_load_dwordx4 v[68:71], v245, s[24:27], s62 offen sc1
  s_waitcnt lgkmcnt(0)
  v_mfma_f32_32x32x16_bf16 v[128:143], v[40:43], a[36:39], v[128:143]
  ds_read_b64_tr_b16 v[32:33], v22 offset:36864
  ds_read_b64_tr_b16 v[34:35], v22 offset:37376
  v_mfma_f32_32x32x16_bf16 v[144:159], v[40:43], a[148:151], v[144:159]
  ds_read_b64_tr_b16 v[36:37], v23 offset:36864
  ds_read_b64_tr_b16 v[38:39], v23 offset:37376
  buffer_load_dwordx4 v[72:75], v245, s[24:27], s63 offen sc1
  v_mfma_f32_32x32x16_bf16 v[160:175], v[44:47], a[36:39], v[160:175]
  s_add_u32 m0, s84, 116736
  s_add_u32 s44, s44, s46
  buffer_load_dwordx4 v21, s[16:19], s44 offen lds
  buffer_load_dwordx4 v90, s[16:19], s44 offen offset:1024 lds
  v_mfma_f32_32x32x16_bf16 v[176:191], v[44:47], a[148:151], v[176:191]
  s_waitcnt vmcnt(16)
  v_xor_b32 v84, s80, v233
  v_bitop3_b32 v84, v235, s80, v84 bitop3:0xbe
  s_waitcnt lgkmcnt(0)
  v_mfma_f32_32x32x16_bf16 v[128:143], v[32:35], a[40:43], v[128:143]
  ds_read_b64_tr_b16 v[40:41], v22 offset:38912
  ds_read_b64_tr_b16 v[42:43], v22 offset:39424
  v_cmp_eq_u32 vcc, 0, v84
  s_nop 0
  s_cmp_eq_u64 vcc, exec
  s_cbranch_scc0 SPIN15
OK14:
  v_mfma_f32_32x32x16_bf16 v[144:159], v[32:35], a[152:155], v[144:159]
  ds_read_b64_tr_b16 v[44:45], v23 offset:38912
  ds_read_b64_tr_b16 v[46:47], v23 offset:39424
  s_mov_b32 s77, 0x01000100
  v_readlane_b32 s78, v11, 22
  v_mfma_f32_32x32x16_bf16 v[160:175], v[36:39], a[40:43], v[160:175]
  v_xor_b32 v84, 0x8000, v232
  v_and_b32 v85, 0xffff0000, v232
  v_perm_b32 v52, v84, v84, s77
  v_rcp_f32 v80, v85
  v_mov_b32 v54, v52
  v_mul_f32 v82, s78, v80
  v_mfma_f32_32x32x16_bf16 v[176:191], v[36:39], a[152:155], v[176:191]
  s_waitcnt lgkmcnt(0)
  s_barrier
  v_mfma_f32_32x32x16_bf16 v[128:143], v[40:43], a[44:47], v[128:143]
  ds_read_b64_tr_b16 v[32:33], v22 offset:49152
  ds_read_b64_tr_b16 v[34:35], v22 offset:49664
  v_xor_b32 v84, 0x8000, v234
  v_and_b32 v85, 0xffff0000, v234
  v_mfma_f32_32x32x16_bf16 v[144:159], v[40:43], a[156:159], v[144:159]
  ds_read_b64_tr_b16 v[36:37], v23 offset:49152
  ds_read_b64_tr_b16 v[38:39], v23 offset:49664
  v_mfma_f32_32x32x16_bf16 v[160:175], v[44:47], a[44:47], v[160:175]
  s_add_u32 m0, s84, 131072
  s_add_u32 s44, s44, s47
  buffer_load_dwordx4 v21, s[16:19], s44 offen lds
  buffer_load_dwordx4 v90, s[16:19], s44 offen offset:1024 lds
  v_mfma_f32_32x32x16_bf16 v[176:191], v[44:47], a[156:159], v[176:191]
  v_perm_b32 v56, v84, v84, s77
  v_rcp_f32 v81, v85
  v_mov_b32 v58, v56
  v_mul_f32 v83, s78, v81
  s_waitcnt lgkmcnt(0)
  v_mfma_f32_32x32x16_bf16 v[128:143], v[32:35], a[48:51], v[128:143]
  ds_read_b64_tr_b16 v[40:41], v22 offset:51200
  ds_read_b64_tr_b16 v[42:43], v22 offset:51712
  v_mfma_f32_32x32x16_bf16 v[192:207], v[76:79], v[52:55], v[192:207]
  v_mfma_f32_32x32x16_bf16 v[208:223], v[76:79], v[56:59], v[208:223]
  v_mfma_f32_32x32x16_bf16 v[144:159], v[32:35], a[160:163], v[144:159]
  ds_read_b64_tr_b16 v[44:45], v23 offset:51200
  ds_read_b64_tr_b16 v[46:47], v23 offset:51712
  v_mfma_f32_32x32x16_bf16 v[160:175], v[36:39], a[48:51], v[160:175]
  s_add_u32 m0, s73, 10240
  s_add_u32 s79, s67, 28672
  buffer_load_dwordx4 v4, s[28:31], s79 offen lds
  buffer_load_dwordx4 v5, s[28:31], s79 offen offset:1024 lds
  v_mfma_f32_32x32x16_bf16 v[176:191], v[36:39], a[160:163], v[176:191]
  s_waitcnt lgkmcnt(0)
  v_mfma_f32_32x32x16_bf16 v[128:143], v[40:43], a[52:55], v[128:143]
  ds_read_b64_tr_b16 v[32:33], v22 offset:53248
  ds_read_b64_tr_b16 v[34:35], v22 offset:53760
  v_mul_f32 v192, v82, v192
  v_mul_f32 v193, v82, v193
  v_mfma_f32_32x32x16_bf16 v[144:159], v[40:43], a[164:167], v[144:159]
  ds_read_b64_tr_b16 v[36:37], v23 offset:53248
  ds_read_b64_tr_b16 v[38:39], v23 offset:53760
  v_mul_f32 v194, v82, v194
  v_mfma_f32_32x32x16_bf16 v[160:175], v[44:47], a[52:55], v[160:175]
  s_add_u32 m0, s84, 133120
  s_add_u32 s44, s44, s46
  buffer_load_dwordx4 v21, s[16:19], s44 offen lds
  buffer_load_dwordx4 v90, s[16:19], s44 offen offset:1024 lds
  v_mfma_f32_32x32x16_bf16 v[176:191], v[44:47], a[164:167], v[176:191]
  v_mul_f32 v195, v82, v195
  v_mul_f32 v196, v82, v196
  v_mul_f32 v197, v82, v197
  v_mul_f32 v198, v82, v198
  v_mul_f32 v199, v82, v199
  s_waitcnt lgkmcnt(0)
  v_mfma_f32_32x32x16_bf16 v[128:143], v[32:35], a[56:59], v[128:143]
  ds_read_b64_tr_b16 v[40:41], v22 offset:55296
  ds_read_b64_tr_b16 v[42:43], v22 offset:55808
  v_cvt_pk_bf16_f32 v112, v192, v193
  v_cvt_pk_bf16_f32 v113, v194, v195
  v_cvt_pk_bf16_f32 v114, v196, v197
  v_mfma_f32_32x32x16_bf16 v[144:159], v[32:35], a[168:171], v[144:159]
  ds_read_b64_tr_b16 v[44:45], v23 offset:55296
  ds_read_b64_tr_b16 v[46:47], v23 offset:55808
  v_cvt_pk_bf16_f32 v115, v198, v199
  v_mul_f32 v200, v82, v200
  v_mfma_f32_32x32x16_bf16 v[160:175], v[36:39], a[56:59], v[160:175]
  v_mul_f32 v201, v82, v201
  v_mul_f32 v202, v82, v202
  v_mul_f32 v203, v82, v203
  v_mul_f32 v204, v82, v204
  v_mul_f32 v205, v82, v205
  v_mul_f32 v206, v82, v206
  v_mul_f32 v207, v82, v207
  v_mfma_f32_32x32x16_bf16 v[176:191], v[36:39], a[168:171], v[176:191]
  s_waitcnt vmcnt(18) lgkmcnt(0)
  s_barrier
  v_mfma_f32_32x32x16_bf16 v[128:143], v[40:43], a[60:63], v[128:143]
  ds_read_b64_tr_b16 v[32:33], v22 offset:0
  ds_read_b64_tr_b16 v[34:35], v22 offset:512
  v_cvt_pk_bf16_f32 v116, v200, v201
  v_mfma_f32_32x32x16_bf16 v[144:159], v[40:43], a[172:175], v[144:159]
  ds_read_b64_tr_b16 v[36:37], v23 offset:0
  ds_read_b64_tr_b16 v[38:39], v23 offset:512
  v_cvt_pk_bf16_f32 v117, v202, v203
  v_mfma_f32_32x32x16_bf16 v[160:175], v[44:47], a[60:63], v[160:175]
  s_add_u32 m0, s84, 147456
  s_nop 0
  buffer_load_dwordx4 v9, s[20:23], s45 offen lds
  buffer_load_dwordx4 v91, s[20:23], s45 offen offset:1024 lds
  v_mfma_f32_32x32x16_bf16 v[176:191], v[44:47], a[172:175], v[176:191]
  v_cvt_pk_bf16_f32 v118, v204, v205
  v_cvt_pk_bf16_f32 v119, v206, v207
  v_permlane32_swap_b32 v112, v114
  s_waitcnt lgkmcnt(0)
  v_mfma_f32_32x32x16_bf16 v[128:143], v[32:35], a[64:67], v[128:143]
  ds_read_b64_tr_b16 v[40:41], v22 offset:2048
  ds_read_b64_tr_b16 v[42:43], v22 offset:2560
  v_permlane32_swap_b32 v113, v115
  v_permlane32_swap_b32 v116, v118
  v_mfma_f32_32x32x16_bf16 v[144:159], v[32:35], a[176:179], v[144:159]
  ds_read_b64_tr_b16 v[44:45], v23 offset:2048
  ds_read_b64_tr_b16 v[46:47], v23 offset:2560
  v_mfma_f32_32x32x16_bf16 v[160:175], v[36:39], a[64:67], v[160:175]
  buffer_store_dwordx4 v[112:115], v2, s[24:27], s48 offen offset:0 sc1
  v_permlane32_swap_b32 v117, v119
  v_mfma_f32_32x32x16_bf16 v[176:191], v[36:39], a[176:179], v[176:191]
  buffer_store_dwordx4 v[116:119], v2, s[24:27], s48 offen offset:1024 sc1
  v_mul_f32 v208, v83, v208
  s_waitcnt lgkmcnt(0)
  v_mfma_f32_32x32x16_bf16 v[128:143], v[40:43], a[68:71], v[128:143]
  ds_read_b64_tr_b16 v[32:33], v22 offset:4096
  ds_read_b64_tr_b16 v[34:35], v22 offset:4608
  v_mul_f32 v209, v83, v209
  v_mul_f32 v210, v83, v210
  v_mfma_f32_32x32x16_bf16 v[144:159], v[40:43], a[180:183], v[144:159]
  ds_read_b64_tr_b16 v[36:37], v23 offset:4096
  ds_read_b64_tr_b16 v[38:39], v23 offset:4608
  v_mul_f32 v211, v83, v211
  v_mfma_f32_32x32x16_bf16 v[160:175], v[44:47], a[68:71], v[160:175]
  s_add_u32 m0, s84, 149504
  s_add_u32 s45, s45, 57344
  buffer_load_dwordx4 v9, s[20:23], s45 offen lds
  buffer_load_dwordx4 v91, s[20:23], s45 offen offset:1024 lds
  v_mfma_f32_32x32x16_bf16 v[176:191], v[44:47], a[180:183], v[176:191]
  v_mul_f32 v212, v83, v212
  v_mul_f32 v213, v83, v213
  v_mul_f32 v214, v83, v214
  v_mul_f32 v215, v83, v215
  v_cvt_pk_bf16_f32 v120, v208, v209
  s_waitcnt lgkmcnt(0)
  v_mfma_f32_32x32x16_bf16 v[128:143], v[32:35], a[72:75], v[128:143]
  ds_read_b64_tr_b16 v[40:41], v22 offset:6144
  ds_read_b64_tr_b16 v[42:43], v22 offset:6656
  v_cvt_pk_bf16_f32 v121, v210, v211
  v_cvt_pk_bf16_f32 v122, v212, v213
  v_cvt_pk_bf16_f32 v123, v214, v215
  v_mfma_f32_32x32x16_bf16 v[144:159], v[32:35], a[184:187], v[144:159]
  ds_read_b64_tr_b16 v[44:45], v23 offset:6144
  ds_read_b64_tr_b16 v[46:47], v23 offset:6656
  v_mul_f32 v216, v83, v216
  v_mul_f32 v217, v83, v217
  v_mfma_f32_32x32x16_bf16 v[160:175], v[36:39], a[72:75], v[160:175]
  v_mul_f32 v218, v83, v218
  v_mul_f32 v219, v83, v219
  v_mul_f32 v220, v83, v220
  v_mul_f32 v221, v83, v221
  v_mul_f32 v222, v83, v222
  v_mul_f32 v223, v83, v223
  v_cvt_pk_bf16_f32 v124, v216, v217
  v_mfma_f32_32x32x16_bf16 v[176:191], v[36:39], a[184:187], v[176:191]
  s_waitcnt vmcnt(12) lgkmcnt(0)
  s_barrier
  v_mfma_f32_32x32x16_bf16 v[128:143], v[40:43], a[76:79], v[128:143]
  ds_read_b64_tr_b16 v[32:33], v22 offset:16384
  ds_read_b64_tr_b16 v[34:35], v22 offset:16896
  v_cvt_pk_bf16_f32 v125, v218, v219
  v_cvt_pk_bf16_f32 v126, v220, v221
  v_mfma_f32_32x32x16_bf16 v[144:159], v[40:43], a[188:191], v[144:159]
  ds_read_b64_tr_b16 v[36:37], v23 offset:16384
  ds_read_b64_tr_b16 v[38:39], v23 offset:16896
  v_mfma_f32_32x32x16_bf16 v[160:175], v[44:47], a[76:79], v[160:175]
  s_add_u32 m0, s84, 98304
  s_add_u32 s45, s45, 172032
  buffer_load_dwordx4 v9, s[20:23], s45 offen lds
  buffer_load_dwordx4 v91, s[20:23], s45 offen offset:1024 lds
  v_mfma_f32_32x32x16_bf16 v[176:191], v[44:47], a[188:191], v[176:191]
  v_cvt_pk_bf16_f32 v127, v222, v223
  v_permlane32_swap_b32 v120, v122
  v_permlane32_swap_b32 v121, v123
  s_waitcnt lgkmcnt(0)
  v_mfma_f32_32x32x16_bf16 v[128:143], v[32:35], a[80:83], v[128:143]
  ds_read_b64_tr_b16 v[40:41], v22 offset:18432
  ds_read_b64_tr_b16 v[42:43], v22 offset:18944
  v_mfma_f32_32x32x16_bf16 v[144:159], v[32:35], a[192:195], v[144:159]
  ds_read_b64_tr_b16 v[44:45], v23 offset:18432
  ds_read_b64_tr_b16 v[46:47], v23 offset:18944
  s_add_u32 m0, s74, 0
  s_add_u32 s79, s67, 43008
  buffer_load_dwordx4 v4, s[28:31], s79 offen lds
  buffer_load_dwordx4 v5, s[28:31], s79 offen offset:1024 lds
  v_mfma_f32_32x32x16_bf16 v[160:175], v[36:39], a[80:83], v[160:175]
  v_permlane32_swap_b32 v124, v126
  v_mfma_f32_32x32x16_bf16 v[176:191], v[36:39], a[192:195], v[176:191]
  buffer_store_dwordx4 v[120:123], v2, s[24:27], s49 offen offset:0 sc1
  s_waitcnt lgkmcnt(0)
  v_mfma_f32_32x32x16_bf16 v[128:143], v[40:43], a[84:87], v[128:143]
  ds_read_b64_tr_b16 v[32:33], v22 offset:20480
  ds_read_b64_tr_b16 v[34:35], v22 offset:20992
  v_permlane32_swap_b32 v125, v127
  v_mfma_f32_32x32x16_bf16 v[144:159], v[40:43], a[196:199], v[144:159]
  ds_read_b64_tr_b16 v[36:37], v23 offset:20480
  ds_read_b64_tr_b16 v[38:39], v23 offset:20992
  v_mfma_f32_32x32x16_bf16 v[160:175], v[44:47], a[84:87], v[160:175]
  s_add_u32 m0, s84, 100352
  s_add_u32 s45, s45, 57344
  buffer_load_dwordx4 v9, s[20:23], s45 offen lds
  buffer_load_dwordx4 v91, s[20:23], s45 offen offset:1024 lds
  v_mfma_f32_32x32x16_bf16 v[176:191], v[44:47], a[196:199], v[176:191]
  buffer_store_dwordx4 v[124:127], v2, s[24:27], s49 offen offset:1024 sc1
  s_waitcnt lgkmcnt(0)
  v_mfma_f32_32x32x16_bf16 v[128:143], v[32:35], a[88:91], v[128:143]
  ds_read_b64_tr_b16 v[40:41], v22 offset:22528
  ds_read_b64_tr_b16 v[42:43], v22 offset:23040
  v_mfma_f32_32x32x16_bf16 v[144:159], v[32:35], a[200:203], v[144:159]
  ds_read_b64_tr_b16 v[44:45], v23 offset:22528
  ds_read_b64_tr_b16 v[46:47], v23 offset:23040
  v_readlane_b32 s67, v11, 29
  s_add_u32 m0, s74, 2048
  s_add_u32 s79, s67, 0
  buffer_load_dwordx4 v4, s[28:31], s79 offen lds
  buffer_load_dwordx4 v5, s[28:31], s79 offen offset:1024 lds
  v_mfma_f32_32x32x16_bf16 v[160:175], v[36:39], a[88:91], v[160:175]
  v_xor_b32 v84, s80, v61
  v_bitop3_b32 v84, v63, s80, v84 bitop3:0xbe
  v_bitop3_b32 v84, v65, s80, v84 bitop3:0xbe
  v_bitop3_b32 v84, v67, s80, v84 bitop3:0xbe
  v_mfma_f32_32x32x16_bf16 v[176:191], v[36:39], a[200:203], v[176:191]
  s_waitcnt vmcnt(16) lgkmcnt(0)
  s_barrier
  v_mfma_f32_32x32x16_bf16 v[128:143], v[40:43], a[92:95], v[128:143]
  ds_read_b64_tr_b16 v[32:33], v22 offset:32768
  ds_read_b64_tr_b16 v[34:35], v22 offset:33280
  v_bitop3_b32 v84, v69, s80, v84 bitop3:0xbe
  v_bitop3_b32 v84, v71, s80, v84 bitop3:0xbe
  v_mfma_f32_32x32x16_bf16 v[144:159], v[40:43], a[204:207], v[144:159]
  ds_read_b64_tr_b16 v[36:37], v23 offset:32768
  ds_read_b64_tr_b16 v[38:39], v23 offset:33280
  v_bitop3_b32 v84, v73, s80, v84 bitop3:0xbe
  v_mfma_f32_32x32x16_bf16 v[160:175], v[44:47], a[92:95], v[160:175]
  s_add_u32 m0, s84, 114688
  s_add_u32 s45, s45, 172032
  buffer_load_dwordx4 v9, s[20:23], s45 offen lds
  buffer_load_dwordx4 v91, s[20:23], s45 offen offset:1024 lds
  v_mfma_f32_32x32x16_bf16 v[176:191], v[44:47], a[204:207], v[176:191]
  v_bitop3_b32 v84, v75, s80, v84 bitop3:0xbe
  v_cmp_eq_u32 vcc, 0, v84
  s_nop 0
  s_cmp_eq_u64 vcc, exec
  s_cbranch_scc0 SPIN17
OK16:
  s_waitcnt lgkmcnt(0)
  v_mfma_f32_32x32x16_bf16 v[128:143], v[32:35], a[96:99], v[128:143]
  ds_read_b64_tr_b16 v[40:41], v22 offset:34816
  ds_read_b64_tr_b16 v[42:43], v22 offset:35328
  v_mfma_f32_32x32x16_bf16 v[144:159], v[32:35], a[208:211], v[144:159]
  ds_read_b64_tr_b16 v[44:45], v23 offset:34816
  ds_read_b64_tr_b16 v[46:47], v23 offset:35328
  v_mfma_f32_32x32x16_bf16 v[160:175], v[36:39], a[96:99], v[160:175]
  s_add_u32 m0, s74, 4096
  s_add_u32 s79, s67, 14336
  buffer_load_dwordx4 v4, s[28:31], s79 offen lds
  buffer_load_dwordx4 v5, s[28:31], s79 offen offset:1024 lds
  v_mfma_f32_32x32x16_bf16 v[176:191], v[36:39], a[208:211], v[176:191]
  s_waitcnt lgkmcnt(0)
  v_mfma_f32_32x32x16_bf16 v[128:143], v[40:43], a[100:103], v[128:143]
  ds_read_b64_tr_b16 v[32:33], v22 offset:36864
  ds_read_b64_tr_b16 v[34:35], v22 offset:37376
  v_readlane_b32 s92, v11, 2
  v_mfma_f32_32x32x16_bf16 v[144:159], v[40:43], a[212:215], v[144:159]
  ds_read_b64_tr_b16 v[36:37], v23 offset:36864
  ds_read_b64_tr_b16 v[38:39], v23 offset:37376
  v_readlane_b32 s93, v11, 0
  v_mfma_f32_32x32x16_bf16 v[160:175], v[44:47], a[100:103], v[160:175]
  s_add_u32 m0, s84, 116736
  s_add_u32 s45, s45, 57344
  buffer_load_dwordx4 v9, s[20:23], s45 offen lds
  buffer_load_dwordx4 v91, s[20:23], s45 offen offset:1024 lds
  v_mfma_f32_32x32x16_bf16 v[176:191], v[44:47], a[212:215], v[176:191]
  v_readlane_b32 s94, v11, 7
  v_readlane_b32 s95, v11, 8
  v_readlane_b32 s96, v11, 12
  v_readlane_b32 s97, v11, 1
  s_waitcnt lgkmcnt(0)
  v_mfma_f32_32x32x16_bf16 v[128:143], v[32:35], a[104:107], v[128:143]
  ds_read_b64_tr_b16 v[40:41], v22 offset:38912
  ds_read_b64_tr_b16 v[42:43], v22 offset:39424
  v_mfma_f32_32x32x16_bf16 v[144:159], v[32:35], a[216:219], v[144:159]
  ds_read_b64_tr_b16 v[44:45], v23 offset:38912
  ds_read_b64_tr_b16 v[46:47], v23 offset:39424
  v_mfma_f32_32x32x16_bf16 v[160:175], v[36:39], a[104:107], v[160:175]
  s_add_u32 m0, s74, 6144
  s_add_u32 s79, s67, 28672
  buffer_load_dwordx4 v4, s[28:31], s79 offen lds
  buffer_load_dwordx4 v5, s[28:31], s79 offen offset:1024 lds
  v_mfma_f32_32x32x16_bf16 v[176:191], v[36:39], a[216:219], v[176:191]
  s_waitcnt vmcnt(10) lgkmcnt(0)
  s_barrier
  v_mfma_f32_32x32x16_bf16 v[128:143], v[40:43], a[108:111], v[128:143]
  ds_read_b64_tr_b16 v[32:33], v24 offset:49152
  ds_read_b64_tr_b16 v[34:35], v24 offset:49664
  s_cmp_lg_u32 s3, 0
  s_cbranch_scc1 L20
  buffer_store_dwordx2 v[6:7], v8, s[24:27], s92 offen sc1
L20:
  v_mfma_f32_32x32x16_bf16 v[144:159], v[40:43], a[220:223], v[144:159]
  ds_read_b64_tr_b16 v[36:37], v25 offset:49152
  ds_read_b64_tr_b16 v[38:39], v25 offset:49664
  v_mfma_f32_32x32x16_bf16 v[160:175], v[44:47], a[108:111], v[160:175]
  s_add_u32 m0, s84, 131072
  s_add_u32 s45, s45, 172032
  buffer_load_dwordx4 v9, s[20:23], s45 offen lds
  buffer_load_dwordx4 v91, s[20:23], s45 offen offset:1024 lds
  v_mfma_f32_32x32x16_bf16 v[176:191], v[44:47], a[220:223], v[176:191]
  s_add_u32 m0, s74, 8192
  s_add_u32 s79, s67, 43008
  buffer_load_dwordx4 v4, s[28:31], s79 offen lds
  buffer_load_dwordx4 v5, s[28:31], s79 offen offset:1024 lds
  s_cmp_eq_u32 s86, 1
  s_cbranch_scc1 LQ21
  s_waitcnt lgkmcnt(0)
  v_mfma_f32_32x32x16_bf16 v[192:207], v[32:35], a[0:3], 0
  ds_read_b64_tr_b16 v[40:41], v24 offset:51200
  ds_read_b64_tr_b16 v[42:43], v24 offset:51712
  v_mfma_f32_32x32x16_bf16 v[128:143], v[60:63], v[52:55], v[128:143]
  v_mfma_f32_32x32x16_bf16 v[144:159], v[60:63], v[56:59], v[144:159]
  v_mfma_f32_32x32x16_bf16 v[208:223], v[32:35], a[112:115], 0
  ds_read_b64_tr_b16 v[44:45], v25 offset:51200
  ds_read_b64_tr_b16 v[46:47], v25 offset:51712
  v_mfma_f32_32x32x16_bf16 v[224:239], v[36:39], a[0:3], 0
  v_mfma_f32_32x32x16_bf16 v[240:255], v[36:39], a[112:115], 0
  s_waitcnt lgkmcnt(0)
  v_mfma_f32_32x32x16_bf16 v[192:207], v[40:43], a[4:7], v[192:207]
  ds_read_b64_tr_b16 v[32:33], v24 offset:53248
  ds_read_b64_tr_b16 v[34:35], v24 offset:53760
  v_mfma_f32_32x32x16_bf16 v[160:175], v[64:67], v[52:55], v[160:175]
  v_mfma_f32_32x32x16_bf16 v[176:191], v[64:67], v[56:59], v[176:191]
  v_mfma_f32_32x32x16_bf16 v[208:223], v[40:43], a[116:119], v[208:223]
  ds_read_b64_tr_b16 v[36:37], v25 offset:53248
  ds_read_b64_tr_b16 v[38:39], v25 offset:53760
  v_mfma_f32_32x32x16_bf16 v[224:239], v[44:47], a[4:7], v[224:239]
  s_add_u32 m0, s84, 133120
  s_add_u32 s45, s45, 57344
  buffer_load_dwordx4 v9, s[20:23], s45 offen lds
  buffer_load_dwordx4 v91, s[20:23], s45 offen offset:1024 lds
  v_mfma_f32_32x32x16_bf16 v[240:255], v[44:47], a[116:119], v[240:255]
  ds_read_b64_tr_b16 a[248:249], v106 offset:0
  ds_read_b64_tr_b16 a[250:251], v106 offset:1024
  ds_read_b64_tr_b16 a[252:253], v107 offset:0
  ds_read_b64_tr_b16 a[254:255], v107 offset:1024
  s_waitcnt lgkmcnt(4)
  v_mfma_f32_32x32x16_bf16 v[192:207], v[32:35], a[8:11], v[192:207]
  ds_read_b64_tr_b16 v[40:41], v24 offset:55296
  ds_read_b64_tr_b16 v[42:43], v24 offset:55808
  v_mul_f32 v128, v128, v136
  v_mul_f32 v129, v129, v137
  v_mul_f32 v130, v130, v138
  v_mul_f32 v131, v131, v139
  v_mul_f32 v132, v132, v140
  v_mul_f32 v133, v133, v141
  v_mfma_f32_32x32x16_bf16 v[208:223], v[32:35], a[120:123], v[208:223]
  ds_read_b64_tr_b16 v[44:45], v25 offset:55296
  ds_read_b64_tr_b16 v[46:47], v25 offset:55808
  s_waitcnt vmcnt(14)
  ds_read_b64_tr_b16 a[240:241], v106 offset:2048
  ds_read_b64_tr_b16 a[242:243], v106 offset:3072
  ds_read_b64_tr_b16 a[244:245], v107 offset:2048
  ds_read_b64_tr_b16 a[246:247], v107 offset:3072
  v_mfma_f32_32x32x16_bf16 v[224:239], v[36:39], a[8:11], v[224:239]
  s_waitcnt lgkmcnt(8)
  v_readlane_b32 s67, v11, 30
  s_add_u32 m0, s74, 0
  s_add_u32 s79, s67, 0
  buffer_load_dwordx4 v4, s[28:31], s79 offen lds
  buffer_load_dwordx4 v5, s[28:31], s79 offen offset:1024 lds
  v_mfma_f32_32x32x16_bf16 v[240:255], v[36:39], a[120:123], v[240:255]
  s_waitcnt lgkmcnt(4)
  s_barrier
  v_mfma_f32_32x32x16_bf16 v[192:207], v[40:43], a[12:15], v[192:207]
  ds_read_b64_tr_b16 v[32:33], v24 offset:0
  ds_read_b64_tr_b16 v[34:35], v24 offset:512
  v_mul_f32 v134, v134, v142
  v_mul_f32 v135, v135, v143
  v_cvt_pk_bf16_f32 v112, v128, v129
  v_cvt_pk_bf16_f32 v113, v130, v131
  v_cvt_pk_bf16_f32 v114, v132, v133
  v_mfma_f32_32x32x16_bf16 v[208:223], v[40:43], a[124:127], v[208:223]
  ds_read_b64_tr_b16 v[36:37], v25 offset:0
  ds_read_b64_tr_b16 v[38:39], v25 offset:512
  v_cvt_pk_bf16_f32 v115, v134, v135
  buffer_store_dwordx4 v[112:115], v2, s[24:27], s50 offen sc1
  v_mfma_f32_32x32x16_bf16 v[224:239], v[44:47], a[12:15], v[224:239]
  s_add_u32 m0, s84, 147456
  s_add_u32 s45, s45, 172032
  buffer_load_dwordx4 v9, s[20:23], s45 offen lds
  buffer_load_dwordx4 v91, s[20:23], s45 offen offset:1024 lds
  v_mfma_f32_32x32x16_bf16 v[240:255], v[44:47], a[124:127], v[240:255]
  v_mul_f32 v144, v144, v152
  v_mul_f32 v145, v145, v153
  v_mul_f32 v146, v146, v154
  v_mul_f32 v147, v147, v155
  v_mul_f32 v148, v148, v156
  v_mul_f32 v149, v149, v157
  v_mul_f32 v150, v150, v158
  v_mul_f32 v151, v151, v159
  s_waitcnt lgkmcnt(0)
  v_mfma_f32_32x32x16_bf16 v[192:207], v[32:35], a[16:19], v[192:207]
  ds_read_b64_tr_b16 v[40:41], v24 offset:2048
  ds_read_b64_tr_b16 v[42:43], v24 offset:2560
  v_cvt_pk_bf16_f32 v116, v144, v145
  v_cvt_pk_bf16_f32 v117, v146, v147
  v_cvt_pk_bf16_f32 v118, v148, v149
  v_cvt_pk_bf16_f32 v119, v150, v151
  v_mfma_f32_32x32x16_bf16 v[208:223], v[32:35], a[128:131], v[208:223]
  ds_read_b64_tr_b16 v[44:45], v25 offset:2048
  ds_read_b64_tr_b16 v[46:47], v25 offset:2560
  buffer_store_dwordx4 v[116:119], v2, s[24:27], s51 offen sc1
  v_mfma_f32_32x32x16_bf16 v[224:239], v[36:39], a[16:19], v[224:239]
  s_waitcnt vmcnt(16)
  ds_read_b64_tr_b16 a[232:233], v106 offset:4096
  ds_read_b64_tr_b16 a[234:235], v106 offset:5120
  ds_read_b64_tr_b16 a[236:237], v107 offset:4096
  ds_read_b64_tr_b16 a[238:239], v107 offset:5120
  v_mfma_f32_32x32x16_bf16 v[240:255], v[36:39], a[128:131], v[240:255]
  s_add_u32 m0, s74, 2048
  s_add_u32 s79, s67, 14336
  buffer_load_dwordx4 v4, s[28:31], s79 offen lds
  buffer_load_dwordx4 v5, s[28:31], s79 offen offset:1024 lds
  s_waitcnt lgkmcnt(4)
  v_mfma_f32_32x32x16_bf16 v[192:207], v[40:43], a[20:23], v[192:207]
  ds_read_b64_tr_b16 v[32:33], v24 offset:4096
  ds_read_b64_tr_b16 v[34:35], v24 offset:4608
  v_mul_f32 v160, v160, v168
  v_mul_f32 v161, v161, v169
  v_mul_f32 v162, v162, v170
  v_mul_f32 v163, v163, v171
  v_mul_f32 v164, v164, v172
  v_mul_f32 v165, v165, v173
  v_mfma_f32_32x32x16_bf16 v[208:223], v[40:43], a[132:135], v[208:223]
  ds_read_b64_tr_b16 v[36:37], v25 offset:4096
  ds_read_b64_tr_b16 v[38:39], v25 offset:4608
  v_mul_f32 v166, v166, v174
  v_mul_f32 v167, v167, v175
  v_cvt_pk_bf16_f32 v120, v160, v161
  v_cvt_pk_bf16_f32 v121, v162, v163
  v_mfma_f32_32x32x16_bf16 v[224:239], v[44:47], a[20:23], v[224:239]
  s_add_u32 m0, s84, 149504
  s_add_u32 s45, s45, 57344
  buffer_load_dwordx4 v9, s[20:23], s45 offen lds
  buffer_load_dwordx4 v91, s[20:23], s45 offen offset:1024 lds
  v_mfma_f32_32x32x16_bf16 v[240:255], v[44:47], a[132:135], v[240:255]
  s_waitcnt vmcnt(16)
  ds_read_b64_tr_b16 a[224:225], v106 offset:6144
  ds_read_b64_tr_b16 a[226:227], v106 offset:7168
  ds_read_b64_tr_b16 a[228:229], v107 offset:6144
  ds_read_b64_tr_b16 a[230:231], v107 offset:7168
  s_waitcnt lgkmcnt(4)
  v_mfma_f32_32x32x16_bf16 v[192:207], v[32:35], a[24:27], v[192:207]
  ds_read_b64_tr_b16 v[40:41], v24 offset:6144
  ds_read_b64_tr_b16 v[42:43], v24 offset:6656
  v_cvt_pk_bf16_f32 v122, v164, v165
  v_cvt_pk_bf16_f32 v123, v166, v167
  v_mfma_f32_32x32x16_bf16 v[208:223], v[32:35], a[136:139], v[208:223]
  ds_read_b64_tr_b16 v[44:45], v25 offset:6144
  ds_read_b64_tr_b16 v[46:47], v25 offset:6656
  s_waitcnt vmcnt(12)
  ds_read_b64_tr_b16 a[0:1], v106 offset:8192
  ds_read_b64_tr_b16 a[2:3], v106 offset:9216
  ds_read_b64_tr_b16 a[112:113], v107 offset:8192
  ds_read_b64_tr_b16 a[114:115], v107 offset:9216
  v_mfma_f32_32x32x16_bf16 v[224:239], v[36:39], a[24:27], v[224:239]
  s_add_u32 m0, s74, 4096
  s_add_u32 s79, s67, 28672
  buffer_load_dwordx4 v4, s[28:31], s79 offen lds
  buffer_load_dwordx4 v5, s[28:31], s79 offen offset:1024 lds
  v_mfma_f32_32x32x16_bf16 v[240:255], v[36:39], a[136:139], v[240:255]
  s_waitcnt lgkmcnt(4)
  s_barrier
  v_mfma_f32_32x32x16_bf16 v[192:207], v[40:43], a[28:31], v[192:207]
  ds_read_b64_tr_b16 v[32:33], v24 offset:16384
  ds_read_b64_tr_b16 v[34:35], v24 offset:16896
  ds_read_b64_tr_b16 a[4:5], v104 offset:0
  ds_read_b64_tr_b16 a[6:7], v104 offset:1024
  ds_read_b64_tr_b16 a[116:117], v105 offset:0
  ds_read_b64_tr_b16 a[118:119], v105 offset:1024
  v_mfma_f32_32x32x16_bf16 v[208:223], v[40:43], a[140:143], v[208:223]
  ds_read_b64_tr_b16 v[36:37], v25 offset:16384
  ds_read_b64_tr_b16 v[38:39], v25 offset:16896
  v_mfma_f32_32x32x16_bf16 v[224:239], v[44:47], a[28:31], v[224:239]
  s_add_u32 m0, s84, 98304
  s_add_u32 s45, s45, 172032
  buffer_load_dwordx4 v9, s[20:23], s45 offen lds
  buffer_load_dwordx4 v91, s[20:23], s45 offen offset:1024 lds
  v_mfma_f32_32x32x16_bf16 v[240:255], v[44:47], a[140:143], v[240:255]
  s_add_u32 m0, s74, 6144
  s_add_u32 s79, s67, 43008
  buffer_load_dwordx4 v4, s[28:31], s79 offen lds
  buffer_load_dwordx4 v5, s[28:31], s79 offen offset:1024 lds
  s_waitcnt lgkmcnt(0)
  v_mfma_f32_32x32x16_bf16 v[192:207], v[32:35], a[32:35], v[192:207]
  ds_read_b64_tr_b16 v[40:41], v24 offset:18432
  ds_read_b64_tr_b16 v[42:43], v24 offset:18944
  buffer_store_dwordx4 v[120:123], v2, s[24:27], s52 offen sc1
  v_mul_f32 v176, v176, v184
  v_mfma_f32_32x32x16_bf16 v[208:223], v[32:35], a[144:147], v[208:223]
  ds_read_b64_tr_b16 v[44:45], v25 offset:18432
  ds_read_b64_tr_b16 v[46:47], v25 offset:18944
  v_mul_f32 v177, v177, v185
  v_mul_f32 v178, v178, v186
  v_mul_f32 v179, v179, v187
  v_mul_f32 v180, v180, v188
  v_mul_f32 v181, v181, v189
  v_mul_f32 v182, v182, v190
  v_mfma_f32_32x32x16_bf16 v[224:239], v[36:39], a[32:35], v[224:239]
  ds_read_b64_tr_b16 a[8:9], v104 offset:2048
  ds_read_b64_tr_b16 a[10:11], v104 offset:3072
  ds_read_b64_tr_b16 a[120:121], v105 offset:2048
  ds_read_b64_tr_b16 a[122:123], v105 offset:3072
  v_mfma_f32_32x32x16_bf16 v[240:255], v[36:39], a[144:147], v[240:255]
  v_readlane_b32 s67, v11, 31
  s_add_u32 m0, s74, 8192
  s_add_u32 s79, s67, 0
  buffer_load_dwordx4 v4, s[32:35], s79 offen lds
  buffer_load_dwordx4 v5, s[32:35], s79 offen offset:1024 lds
  s_waitcnt lgkmcnt(4)
  v_mfma_f32_32x32x16_bf16 v[192:207], v[40:43], a[36:39], v[192:207]
  ds_read_b64_tr_b16 v[32:33], v24 offset:20480
  ds_read_b64_tr_b16 v[34:35], v24 offset:20992
  v_mul_f32 v183, v183, v191
  v_cvt_pk_bf16_f32 v124, v176, v177
  v_cvt_pk_bf16_f32 v125, v178, v179
  v_cvt_pk_bf16_f32 v126, v180, v181
  v_cvt_pk_bf16_f32 v127, v182, v183
  v_mfma_f32_32x32x16_bf16 v[208:223], v[40:43], a[148:151], v[208:223]
  ds_read_b64_tr_b16 v[36:37], v25 offset:20480
  ds_read_b64_tr_b16 v[38:39], v25 offset:20992
  buffer_store_dwordx4 v[124:127], v2, s[24:27], s53 offen sc1
  v_mfma_f32_32x32x16_bf16 v[224:239], v[44:47], a[36:39], v[224:239]
  s_add_u32 m0, s84, 100352
  s_add_u32 s45, s45, 57344
  buffer_load_dwordx4 v9, s[20:23], s45 offen lds
  buffer_load_dwordx4 v91, s[20:23], s45 offen offset:1024 lds
  v_mfma_f32_32x32x16_bf16 v[240:255], v[44:47], a[148:151], v[240:255]
  ds_read_b64_tr_b16 a[12:13], v104 offset:4096
  ds_read_b64_tr_b16 a[14:15], v104 offset:5120
  ds_read_b64_tr_b16 a[124:125], v105 offset:4096
  ds_read_b64_tr_b16 a[126:127], v105 offset:5120
  s_branch LJ22
LQ21:
  s_waitcnt lgkmcnt(0)
  v_mfma_f32_32x32x16_bf16 v[192:207], v[32:35], a[0:3], 0
  ds_read_b64_tr_b16 v[40:41], v24 offset:51200
  ds_read_b64_tr_b16 v[42:43], v24 offset:51712
  v_mfma_f32_32x32x16_bf16 v[128:143], v[60:63], v[52:55], v[128:143]
  v_mfma_f32_32x32x16_bf16 v[144:159], v[60:63], v[56:59], v[144:159]
  v_mfma_f32_32x32x16_bf16 v[208:223], v[32:35], a[112:115], 0
  ds_read_b64_tr_b16 v[44:45], v25 offset:51200
  ds_read_b64_tr_b16 v[46:47], v25 offset:51712
  v_mfma_f32_32x32x16_bf16 v[224:239], v[36:39], a[0:3], 0
  v_mfma_f32_32x32x16_bf16 v[240:255], v[36:39], a[112:115], 0
  s_waitcnt lgkmcnt(0)
  v_mfma_f32_32x32x16_bf16 v[192:207], v[40:43], a[4:7], v[192:207]
  ds_read_b64_tr_b16 v[32:33], v24 offset:53248
  ds_read_b64_tr_b16 v[34:35], v24 offset:53760
  v_mfma_f32_32x32x16_bf16 v[160:175], v[64:67], v[52:55], v[160:175]
  v_mfma_f32_32x32x16_bf16 v[176:191], v[64:67], v[56:59], v[176:191]
  v_mfma_f32_32x32x16_bf16 v[208:223], v[40:43], a[116:119], v[208:223]
  ds_read_b64_tr_b16 v[36:37], v25 offset:53248
  ds_read_b64_tr_b16 v[38:39], v25 offset:53760
  v_mfma_f32_32x32x16_bf16 v[224:239], v[44:47], a[4:7], v[224:239]
  s_add_u32 m0, s84, 133120
  s_add_u32 s45, s45, 57344
  buffer_load_dwordx4 v9, s[20:23], s45 offen lds
  buffer_load_dwordx4 v91, s[20:23], s45 offen offset:1024 lds
  v_mfma_f32_32x32x16_bf16 v[240:255], v[44:47], a[116:119], v[240:255]
  ds_read_b64_tr_b16 a[248:249], v106 offset:0
  ds_read_b64_tr_b16 a[250:251], v106 offset:1024
  ds_read_b64_tr_b16 a[252:253], v107 offset:0
  ds_read_b64_tr_b16 a[254:255], v107 offset:1024
  s_waitcnt lgkmcnt(4)
  v_mfma_f32_32x32x16_bf16 v[192:207], v[32:35], a[8:11], v[192:207]
  ds_read_b64_tr_b16 v[40:41], v24 offset:55296
  ds_read_b64_tr_b16 v[42:43], v24 offset:55808
  v_mul_f32 v128, v80, v128
  v_mul_f32 v129, v80, v129
  v_mul_f32 v130, v80, v130
  v_mul_f32 v131, v80, v131
  v_mul_f32 v132, v80, v132
  v_mul_f32 v133, v80, v133
  v_mul_f32 v134, v80, v134
  v_mul_f32 v135, v80, v135
  v_cvt_pk_bf16_f32 v112, v128, v129
  v_cvt_pk_bf16_f32 v113, v130, v131
  v_cvt_pk_bf16_f32 v114, v132, v133
  v_mfma_f32_32x32x16_bf16 v[208:223], v[32:35], a[120:123], v[208:223]
  ds_read_b64_tr_b16 v[44:45], v25 offset:55296
  ds_read_b64_tr_b16 v[46:47], v25 offset:55808
  v_cvt_pk_bf16_f32 v115, v134, v135
  v_mul_f32 v136, v80, v136
  v_mul_f32 v137, v80, v137
  v_mul_f32 v138, v80, v138
  v_mul_f32 v139, v80, v139
  v_mul_f32 v140, v80, v140
  v_mul_f32 v141, v80, v141
  v_mfma_f32_32x32x16_bf16 v[224:239], v[36:39], a[8:11], v[224:239]
  s_waitcnt vmcnt(14)
  ds_read_b64_tr_b16 a[240:241], v106 offset:2048
  ds_read_b64_tr_b16 a[242:243], v106 offset:3072
  ds_read_b64_tr_b16 a[244:245], v107 offset:2048
  ds_read_b64_tr_b16 a[246:247], v107 offset:3072
  s_waitcnt lgkmcnt(8)
  v_readlane_b32 s67, v11, 30
  s_add_u32 m0, s74, 0
  s_add_u32 s79, s67, 0
  buffer_load_dwordx4 v4, s[28:31], s79 offen lds
  buffer_load_dwordx4 v5, s[28:31], s79 offen offset:1024 lds
  v_mfma_f32_32x32x16_bf16 v[240:255], v[36:39], a[120:123], v[240:255]
  s_waitcnt lgkmcnt(4)
  s_barrier
  v_mfma_f32_32x32x16_bf16 v[192:207], v[40:43], a[12:15], v[192:207]
  ds_read_b64_tr_b16 v[32:33], v24 offset:0
  ds_read_b64_tr_b16 v[34:35], v24 offset:512
  v_mul_f32 v142, v80, v142
  v_mul_f32 v143, v80, v143
  v_cvt_pk_bf16_f32 v116, v136, v137
  v_cvt_pk_bf16_f32 v117, v138, v139
  v_cvt_pk_bf16_f32 v118, v140, v141
  v_cvt_pk_bf16_f32 v119, v142, v143
  v_permlane32_swap_b32 v112, v114
  v_mfma_f32_32x32x16_bf16 v[208:223], v[40:43], a[124:127], v[208:223]
  ds_read_b64_tr_b16 v[36:37], v25 offset:0
  ds_read_b64_tr_b16 v[38:39], v25 offset:512
  v_permlane32_swap_b32 v113, v115
  v_permlane32_swap_b32 v116, v118
  buffer_store_dwordx4 v[112:115], v2, s[24:27], s50 offen offset:0 sc1
  v_mfma_f32_32x32x16_bf16 v[224:239], v[44:47], a[12:15], v[224:239]
  s_add_u32 m0, s84, 147456
  s_add_u32 s45, s45, 172032
  buffer_load_dwordx4 v9, s[20:23], s45 offen lds
  buffer_load_dwordx4 v91, s[20:23], s45 offen offset:1024 lds
  v_permlane32_swap_b32 v117, v119
  v_mfma_f32_32x32x16_bf16 v[240:255], v[44:47], a[124:127], v[240:255]
  buffer_store_dwordx4 v[116:119], v2, s[24:27], s50 offen offset:1024 sc1
  v_mul_f32 v144, v81, v144
  v_mul_f32 v145, v81, v145
  v_mul_f32 v146, v81, v146
  v_mul_f32 v147, v81, v147
  v_mul_f32 v148, v81, v148
  v_mul_f32 v149, v81, v149
  v_mul_f32 v150, v81, v150
  v_mul_f32 v151, v81, v151
  s_waitcnt lgkmcnt(0)
  v_mfma_f32_32x32x16_bf16 v[192:207], v[32:35], a[16:19], v[192:207]
  ds_read_b64_tr_b16 v[40:41], v24 offset:2048
  ds_read_b64_tr_b16 v[42:43], v24 offset:2560
  v_cvt_pk_bf16_f32 v120, v144, v145
  v_cvt_pk_bf16_f32 v121, v146, v147
  v_cvt_pk_bf16_f32 v122, v148, v149
  v_cvt_pk_bf16_f32 v123, v150, v151
  v_mul_f32 v152, v81, v152
  v_mul_f32 v153, v81, v153
  v_mul_f32 v154, v81, v154
  v_mul_f32 v155, v81, v155
  v_mul_f32 v156, v81, v156
  v_mfma_f32_32x32x16_bf16 v[208:223], v[32:35], a[128:131], v[208:223]
  ds_read_b64_tr_b16 v[44:45], v25 offset:2048
  ds_read_b64_tr_b16 v[46:47], v25 offset:2560
  v_mul_f32 v157, v81, v157
  v_mul_f32 v158, v81, v158
  v_mul_f32 v159, v81, v159
  v_cvt_pk_bf16_f32 v124, v152, v153
  v_cvt_pk_bf16_f32 v125, v154, v155
  v_cvt_pk_bf16_f32 v126, v156, v157
  v_cvt_pk_bf16_f32 v127, v158, v159
  v_mfma_f32_32x32x16_bf16 v[224:239], v[36:39], a[16:19], v[224:239]
  v_permlane32_swap_b32 v120, v122
  v_permlane32_swap_b32 v121, v123
  v_permlane32_swap_b32 v124, v126
  s_waitcnt vmcnt(16)
  ds_read_b64_tr_b16 a[232:233], v106 offset:4096
  ds_read_b64_tr_b16 a[234:235], v106 offset:5120
  ds_read_b64_tr_b16 a[236:237], v107 offset:4096
  ds_read_b64_tr_b16 a[238:239], v107 offset:5120
  v_mfma_f32_32x32x16_bf16 v[240:255], v[36:39], a[128:131], v[240:255]
  s_add_u32 m0, s74, 2048
  s_add_u32 s79, s67, 14336
  buffer_load_dwordx4 v4, s[28:31], s79 offen lds
  buffer_load_dwordx4 v5, s[28:31], s79 offen offset:1024 lds
  s_waitcnt lgkmcnt(4)
  v_mfma_f32_32x32x16_bf16 v[192:207], v[40:43], a[20:23], v[192:207]
  ds_read_b64_tr_b16 v[32:33], v24 offset:4096
  ds_read_b64_tr_b16 v[34:35], v24 offset:4608
  buffer_store_dwordx4 v[120:123], v2, s[24:27], s51 offen offset:0 sc1
  v_permlane32_swap_b32 v125, v127
  v_mfma_f32_32x32x16_bf16 v[208:223], v[40:43], a[132:135], v[208:223]
  ds_read_b64_tr_b16 v[36:37], v25 offset:4096
  ds_read_b64_tr_b16 v[38:39], v25 offset:4608
  buffer_store_dwordx4 v[124:127], v2, s[24:27], s51 offen offset:1024 sc1
  v_mul_f32 v160, v80, v160
  v_mul_f32 v161, v80, v161
  v_mul_f32 v162, v80, v162
  v_mul_f32 v163, v80, v163
  v_mfma_f32_32x32x16_bf16 v[224:239], v[44:47], a[20:23], v[224:239]
  s_add_u32 m0, s84, 149504
  s_add_u32 s45, s45, 57344
  buffer_load_dwordx4 v9, s[20:23], s45 offen lds
  buffer_load_dwordx4 v91, s[20:23], s45 offen offset:1024 lds
  v_mul_f32 v164, v80, v164
  v_mul_f32 v165, v80, v165
  v_mul_f32 v166, v80, v166
  v_mfma_f32_32x32x16_bf16 v[240:255], v[44:47], a[132:135], v[240:255]
  v_mul_f32 v167, v80, v167
  v_cvt_pk_bf16_f32 v112, v160, v161
  v_cvt_pk_bf16_f32 v113, v162, v163
  s_waitcnt vmcnt(18)
  ds_read_b64_tr_b16 a[224:225], v106 offset:6144
  ds_read_b64_tr_b16 a[226:227], v106 offset:7168
  ds_read_b64_tr_b16 a[228:229], v107 offset:6144
  ds_read_b64_tr_b16 a[230:231], v107 offset:7168
  s_waitcnt lgkmcnt(4)
  v_mfma_f32_32x32x16_bf16 v[192:207], v[32:35], a[24:27], v[192:207]
  ds_read_b64_tr_b16 v[40:41], v24 offset:6144
  ds_read_b64_tr_b16 v[42:43], v24 offset:6656
  v_cvt_pk_bf16_f32 v114, v164, v165
  v_cvt_pk_bf16_f32 v115, v166, v167
  v_mul_f32 v168, v80, v168
  v_mul_f32 v169, v80, v169
  v_mul_f32 v170, v80, v170
  v_mul_f32 v171, v80, v171
  v_mul_f32 v172, v80, v172
  v_mul_f32 v173, v80, v173
  v_mul_f32 v174, v80, v174
  v_mul_f32 v175, v80, v175
  v_cvt_pk_bf16_f32 v116, v168, v169
  v_cvt_pk_bf16_f32 v117, v170, v171
  v_mfma_f32_32x32x16_bf16 v[208:223], v[32:35], a[136:139], v[208:223]
  ds_read_b64_tr_b16 v[44:45], v25 offset:6144
  ds_read_b64_tr_b16 v[46:47], v25 offset:6656
  v_cvt_pk_bf16_f32 v118, v172, v173
  v_cvt_pk_bf16_f32 v119, v174, v175
  v_permlane32_swap_b32 v112, v114
  v_permlane32_swap_b32 v113, v115
  v_mfma_f32_32x32x16_bf16 v[224:239], v[36:39], a[24:27], v[224:239]
  s_waitcnt vmcnt(14)
  ds_read_b64_tr_b16 a[0:1], v106 offset:8192
  ds_read_b64_tr_b16 a[2:3], v106 offset:9216
  ds_read_b64_tr_b16 a[112:113], v107 offset:8192
  ds_read_b64_tr_b16 a[114:115], v107 offset:9216
  s_add_u32 m0, s74, 4096
  s_add_u32 s79, s67, 28672
  buffer_load_dwordx4 v4, s[28:31], s79 offen lds
  buffer_load_dwordx4 v5, s[28:31], s79 offen offset:1024 lds
  v_mfma_f32_32x32x16_bf16 v[240:255], v[36:39], a[136:139], v[240:255]
  s_waitcnt lgkmcnt(4)
  s_barrier
  v_mfma_f32_32x32x16_bf16 v[192:207], v[40:43], a[28:31], v[192:207]
  ds_read_b64_tr_b16 v[32:33], v24 offset:16384
  ds_read_b64_tr_b16 v[34:35], v24 offset:16896
  v_permlane32_swap_b32 v116, v118
  buffer_store_dwordx4 v[112:115], v2, s[24:27], s52 offen offset:0 sc1
  v_mfma_f32_32x32x16_bf16 v[208:223], v[40:43], a[140:143], v[208:223]
  ds_read_b64_tr_b16 v[36:37], v25 offset:16384
  ds_read_b64_tr_b16 v[38:39], v25 offset:16896
  v_permlane32_swap_b32 v117, v119
  ds_read_b64_tr_b16 a[4:5], v104 offset:0
  ds_read_b64_tr_b16 a[6:7], v104 offset:1024
  ds_read_b64_tr_b16 a[116:117], v105 offset:0
  ds_read_b64_tr_b16 a[118:119], v105 offset:1024
  v_mfma_f32_32x32x16_bf16 v[224:239], v[44:47], a[28:31], v[224:239]
  s_add_u32 m0, s84, 98304
  s_add_u32 s45, s45, 172032
  buffer_load_dwordx4 v9, s[20:23], s45 offen lds
  buffer_load_dwordx4 v91, s[20:23], s45 offen offset:1024 lds
  v_mfma_f32_32x32x16_bf16 v[240:255], v[44:47], a[140:143], v[240:255]
  s_add_u32 m0, s74, 6144
  s_add_u32 s79, s67, 43008
  buffer_load_dwordx4 v4, s[28:31], s79 offen lds
  buffer_load_dwordx4 v5, s[28:31], s79 offen offset:1024 lds
  s_waitcnt lgkmcnt(4)
  v_mfma_f32_32x32x16_bf16 v[192:207], v[32:35], a[32:35], v[192:207]
  ds_read_b64_tr_b16 v[40:41], v24 offset:18432
  ds_read_b64_tr_b16 v[42:43], v24 offset:18944
  buffer_store_dwordx4 v[116:119], v2, s[24:27], s52 offen offset:1024 sc1
  v_mul_f32 v176, v81, v176
  v_mul_f32 v177, v81, v177
  v_mul_f32 v178, v81, v178
  v_mul_f32 v179, v81, v179
  v_mul_f32 v180, v81, v180
  v_mfma_f32_32x32x16_bf16 v[208:223], v[32:35], a[144:147], v[208:223]
  ds_read_b64_tr_b16 v[44:45], v25 offset:18432
  ds_read_b64_tr_b16 v[46:47], v25 offset:18944
  v_mul_f32 v181, v81, v181
  v_mul_f32 v182, v81, v182
  v_mul_f32 v183, v81, v183
  v_cvt_pk_bf16_f32 v120, v176, v177
  v_cvt_pk_bf16_f32 v121, v178, v179
  v_cvt_pk_bf16_f32 v122, v180, v181
  v_cvt_pk_bf16_f32 v123, v182, v183
  v_mul_f32 v184, v81, v184
  v_mfma_f32_32x32x16_bf16 v[224:239], v[36:39], a[32:35], v[224:239]
  v_mul_f32 v185, v81, v185
  v_mul_f32 v186, v81, v186
  v_mul_f32 v187, v81, v187
  v_mul_f32 v188, v81, v188
  v_mul_f32 v189, v81, v189
  v_mul_f32 v190, v81, v190
  v_mul_f32 v191, v81, v191
  ds_read_b64_tr_b16 a[8:9], v104 offset:2048
  ds_read_b64_tr_b16 a[10:11], v104 offset:3072
  ds_read_b64_tr_b16 a[120:121], v105 offset:2048
  ds_read_b64_tr_b16 a[122:123], v105 offset:3072
  v_mfma_f32_32x32x16_bf16 v[240:255], v[36:39], a[144:147], v[240:255]
  v_readlane_b32 s67, v11, 31
  s_add_u32 m0, s74, 8192
  s_add_u32 s79, s67, 0
  buffer_load_dwordx4 v4, s[32:35], s79 offen lds
  buffer_load_dwordx4 v5, s[32:35], s79 offen offset:1024 lds
  s_waitcnt lgkmcnt(4)
  v_mfma_f32_32x32x16_bf16 v[192:207], v[40:43], a[36:39], v[192:207]
  ds_read_b64_tr_b16 v[32:33], v24 offset:20480
  ds_read_b64_tr_b16 v[34:35], v24 offset:20992
  v_cvt_pk_bf16_f32 v124, v184, v185
  v_cvt_pk_bf16_f32 v125, v186, v187
  v_cvt_pk_bf16_f32 v126, v188, v189
  v_cvt_pk_bf16_f32 v127, v190, v191
  v_permlane32_swap_b32 v120, v122
  v_permlane32_swap_b32 v121, v123
  v_mfma_f32_32x32x16_bf16 v[208:223], v[40:43], a[148:151], v[208:223]
  ds_read_b64_tr_b16 v[36:37], v25 offset:20480
  ds_read_b64_tr_b16 v[38:39], v25 offset:20992
  v_permlane32_swap_b32 v124, v126
  buffer_store_dwordx4 v[120:123], v2, s[24:27], s53 offen offset:0 sc1
  v_permlane32_swap_b32 v125, v127
  v_mfma_f32_32x32x16_bf16 v[224:239], v[44:47], a[36:39], v[224:239]
  s_add_u32 m0, s84, 100352
  s_add_u32 s45, s45, 57344
  buffer_load_dwordx4 v9, s[20:23], s45 offen lds
  buffer_load_dwordx4 v91, s[20:23], s45 offen offset:1024 lds
  v_mfma_f32_32x32x16_bf16 v[240:255], v[44:47], a[148:151], v[240:255]
  buffer_store_dwordx4 v[124:127], v2, s[24:27], s53 offen offset:1024 sc1
  ds_read_b64_tr_b16 a[12:13], v104 offset:4096
  ds_read_b64_tr_b16 a[14:15], v104 offset:5120
  ds_read_b64_tr_b16 a[124:125], v105 offset:4096
  ds_read_b64_tr_b16 a[126:127], v105 offset:5120
LJ22:
  s_waitcnt lgkmcnt(4)
  v_mfma_f32_32x32x16_bf16 v[192:207], v[32:35], a[40:43], v[192:207]
  ds_read_b64_tr_b16 v[40:41], v24 offset:22528
  ds_read_b64_tr_b16 v[42:43], v24 offset:23040
  s_waitcnt vmcnt(20)
  ds_read_b64_tr_b16 a[16:17], v106 offset:0
  ds_read_b64_tr_b16 a[18:19], v106 offset:1024
  ds_read_b64_tr_b16 a[128:129], v107 offset:0
  ds_read_b64_tr_b16 a[130:131], v107 offset:1024
  v_mfma_f32_32x32x16_bf16 v[208:223], v[32:35], a[152:155], v[208:223]
  ds_read_b64_tr_b16 v[44:45], v25 offset:22528
  ds_read_b64_tr_b16 v[46:47], v25 offset:23040
  v_mfma_f32_32x32x16_bf16 v[224:239], v[36:39], a[40:43], v[224:239]
  v_lshrrev_b32 v86, 5, v1
  v_and_b32 v84, 31, v1
  v_lshlrev_b32 v86, 2, v86
  v_sub_u32 v84, v84, v86
  v_mov_b32 v85, 0xf149f2ca
  v_cmp_gt_i32 s[88:89], 0, v84
  v_cmp_gt_i32 s[90:91], 1, v84
  v_mfma_f32_32x32x16_bf16 v[240:255], v[36:39], a[152:155], v[240:255]
  s_waitcnt lgkmcnt(0)
  s_barrier
  v_mfma_f32_32x32x16_bf16 v[192:207], v[40:43], a[44:47], v[192:207]
  ds_read_b64_tr_b16 v[32:33], v24 offset:32768
  ds_read_b64_tr_b16 v[34:35], v24 offset:33280
  s_waitcnt vmcnt(14)
  ds_read_b64_tr_b16 a[20:21], v106 offset:2048
  ds_read_b64_tr_b16 a[22:23], v106 offset:3072
  ds_read_b64_tr_b16 a[132:133], v107 offset:2048
  ds_read_b64_tr_b16 a[134:135], v107 offset:3072
  v_mfma_f32_32x32x16_bf16 v[208:223], v[40:43], a[156:159], v[208:223]
  ds_read_b64_tr_b16 v[36:37], v25 offset:32768
  ds_read_b64_tr_b16 v[38:39], v25 offset:33280
  v_mfma_f32_32x32x16_bf16 v[224:239], v[44:47], a[44:47], v[224:239]
  s_add_u32 m0, s84, 114688
  s_add_u32 s45, s45, 172032
  buffer_load_dwordx4 v9, s[20:23], s45 offen lds
  buffer_load_dwordx4 v91, s[20:23], s45 offen offset:1024 lds
  v_mfma_f32_32x32x16_bf16 v[240:255], v[44:47], a[156:159], v[240:255]
  s_add_u32 m0, s74, 0
  s_add_u32 s79, s67, 14336
  buffer_load_dwordx4 v4, s[32:35], s79 offen lds
  buffer_load_dwordx4 v5, s[32:35], s79 offen offset:1024 lds
  s_waitcnt lgkmcnt(0)
  v_mfma_f32_32x32x16_bf16 v[192:207], v[32:35], a[48:51], v[192:207]
  ds_read_b64_tr_b16 v[40:41], v24 offset:34816
  ds_read_b64_tr_b16 v[42:43], v24 offset:35328
  v_mfma_f32_32x32x16_bf16 v[208:223], v[32:35], a[160:163], v[208:223]
  ds_read_b64_tr_b16 v[44:45], v25 offset:34816
  ds_read_b64_tr_b16 v[46:47], v25 offset:35328
  s_waitcnt vmcnt(14)
  ds_read_b64_tr_b16 a[24:25], v106 offset:4096
  ds_read_b64_tr_b16 a[26:27], v106 offset:5120
  ds_read_b64_tr_b16 a[136:137], v107 offset:4096
  ds_read_b64_tr_b16 a[138:139], v107 offset:5120
  v_mfma_f32_32x32x16_bf16 v[224:239], v[36:39], a[48:51], v[224:239]
  v_readlane_b32 s67, v11, 32
  s_add_u32 m0, s74, 2048
  s_add_u32 s79, s67, 0
  buffer_load_dwordx4 v4, s[32:35], s79 offen lds
  buffer_load_dwordx4 v5, s[32:35], s79 offen offset:1024 lds
  v_mfma_f32_32x32x16_bf16 v[240:255], v[36:39], a[160:163], v[240:255]
  v_cmp_gt_i32 s[50:51], 2, v84
  v_cndmask_b32 v144, 0, v85, s[88:89]
  s_waitcnt lgkmcnt(4)
  v_mfma_f32_32x32x16_bf16 v[192:207], v[40:43], a[52:55], v[192:207]
  ds_read_b64_tr_b16 v[32:33], v24 offset:36864
  ds_read_b64_tr_b16 v[34:35], v24 offset:37376
  s_waitcnt vmcnt(12)
  ds_read_b64_tr_b16 a[28:29], v106 offset:6144
  ds_read_b64_tr_b16 a[30:31], v106 offset:7168
  ds_read_b64_tr_b16 a[140:141], v107 offset:6144
  ds_read_b64_tr_b16 a[142:143], v107 offset:7168
  v_mfma_f32_32x32x16_bf16 v[208:223], v[40:43], a[164:167], v[208:223]
  ds_read_b64_tr_b16 v[36:37], v25 offset:36864
  ds_read_b64_tr_b16 v[38:39], v25 offset:37376
  v_mfma_f32_32x32x16_bf16 v[224:239], v[44:47], a[52:55], v[224:239]
  s_add_u32 m0, s84, 116736
  s_add_u32 s45, s45, 57344
  buffer_load_dwordx4 v9, s[20:23], s45 offen lds
  buffer_load_dwordx4 v91, s[20:23], s45 offen offset:1024 lds
  v_mfma_f32_32x32x16_bf16 v[240:255], v[44:47], a[164:167], v[240:255]
  s_waitcnt lgkmcnt(8)
  s_add_u32 m0, s74, 4096
  s_add_u32 s79, s67, 14336
  buffer_load_dwordx4 v4, s[32:35], s79 offen lds
  buffer_load_dwordx4 v5, s[32:35], s79 offen offset:1024 lds
  s_waitcnt lgkmcnt(0)
  v_mfma_f32_32x32x16_bf16 v[192:207], v[32:35], a[56:59], v[192:207]
  ds_read_b64_tr_b16 v[40:41], v24 offset:38912
  ds_read_b64_tr_b16 v[42:43], v24 offset:39424
  s_waitcnt vmcnt(13)
  ds_read_b64_tr_b16 a[32:33], v106 offset:8192
  ds_read_b64_tr_b16 a[34:35], v106 offset:9216
  ds_read_b64_tr_b16 a[144:145], v107 offset:8192
  ds_read_b64_tr_b16 a[146:147], v107 offset:9216
  v_mfma_f32_32x32x16_bf16 v[208:223], v[32:35], a[168:171], v[208:223]
  ds_read_b64_tr_b16 v[44:45], v25 offset:38912
  ds_read_b64_tr_b16 v[46:47], v25 offset:39424
  v_mfma_f32_32x32x16_bf16 v[224:239], v[36:39], a[56:59], v[224:239]
  v_readlane_b32 s67, v11, 33
  s_add_u32 m0, s74, 6144
  s_add_u32 s79, s67, 0
  buffer_load_dwordx4 v4, s[32:35], s79 offen lds
  buffer_load_dwordx4 v5, s[32:35], s79 offen offset:1024 lds
  v_mfma_f32_32x32x16_bf16 v[240:255], v[36:39], a[168:171], v[240:255]
  s_waitcnt lgkmcnt(0)
  s_barrier
  v_mfma_f32_32x32x16_bf16 v[192:207], v[40:43], a[60:63], v[192:207]
  ds_read_b64_tr_b16 v[32:33], v24 offset:49152
  ds_read_b64_tr_b16 v[34:35], v24 offset:49664
  s_waitcnt vmcnt(12)
  v_mfma_f32_32x32x16_bf16 v[208:223], v[40:43], a[172:175], v[208:223]
  ds_read_b64_tr_b16 v[36:37], v25 offset:49152
  ds_read_b64_tr_b16 v[38:39], v25 offset:49664
  buffer_store_dwordx2 v[6:7], v8, s[24:27], s93 offen sc1
  v_mfma_f32_32x32x16_bf16 v[224:239], v[44:47], a[60:63], v[224:239]
  ds_read_b64_tr_b16 a[36:37], v104 offset:6144
  ds_read_b64_tr_b16 a[38:39], v104 offset:7168
  ds_read_b64_tr_b16 a[148:149], v105 offset:6144
  ds_read_b64_tr_b16 a[150:151], v105 offset:7168
  v_mfma_f32_32x32x16_bf16 v[240:255], v[44:47], a[172:175], v[240:255]
  v_sub_f32 v128, v85, v144
  v_cmp_gt_i32 s[88:89], 3, v84
  v_cndmask_b32 v145, 0, v85, s[90:91]
  v_sub_f32 v129, v85, v145
  v_cmp_gt_i32 s[90:91], 8, v84
  s_waitcnt lgkmcnt(4)
  v_mfma_f32_32x32x16_bf16 v[192:207], v[32:35], a[64:67], v[192:207]
  ds_read_b64_tr_b16 v[40:41], v24 offset:51200
  ds_read_b64_tr_b16 v[42:43], v24 offset:51712
  ds_read_b64_tr_b16 a[40:41], v104 offset:8192
  ds_read_b64_tr_b16 a[42:43], v104 offset:9216
  ds_read_b64_tr_b16 a[152:153], v105 offset:8192
  ds_read_b64_tr_b16 a[154:155], v105 offset:9216
  v_mfma_f32_32x32x16_bf16 v[208:223], v[32:35], a[176:179], v[208:223]
  ds_read_b64_tr_b16 v[44:45], v25 offset:51200
  ds_read_b64_tr_b16 v[46:47], v25 offset:51712
  v_mfma_f32_32x32x16_bf16 v[224:239], v[36:39], a[64:67], v[224:239]
  v_readlane_b32 s67, v11, 25
  s_add_u32 m0, s74, 8192
  s_add_u32 s79, s67, 0
  buffer_load_dwordx4 v4, s[28:31], s79 offen lds
  buffer_load_dwordx4 v5, s[28:31], s79 offen offset:1024 lds
  v_mfma_f32_32x32x16_bf16 v[240:255], v[36:39], a[176:179], v[240:255]
  buffer_load_dwordx2 v[16:17], v26, s[24:27], 0 offen sc1
  s_waitcnt lgkmcnt(0)
  v_mfma_f32_32x32x16_bf16 v[192:207], v[40:43], a[68:71], v[192:207]
  ds_read_b64_tr_b16 v[32:33], v24 offset:53248
  ds_read_b64_tr_b16 v[34:35], v24 offset:53760
  v_mfma_f32_32x32x16_bf16 v[208:223], v[40:43], a[180:183], v[208:223]
  ds_read_b64_tr_b16 v[36:37], v25 offset:53248
  ds_read_b64_tr_b16 v[38:39], v25 offset:53760
  ds_read_b64_tr_b16 a[44:45], v104 offset:10240
  ds_read_b64_tr_b16 a[46:47], v104 offset:11264
  ds_read_b64_tr_b16 a[156:157], v105 offset:10240
  ds_read_b64_tr_b16 a[158:159], v105 offset:11264
  v_mfma_f32_32x32x16_bf16 v[224:239], v[44:47], a[68:71], v[224:239]
  v_cndmask_b32 v146, 0, v85, s[50:51]
  v_sub_f32 v130, v85, v146
  v_cmp_gt_i32 s[50:51], 9, v84
  v_cndmask_b32 v147, 0, v85, s[88:89]
  v_sub_f32 v131, v85, v147
  v_mfma_f32_32x32x16_bf16 v[240:255], v[44:47], a[180:183], v[240:255]
  v_cmp_gt_i32 s[88:89], 10, v84
  v_cndmask_b32 v148, 0, v85, s[90:91]
  v_sub_f32 v132, v85, v148
  v_cmp_gt_i32 s[90:91], 11, v84
  v_cndmask_b32 v149, 0, v85, s[50:51]
  v_sub_f32 v133, v85, v149
  s_waitcnt lgkmcnt(4)
  v_mfma_f32_32x32x16_bf16 v[192:207], v[32:35], a[72:75], v[192:207]
  ds_read_b64_tr_b16 v[40:41], v24 offset:55296
  ds_read_b64_tr_b16 v[42:43], v24 offset:55808
  v_mfma_f32_32x32x16_bf16 v[208:223], v[32:35], a[184:187], v[208:223]
  ds_read_b64_tr_b16 v[44:45], v25 offset:55296
  ds_read_b64_tr_b16 v[46:47], v25 offset:55808
  s_add_u32 m0, s84, 131072
  s_add_u32 s79, s67, 14336
  buffer_load_dwordx4 v4, s[28:31], s79 offen lds
  buffer_load_dwordx4 v5, s[28:31], s79 offen offset:1024 lds
  v_mfma_f32_32x32x16_bf16 v[224:239], v[36:39], a[72:75], v[224:239]
  v_cmp_gt_i32 s[50:51], 16, v84
  v_cndmask_b32 v150, 0, v85, s[88:89]
  v_sub_f32 v134, v85, v150
  v_cmp_gt_i32 s[88:89], 17, v84
  v_cndmask_b32 v151, 0, v85, s[90:91]
  v_sub_f32 v135, v85, v151
  v_mfma_f32_32x32x16_bf16 v[240:255], v[36:39], a[184:187], v[240:255]
  s_waitcnt lgkmcnt(0)
  s_barrier
  v_mfma_f32_32x32x16_bf16 v[192:207], v[40:43], a[76:79], v[192:207]
  ds_read_b64_tr_b16 v[32:33], v24 offset:0
  ds_read_b64_tr_b16 v[34:35], v24 offset:512
  v_mfma_f32_32x32x16_bf16 v[208:223], v[40:43], a[188:191], v[208:223]
  ds_read_b64_tr_b16 v[36:37], v25 offset:0
  ds_read_b64_tr_b16 v[38:39], v25 offset:512
  s_waitcnt vmcnt(14)
  ds_read_b64_tr_b16 a[48:49], v106 offset:0
  ds_read_b64_tr_b16 a[50:51], v106 offset:1024
  ds_read_b64_tr_b16 a[160:161], v107 offset:0
  ds_read_b64_tr_b16 a[162:163], v107 offset:1024
  v_mfma_f32_32x32x16_bf16 v[224:239], v[44:47], a[76:79], v[224:239]
  s_add_u32 m0, s84, 133120
  s_add_u32 s79, s67, 28672
  buffer_load_dwordx4 v4, s[28:31], s79 offen lds
  buffer_load_dwordx4 v5, s[28:31], s79 offen offset:1024 lds
  v_mfma_f32_32x32x16_bf16 v[240:255], v[44:47], a[188:191], v[240:255]
  v_cmp_gt_i32 s[90:91], 18, v84
  v_cndmask_b32 v152, 0, v85, s[50:51]
  s_waitcnt lgkmcnt(4)
  v_mfma_f32_32x32x16_bf16 v[192:207], v[32:35], a[80:83], v[192:207]
  ds_read_b64_tr_b16 v[40:41], v24 offset:2048
  ds_read_b64_tr_b16 v[42:43], v24 offset:2560
  v_mfma_f32_32x32x16_bf16 v[208:223], v[32:35], a[192:195], v[208:223]
  ds_read_b64_tr_b16 v[44:45], v25 offset:2048
  ds_read_b64_tr_b16 v[46:47], v25 offset:2560
  s_waitcnt vmcnt(14)
  ds_read_b64_tr_b16 a[52:53], v106 offset:2048
  ds_read_b64_tr_b16 a[54:55], v106 offset:3072
  ds_read_b64_tr_b16 a[164:165], v107 offset:2048
  ds_read_b64_tr_b16 a[166:167], v107 offset:3072
  v_mfma_f32_32x32x16_bf16 v[224:239], v[36:39], a[80:83], v[224:239]
  s_waitcnt vmcnt(4)
  v_cmp_eq_u64 vcc, s[80:81], v[16:17]
  s_nop 0
  s_cmp_eq_u64 vcc, exec
  s_cbranch_scc0 SPIN19
OK18:
  v_sub_f32 v136, v85, v152
  v_mfma_f32_32x32x16_bf16 v[240:255], v[36:39], a[192:195], v[240:255]
  v_cmp_gt_i32 s[50:51], 19, v84
  v_cndmask_b32 v153, 0, v85, s[88:89]
  v_sub_f32 v137, v85, v153
  v_cmp_gt_i32 s[88:89], 24, v84
  v_cndmask_b32 v154, 0, v85, s[90:91]
  v_sub_f32 v138, v85, v154
  s_waitcnt lgkmcnt(4)
  v_mfma_f32_32x32x16_bf16 v[192:207], v[40:43], a[84:87], v[192:207]
  ds_read_b64_tr_b16 v[32:33], v24 offset:4096
  ds_read_b64_tr_b16 v[34:35], v24 offset:4608
  ds_read_b64_tr_b16 a[56:57], v106 offset:4096
  ds_read_b64_tr_b16 a[58:59], v106 offset:5120
  ds_read_b64_tr_b16 a[168:169], v107 offset:4096
  ds_read_b64_tr_b16 a[170:171], v107 offset:5120
  v_mfma_f32_32x32x16_bf16 v[208:223], v[40:43], a[196:199], v[208:223]
  ds_read_b64_tr_b16 v[36:37], v25 offset:4096
  ds_read_b64_tr_b16 v[38:39], v25 offset:4608
  v_mfma_f32_32x32x16_bf16 v[224:239], v[44:47], a[84:87], v[224:239]
  v_readlane_b32 s67, v11, 24
  s_add_u32 m0, s74, 0
  s_add_u32 s79, s67, 0
  buffer_load_dwordx4 v4, s[28:31], s79 offen lds
  buffer_load_dwordx4 v5, s[28:31], s79 offen offset:1024 lds
  v_and_b32 v21, 31, v1
  v_lshlrev_b32 v21, 3, v21
  v_mfma_f32_32x32x16_bf16 v[240:255], v[44:47], a[196:199], v[240:255]
  buffer_load_dwordx4 v[96:99], v2, s[24:27], s94 offen offset:0 sc1
  buffer_load_dwordx4 v[100:103], v2, s[24:27], s94 offen offset:1024 sc1
  buffer_load_dword v21, v21, s[24:27], s95 offen sc1
  s_waitcnt lgkmcnt(0)
  v_mfma_f32_32x32x16_bf16 v[192:207], v[32:35], a[88:91], v[192:207]
  ds_read_b64_tr_b16 v[40:41], v24 offset:6144
  ds_read_b64_tr_b16 v[42:43], v24 offset:6656
  ds_read_b64_tr_b16 a[60:61], v106 offset:6144
  ds_read_b64_tr_b16 a[62:63], v106 offset:7168
  ds_read_b64_tr_b16 a[172:173], v107 offset:6144
  ds_read_b64_tr_b16 a[174:175], v107 offset:7168
  v_mfma_f32_32x32x16_bf16 v[208:223], v[32:35], a[200:203], v[208:223]
  ds_read_b64_tr_b16 v[44:45], v25 offset:6144
  ds_read_b64_tr_b16 v[46:47], v25 offset:6656
  s_add_u32 m0, s74, 2048
  s_add_u32 s79, s67, 14336
  buffer_load_dwordx4 v4, s[28:31], s79 offen lds
  buffer_load_dwordx4 v5, s[28:31], s79 offen offset:1024 lds
  v_mfma_f32_32x32x16_bf16 v[224:239], v[36:39], a[88:91], v[224:239]
  s_add_u32 m0, s75, 0
  s_add_u32 s70, s70, 28672
  buffer_load_dwordx4 v2, s[24:27], s70 offen sc1 lds
  buffer_load_dwordx4 v2, s[24:27], s70 offen offset:1024 sc1 lds
  v_mfma_f32_32x32x16_bf16 v[240:255], v[36:39], a[200:203], v[240:255]
  s_waitcnt lgkmcnt(0)
  s_barrier
  v_mfma_f32_32x32x16_bf16 v[192:207], v[40:43], a[92:95], v[192:207]
  ds_read_b64_tr_b16 v[32:33], v24 offset:16384
  ds_read_b64_tr_b16 v[34:35], v24 offset:16896
  v_mfma_f32_32x32x16_bf16 v[208:223], v[40:43], a[204:207], v[208:223]
  ds_read_b64_tr_b16 v[36:37], v25 offset:16384
  ds_read_b64_tr_b16 v[38:39], v25 offset:16896
  s_add_u32 m0, s75, 2048
  s_add_u32 s71, s71, 28672
  buffer_load_dwordx4 v2, s[24:27], s71 offen sc1 lds
  buffer_load_dwordx4 v2, s[24:27], s71 offen offset:1024 sc1 lds
  v_mfma_f32_32x32x16_bf16 v[224:239], v[44:47], a[92:95], v[224:239]
  v_cmp_gt_i32 s[90:91], 25, v84
  v_cndmask_b32 v155, 0, v85, s[50:51]
  v_sub_f32 v139, v85, v155
  v_cmp_gt_i32 s[50:51], 26, v84
  v_mfma_f32_32x32x16_bf16 v[240:255], v[44:47], a[204:207], v[240:255]
  v_cndmask_b32 v156, 0, v85, s[88:89]
  v_sub_f32 v140, v85, v156
  v_cmp_gt_i32 s[88:89], 27, v84
  v_cndmask_b32 v157, 0, v85, s[90:91]
  v_sub_f32 v141, v85, v157
  v_cndmask_b32 v158, 0, v85, s[50:51]
  s_waitcnt lgkmcnt(0)
  v_mfma_f32_32x32x16_bf16 v[192:207], v[32:35], a[96:99], v[192:207]
  ds_read_b64_tr_b16 v[40:41], v24 offset:18432
  ds_read_b64_tr_b16 v[42:43], v24 offset:18944
  v_mfma_f32_32x32x16_bf16 v[208:223], v[32:35], a[208:211], v[208:223]
  ds_read_b64_tr_b16 v[44:45], v25 offset:18432
  ds_read_b64_tr_b16 v[46:47], v25 offset:18944
  v_readlane_b32 s67, v11, 25
  s_add_u32 m0, s84, 147456
  s_add_u32 s79, s67, 43008
  buffer_load_dwordx4 v4, s[28:31], s79 offen lds
  buffer_load_dwordx4 v5, s[28:31], s79 offen offset:1024 lds
  v_mfma_f32_32x32x16_bf16 v[224:239], v[36:39], a[96:99], v[224:239]
  v_mfma_f32_32x32x16_bf16 v[240:255], v[36:39], a[208:211], v[240:255]
  s_add_u32 m0, s75, 4096
  s_add_u32 s72, s72, 28672
  buffer_load_dwordx4 v2, s[24:27], s72 offen sc1 lds
  buffer_load_dwordx4 v2, s[24:27], s72 offen offset:1024 sc1 lds
  v_sub_f32 v142, v85, v158
  s_waitcnt lgkmcnt(0)
  v_mfma_f32_32x32x16_bf16 v[192:207], v[40:43], a[100:103], v[192:207]
  ds_read_b64_tr_b16 v[32:33], v24 offset:20480
  ds_read_b64_tr_b16 v[34:35], v24 offset:20992
  v_mfma_f32_32x32x16_bf16 v[208:223], v[40:43], a[212:215], v[208:223]
  ds_read_b64_tr_b16 v[36:37], v25 offset:20480
  ds_read_b64_tr_b16 v[38:39], v25 offset:20992
  v_readlane_b32 s67, v11, 24
  s_add_u32 m0, s74, 4096
  s_add_u32 s79, s67, 28672
  buffer_load_dwordx4 v4, s[28:31], s79 offen lds
  buffer_load_dwordx4 v5, s[28:31], s79 offen offset:1024 lds
  v_mfma_f32_32x32x16_bf16 v[224:239], v[44:47], a[100:103], v[224:239]
  buffer_load_dwordx2 v[18:19], v27, s[24:27], 0 offen sc1
  v_mfma_f32_32x32x16_bf16 v[240:255], v[44:47], a[212:215], v[240:255]
  buffer_load_dwordx2 v[16:17], v12, s[24:27], s96 offen sc1
  v_cndmask_b32 v159, 0, v85, s[88:89]
  v_sub_f32 v143, v85, v159
  s_waitcnt lgkmcnt(0)
  v_mfma_f32_32x32x16_bf16 v[192:207], v[32:35], a[104:107], v[192:207]
  ds_read_b64_tr_b16 v[40:41], v24 offset:22528
  ds_read_b64_tr_b16 v[42:43], v24 offset:23040
  v_mfma_f32_32x32x16_bf16 v[208:223], v[32:35], a[216:219], v[208:223]
  ds_read_b64_tr_b16 v[44:45], v25 offset:22528
  ds_read_b64_tr_b16 v[46:47], v25 offset:23040
  v_mfma_f32_32x32x16_bf16 v[224:239], v[36:39], a[104:107], v[224:239]
  s_add_u32 m0, s74, 6144
  s_add_u32 s79, s67, 43008
  buffer_load_dwordx4 v4, s[28:31], s79 offen lds
  buffer_load_dwordx4 v5, s[28:31], s79 offen offset:1024 lds
  v_mfma_f32_32x32x16_bf16 v[240:255], v[36:39], a[216:219], v[240:255]
  v_readlane_b32 s89, v11, 18
  v_readlane_b32 s90, v11, 19
  s_mov_b32 s88, 0
  s_mov_b32 s91, 0
  s_waitcnt lgkmcnt(0)
  v_mfma_f32_32x32x16_bf16 v[192:207], v[40:43], a[108:111], v[192:207]
  v_mfma_f32_32x32x16_bf16 v[208:223], v[40:43], a[220:223], v[208:223]
  v_mfma_f32_32x32x16_bf16 v[224:239], v[44:47], a[108:111], v[224:239]
  v_readlane_b32 s67, v11, 26
  s_add_u32 m0, s84, 149504
  s_add_u32 s79, s67, 0
  buffer_load_dwordx4 v4, s[28:31], s79 offen lds
  buffer_load_dwordx4 v5, s[28:31], s79 offen offset:1024 lds
  v_mfma_f32_32x32x16_bf16 v[240:255], v[44:47], a[220:223], v[240:255]
  v_readlane_b32 s92, v11, 14
  v_readlane_b32 s93, v11, 15
  v_readlane_b32 s94, v11, 16
  v_mov_b32 v84, 0x3f803f80
  v_mfma_f32_32x32x16_bf16 v[192:207], v[68:71], v[52:55], v[192:207]
  v_mov_b32 v22, 0xf14a
  s_waitcnt vmcnt(8)
  v_mov_b32 v85, s92
  ds_write_b64 v95, v[84:85] offset:0
  v_mfma_f32_32x32x16_bf16 v[208:223], v[68:71], v[56:59], v[208:223]
  v_mov_b32 v85, s93
  ds_write_b64 v95, v[84:85] offset:2048
  v_mfma_f32_32x32x16_bf16 v[224:239], v[72:75], v[52:55], v[224:239]
  v_mov_b32 v85, s94
  ds_write_b64 v95, v[84:85] offset:4096
  v_mfma_f32_32x32x16_bf16 v[240:255], v[72:75], v[56:59], v[240:255]
  v_cndmask_b32 v102, v102, 0, s[88:89]
  v_cndmask_b32 v96, v96, 0, s[90:91]
  v_cndmask_b32 v103, v103, v22, s[88:89]
  v_cndmask_b32 v97, v97, v22, s[90:91]
  s_waitcnt vmcnt(5)
  v_cmp_eq_u64 vcc, s[80:81], v[18:19]
  s_nop 0
  s_cmp_eq_u64 vcc, exec
  s_cbranch_scc0 SPIN24
OK23:
  s_waitcnt lgkmcnt(0)
  s_barrier
  ds_read_b128 v[28:31], v92 offset:16384
  ds_read_b128 v[32:35], v92 offset:17408
  ds_read_b128 v[84:87], v92 offset:14336
  ds_read_b128 v[88:91], v92 offset:15360
  s_add_u32 m0, s75, 24576
  s_add_u32 s70, s70, 28672
  buffer_load_dwordx4 v110, s[24:27], s70 offen sc1 lds
  buffer_load_dwordx4 v111, s[24:27], s70 offen offset:1024 sc1 lds
  s_add_u32 m0, s75, 26624
  s_add_u32 s71, s71, 28672
  buffer_load_dwordx4 v110, s[24:27], s71 offen sc1 lds
  buffer_load_dwordx4 v111, s[24:27], s71 offen offset:1024 sc1 lds
  s_add_u32 m0, s75, 28672
  s_add_u32 s72, s72, 28672
  buffer_load_dwordx4 v110, s[24:27], s72 offen sc1 lds
  buffer_load_dwordx4 v111, s[24:27], s72 offen offset:1024 sc1 lds
  v_mul_f32 v192, v192, v200
  v_mul_f32 v193, v193, v201
  v_mul_f32 v194, v194, v202
  v_mul_f32 v195, v195, v203
  v_mul_f32 v196, v196, v204
  v_mul_f32 v197, v197, v205
  v_mul_f32 v198, v198, v206
  v_mul_f32 v199, v199, v207
  v_cvt_pk_bf16_f32 v112, v192, v193
  v_cvt_pk_bf16_f32 v113, v194, v195
  v_cvt_pk_bf16_f32 v114, v196, v197
  v_cvt_pk_bf16_f32 v115, v198, v199
  buffer_store_dwordx4 v[112:115], v2, s[24:27], s54 offen sc1
  s_waitcnt lgkmcnt(2)
  v_mfma_f32_32x32x16_bf16 v[176:191], v[28:31], v[96:99], v[144:159]
  v_mfma_f32_32x32x16_bf16 v[176:191], v[32:35], v[100:103], v[176:191]
  v_mul_f32 v208, v208, v216
  v_mul_f32 v209, v209, v217
  v_mul_f32 v210, v210, v218
  v_mul_f32 v211, v211, v219
  v_mul_f32 v212, v212, v220
  v_mul_f32 v213, v213, v221
  v_mul_f32 v214, v214, v222
  v_mul_f32 v215, v215, v223
  v_cvt_pk_bf16_f32 v116, v208, v209
  v_cvt_pk_bf16_f32 v117, v210, v211
  v_cvt_pk_bf16_f32 v118, v212, v213
  v_cvt_pk_bf16_f32 v119, v214, v215
  buffer_store_dwordx4 v[116:119], v2, s[24:27], s55 offen sc1
  v_mul_f32 v224, v224, v232
  v_mul_f32 v225, v225, v233
  v_mul_f32 v226, v226, v234
  v_mul_f32 v227, v227, v235
  v_mul_f32 v228, v228, v236
  v_mul_f32 v229, v229, v237
  v_max_f32 v22, v176, v177
  v_max3_f32 v22, v178, v179, v22
  v_max3_f32 v22, v180, v181, v22
  v_max3_f32 v22, v182, v183, v22
  v_max3_f32 v22, v184, v185, v22
  v_max3_f32 v22, v186, v187, v22
  v_max3_f32 v22, v188, v189, v22
  v_max3_f32 v22, v190, v191, v22
  v_mov_b32 v23, v22
  s_nop 1
  v_permlane32_swap_b32 v22, v23
  v_max_f32 v22, v22, v23
  v_cvt_pk_bf16_f32 v23, -v22, -v22
  v_lshlrev_b32 v23, 16, v23
  v_add_f32 v22, v22, v23
  v_cvt_pk_bf16_f32 v23, v23, -v22
  v_cndmask_b32 v96, v96, v23, s[90:91]
  v_cndmask_b32 v102, v102, v23, s[88:89]
  v_mul_f32 v230, v230, v238
  v_mul_f32 v231, v231, v239
  v_mfma_f32_32x32x16_bf16 v[160:175], v[28:31], v[96:99], v[144:159]
  v_mfma_f32_32x32x16_bf16 v[160:175], v[32:35], v[100:103], v[160:175]
  v_cvt_pk_bf16_f32 v120, v224, v225
  v_cvt_pk_bf16_f32 v121, v226, v227
  v_cvt_pk_bf16_f32 v122, v228, v229
  v_cvt_pk_bf16_f32 v123, v230, v231
  buffer_store_dwordx4 v[120:123], v2, s[24:27], s56 offen sc1
  v_mul_f32 v240, v240, v248
  v_mul_f32 v241, v241, v249
  v_mul_f32 v242, v242, v250
  v_mul_f32 v243, v243, v251
  v_mul_f32 v244, v244, v252
  v_mul_f32 v245, v245, v253
  v_mul_f32 v246, v246, v254
  v_mul_f32 v247, v247, v255
  v_cvt_pk_bf16_f32 v124, v240, v241
  v_cvt_pk_bf16_f32 v125, v242, v243
  v_cvt_pk_bf16_f32 v126, v244, v245
  v_cvt_pk_bf16_f32 v127, v246, v247
  buffer_store_dwordx4 v[124:127], v2, s[24:27], s57 offen sc1
  s_waitcnt vmcnt(14)
  v_cmp_eq_u64 vcc, s[80:81], v[16:17]
  s_nop 0
  s_cmp_eq_u64 vcc, exec
  s_cbranch_scc0 SPIN26
OK25:
  v_and_b32 v21, 0xffff0000, v21
  v_mul_f32 v21, v21, v21
  s_waitcnt lgkmcnt(0)
  v_exp_f32 v160, v160
  v_exp_f32 v161, v161
  v_exp_f32 v162, v162
  v_exp_f32 v163, v163
  v_mfma_f32_32x32x16_bf16 v[176:191], v[84:87], v[96:99], 0
  ds_read_b128 v[76:79], v92 offset:12288
  ds_read_b128 v[80:83], v92 offset:13312
  v_exp_f32 v164, v164
  v_exp_f32 v165, v165
  v_exp_f32 v166, v166
  v_exp_f32 v167, v167
  v_cvt_pk_bf16_f32 v240, v160, v161
  v_cvt_pk_bf16_f32 v241, v162, v163
  v_cvt_pk_bf16_f32 v242, v164, v165
  v_cvt_pk_bf16_f32 v243, v166, v167
  v_mfma_f32_32x32x16_bf16 v[176:191], v[88:91], v[100:103], v[176:191]
  v_exp_f32 v168, v168
  v_exp_f32 v169, v169
  v_exp_f32 v170, v170
  v_exp_f32 v171, v171
  v_exp_f32 v172, v172
  v_exp_f32 v173, v173
  v_exp_f32 v174, v174
  v_exp_f32 v175, v175
  v_readlane_b32 s78, v11, 35
  s_nop 0
  s_mov_b32 s87, s78
  buffer_load_dwordx4 a[64:67], v2, s[24:27], s87 offen offset:0 sc1
  buffer_load_dwordx4 a[176:179], v10, s[24:27], s87 offen offset:0 sc1
  buffer_load_dwordx4 a[68:71], v2, s[24:27], s87 offen offset:1024 sc1
  buffer_load_dwordx4 a[180:183], v10, s[24:27], s87 offen offset:1024 sc1
  s_add_u32 m0, s84, 98304
  s_add_u32 s79, s67, 14336
  buffer_load_dwordx4 v4, s[28:31], s79 offen lds
  buffer_load_dwordx4 v5, s[28:31], s79 offen offset:1024 lds
  v_cvt_pk_bf16_f32 v244, v168, v169
  v_cvt_pk_bf16_f32 v245, v170, v171
  v_cvt_pk_bf16_f32 v246, v172, v173
  v_cvt_pk_bf16_f32 v247, v174, v175
  s_waitcnt lgkmcnt(0)
  v_exp_f32 v176, v176
  v_exp_f32 v177, v177
  v_exp_f32 v178, v178
  v_exp_f32 v179, v179
  v_mfma_f32_32x32x16_bf16 v[160:175], v[76:79], v[96:99], 0
  ds_read_b128 v[68:71], v92 offset:10240
  ds_read_b128 v[72:75], v92 offset:11264
  v_exp_f32 v180, v180
  v_exp_f32 v181, v181
  v_exp_f32 v182, v182
  v_exp_f32 v183, v183
  v_cvt_pk_bf16_f32 v248, v176, v177
  v_cvt_pk_bf16_f32 v249, v178, v179
  v_cvt_pk_bf16_f32 v250, v180, v181
  v_cvt_pk_bf16_f32 v251, v182, v183
  v_mfma_f32_32x32x16_bf16 v[160:175], v[80:83], v[100:103], v[160:175]
  v_exp_f32 v184, v184
  v_exp_f32 v185, v185
  v_exp_f32 v186, v186
  v_exp_f32 v187, v187
  v_exp_f32 v188, v188
  v_exp_f32 v189, v189
  v_exp_f32 v190, v190
  v_exp_f32 v191, v191
  buffer_load_dwordx4 a[72:75], v2, s[24:27], s87 offen offset:2048 sc1
  buffer_load_dwordx4 a[184:187], v10, s[24:27], s87 offen offset:2048 sc1
  s_add_u32 s96, s96, 8192
  v_readlane_b32 s92, v11, 9
  v_readlane_b32 s93, v11, 3
  v_readlane_b32 s94, v11, 13
  v_cvt_pk_bf16_f32 v252, v184, v185
  v_cvt_pk_bf16_f32 v253, v186, v187
  v_cvt_pk_bf16_f32 v254, v188, v189
  v_cvt_pk_bf16_f32 v255, v190, v191
  v_mov_b32 v112, 0x3f803f80
  v_mov_b32 v113, 0x3f803f80
  s_waitcnt vmcnt(12)
  ds_write_b64 v95, v[112:113] offset:24576
  ds_write_b64 v95, v[112:113] offset:26624
  ds_write_b64 v95, v[112:113] offset:28672
  s_waitcnt lgkmcnt(0)
  s_barrier
  ds_read_b64_tr_b16 v[224:225], v93 offset:16384
  ds_read_b64_tr_b16 v[226:227], v94 offset:16384
  ds_read_b64_tr_b16 v[228:229], v93 offset:16640
  ds_read_b64_tr_b16 v[230:231], v94 offset:16640
  ds_read_b64_tr_b16 v[232:233], v93 offset:14336
  ds_read_b64_tr_b16 v[234:235], v94 offset:14336
  ds_read_b64_tr_b16 v[236:237], v93 offset:14592
  ds_read_b64_tr_b16 v[238:239], v94 offset:14592
  v_exp_f32 v160, v160
  v_exp_f32 v161, v161
  v_exp_f32 v162, v162
  v_exp_f32 v163, v163
  v_mfma_f32_32x32x16_bf16 v[176:191], v[68:71], v[96:99], 0
  ds_read_b128 v[60:63], v92 offset:8192
  ds_read_b128 v[64:67], v92 offset:9216
  v_exp_f32 v164, v164
  v_exp_f32 v165, v165
  v_exp_f32 v166, v166
  v_exp_f32 v167, v167
  s_waitcnt lgkmcnt(2)
  v_mfma_f32_32x32x16_bf16 v[208:223], v[224:227], v[240:243], 0
  v_cvt_pk_bf16_f32 v36, v160, v161
  v_cvt_pk_bf16_f32 v37, v162, v163
  v_cvt_pk_bf16_f32 v38, v164, v165
  v_cvt_pk_bf16_f32 v39, v166, v167
  v_mfma_f32_32x32x16_bf16 v[176:191], v[72:75], v[100:103], v[176:191]
  v_exp_f32 v168, v168
  v_exp_f32 v169, v169
  v_exp_f32 v170, v170
  v_mfma_f32_32x32x16_bf16 v[208:223], v[228:231], v[244:247], v[208:223]
  v_exp_f32 v171, v171
  ds_read_b64_tr_b16 v[224:225], v93 offset:12288
  ds_read_b64_tr_b16 v[226:227], v94 offset:12288
  v_exp_f32 v172, v172
  v_exp_f32 v173, v173
  v_mfma_f32_32x32x16_bf16 v[208:223], v[232:235], v[248:251], v[208:223]
  v_exp_f32 v174, v174
  ds_read_b64_tr_b16 v[228:229], v93 offset:12544
  ds_read_b64_tr_b16 v[230:231], v94 offset:12544
  v_exp_f32 v175, v175
  s_waitcnt vmcnt(8)
  buffer_store_dwordx2 v[6:7], v8, s[24:27], s97 offen sc1
  buffer_load_dwordx4 a[76:79], v2, s[24:27], s87 offen offset:3072 sc1
  buffer_load_dwordx4 a[188:191], v10, s[24:27], s87 offen offset:3072 sc1
  v_readlane_b32 s78, v11, 36
  s_nop 0
  s_mov_b32 s87, s78
  buffer_load_dwordx4 a[80:83], v2, s[24:27], s87 offen offset:0 sc1
  buffer_load_dwordx4 a[192:195], v10, s[24:27], s87 offen offset:0 sc1
  s_add_u32 m0, s84, 100352
  s_add_u32 s79, s67, 28672
  buffer_load_dwordx4 v4, s[28:31], s79 offen lds
  buffer_load_dwordx4 v5, s[28:31], s79 offen offset:1024 lds
  v_mfma_f32_32x32x16_bf16 v[208:223], v[236:239], v[252:255], v[208:223]
  v_cvt_pk_bf16_f32 v40, v168, v169
  v_cvt_pk_bf16_f32 v41, v170, v171
  v_cvt_pk_bf16_f32 v42, v172, v173
  v_cvt_pk_bf16_f32 v43, v174, v175
  s_waitcnt lgkmcnt(0)
  v_mfma_f32_32x32x16_bf16 v[208:223], v[224:227], v[36:39], v[208:223]
  v_exp_f32 v176, v176
  v_exp_f32 v177, v177
  v_exp_f32 v178, v178
  v_exp_f32 v179, v179
  v_mfma_f32_32x32x16_bf16 v[160:175], v[60:63], v[96:99], 0
  ds_read_b128 v[52:55], v92 offset:6144
  ds_read_b128 v[56:59], v92 offset:7168
  v_exp_f32 v180, v180
  v_exp_f32 v181, v181
  v_exp_f32 v182, v182
  v_exp_f32 v183, v183
  v_mfma_f32_32x32x16_bf16 v[208:223], v[228:231], v[40:43], v[208:223]
  v_cvt_pk_bf16_f32 v240, v176, v177
  v_cvt_pk_bf16_f32 v241, v178, v179
  v_cvt_pk_bf16_f32 v242, v180, v181
  v_cvt_pk_bf16_f32 v243, v182, v183
  ds_read_b64_tr_b16 v[232:233], v93 offset:10240
  ds_read_b64_tr_b16 v[234:235], v94 offset:10240
  ds_read_b64_tr_b16 v[236:237], v93 offset:10496
  ds_read_b64_tr_b16 v[238:239], v94 offset:10496
  v_mfma_f32_32x32x16_bf16 v[160:175], v[64:67], v[100:103], v[160:175]
  v_exp_f32 v184, v184
  v_exp_f32 v185, v185
  v_exp_f32 v186, v186
  v_exp_f32 v187, v187
  v_exp_f32 v188, v188
  v_exp_f32 v189, v189
  v_exp_f32 v190, v190
  v_exp_f32 v191, v191
  buffer_load_dwordx4 a[84:87], v2, s[24:27], s87 offen offset:1024 sc1
  buffer_load_dwordx4 a[196:199], v10, s[24:27], s87 offen offset:1024 sc1
  v_cvt_pk_bf16_f32 v244, v184, v185
  v_cvt_pk_bf16_f32 v245, v186, v187
  v_cvt_pk_bf16_f32 v246, v188, v189
  v_cvt_pk_bf16_f32 v247, v190, v191
  s_waitcnt lgkmcnt(0)
  v_mfma_f32_32x32x16_bf16 v[208:223], v[232:235], v[240:243], v[208:223]
  v_exp_f32 v160, v160
  v_exp_f32 v161, v161
  v_exp_f32 v162, v162
  v_exp_f32 v163, v163
  v_mfma_f32_32x32x16_bf16 v[176:191], v[52:55], v[96:99], 0
  ds_read_b128 v[44:47], v92 offset:4096
  ds_read_b128 v[48:51], v92 offset:5120
  v_exp_f32 v164, v164
  v_exp_f32 v165, v165
  v_exp_f32 v166, v166
  v_exp_f32 v167, v167
  v_mfma_f32_32x32x16_bf16 v[208:223], v[236:239], v[244:247], v[208:223]
  v_cvt_pk_bf16_f32 v248, v160, v161
  v_cvt_pk_bf16_f32 v249, v162, v163
  v_cvt_pk_bf16_f32 v250, v164, v165
  v_cvt_pk_bf16_f32 v251, v166, v167
  ds_read_b64_tr_b16 v[224:225], v93 offset:8192
  ds_read_b64_tr_b16 v[226:227], v94 offset:8192
  ds_read_b64_tr_b16 v[228:229], v93 offset:8448
  ds_read_b64_tr_b16 v[230:231], v94 offset:8448
  v_mfma_f32_32x32x16_bf16 v[176:191], v[56:59], v[100:103], v[176:191]
  v_exp_f32 v168, v168
  v_exp_f32 v169, v169
  v_exp_f32 v170, v170
  v_exp_f32 v171, v171
  v_exp_f32 v172, v172
  v_exp_f32 v173, v173
  v_exp_f32 v174, v174
  v_exp_f32 v175, v175
  buffer_load_dwordx4 a[88:91], v2, s[24:27], s87 offen offset:2048 sc1
  buffer_load_dwordx4 a[200:203], v10, s[24:27], s87 offen offset:2048 sc1
  buffer_load_dwordx4 a[92:95], v2, s[24:27], s87 offen offset:3072 sc1
  buffer_load_dwordx4 a[204:207], v10, s[24:27], s87 offen offset:3072 sc1
  s_add_u32 m0, s84, 114688
  s_add_u32 s79, s67, 43008
  buffer_load_dwordx4 v4, s[28:31], s79 offen lds
  buffer_load_dwordx4 v5, s[28:31], s79 offen offset:1024 lds
  v_cvt_pk_bf16_f32 v252, v168, v169
  v_cvt_pk_bf16_f32 v253, v170, v171
  v_cvt_pk_bf16_f32 v254, v172, v173
  v_cvt_pk_bf16_f32 v255, v174, v175
  s_waitcnt lgkmcnt(0)
  v_mfma_f32_32x32x16_bf16 v[208:223], v[224:227], v[248:251], v[208:223]
  v_exp_f32 v176, v176
  v_exp_f32 v177, v177
  v_exp_f32 v178, v178
  v_exp_f32 v179, v179
  v_mfma_f32_32x32x16_bf16 v[160:175], v[44:47], v[96:99], 0
  ds_read_b128 v[200:203], v92 offset:2048
  ds_read_b128 v[204:207], v92 offset:3072
  v_exp_f32 v180, v180
  v_exp_f32 v181, v181
  v_exp_f32 v182, v182
  v_exp_f32 v183, v183
  v_mfma_f32_32x32x16_bf16 v[208:223], v[228:231], v[252:255], v[208:223]
  v_cvt_pk_bf16_f32 v36, v176, v177
  v_cvt_pk_bf16_f32 v37, v178, v179
  v_cvt_pk_bf16_f32 v38, v180, v181
  v_cvt_pk_bf16_f32 v39, v182, v183
  ds_read_b64_tr_b16 v[232:233], v93 offset:6144
  ds_read_b64_tr_b16 v[234:235], v94 offset:6144
  ds_read_b64_tr_b16 v[236:237], v93 offset:6400
  ds_read_b64_tr_b16 v[238:239], v94 offset:6400
  v_mfma_f32_32x32x16_bf16 v[160:175], v[48:51], v[100:103], v[160:175]
  v_exp_f32 v184, v184
  v_exp_f32 v185, v185
  v_exp_f32 v186, v186
  v_exp_f32 v187, v187
  v_exp_f32 v188, v188
  v_exp_f32 v189, v189
  v_exp_f32 v190, v190
  v_exp_f32 v191, v191
  v_readlane_b32 s78, v11, 37
  s_nop 0
  s_mov_b32 s87, s78
  buffer_load_dwordx4 a[96:99], v2, s[24:27], s87 offen offset:0 sc1
  buffer_load_dwordx4 a[208:211], v10, s[24:27], s87 offen offset:0 sc1
  v_readlane_b32 s67, v11, 27
  s_add_u32 m0, s84, 116736
  s_add_u32 s79, s67, 0
  buffer_load_dwordx4 v4, s[28:31], s79 offen lds
  buffer_load_dwordx4 v5, s[28:31], s79 offen offset:1024 lds
  v_cvt_pk_bf16_f32 v40, v184, v185
  v_cvt_pk_bf16_f32 v41, v186, v187
  v_cvt_pk_bf16_f32 v42, v188, v189
  v_cvt_pk_bf16_f32 v43, v190, v191
  s_waitcnt lgkmcnt(0)
  v_mfma_f32_32x32x16_bf16 v[208:223], v[232:235], v[36:39], v[208:223]
  v_exp_f32 v160, v160
  v_exp_f32 v161, v161
  v_exp_f32 v162, v162
  v_exp_f32 v163, v163
  v_mfma_f32_32x32x16_bf16 v[176:191], v[200:203], v[96:99], 0
  ds_read_b128 v[192:195], v92 offset:0
  ds_read_b128 v[196:199], v92 offset:1024
  v_exp_f32 v164, v164
  v_exp_f32 v165, v165
  v_exp_f32 v166, v166
  v_exp_f32 v167, v167
  v_mfma_f32_32x32x16_bf16 v[208:223], v[236:239], v[40:43], v[208:223]
  v_cvt_pk_bf16_f32 v240, v160, v161
  v_cvt_pk_bf16_f32 v241, v162, v163
  v_cvt_pk_bf16_f32 v242, v164, v165
  v_cvt_pk_bf16_f32 v243, v166, v167
  ds_read_b64_tr_b16 v[224:225], v93 offset:4096
  ds_read_b64_tr_b16 v[226:227], v94 offset:4096
  ds_read_b64_tr_b16 v[228:229], v93 offset:4352
  ds_read_b64_tr_b16 v[230:231], v94 offset:4352
  v_mfma_f32_32x32x16_bf16 v[176:191], v[204:207], v[100:103], v[176:191]
  v_exp_f32 v168, v168
  v_exp_f32 v169, v169
  v_exp_f32 v170, v170
  v_exp_f32 v171, v171
  v_exp_f32 v172, v172
  v_exp_f32 v173, v173
  v_exp_f32 v174, v174
  v_exp_f32 v175, v175
  buffer_load_dwordx4 a[100:103], v2, s[24:27], s87 offen offset:1024 sc1
  buffer_load_dwordx4 a[212:215], v10, s[24:27], s87 offen offset:1024 sc1
  buffer_load_dwordx4 a[104:107], v2, s[24:27], s87 offen offset:2048 sc1
  buffer_load_dwordx4 a[216:219], v10, s[24:27], s87 offen offset:2048 sc1
  v_cvt_pk_bf16_f32 v244, v168, v169
  v_cvt_pk_bf16_f32 v245, v170, v171
  v_cvt_pk_bf16_f32 v246, v172, v173
  v_cvt_pk_bf16_f32 v247, v174, v175
  s_waitcnt lgkmcnt(0)
  v_mfma_f32_32x32x16_bf16 v[208:223], v[224:227], v[240:243], v[208:223]
  v_exp_f32 v176, v176
  v_exp_f32 v177, v177
  v_exp_f32 v178, v178
  v_exp_f32 v179, v179
  v_mfma_f32_32x32x16_bf16 v[160:175], v[192:195], v[96:99], v[128:143]
  v_exp_f32 v180, v180
  v_exp_f32 v181, v181
  v_exp_f32 v182, v182
  v_exp_f32 v183, v183
  v_mfma_f32_32x32x16_bf16 v[208:223], v[228:231], v[244:247], v[208:223]
  v_cvt_pk_bf16_f32 v248, v176, v177
  v_cvt_pk_bf16_f32 v249, v178, v179
  v_cvt_pk_bf16_f32 v250, v180, v181
  v_cvt_pk_bf16_f32 v251, v182, v183
  ds_read_b64_tr_b16 v[232:233], v93 offset:2048
  ds_read_b64_tr_b16 v[234:235], v94 offset:2048
  ds_read_b64_tr_b16 v[236:237], v93 offset:2304
  ds_read_b64_tr_b16 v[238:239], v94 offset:2304
  v_mfma_f32_32x32x16_bf16 v[160:175], v[196:199], v[100:103], v[160:175]
  v_exp_f32 v184, v184
  v_exp_f32 v185, v185
  v_exp_f32 v186, v186
  v_exp_f32 v187, v187
  v_exp_f32 v188, v188
  v_exp_f32 v189, v189
  v_exp_f32 v190, v190
  v_exp_f32 v191, v191
  buffer_load_dwordx4 a[108:111], v2, s[24:27], s87 offen offset:3072 sc1
  buffer_load_dwordx4 a[220:223], v10, s[24:27], s87 offen offset:3072 sc1
  v_cvt_pk_bf16_f32 v252, v184, v185
  v_cvt_pk_bf16_f32 v253, v186, v187
  v_cvt_pk_bf16_f32 v254, v188, v189
  v_cvt_pk_bf16_f32 v255, v190, v191
  s_waitcnt lgkmcnt(0)
  v_mfma_f32_32x32x16_bf16 v[208:223], v[232:235], v[248:251], v[208:223]
  v_exp_f32 v160, v160
  v_exp_f32 v161, v161
  v_exp_f32 v162, v162
  v_exp_f32 v163, v163
  v_exp_f32 v164, v164
  v_exp_f32 v165, v165
  v_exp_f32 v166, v166
  v_exp_f32 v167, v167
  v_mfma_f32_32x32x16_bf16 v[208:223], v[236:239], v[252:255], v[208:223]
  v_cvt_pk_bf16_f32 v36, v160, v161
  v_cvt_pk_bf16_f32 v37, v162, v163
  v_cvt_pk_bf16_f32 v38, v164, v165
  v_cvt_pk_bf16_f32 v39, v166, v167
  ds_read_b64_tr_b16 v[224:225], v93 offset:0
  ds_read_b64_tr_b16 v[226:227], v94 offset:0
  ds_read_b64_tr_b16 v[228:229], v93 offset:256
  ds_read_b64_tr_b16 v[230:231], v94 offset:256
  v_exp_f32 v168, v168
  v_exp_f32 v169, v169
  v_exp_f32 v170, v170
  v_exp_f32 v171, v171
  v_exp_f32 v172, v172
  v_exp_f32 v173, v173
  v_exp_f32 v174, v174
  v_exp_f32 v175, v175
  buffer_load_dwordx2 v[16:17], v13, s[24:27], s96 offen sc1
  ds_read_b64_tr_b16 v[112:113], v106 offset:0
  ds_read_b64_tr_b16 v[114:115], v106 offset:1024
  ds_read_b64_tr_b16 v[116:117], v107 offset:0
  ds_read_b64_tr_b16 v[118:119], v107 offset:1024
  v_cvt_pk_bf16_f32 v40, v168, v169
  v_cvt_pk_bf16_f32 v41, v170, v171
  v_cvt_pk_bf16_f32 v42, v172, v173
  v_cvt_pk_bf16_f32 v43, v174, v175
  s_waitcnt lgkmcnt(4)
  v_mfma_f32_32x32x16_bf16 v[208:223], v[224:227], v[36:39], v[208:223]
  v_mfma_f32_32x32x16_bf16 v[208:223], v[228:231], v[40:43], v[208:223]
  s_mov_b32 s76, 0x4b800000
  s_nop 10
  v_cmp_ngt_f32 vcc, s76, v220
  s_nop 0
  s_cmp_lg_u32 vcc_hi, 0
  s_cbranch_scc1 FB27
FOK28:
  s_cmp_lt_u32 s6, 28
  s_cbranch_scc1 L29
  s_mov_b32 s88, 0
  s_mov_b32 s89, -1
  v_mov_b32 v22, v220
  v_mov_b32 v23, v220
  s_nop 1
  v_permlane32_swap_b32 v22, v23
  v_rcp_f32 v22, v23
  s_nop 0
  v_mul_f32 v22, v22, v21
  v_cndmask_b32 v23, v22, 0, s[88:89]
  v_mul_f32 v208, v22, v208
  v_mul_f32 v209, v22, v209
  v_mul_f32 v210, v22, v210
  v_mul_f32 v211, v22, v211
  v_mul_f32 v212, v22, v212
  v_mul_f32 v213, v22, v213
  v_mul_f32 v214, v22, v214
  v_mul_f32 v215, v22, v215
  v_cvt_pk_bf16_f32 v240, v208, v209
  v_cvt_pk_bf16_f32 v241, v210, v211
  v_cvt_pk_bf16_f32 v242, v212, v213
  v_cvt_pk_bf16_f32 v243, v214, v215
  buffer_store_dwordx4 v[240:243], v2, s[24:27], s92 offen offset:0 sc1
  v_mul_f32 v216, v22, v216
  v_mul_f32 v217, v22, v217
  v_mul_f32 v218, v22, v218
  v_mul_f32 v219, v22, v219
  v_mul_f32 v220, v23, v220
  v_mul_f32 v221, v23, v221
  v_mul_f32 v222, v23, v222
  v_mul_f32 v223, v23, v223
  v_cvt_pk_bf16_f32 v244, v216, v217
  v_cvt_pk_bf16_f32 v245, v218, v219
  v_cvt_pk_bf16_f32 v246, v220, v221
  v_cvt_pk_bf16_f32 v247, v222, v223
  buffer_store_dwordx4 v[244:247], v2, s[24:27], s92 offen offset:1024 sc1
  s_waitcnt vmcnt(0)
  buffer_store_dwordx2 v[6:7], v8, s[24:27], s93 offen sc1
  s_branch L_END
L29:
  s_waitcnt vmcnt(32) lgkmcnt(0)
  v_mfma_f32_32x32x16_bf16 v[128:143], v[112:115], a[64:67], 0
  ds_read_b64_tr_b16 v[120:121], v106 offset:2048
  ds_read_b64_tr_b16 v[122:123], v106 offset:3072
  v_mfma_f32_32x32x16_bf16 v[144:159], v[112:115], a[176:179], 0
  ds_read_b64_tr_b16 v[124:125], v107 offset:2048
  ds_read_b64_tr_b16 v[126:127], v107 offset:3072
  v_mfma_f32_32x32x16_bf16 v[160:175], v[116:119], a[64:67], 0
  s_mov_b32 s88, 0
  s_mov_b32 s89, -1
  v_mov_b32 v22, v220
  v_mov_b32 v23, v220
  s_nop 1
  v_permlane32_swap_b32 v22, v23
  v_rcp_f32 v22, v23
  s_nop 0
  v_mul_f32 v22, v22, v21
  v_cndmask_b32 v23, v22, 0, s[88:89]
  v_mul_f32 v208, v22, v208
  v_mul_f32 v209, v22, v209
  v_mul_f32 v210, v22, v210
  v_mul_f32 v211, v22, v211
  v_mfma_f32_32x32x16_bf16 v[176:191], v[116:119], a[176:179], 0
  v_mul_f32 v212, v22, v212
  v_mul_f32 v213, v22, v213
  v_mul_f32 v214, v22, v214
  v_mul_f32 v215, v22, v215
  v_cvt_pk_bf16_f32 v240, v208, v209
  v_cvt_pk_bf16_f32 v241, v210, v211
  v_cvt_pk_bf16_f32 v242, v212, v213
  v_cvt_pk_bf16_f32 v243, v214, v215
  buffer_store_dwordx4 v[240:243], v2, s[24:27], s92 offen offset:0 sc1
  s_waitcnt vmcnt(31) lgkmcnt(0)
  v_mfma_f32_32x32x16_bf16 v[128:143], v[120:123], a[68:71], v[128:143]
  ds_read_b64_tr_b16 v[112:113], v106 offset:4096
  ds_read_b64_tr_b16 v[114:115], v106 offset:5120
  v_mul_f32 v216, v22, v216
  v_mul_f32 v217, v22, v217
  v_mfma_f32_32x32x16_bf16 v[144:159], v[120:123], a[180:183], v[144:159]
  ds_read_b64_tr_b16 v[116:117], v107 offset:4096
  ds_read_b64_tr_b16 v[118:119], v107 offset:5120
  v_mul_f32 v218, v22, v218
  v_mul_f32 v219, v22, v219
  v_mfma_f32_32x32x16_bf16 v[160:175], v[124:127], a[68:71], v[160:175]
  v_mul_f32 v220, v23, v220
  v_mul_f32 v221, v23, v221
  v_mul_f32 v222, v23, v222
  v_mul_f32 v223, v23, v223
  v_cvt_pk_bf16_f32 v244, v216, v217
  v_cvt_pk_bf16_f32 v245, v218, v219
  v_mfma_f32_32x32x16_bf16 v[176:191], v[124:127], a[180:183], v[176:191]
  v_cvt_pk_bf16_f32 v246, v220, v221
  v_cvt_pk_bf16_f32 v247, v222, v223
  buffer_store_dwordx4 v[244:247], v2, s[24:27], s92 offen offset:1024 sc1
  s_waitcnt vmcnt(28) lgkmcnt(0)
  v_mfma_f32_32x32x16_bf16 v[128:143], v[112:115], a[72:75], v[128:143]
  ds_read_b64_tr_b16 v[120:121], v106 offset:6144
  ds_read_b64_tr_b16 v[122:123], v106 offset:7168
  v_mfma_f32_32x32x16_bf16 v[144:159], v[112:115], a[184:187], v[144:159]
  ds_read_b64_tr_b16 v[124:125], v107 offset:6144
  ds_read_b64_tr_b16 v[126:127], v107 offset:7168
  v_mfma_f32_32x32x16_bf16 v[160:175], v[116:119], a[72:75], v[160:175]
  v_mfma_f32_32x32x16_bf16 v[176:191], v[116:119], a[184:187], v[176:191]
  s_waitcnt vmcnt(25) lgkmcnt(0)
  v_mfma_f32_32x32x16_bf16 v[128:143], v[120:123], a[76:79], v[128:143]
  ds_read_b64_tr_b16 v[112:113], v106 offset:8192
  ds_read_b64_tr_b16 v[114:115], v106 offset:9216
  s_waitcnt vmcnt(2)
  v_cmp_eq_u64 vcc, s[80:81], v[16:17]
  v_mfma_f32_32x32x16_bf16 v[144:159], v[120:123], a[188:191], v[144:159]
  ds_read_b64_tr_b16 v[116:117], v107 offset:8192
  ds_read_b64_tr_b16 v[118:119], v107 offset:9216
  s_cmp_eq_u64 vcc, exec
  s_cbranch_scc0 SPIN31
OK30:
  v_readlane_b32 s78, v11, 38
  v_mfma_f32_32x32x16_bf16 v[160:175], v[124:127], a[76:79], v[160:175]
  s_nop 0
  s_mov_b32 s87, s78
  buffer_load_dwordx4 a[64:67], v2, s[24:27], s87 offen offset:0 sc1
  buffer_load_dwordx4 a[176:179], v10, s[24:27], s87 offen offset:0 sc1
  v_mfma_f32_32x32x16_bf16 v[176:191], v[124:127], a[188:191], v[176:191]
  buffer_load_dwordx4 a[68:71], v2, s[24:27], s87 offen offset:1024 sc1
  buffer_load_dwordx4 a[180:183], v10, s[24:27], s87 offen offset:1024 sc1
  s_waitcnt lgkmcnt(0)
  v_mfma_f32_32x32x16_bf16 v[128:143], v[112:115], a[80:83], v[128:143]
  ds_read_b64_tr_b16 v[120:121], v108 offset:32768
  ds_read_b64_tr_b16 v[122:123], v108 offset:33792
  buffer_load_dwordx4 a[72:75], v2, s[24:27], s87 offen offset:2048 sc1
  v_mfma_f32_32x32x16_bf16 v[144:159], v[112:115], a[192:195], v[144:159]
  ds_read_b64_tr_b16 v[124:125], v109 offset:32768
  ds_read_b64_tr_b16 v[126:127], v109 offset:33792
  v_mfma_f32_32x32x16_bf16 v[160:175], v[116:119], a[80:83], v[160:175]
  buffer_load_dwordx4 a[184:187], v10, s[24:27], s87 offen offset:2048 sc1
  v_mfma_f32_32x32x16_bf16 v[176:191], v[116:119], a[192:195], v[176:191]
  s_waitcnt lgkmcnt(0)
  v_mfma_f32_32x32x16_bf16 v[128:143], v[120:123], a[84:87], v[128:143]
  ds_read_b64_tr_b16 v[112:113], v108 offset:34816
  ds_read_b64_tr_b16 v[114:115], v108 offset:35840
  buffer_load_dwordx4 a[76:79], v2, s[24:27], s87 offen offset:3072 sc1
  v_mfma_f32_32x32x16_bf16 v[144:159], v[120:123], a[196:199], v[144:159]
  ds_read_b64_tr_b16 v[116:117], v109 offset:34816
  ds_read_b64_tr_b16 v[118:119], v109 offset:35840
  v_mfma_f32_32x32x16_bf16 v[160:175], v[124:127], a[84:87], v[160:175]
  buffer_load_dwordx4 a[188:191], v10, s[24:27], s87 offen offset:3072 sc1
  v_mfma_f32_32x32x16_bf16 v[176:191], v[124:127], a[196:199], v[176:191]
  s_waitcnt lgkmcnt(0)
  v_mfma_f32_32x32x16_bf16 v[128:143], v[112:115], a[88:91], v[128:143]
  ds_read_b64_tr_b16 v[120:121], v108 offset:49152
  ds_read_b64_tr_b16 v[122:123], v108 offset:50176
  v_readlane_b32 s78, v11, 39
  s_nop 0
  v_mfma_f32_32x32x16_bf16 v[144:159], v[112:115], a[200:203], v[144:159]
  ds_read_b64_tr_b16 v[124:125], v109 offset:49152
  ds_read_b64_tr_b16 v[126:127], v109 offset:50176
  s_mov_b32 s87, s78
  v_mfma_f32_32x32x16_bf16 v[160:175], v[116:119], a[88:91], v[160:175]
  buffer_load_dwordx4 v[24:27], v2, s[24:27], s87 offen offset:0 sc1
  buffer_load_dwordx4 v[28:31], v10, s[24:27], s87 offen offset:0 sc1
  v_mfma_f32_32x32x16_bf16 v[176:191], v[116:119], a[200:203], v[176:191]
  s_waitcnt lgkmcnt(0)
  v_mfma_f32_32x32x16_bf16 v[128:143], v[120:123], a[92:95], v[128:143]
  ds_read_b64_tr_b16 v[112:113], v108 offset:51200
  ds_read_b64_tr_b16 v[114:115], v108 offset:52224
  s_waitcnt vmcnt(10)
  v_mfma_f32_32x32x16_bf16 v[144:159], v[120:123], a[204:207], v[144:159]
  ds_read_b64_tr_b16 v[116:117], v109 offset:51200
  ds_read_b64_tr_b16 v[118:119], v109 offset:52224
  buffer_store_dwordx2 v[6:7], v8, s[24:27], s93 offen sc1
  v_mfma_f32_32x32x16_bf16 v[160:175], v[124:127], a[92:95], v[160:175]
  buffer_load_dwordx4 v[32:35], v2, s[24:27], s87 offen offset:1024 sc1
  v_mfma_f32_32x32x16_bf16 v[176:191], v[124:127], a[204:207], v[176:191]
  buffer_load_dwordx4 v[36:39], v10, s[24:27], s87 offen offset:1024 sc1
  s_waitcnt lgkmcnt(0)
  v_mfma_f32_32x32x16_bf16 v[128:143], v[112:115], a[96:99], v[128:143]
  ds_read_b64_tr_b16 v[120:121], v108 offset:0
  ds_read_b64_tr_b16 v[122:123], v108 offset:1024
  buffer_load_dwordx4 v[40:43], v2, s[24:27], s87 offen offset:2048 sc1
  v_mfma_f32_32x32x16_bf16 v[144:159], v[112:115], a[208:211], v[144:159]
  ds_read_b64_tr_b16 v[124:125], v109 offset:0
  ds_read_b64_tr_b16 v[126:127], v109 offset:1024
  v_mfma_f32_32x32x16_bf16 v[160:175], v[116:119], a[96:99], v[160:175]
  buffer_load_dwordx4 v[44:47], v10, s[24:27], s87 offen offset:2048 sc1
  v_mfma_f32_32x32x16_bf16 v[176:191], v[116:119], a[208:211], v[176:191]
  s_waitcnt lgkmcnt(0)
  v_mfma_f32_32x32x16_bf16 v[128:143], v[120:123], a[100:103], v[128:143]
  ds_read_b64_tr_b16 v[112:113], v108 offset:2048
  ds_read_b64_tr_b16 v[114:115], v108 offset:3072
  buffer_load_dwordx4 v[48:51], v2, s[24:27], s87 offen offset:3072 sc1
  v_mfma_f32_32x32x16_bf16 v[144:159], v[120:123], a[212:215], v[144:159]
  ds_read_b64_tr_b16 v[116:117], v109 offset:2048
  ds_read_b64_tr_b16 v[118:119], v109 offset:3072
  v_mfma_f32_32x32x16_bf16 v[160:175], v[124:127], a[100:103], v[160:175]
  buffer_load_dwordx4 v[52:55], v10, s[24:27], s87 offen offset:3072 sc1
  v_mfma_f32_32x32x16_bf16 v[176:191], v[124:127], a[212:215], v[176:191]
  s_waitcnt lgkmcnt(0)
  v_mfma_f32_32x32x16_bf16 v[128:143], v[112:115], a[104:107], v[128:143]
  ds_read_b64_tr_b16 v[120:121], v108 offset:16384
  ds_read_b64_tr_b16 v[122:123], v108 offset:17408
  v_readlane_b32 s78, v11, 40
  s_nop 0
  v_mfma_f32_32x32x16_bf16 v[144:159], v[112:115], a[216:219], v[144:159]
  ds_read_b64_tr_b16 v[124:125], v109 offset:16384
  ds_read_b64_tr_b16 v[126:127], v109 offset:17408
  s_mov_b32 s87, s78
  v_mfma_f32_32x32x16_bf16 v[160:175], v[116:119], a[104:107], v[160:175]
  buffer_load_dwordx4 v[56:59], v2, s[24:27], s87 offen offset:0 sc1
  buffer_load_dwordx4 v[60:63], v10, s[24:27], s87 offen offset:0 sc1
  v_mfma_f32_32x32x16_bf16 v[176:191], v[116:119], a[216:219], v[176:191]
  s_waitcnt lgkmcnt(0)
  v_mfma_f32_32x32x16_bf16 v[128:143], v[120:123], a[108:111], v[128:143]
  ds_read_b64_tr_b16 v[112:113], v108 offset:18432
  ds_read_b64_tr_b16 v[114:115], v108 offset:19456
  buffer_load_dwordx4 v[64:67], v2, s[24:27], s87 offen offset:1024 sc1
  v_mfma_f32_32x32x16_bf16 v[144:159], v[120:123], a[220:223], v[144:159]
  ds_read_b64_tr_b16 v[116:117], v109 offset:18432
  ds_read_b64_tr_b16 v[118:119], v109 offset:19456
  v_mfma_f32_32x32x16_bf16 v[160:175], v[124:127], a[108:111], v[160:175]
  buffer_load_dwordx4 v[68:71], v10, s[24:27], s87 offen offset:1024 sc1
  v_mfma_f32_32x32x16_bf16 v[176:191], v[124:127], a[220:223], v[176:191]
  s_waitcnt vmcnt(19) lgkmcnt(0)
  v_mfma_f32_32x32x16_bf16 v[128:143], v[112:115], a[64:67], v[128:143]
  buffer_load_dwordx4 v[72:75], v2, s[24:27], s87 offen offset:2048 sc1
  buffer_load_dwordx4 v[76:79], v10, s[24:27], s87 offen offset:2048 sc1
  v_mfma_f32_32x32x16_bf16 v[144:159], v[112:115], a[176:179], v[144:159]
  v_mfma_f32_32x32x16_bf16 v[160:175], v[116:119], a[64:67], v[160:175]
  v_mfma_f32_32x32x16_bf16 v[176:191], v[116:119], a[176:179], v[176:191]
  s_waitcnt vmcnt(19)
  v_mfma_f32_32x32x16_bf16 v[128:143], a[4:7], a[68:71], v[128:143]
  buffer_load_dwordx4 v[80:83], v2, s[24:27], s87 offen offset:3072 sc1
  buffer_load_dwordx4 v[84:87], v10, s[24:27], s87 offen offset:3072 sc1
  v_mfma_f32_32x32x16_bf16 v[144:159], a[4:7], a[180:183], v[144:159]
  s_load_dwordx2 s[36:37], s[0:1], 56
  v_mfma_f32_32x32x16_bf16 v[160:175], a[116:119], a[68:71], v[160:175]
  v_mfma_f32_32x32x16_bf16 v[176:191], a[116:119], a[180:183], v[176:191]
  s_waitcnt vmcnt(19)
  v_mfma_f32_32x32x16_bf16 v[128:143], a[8:11], a[72:75], v[128:143]
  v_readlane_b32 s78, v11, 41
  s_nop 0
  s_mov_b32 s87, s78
  buffer_load_dwordx4 v[88:91], v2, s[24:27], s87 offen offset:0 sc1
  v_mfma_f32_32x32x16_bf16 v[144:159], a[8:11], a[184:187], v[144:159]
  buffer_load_dwordx4 v[92:95], v10, s[24:27], s87 offen offset:0 sc1
  v_mfma_f32_32x32x16_bf16 v[160:175], a[120:123], a[72:75], v[160:175]
  v_mfma_f32_32x32x16_bf16 v[176:191], a[120:123], a[184:187], v[176:191]
  s_waitcnt vmcnt(19)
  v_mfma_f32_32x32x16_bf16 v[128:143], a[12:15], a[76:79], v[128:143]
  buffer_load_dwordx4 v[96:99], v2, s[24:27], s87 offen offset:1024 sc1
  buffer_load_dwordx4 v[100:103], v10, s[24:27], s87 offen offset:1024 sc1
  v_mfma_f32_32x32x16_bf16 v[144:159], a[12:15], a[188:191], v[144:159]
  v_mfma_f32_32x32x16_bf16 v[160:175], a[124:127], a[76:79], v[160:175]
  v_mfma_f32_32x32x16_bf16 v[176:191], a[124:127], a[188:191], v[176:191]
  s_waitcnt vmcnt(19)
  v_mfma_f32_32x32x16_bf16 v[128:143], a[36:39], v[24:27], v[128:143]
  buffer_load_dwordx4 v[192:195], v2, s[24:27], s87 offen offset:2048 sc1
  buffer_load_dwordx4 v[196:199], v10, s[24:27], s87 offen offset:2048 sc1
  v_mfma_f32_32x32x16_bf16 v[144:159], a[36:39], v[28:31], v[144:159]
  v_mfma_f32_32x32x16_bf16 v[160:175], a[148:151], v[24:27], v[160:175]
  v_mfma_f32_32x32x16_bf16 v[176:191], a[148:151], v[28:31], v[176:191]
  s_waitcnt vmcnt(18)
  v_mfma_f32_32x32x16_bf16 v[128:143], a[40:43], v[32:35], v[128:143]
  buffer_load_dwordx4 v[200:203], v2, s[24:27], s87 offen offset:3072 sc1
  buffer_load_dwordx4 v[204:207], v10, s[24:27], s87 offen offset:3072 sc1
  v_mfma_f32_32x32x16_bf16 v[144:159], a[40:43], v[36:39], v[144:159]
  v_mfma_f32_32x32x16_bf16 v[160:175], a[152:155], v[32:35], v[160:175]
  v_mfma_f32_32x32x16_bf16 v[176:191], a[152:155], v[36:39], v[176:191]
  s_waitcnt vmcnt(18)
  v_mfma_f32_32x32x16_bf16 v[128:143], a[44:47], v[40:43], v[128:143]
  s_waitcnt lgkmcnt(0)
  s_mov_b32 s38, 1835008
  s_mov_b32 s39, 0x20000
  v_mfma_f32_32x32x16_bf16 v[144:159], a[44:47], v[44:47], v[144:159]
  v_mfma_f32_32x32x16_bf16 v[160:175], a[156:159], v[40:43], v[160:175]
  v_mfma_f32_32x32x16_bf16 v[176:191], a[156:159], v[44:47], v[176:191]
  s_waitcnt vmcnt(16)
  v_mfma_f32_32x32x16_bf16 v[128:143], a[248:251], v[48:51], v[128:143]
  v_readlane_b32 s67, v11, 33
  s_add_u32 m0, s74, 0
  s_add_u32 s79, s67, 14336
  buffer_load_dwordx4 v4, s[32:35], s79 offen lds
  buffer_load_dwordx4 v5, s[32:35], s79 offen offset:1024 lds
  v_mfma_f32_32x32x16_bf16 v[144:159], a[248:251], v[52:55], v[144:159]
  v_mfma_f32_32x32x16_bf16 v[160:175], a[252:255], v[48:51], v[160:175]
  v_lshrrev_b32 v34, 3, v1
  v_mul_u32_u24 v36, 896, v34
  v_and_b32 v35, 7, v1
  v_lshl_add_u32 v32, v35, 4, v36
  v_add_u32 v33, 28672, v32
  v_mfma_f32_32x32x16_bf16 v[176:191], a[252:255], v[52:55], v[176:191]
  v_lshlrev_b32 v46, 3, v34
  v_readlane_b32 s82, v11, 10
  v_readlane_b32 s90, v11, 11
  s_waitcnt vmcnt(16)
  v_mfma_f32_32x32x16_bf16 v[128:143], a[240:243], v[56:59], v[128:143]
  v_readlane_b32 s67, v11, 34
  s_add_u32 m0, s74, 2048
  s_add_u32 s79, s67, 0
  buffer_load_dwordx4 v4, s[32:35], s79 offen lds
  buffer_load_dwordx4 v5, s[32:35], s79 offen offset:1024 lds
  v_mfma_f32_32x32x16_bf16 v[144:159], a[240:243], v[60:63], v[144:159]
  buffer_load_dwordx2 v[18:19], v14, s[24:27], s94 offen sc1
  v_mfma_f32_32x32x16_bf16 v[160:175], a[244:247], v[56:59], v[160:175]
  v_bfe_u32 v34, v1, 4, 1
  v_and_b32 v35, 15, v1
  v_lshlrev_b32 v34, 14, v34
  v_lshl_add_u32 v34, v35, 8, v34
  v_mfma_f32_32x32x16_bf16 v[176:191], a[244:247], v[60:63], v[176:191]
  v_add_u32 v34, s84, v34
  v_add_u32 v34, 98304, v34
  v_lshrrev_b32 v35, 5, v1
  v_and_b32 v36, 7, v1
  v_xor_b32 v35, v35, v36
  s_waitcnt vmcnt(17)
  v_mfma_f32_32x32x16_bf16 v[128:143], a[232:235], v[64:67], v[128:143]
  buffer_load_dwordx4 v[24:27], v32, s[8:11], s82 offen
  buffer_load_dwordx4 v[28:31], v33, s[8:11], s82 offen
  v_mfma_f32_32x32x16_bf16 v[144:159], a[232:235], v[68:71], v[144:159]
  buffer_load_dword v44, v46, s[24:27], s90 offen offset:0 sc1
  v_mfma_f32_32x32x16_bf16 v[160:175], a[236:239], v[64:67], v[160:175]
  buffer_load_dword v45, v46, s[24:27], s90 offen offset:256 sc1
  v_mfma_f32_32x32x16_bf16 v[176:191], a[236:239], v[68:71], v[176:191]
  s_waitcnt vmcnt(19)
  v_mfma_f32_32x32x16_bf16 v[128:143], a[224:227], v[72:75], v[128:143]
  s_add_u32 m0, s74, 4096
  s_add_u32 s79, s67, 14336
  buffer_load_dwordx4 v4, s[32:35], s79 offen lds
  buffer_load_dwordx4 v5, s[32:35], s79 offen offset:1024 lds
  v_mfma_f32_32x32x16_bf16 v[144:159], a[224:227], v[76:79], v[144:159]
  v_mfma_f32_32x32x16_bf16 v[160:175], a[228:231], v[72:75], v[160:175]
  v_xor_b32 v37, 0, v35
  v_lshl_add_u32 v40, v37, 4, v34
  v_xor_b32 v37, 2, v35
  v_lshl_add_u32 v41, v37, 4, v34
  v_xor_b32 v37, 4, v35
  v_mfma_f32_32x32x16_bf16 v[176:191], a[228:231], v[76:79], v[176:191]
  v_lshl_add_u32 v42, v37, 4, v34
  v_xor_b32 v37, 6, v35
  v_lshl_add_u32 v43, v37, 4, v34
  s_waitcnt vmcnt(19)
  v_mfma_f32_32x32x16_bf16 v[128:143], a[0:3], v[80:83], v[128:143]
  v_lshrrev_b32 v34, 3, v1
  v_lshlrev_b32 v35, 1, v36
  v_xor_b32 v35, v35, v34
  s_lshl_b32 s76, s4, 14
  s_lshl_b32 s77, s5, 11
  v_mfma_f32_32x32x16_bf16 v[144:159], a[0:3], v[84:87], v[144:159]
  s_add_u32 s76, s76, s77
  s_add_u32 s76, s76, 98304
  v_lshlrev_b32 v34, 8, v34
  v_lshl_add_u32 v34, v35, 4, v34
  v_add_u32 v38, s76, v34
  v_mfma_f32_32x32x16_bf16 v[160:175], a[112:115], v[80:83], v[160:175]
  v_xor_b32 v39, 16, v38
  v_mfma_f32_32x32x16_bf16 v[176:191], a[112:115], v[84:87], v[176:191]
  s_waitcnt vmcnt(17)
  v_mfma_f32_32x32x16_bf16 v[128:143], a[16:19], v[88:91], v[128:143]
  s_waitcnt vmcnt(6)
  v_cmp_eq_u64 vcc, s[80:81], v[18:19]
  s_nop 0
  s_cmp_eq_u64 vcc, exec
  s_cbranch_scc0 SPIN33
OK32:
  v_readlane_b32 s78, v11, 42
  v_mfma_f32_32x32x16_bf16 v[144:159], a[16:19], v[92:95], v[144:159]
  s_nop 0
  s_mov_b32 s87, s78
  buffer_load_dwordx4 v[208:211], v2, s[24:27], s87 offen offset:0 sc1
  v_mfma_f32_32x32x16_bf16 v[160:175], a[128:131], v[88:91], v[160:175]
  buffer_load_dwordx4 v[212:215], v10, s[24:27], s87 offen offset:0 sc1
  buffer_load_dwordx4 v[216:219], v2, s[24:27], s87 offen offset:1024 sc1
  v_mfma_f32_32x32x16_bf16 v[176:191], a[128:131], v[92:95], v[176:191]
  buffer_load_dwordx4 v[220:223], v10, s[24:27], s87 offen offset:1024 sc1
  v_mfma_f32_32x32x16_bf16 v[128:143], a[20:23], v[96:99], v[128:143]
  v_readlane_b32 s78, v11, 43
  s_nop 0
  s_mov_b32 s87, s78
  buffer_load_dwordx4 v[224:227], v2, s[24:27], s87 offen offset:0 sc1
  v_mfma_f32_32x32x16_bf16 v[144:159], a[20:23], v[100:103], v[144:159]
  buffer_load_dwordx4 v[228:231], v10, s[24:27], s87 offen offset:0 sc1
  v_mfma_f32_32x32x16_bf16 v[160:175], a[132:135], v[96:99], v[160:175]
  buffer_load_dwordx4 v[232:235], v2, s[24:27], s87 offen offset:1024 sc1
  buffer_load_dwordx4 v[236:239], v10, s[24:27], s87 offen offset:1024 sc1
  v_mfma_f32_32x32x16_bf16 v[176:191], a[132:135], v[100:103], v[176:191]
  v_mfma_f32_32x32x16_bf16 v[128:143], a[24:27], v[192:195], v[128:143]
  v_readlane_b32 s78, v11, 44
  s_nop 0
  s_mov_b32 s87, s78
  buffer_load_dwordx4 v[240:243], v2, s[24:27], s87 offen offset:0 sc1
  v_mfma_f32_32x32x16_bf16 v[144:159], a[24:27], v[196:199], v[144:159]
  buffer_load_dwordx4 v[244:247], v10, s[24:27], s87 offen offset:0 sc1
  buffer_load_dwordx4 v[248:251], v2, s[24:27], s87 offen offset:1024 sc1
  v_mfma_f32_32x32x16_bf16 v[160:175], a[136:139], v[192:195], v[160:175]
  buffer_load_dwordx4 v[252:255], v10, s[24:27], s87 offen offset:1024 sc1
  s_waitcnt vmcnt(14)
  v_and_b32 v44, 0xffff0000, v44
  v_mfma_f32_32x32x16_bf16 v[176:191], a[136:139], v[196:199], v[176:191]
  v_and_b32 v45, 0xffff0000, v45
  v_mul_f32 v44, v44, v44
  v_mul_f32 v45, v45, v45
  v_rcp_f32 v44, v44
  v_rcp_f32 v45, v45
  v_mfma_f32_32x32x16_bf16 v[128:143], a[28:31], v[200:203], v[128:143]
  v_readlane_b32 s78, v11, 45
  s_nop 0
  s_mov_b32 s87, s78
  buffer_load_dwordx4 a[80:83], v2, s[24:27], s87 offen offset:0 sc1
  v_mfma_f32_32x32x16_bf16 v[144:159], a[28:31], v[204:207], v[144:159]
  buffer_load_dwordx4 a[192:195], v10, s[24:27], s87 offen offset:0 sc1
  buffer_load_dwordx4 a[84:87], v2, s[24:27], s87 offen offset:1024 sc1
  v_mfma_f32_32x32x16_bf16 v[160:175], a[140:143], v[200:203], v[160:175]
  buffer_load_dwordx4 a[196:199], v10, s[24:27], s87 offen offset:1024 sc1
  v_lshlrev_b32 v48, 16, v24
  v_and_b32 v49, 0xffff0000, v24
  v_lshlrev_b32 v50, 16, v25
  v_mfma_f32_32x32x16_bf16 v[176:191], a[140:143], v[204:207], v[176:191]
  v_and_b32 v51, 0xffff0000, v25
  v_lshlrev_b32 v52, 16, v26
  v_and_b32 v53, 0xffff0000, v26
  v_lshlrev_b32 v54, 16, v27
  v_and_b32 v55, 0xffff0000, v27
  s_waitcnt vmcnt(14)
  v_mfma_f32_32x32x16_bf16 v[128:143], a[32:35], v[208:211], v[128:143]
  v_lshlrev_b32 v56, 16, v28
  v_and_b32 v57, 0xffff0000, v28
  v_lshlrev_b32 v58, 16, v29
  v_and_b32 v59, 0xffff0000, v29
  v_lshlrev_b32 v60, 16, v30
  v_mfma_f32_32x32x16_bf16 v[144:159], a[32:35], v[212:215], v[144:159]
  v_and_b32 v61, 0xffff0000, v30
  v_lshlrev_b32 v62, 16, v31
  v_and_b32 v63, 0xffff0000, v31
  v_mfma_f32_32x32x16_bf16 v[160:175], a[144:147], v[208:211], v[160:175]
  v_mfma_f32_32x32x16_bf16 v[176:191], a[144:147], v[212:215], v[176:191]
  s_waitcnt vmcnt(12)
  v_mfma_f32_32x32x16_bf16 v[128:143], a[48:51], v[216:219], v[128:143]
  v_mfma_f32_32x32x16_bf16 v[144:159], a[48:51], v[220:223], v[144:159]
  v_mfma_f32_32x32x16_bf16 v[160:175], a[160:163], v[216:219], v[160:175]
  v_mfma_f32_32x32x16_bf16 v[176:191], a[160:163], v[220:223], v[176:191]
  s_waitcnt vmcnt(10)
  v_mfma_f32_32x32x16_bf16 v[128:143], a[52:55], v[224:227], v[128:143]
  v_mfma_f32_32x32x16_bf16 v[144:159], a[52:55], v[228:231], v[144:159]
  v_mfma_f32_32x32x16_bf16 v[160:175], a[164:167], v[224:227], v[160:175]
  v_mfma_f32_32x32x16_bf16 v[176:191], a[164:167], v[228:231], v[176:191]
  s_waitcnt vmcnt(8)
  v_mfma_f32_32x32x16_bf16 v[128:143], a[56:59], v[232:235], v[128:143]
  ds_read_b64_tr_b16 v[68:69], v106 offset:0
  ds_read_b64_tr_b16 v[70:71], v106 offset:1024
  ds_read_b64_tr_b16 v[72:73], v106 offset:2048
  v_mfma_f32_32x32x16_bf16 v[144:159], a[56:59], v[236:239], v[144:159]
  ds_read_b64_tr_b16 v[74:75], v106 offset:3072
  ds_read_b64_tr_b16 v[76:77], v106 offset:4096
  ds_read_b64_tr_b16 v[78:79], v106 offset:5120
  v_mfma_f32_32x32x16_bf16 v[160:175], a[168:171], v[232:235], v[160:175]
  v_mfma_f32_32x32x16_bf16 v[176:191], a[168:171], v[236:239], v[176:191]
  s_waitcnt vmcnt(6)
  v_mfma_f32_32x32x16_bf16 v[128:143], a[60:63], v[240:243], v[128:143]
  ds_read_b64_tr_b16 v[92:93], v107 offset:0
  ds_read_b64_tr_b16 v[94:95], v107 offset:1024
  s_waitcnt vmcnt(4) lgkmcnt(6)
  v_mfma_f32_32x32x16_bf16 v[128:143], v[68:71], v[248:251], v[128:143]
  ds_read_b64_tr_b16 v[96:97], v107 offset:2048
  ds_read_b64_tr_b16 v[98:99], v107 offset:3072
  s_waitcnt vmcnt(2) lgkmcnt(6)
  v_mfma_f32_32x32x16_bf16 v[128:143], v[72:75], a[80:83], v[128:143]
  ds_read_b64_tr_b16 v[100:101], v107 offset:4096
  ds_read_b64_tr_b16 v[102:103], v107 offset:5120
  s_waitcnt vmcnt(0) lgkmcnt(6)
  v_mfma_f32_32x32x16_bf16 v[128:143], v[76:79], a[84:87], v[128:143]
  v_mfma_f32_32x32x16_bf16 v[144:159], a[60:63], v[244:247], v[144:159]
  s_nop 10
  ds_write_b128 v40, v[128:131] offset:0
  v_mfma_f32_32x32x16_bf16 v[144:159], v[68:71], v[252:255], v[144:159]
  ds_write_b128 v41, v[132:135] offset:0
  v_mfma_f32_32x32x16_bf16 v[144:159], v[72:75], a[192:195], v[144:159]
  ds_write_b128 v42, v[136:139] offset:0
  v_mfma_f32_32x32x16_bf16 v[144:159], v[76:79], a[196:199], v[144:159]
  ds_write_b128 v43, v[140:143] offset:0
  v_mfma_f32_32x32x16_bf16 v[160:175], a[172:175], v[240:243], v[160:175]
  s_nop 9
  ds_write_b128 v40, v[144:147] offset:32768
  s_waitcnt lgkmcnt(9)
  v_mfma_f32_32x32x16_bf16 v[160:175], v[92:95], v[248:251], v[160:175]
  ds_write_b128 v41, v[148:151] offset:32768
  s_waitcnt lgkmcnt(8)
  v_mfma_f32_32x32x16_bf16 v[160:175], v[96:99], a[80:83], v[160:175]
  ds_write_b128 v42, v[152:155] offset:32768
  s_waitcnt lgkmcnt(7)
  v_mfma_f32_32x32x16_bf16 v[160:175], v[100:103], a[84:87], v[160:175]
  ds_write_b128 v43, v[156:159] offset:32768
  v_mfma_f32_32x32x16_bf16 v[176:191], a[172:175], v[244:247], v[176:191]
  s_nop 9
  ds_write_b128 v40, v[160:163] offset:128
  v_mfma_f32_32x32x16_bf16 v[176:191], v[92:95], v[252:255], v[176:191]
  ds_write_b128 v41, v[164:167] offset:128
  v_mfma_f32_32x32x16_bf16 v[176:191], v[96:99], a[192:195], v[176:191]
  ds_write_b128 v42, v[168:171] offset:128
  v_mfma_f32_32x32x16_bf16 v[176:191], v[100:103], a[196:199], v[176:191]
  ds_write_b128 v43, v[172:175] offset:128
  s_nop 10
  ds_write_b128 v40, v[176:179] offset:32896
  ds_write_b128 v41, v[180:183] offset:32896
  ds_write_b128 v42, v[184:187] offset:32896
  ds_write_b128 v43, v[188:191] offset:32896
  s_waitcnt lgkmcnt(0)
  s_barrier
  ds_read_b128 v[192:195], v38 offset:0
  ds_read_b128 v[196:199], v39 offset:0
  ds_read_b128 v[200:203], v38 offset:4096
  ds_read_b128 v[204:207], v39 offset:4096
  ds_read_b128 v[208:211], v38 offset:8192
  ds_read_b128 v[212:215], v39 offset:8192
  ds_read_b128 v[216:219], v38 offset:12288
  ds_read_b128 v[220:223], v39 offset:12288
  ds_read_b128 v[224:227], v38 offset:32768
  ds_read_b128 v[228:231], v39 offset:32768
  ds_read_b128 v[232:235], v38 offset:36864
  ds_read_b128 v[236:239], v39 offset:36864
  ds_read_b128 v[240:243], v38 offset:40960
  ds_read_b128 v[244:247], v39 offset:40960
  ds_read_b128 v[248:251], v38 offset:45056
  ds_read_b128 v[252:255], v39 offset:45056
  s_waitcnt lgkmcnt(12)
  v_pk_add_f32 v[192:193], v[192:193], v[200:201]
  v_pk_add_f32 v[194:195], v[194:195], v[202:203]
  v_pk_add_f32 v[196:197], v[196:197], v[204:205]
  v_pk_add_f32 v[198:199], v[198:199], v[206:207]
  s_waitcnt lgkmcnt(10)
  v_pk_add_f32 v[192:193], v[192:193], v[208:209]
  v_pk_add_f32 v[194:195], v[194:195], v[210:211]
  v_pk_add_f32 v[196:197], v[196:197], v[212:213]
  v_pk_add_f32 v[198:199], v[198:199], v[214:215]
  s_waitcnt lgkmcnt(8)
  v_pk_add_f32 v[192:193], v[192:193], v[216:217]
  v_pk_add_f32 v[194:195], v[194:195], v[218:219]
  v_pk_add_f32 v[196:197], v[196:197], v[220:221]
  v_pk_add_f32 v[198:199], v[198:199], v[222:223]
  v_pk_fma_f32 v[48:49], v[192:193], v[44:45], v[48:49] op_sel:[0,0,0] op_sel_hi:[1,0,1]
  v_pk_fma_f32 v[50:51], v[194:195], v[44:45], v[50:51] op_sel:[0,0,0] op_sel_hi:[1,0,1]
  v_pk_fma_f32 v[52:53], v[196:197], v[44:45], v[52:53] op_sel:[0,0,0] op_sel_hi:[1,0,1]
  v_pk_fma_f32 v[54:55], v[198:199], v[44:45], v[54:55] op_sel:[0,0,0] op_sel_hi:[1,0,1]
  v_cvt_pk_bf16_f32 v192, v48, v49
  v_cvt_pk_bf16_f32 v193, v50, v51
  v_cvt_pk_bf16_f32 v194, v52, v53
  v_cvt_pk_bf16_f32 v195, v54, v55
  buffer_store_dwordx4 v[192:195], v32, s[36:39], s82 offen sc1
  s_waitcnt lgkmcnt(4)
  v_pk_add_f32 v[224:225], v[224:225], v[232:233]
  v_pk_add_f32 v[226:227], v[226:227], v[234:235]
  v_pk_add_f32 v[228:229], v[228:229], v[236:237]
  v_pk_add_f32 v[230:231], v[230:231], v[238:239]
  s_waitcnt lgkmcnt(2)
  v_pk_add_f32 v[224:225], v[224:225], v[240:241]
  v_pk_add_f32 v[226:227], v[226:227], v[242:243]
  v_pk_add_f32 v[228:229], v[228:229], v[244:245]
  v_pk_add_f32 v[230:231], v[230:231], v[246:247]
  s_waitcnt lgkmcnt(0)
  v_pk_add_f32 v[224:225], v[224:225], v[248:249]
  v_pk_add_f32 v[226:227], v[226:227], v[250:251]
  v_pk_add_f32 v[228:229], v[228:229], v[252:253]
  v_pk_add_f32 v[230:231], v[230:231], v[254:255]
  v_pk_fma_f32 v[56:57], v[224:225], v[44:45], v[56:57] op_sel:[0,1,0] op_sel_hi:[1,1,1]
  v_pk_fma_f32 v[58:59], v[226:227], v[44:45], v[58:59] op_sel:[0,1,0] op_sel_hi:[1,1,1]
  v_pk_fma_f32 v[60:61], v[228:229], v[44:45], v[60:61] op_sel:[0,1,0] op_sel_hi:[1,1,1]
  v_pk_fma_f32 v[62:63], v[230:231], v[44:45], v[62:63] op_sel:[0,1,0] op_sel_hi:[1,1,1]
  v_cvt_pk_bf16_f32 v224, v56, v57
  v_cvt_pk_bf16_f32 v225, v58, v59
  v_cvt_pk_bf16_f32 v226, v60, v61
  v_cvt_pk_bf16_f32 v227, v62, v63
  buffer_store_dwordx4 v[224:227], v33, s[36:39], s82 offen sc1
L_END:
  s_endpgm
SPIN3:
  s_mov_b32 s7, 0
SPIN3L:
  s_sleep 4
  buffer_load_dwordx2 v[6:7], v249, s[40:43], 0 offen sc1
  s_add_u32 s7, s7, 1
  s_cmp_ge_u32 s7, 200000
  s_waitcnt vmcnt(0)
  s_cbranch_scc1 SPIN3X
  v_readfirstlane_b32 s80, v6
  s_nop 1
  v_readfirstlane_b32 s81, v7
  s_nop 1
  s_min_u32 s90, s80, s81
  s_nop 1
  s_cmp_lg_u32 s90, 0
  s_nop 1
  s_cbranch_scc0 SPIN3L
SPIN3X:
  s_nop 4
  s_branch OK2
SPIN15:
  s_mov_b32 s7, 0
SPIN15L:
  s_sleep 4
  buffer_load_dwordx2 v[232:233], v246, s[24:27], s92 offen sc1
  buffer_load_dwordx2 v[234:235], v247, s[24:27], s92 offen sc1
  s_add_u32 s7, s7, 1
  s_cmp_ge_u32 s7, 200000
  s_waitcnt vmcnt(0)
  s_cbranch_scc1 SPIN15X
  v_xor_b32 v84, s80, v233
  s_nop 1
  v_bitop3_b32 v84, v235, s80, v84 bitop3:0xbe
  s_nop 1
  v_cmp_eq_u32 vcc, 0, v84
  s_nop 1
  s_cmp_eq_u64 vcc, exec
  s_nop 1
  s_cbranch_scc0 SPIN15L
SPIN15X:
  s_nop 4
  s_branch OK14
SPIN17:
  s_mov_b32 s7, 0
SPIN17L:
  s_sleep 4
  buffer_load_dwordx4 v[60:63], v244, s[24:27], s60 offen sc1
  buffer_load_dwordx4 v[64:67], v244, s[24:27], s61 offen sc1
  buffer_load_dwordx4 v[68:71], v245, s[24:27], s62 offen sc1
  buffer_load_dwordx4 v[72:75], v245, s[24:27], s63 offen sc1
  s_add_u32 s7, s7, 1
  s_cmp_ge_u32 s7, 200000
  s_waitcnt vmcnt(0)
  s_cbranch_scc1 SPIN17X
  v_xor_b32 v84, s80, v61
  s_nop 1
  v_bitop3_b32 v84, v63, s80, v84 bitop3:0xbe
  s_nop 1
  v_bitop3_b32 v84, v65, s80, v84 bitop3:0xbe
  s_nop 1
  v_bitop3_b32 v84, v67, s80, v84 bitop3:0xbe
  s_nop 1
  v_bitop3_b32 v84, v69, s80, v84 bitop3:0xbe
  s_nop 1
  v_bitop3_b32 v84, v71, s80, v84 bitop3:0xbe
  s_nop 1
  v_bitop3_b32 v84, v73, s80, v84 bitop3:0xbe
  s_nop 1
  v_bitop3_b32 v84, v75, s80, v84 bitop3:0xbe
  s_nop 1
  v_cmp_eq_u32 vcc, 0, v84
  s_nop 1
  s_cmp_eq_u64 vcc, exec
  s_nop 1
  s_cbranch_scc0 SPIN17L
SPIN17X:
  s_nop 4
  s_branch OK16
SPIN19:
  s_mov_b32 s7, 0
SPIN19L:
  s_sleep 4
  buffer_load_dwordx2 v[16:17], v26, s[24:27], 0 offen sc1
  s_add_u32 s7, s7, 1
  s_cmp_ge_u32 s7, 200000
  s_waitcnt vmcnt(0)
  s_cbranch_scc1 SPIN19X
  v_cmp_eq_u64 vcc, s[80:81], v[16:17]
  s_nop 1
  s_cmp_eq_u64 vcc, exec
  s_nop 1
  s_cbranch_scc0 SPIN19L
SPIN19X:
  s_nop 4
  s_branch OK18
SPIN24:
  s_mov_b32 s7, 0
SPIN24L:
  s_sleep 4
  buffer_load_dwordx2 v[18:19], v27, s[24:27], 0 offen sc1
  s_add_u32 s7, s7, 1
  s_cmp_ge_u32 s7, 200000
  s_waitcnt vmcnt(0)
  s_cbranch_scc1 SPIN24X
  v_cmp_eq_u64 vcc, s[80:81], v[18:19]
  s_nop 1
  s_cmp_eq_u64 vcc, exec
  s_nop 1
  s_cbranch_scc0 SPIN24L
SPIN24X:
  s_nop 4
  s_branch OK23
SPIN26:
  s_mov_b32 s7, 0
SPIN26L:
  s_sleep 4
  buffer_load_dwordx2 v[16:17], v12, s[24:27], s96 offen sc1
  s_add_u32 s7, s7, 1
  s_cmp_ge_u32 s7, 200000
  s_waitcnt vmcnt(0)
  s_cbranch_scc1 SPIN26X
  v_cmp_eq_u64 vcc, s[80:81], v[16:17]
  s_nop 1
  s_cmp_eq_u64 vcc, exec
  s_nop 1
  s_cbranch_scc0 SPIN26L
SPIN26X:
  s_nop 4
  s_branch OK25
FB27:
  s_waitcnt lgkmcnt(0)
  v_cndmask_b32 v102, v102, 0, s[88:89]
  v_cndmask_b32 v96, v96, 0, s[90:91]
  s_nop 1
  v_mfma_f32_32x32x16_bf16 v[160:175], v[192:195], v[96:99], v[128:143]
  v_mfma_f32_32x32x16_bf16 v[160:175], v[196:199], v[100:103], v[160:175]
  s_nop 11
  v_max_f32 v22, v160, v161
  v_max3_f32 v22, v162, v163, v22
  v_max3_f32 v22, v164, v165, v22
  v_max3_f32 v22, v166, v167, v22
  v_max3_f32 v22, v168, v169, v22
  v_max3_f32 v22, v170, v171, v22
  v_max3_f32 v22, v172, v173, v22
  v_max3_f32 v22, v174, v175, v22
  v_mfma_f32_32x32x16_bf16 v[160:175], v[200:203], v[96:99], 0
  v_mfma_f32_32x32x16_bf16 v[160:175], v[204:207], v[100:103], v[160:175]
  s_nop 11
  v_max3_f32 v22, v160, v161, v22
  v_max3_f32 v22, v162, v163, v22
  v_max3_f32 v22, v164, v165, v22
  v_max3_f32 v22, v166, v167, v22
  v_max3_f32 v22, v168, v169, v22
  v_max3_f32 v22, v170, v171, v22
  v_max3_f32 v22, v172, v173, v22
  v_max3_f32 v22, v174, v175, v22
  v_mfma_f32_32x32x16_bf16 v[160:175], v[44:47], v[96:99], 0
  v_mfma_f32_32x32x16_bf16 v[160:175], v[48:51], v[100:103], v[160:175]
  s_nop 11
  v_max3_f32 v22, v160, v161, v22
  v_max3_f32 v22, v162, v163, v22
  v_max3_f32 v22, v164, v165, v22
  v_max3_f32 v22, v166, v167, v22
  v_max3_f32 v22, v168, v169, v22
  v_max3_f32 v22, v170, v171, v22
  v_max3_f32 v22, v172, v173, v22
  v_max3_f32 v22, v174, v175, v22
  v_mfma_f32_32x32x16_bf16 v[160:175], v[52:55], v[96:99], 0
  v_mfma_f32_32x32x16_bf16 v[160:175], v[56:59], v[100:103], v[160:175]
  s_nop 11
  v_max3_f32 v22, v160, v161, v22
  v_max3_f32 v22, v162, v163, v22
  v_max3_f32 v22, v164, v165, v22
  v_max3_f32 v22, v166, v167, v22
  v_max3_f32 v22, v168, v169, v22
  v_max3_f32 v22, v170, v171, v22
  v_max3_f32 v22, v172, v173, v22
  v_max3_f32 v22, v174, v175, v22
  v_mfma_f32_32x32x16_bf16 v[160:175], v[60:63], v[96:99], 0
  v_mfma_f32_32x32x16_bf16 v[160:175], v[64:67], v[100:103], v[160:175]
  s_nop 11
  v_max3_f32 v22, v160, v161, v22
  v_max3_f32 v22, v162, v163, v22
  v_max3_f32 v22, v164, v165, v22
  v_max3_f32 v22, v166, v167, v22
  v_max3_f32 v22, v168, v169, v22
  v_max3_f32 v22, v170, v171, v22
  v_max3_f32 v22, v172, v173, v22
  v_max3_f32 v22, v174, v175, v22
  v_mfma_f32_32x32x16_bf16 v[160:175], v[68:71], v[96:99], 0
  v_mfma_f32_32x32x16_bf16 v[160:175], v[72:75], v[100:103], v[160:175]
  s_nop 11
  v_max3_f32 v22, v160, v161, v22
  v_max3_f32 v22, v162, v163, v22
  v_max3_f32 v22, v164, v165, v22
  v_max3_f32 v22, v166, v167, v22
  v_max3_f32 v22, v168, v169, v22
  v_max3_f32 v22, v170, v171, v22
  v_max3_f32 v22, v172, v173, v22
  v_max3_f32 v22, v174, v175, v22
  v_mfma_f32_32x32x16_bf16 v[160:175], v[76:79], v[96:99], 0
  v_mfma_f32_32x32x16_bf16 v[160:175], v[80:83], v[100:103], v[160:175]
  s_nop 11
  v_max3_f32 v22, v160, v161, v22
  v_max3_f32 v22, v162, v163, v22
  v_max3_f32 v22, v164, v165, v22
  v_max3_f32 v22, v166, v167, v22
  v_max3_f32 v22, v168, v169, v22
  v_max3_f32 v22, v170, v171, v22
  v_max3_f32 v22, v172, v173, v22
  v_max3_f32 v22, v174, v175, v22
  v_mfma_f32_32x32x16_bf16 v[160:175], v[84:87], v[96:99], 0
  v_mfma_f32_32x32x16_bf16 v[160:175], v[88:91], v[100:103], v[160:175]
  s_nop 11
  v_max3_f32 v22, v160, v161, v22
  v_max3_f32 v22, v162, v163, v22
  v_max3_f32 v22, v164, v165, v22
  v_max3_f32 v22, v166, v167, v22
  v_max3_f32 v22, v168, v169, v22
  v_max3_f32 v22, v170, v171, v22
  v_max3_f32 v22, v172, v173, v22
  v_max3_f32 v22, v174, v175, v22
  v_mfma_f32_32x32x16_bf16 v[160:175], v[28:31], v[96:99], v[144:159]
  v_mfma_f32_32x32x16_bf16 v[160:175], v[32:35], v[100:103], v[160:175]
  s_nop 11
  v_max3_f32 v22, v160, v161, v22
  v_max3_f32 v22, v162, v163, v22
  v_max3_f32 v22, v164, v165, v22
  v_max3_f32 v22, v166, v167, v22
  v_max3_f32 v22, v168, v169, v22
  v_max3_f32 v22, v170, v171, v22
  v_max3_f32 v22, v172, v173, v22
  v_max3_f32 v22, v174, v175, v22
  v_mov_b32 v23, v22
  s_nop 1
  v_permlane32_swap_b32 v22, v23
  v_max_f32 v22, v22, v23
  v_cvt_pk_bf16_f32 v23, -v22, -v22
  v_lshlrev_b32 v23, 16, v23
  v_add_f32 v22, v22, v23
  v_cvt_pk_bf16_f32 v23, v23, -v22
  v_cndmask_b32 v96, v96, v23, s[90:91]
  v_cndmask_b32 v102, v102, v23, s[88:89]
  s_nop 1
  v_mfma_f32_32x32x16_bf16 v[160:175], v[28:31], v[96:99], v[144:159]
  v_mfma_f32_32x32x16_bf16 v[160:175], v[32:35], v[100:103], v[160:175]
  s_nop 11
  v_exp_f32 v160, v160
  v_exp_f32 v161, v161
  v_exp_f32 v162, v162
  v_exp_f32 v163, v163
  v_mfma_f32_32x32x16_bf16 v[176:191], v[84:87], v[96:99], 0
  v_exp_f32 v164, v164
  v_exp_f32 v165, v165
  v_exp_f32 v166, v166
  v_exp_f32 v167, v167
  v_cvt_pk_bf16_f32 v240, v160, v161
  v_cvt_pk_bf16_f32 v241, v162, v163
  v_cvt_pk_bf16_f32 v242, v164, v165
  v_cvt_pk_bf16_f32 v243, v166, v167
  v_mfma_f32_32x32x16_bf16 v[176:191], v[88:91], v[100:103], v[176:191]
  v_exp_f32 v168, v168
  v_exp_f32 v169, v169
  v_exp_f32 v170, v170
  v_exp_f32 v171, v171
  v_exp_f32 v172, v172
  v_exp_f32 v173, v173
  v_exp_f32 v174, v174
  v_exp_f32 v175, v175
  v_cvt_pk_bf16_f32 v244, v168, v169
  v_cvt_pk_bf16_f32 v245, v170, v171
  v_cvt_pk_bf16_f32 v246, v172, v173
  v_cvt_pk_bf16_f32 v247, v174, v175
  v_exp_f32 v176, v176
  v_exp_f32 v177, v177
  v_exp_f32 v178, v178
  v_exp_f32 v179, v179
  v_mfma_f32_32x32x16_bf16 v[160:175], v[76:79], v[96:99], 0
  v_exp_f32 v180, v180
  v_exp_f32 v181, v181
  v_exp_f32 v182, v182
  v_exp_f32 v183, v183
  v_cvt_pk_bf16_f32 v248, v176, v177
  v_cvt_pk_bf16_f32 v249, v178, v179
  v_cvt_pk_bf16_f32 v250, v180, v181
  v_cvt_pk_bf16_f32 v251, v182, v183
  v_mfma_f32_32x32x16_bf16 v[160:175], v[80:83], v[100:103], v[160:175]
  v_exp_f32 v184, v184
  v_exp_f32 v185, v185
  v_exp_f32 v186, v186
  v_exp_f32 v187, v187
  v_exp_f32 v188, v188
  v_exp_f32 v189, v189
  v_exp_f32 v190, v190
  v_exp_f32 v191, v191
  v_cvt_pk_bf16_f32 v252, v184, v185
  v_cvt_pk_bf16_f32 v253, v186, v187
  v_cvt_pk_bf16_f32 v254, v188, v189
  v_cvt_pk_bf16_f32 v255, v190, v191
  ds_read_b64_tr_b16 v[224:225], v93 offset:16384
  ds_read_b64_tr_b16 v[226:227], v94 offset:16384
  ds_read_b64_tr_b16 v[228:229], v93 offset:16640
  ds_read_b64_tr_b16 v[230:231], v94 offset:16640
  ds_read_b64_tr_b16 v[232:233], v93 offset:14336
  ds_read_b64_tr_b16 v[234:235], v94 offset:14336
  ds_read_b64_tr_b16 v[236:237], v93 offset:14592
  ds_read_b64_tr_b16 v[238:239], v94 offset:14592
  v_exp_f32 v160, v160
  v_exp_f32 v161, v161
  v_exp_f32 v162, v162
  v_exp_f32 v163, v163
  v_mfma_f32_32x32x16_bf16 v[176:191], v[68:71], v[96:99], 0
  v_exp_f32 v164, v164
  v_exp_f32 v165, v165
  v_exp_f32 v166, v166
  v_exp_f32 v167, v167
  s_waitcnt lgkmcnt(0)
  v_mfma_f32_32x32x16_bf16 v[208:223], v[224:227], v[240:243], 0
  v_cvt_pk_bf16_f32 v36, v160, v161
  v_cvt_pk_bf16_f32 v37, v162, v163
  v_cvt_pk_bf16_f32 v38, v164, v165
  v_cvt_pk_bf16_f32 v39, v166, v167
  v_mfma_f32_32x32x16_bf16 v[176:191], v[72:75], v[100:103], v[176:191]
  v_exp_f32 v168, v168
  v_exp_f32 v169, v169
  v_exp_f32 v170, v170
  v_mfma_f32_32x32x16_bf16 v[208:223], v[228:231], v[244:247], v[208:223]
  v_exp_f32 v171, v171
  ds_read_b64_tr_b16 v[224:225], v93 offset:12288
  ds_read_b64_tr_b16 v[226:227], v94 offset:12288
  v_exp_f32 v172, v172
  v_exp_f32 v173, v173
  v_mfma_f32_32x32x16_bf16 v[208:223], v[232:235], v[248:251], v[208:223]
  v_exp_f32 v174, v174
  ds_read_b64_tr_b16 v[228:229], v93 offset:12544
  ds_read_b64_tr_b16 v[230:231], v94 offset:12544
  v_exp_f32 v175, v175
  v_mfma_f32_32x32x16_bf16 v[208:223], v[236:239], v[252:255], v[208:223]
  v_cvt_pk_bf16_f32 v40, v168, v169
  v_cvt_pk_bf16_f32 v41, v170, v171
  v_cvt_pk_bf16_f32 v42, v172, v173
  v_cvt_pk_bf16_f32 v43, v174, v175
  s_waitcnt lgkmcnt(0)
  v_mfma_f32_32x32x16_bf16 v[208:223], v[224:227], v[36:39], v[208:223]
  v_exp_f32 v176, v176
  v_exp_f32 v177, v177
  v_exp_f32 v178, v178
  v_exp_f32 v179, v179
  v_mfma_f32_32x32x16_bf16 v[160:175], v[60:63], v[96:99], 0
  v_exp_f32 v180, v180
  v_exp_f32 v181, v181
  v_exp_f32 v182, v182
  v_exp_f32 v183, v183
  v_mfma_f32_32x32x16_bf16 v[208:223], v[228:231], v[40:43], v[208:223]
  v_cvt_pk_bf16_f32 v240, v176, v177
  v_cvt_pk_bf16_f32 v241, v178, v179
  v_cvt_pk_bf16_f32 v242, v180, v181
  v_cvt_pk_bf16_f32 v243, v182, v183
  ds_read_b64_tr_b16 v[232:233], v93 offset:10240
  ds_read_b64_tr_b16 v[234:235], v94 offset:10240
  ds_read_b64_tr_b16 v[236:237], v93 offset:10496
  ds_read_b64_tr_b16 v[238:239], v94 offset:10496
  v_mfma_f32_32x32x16_bf16 v[160:175], v[64:67], v[100:103], v[160:175]
  v_exp_f32 v184, v184
  v_exp_f32 v185, v185
  v_exp_f32 v186, v186
  v_exp_f32 v187, v187
  v_exp_f32 v188, v188
  v_exp_f32 v189, v189
  v_exp_f32 v190, v190
  v_exp_f32 v191, v191
  v_cvt_pk_bf16_f32 v244, v184, v185
  v_cvt_pk_bf16_f32 v245, v186, v187
  v_cvt_pk_bf16_f32 v246, v188, v189
  v_cvt_pk_bf16_f32 v247, v190, v191
  s_waitcnt lgkmcnt(0)
  v_mfma_f32_32x32x16_bf16 v[208:223], v[232:235], v[240:243], v[208:223]
  v_exp_f32 v160, v160
  v_exp_f32 v161, v161
  v_exp_f32 v162, v162
  v_exp_f32 v163, v163
  v_mfma_f32_32x32x16_bf16 v[176:191], v[52:55], v[96:99], 0
  v_exp_f32 v164, v164
  v_exp_f32 v165, v165
  v_exp_f32 v166, v166
  v_exp_f32 v167, v167
  v_mfma_f32_32x32x16_bf16 v[208:223], v[236:239], v[244:247], v[208:223]
  v_cvt_pk_bf16_f32 v248, v160, v161
  v_cvt_pk_bf16_f32 v249, v162, v163
  v_cvt_pk_bf16_f32 v250, v164, v165
  v_cvt_pk_bf16_f32 v251, v166, v167
  ds_read_b64_tr_b16 v[224:225], v93 offset:8192
  ds_read_b64_tr_b16 v[226:227], v94 offset:8192
  ds_read_b64_tr_b16 v[228:229], v93 offset:8448
  ds_read_b64_tr_b16 v[230:231], v94 offset:8448
  v_mfma_f32_32x32x16_bf16 v[176:191], v[56:59], v[100:103], v[176:191]
  v_exp_f32 v168, v168
  v_exp_f32 v169, v169
  v_exp_f32 v170, v170
  v_exp_f32 v171, v171
  v_exp_f32 v172, v172
  v_exp_f32 v173, v173
  v_exp_f32 v174, v174
  v_exp_f32 v175, v175
  v_cvt_pk_bf16_f32 v252, v168, v169
  v_cvt_pk_bf16_f32 v253, v170, v171
  v_cvt_pk_bf16_f32 v254, v172, v173
  v_cvt_pk_bf16_f32 v255, v174, v175
  s_waitcnt lgkmcnt(0)
  v_mfma_f32_32x32x16_bf16 v[208:223], v[224:227], v[248:251], v[208:223]
  v_exp_f32 v176, v176
  v_exp_f32 v177, v177
  v_exp_f32 v178, v178
  v_exp_f32 v179, v179
  v_mfma_f32_32x32x16_bf16 v[160:175], v[44:47], v[96:99], 0
  v_exp_f32 v180, v180
  v_exp_f32 v181, v181
  v_exp_f32 v182, v182
  v_exp_f32 v183, v183
  v_mfma_f32_32x32x16_bf16 v[208:223], v[228:231], v[252:255], v[208:223]
  v_cvt_pk_bf16_f32 v36, v176, v177
  v_cvt_pk_bf16_f32 v37, v178, v179
  v_cvt_pk_bf16_f32 v38, v180, v181
  v_cvt_pk_bf16_f32 v39, v182, v183
  ds_read_b64_tr_b16 v[232:233], v93 offset:6144
  ds_read_b64_tr_b16 v[234:235], v94 offset:6144
  ds_read_b64_tr_b16 v[236:237], v93 offset:6400
  ds_read_b64_tr_b16 v[238:239], v94 offset:6400
  v_mfma_f32_32x32x16_bf16 v[160:175], v[48:51], v[100:103], v[160:175]
  v_exp_f32 v184, v184
  v_exp_f32 v185, v185
  v_exp_f32 v186, v186
  v_exp_f32 v187, v187
  v_exp_f32 v188, v188
  v_exp_f32 v189, v189
  v_exp_f32 v190, v190
  v_exp_f32 v191, v191
  v_cvt_pk_bf16_f32 v40, v184, v185
  v_cvt_pk_bf16_f32 v41, v186, v187
  v_cvt_pk_bf16_f32 v42, v188, v189
  v_cvt_pk_bf16_f32 v43, v190, v191
  s_waitcnt lgkmcnt(0)
  v_mfma_f32_32x32x16_bf16 v[208:223], v[232:235], v[36:39], v[208:223]
  v_exp_f32 v160, v160
  v_exp_f32 v161, v161
  v_exp_f32 v162, v162
  v_exp_f32 v163, v163
  v_mfma_f32_32x32x16_bf16 v[176:191], v[200:203], v[96:99], 0
  v_exp_f32 v164, v164
  v_exp_f32 v165, v165
  v_exp_f32 v166, v166
  v_exp_f32 v167, v167
  v_mfma_f32_32x32x16_bf16 v[208:223], v[236:239], v[40:43], v[208:223]
  v_cvt_pk_bf16_f32 v240, v160, v161
  v_cvt_pk_bf16_f32 v241, v162, v163
  v_cvt_pk_bf16_f32 v242, v164, v165
  v_cvt_pk_bf16_f32 v243, v166, v167
  ds_read_b64_tr_b16 v[224:225], v93 offset:4096
  ds_read_b64_tr_b16 v[226:227], v94 offset:4096
  ds_read_b64_tr_b16 v[228:229], v93 offset:4352
  ds_read_b64_tr_b16 v[230:231], v94 offset:4352
  v_mfma_f32_32x32x16_bf16 v[176:191], v[204:207], v[100:103], v[176:191]
  v_exp_f32 v168, v168
  v_exp_f32 v169, v169
  v_exp_f32 v170, v170
  v_exp_f32 v171, v171
  v_exp_f32 v172, v172
  v_exp_f32 v173, v173
  v_exp_f32 v174, v174
  v_exp_f32 v175, v175
  v_cvt_pk_bf16_f32 v244, v168, v169
  v_cvt_pk_bf16_f32 v245, v170, v171
  v_cvt_pk_bf16_f32 v246, v172, v173
  v_cvt_pk_bf16_f32 v247, v174, v175
  s_waitcnt lgkmcnt(0)
  v_mfma_f32_32x32x16_bf16 v[208:223], v[224:227], v[240:243], v[208:223]
  v_exp_f32 v176, v176
  v_exp_f32 v177, v177
  v_exp_f32 v178, v178
  v_exp_f32 v179, v179
  v_mfma_f32_32x32x16_bf16 v[160:175], v[192:195], v[96:99], v[128:143]
  v_exp_f32 v180, v180
  v_exp_f32 v181, v181
  v_exp_f32 v182, v182
  v_exp_f32 v183, v183
  v_mfma_f32_32x32x16_bf16 v[208:223], v[228:231], v[244:247], v[208:223]
  v_cvt_pk_bf16_f32 v248, v176, v177
  v_cvt_pk_bf16_f32 v249, v178, v179
  v_cvt_pk_bf16_f32 v250, v180, v181
  v_cvt_pk_bf16_f32 v251, v182, v183
  ds_read_b64_tr_b16 v[232:233], v93 offset:2048
  ds_read_b64_tr_b16 v[234:235], v94 offset:2048
  ds_read_b64_tr_b16 v[236:237], v93 offset:2304
  ds_read_b64_tr_b16 v[238:239], v94 offset:2304
  v_mfma_f32_32x32x16_bf16 v[160:175], v[196:199], v[100:103], v[160:175]
  v_exp_f32 v184, v184
  v_exp_f32 v185, v185
  v_exp_f32 v186, v186
  v_exp_f32 v187, v187
  v_exp_f32 v188, v188
  v_exp_f32 v189, v189
  v_exp_f32 v190, v190
  v_exp_f32 v191, v191
  v_cvt_pk_bf16_f32 v252, v184, v185
  v_cvt_pk_bf16_f32 v253, v186, v187
  v_cvt_pk_bf16_f32 v254, v188, v189
  v_cvt_pk_bf16_f32 v255, v190, v191
  s_waitcnt lgkmcnt(0)
  v_mfma_f32_32x32x16_bf16 v[208:223], v[232:235], v[248:251], v[208:223]
  v_exp_f32 v160, v160
  v_exp_f32 v161, v161
  v_exp_f32 v162, v162
  v_exp_f32 v163, v163
  v_exp_f32 v164, v164
  v_exp_f32 v165, v165
  v_exp_f32 v166, v166
  v_exp_f32 v167, v167
  v_mfma_f32_32x32x16_bf16 v[208:223], v[236:239], v[252:255], v[208:223]
  v_cvt_pk_bf16_f32 v36, v160, v161
  v_cvt_pk_bf16_f32 v37, v162, v163
  v_cvt_pk_bf16_f32 v38, v164, v165
  v_cvt_pk_bf16_f32 v39, v166, v167
  ds_read_b64_tr_b16 v[224:225], v93 offset:0
  ds_read_b64_tr_b16 v[226:227], v94 offset:0
  ds_read_b64_tr_b16 v[228:229], v93 offset:256
  ds_read_b64_tr_b16 v[230:231], v94 offset:256
  v_exp_f32 v168, v168
  v_exp_f32 v169, v169
  v_exp_f32 v170, v170
  v_exp_f32 v171, v171
  v_exp_f32 v172, v172
  v_exp_f32 v173, v173
  v_exp_f32 v174, v174
  v_exp_f32 v175, v175
  v_cvt_pk_bf16_f32 v40, v168, v169
  v_cvt_pk_bf16_f32 v41, v170, v171
  v_cvt_pk_bf16_f32 v42, v172, v173
  v_cvt_pk_bf16_f32 v43, v174, v175
  s_waitcnt lgkmcnt(0)
  v_mfma_f32_32x32x16_bf16 v[208:223], v[224:227], v[36:39], v[208:223]
  v_mfma_f32_32x32x16_bf16 v[208:223], v[228:231], v[40:43], v[208:223]
  s_nop 11
  s_branch FOK28
SPIN31:
  s_mov_b32 s7, 0
SPIN31L:
  s_sleep 4
  buffer_load_dwordx2 v[16:17], v13, s[24:27], s96 offen sc1
  s_add_u32 s7, s7, 1
  s_cmp_ge_u32 s7, 200000
  s_waitcnt vmcnt(0)
  s_cbranch_scc1 SPIN31X
  v_cmp_eq_u64 vcc, s[80:81], v[16:17]
  s_nop 1
  s_cmp_eq_u64 vcc, exec
  s_nop 1
  s_cbranch_scc0 SPIN31L
SPIN31X:
  s_nop 4
  s_branch OK30
SPIN33:
  s_mov_b32 s7, 0
SPIN33L:
  s_sleep 4
  buffer_load_dwordx2 v[18:19], v14, s[24:27], s94 offen sc1
  s_add_u32 s7, s7, 1
  s_cmp_ge_u32 s7, 200000
  s_waitcnt vmcnt(0)
  s_cbranch_scc1 SPIN33X
  v_cmp_eq_u64 vcc, s[80:81], v[18:19]
  s_nop 1
  s_cmp_eq_u64 vcc, exec
  s_nop 1
  s_cbranch_scc0 SPIN33L
SPIN33X:
  s_nop 4
  s_branch OK32
L_CEND:
  s_endpgm
.p2align 8
.type L_TABLE,@object
L_TABLE:
.long 0,128,57344,172032,262144,348160,5767168,5914624,5768192,5915648,5771264,5918720,5772288,5919744,0,28672,65536,65792,67584,67840,229376,0,0,0,0,0,262144,262144,262144,0,49152,0,4096,12288,0,20480,65536,32768,32768,262144,32768,5881856,0,32768,4096,20480,16256,16256,16256,0,4294967295,0,0,1544,1049336022,3584,0,114688,229376,57344,172032,286720,1376256,0,25088,50176,75264,5767168,5775360,5783552,5771264,5779456,5787648,5865472,5881856,5883904,5885952,5888000,0,128,516096
.long 114688,114816,57344,172032,350208,264192,5916672,5769216,5917696,5770240,5920768,5773312,5921792,5774336,200704,28672,66048,66304,68096,68352,229376,0,0,0,0,0,262144,262144,262144,12288,59392,6144,4104,12296,0,20488,66048,32784,32768,348160,33024,6029312,7168,32832,4192,20608,16256,16256,16256,0,4294967295,0,0,7688,1049336022,3584,344064,458752,573440,401408,516096,630784,1433600,100352,125440,150528,175616,5791744,5799936,5808128,5795840,5804032,5812224,5869568,5890048,5892096,5894144,5896192,50176,50304,526848
.long 0,128,57344,172032,434176,520192,6063104,6210560,6062080,6209536,6067200,6214656,6066176,6213632,401408,28672,65792,65536,67840,67584,229376,0,0,0,0,0,262144,262144,262144,24576,69632,12288,4112,12304,0,20496,65544,32800,33280,434176,33280,6176768,14336,32896,4288,20736,16256,16256,0,0,4294967295,0,0,13832,1049336022,3584,688128,802816,917504,745472,860160,974848,1490944,200704,225792,250880,275968,5816320,5824512,5832704,5820416,5828608,5836800,5873664,5898240,5900288,5902336,5904384,0,128,537600
.long 114688,114816,57344,172032,522240,436224,6212608,6065152,6211584,6064128,6216704,6069248,6215680,6068224,602112,28672,66304,66048,68352,68096,229376,0,0,0,0,0,348160,434176,520192,36864,79872,18432,4120,12312,0,20504,66056,32816,33280,520192,33536,6324224,21504,32960,4384,20864,0,0,0,0,4294967295,0,0,19976,1049336022,3584,1032192,1146880,1261568,1089536,1204224,1318912,1548288,301056,326144,351232,376320,5840896,5849088,5857280,5844992,5853184,5861376,5877760,5906432,5908480,5910528,5912576,50176,50304,548352
.long 0,128,57344,172032,3014656,3100672,10485760,10633216,10486784,10634240,10489856,10637312,10490880,10638336,802816,28672,65536,65792,67584,67840,229376,0,0,0,0,0,265728,265728,265728,0,49152,0,8192,16384,1024,20544,66560,40960,40960,265728,32768,5885952,229376,34816,5120,21504,16256,16256,16256,0,4294967295,0,0,1544,1049336022,3584,0,114688,229376,57344,172032,286720,1376256,0,25088,50176,75264,6946816,6955008,6963200,6950912,6959104,6967296,7045120,7061504,7063552,7065600,7067648,802816,802944,860160
.long 114688,114816,57344,172032,3102720,3016704,10635264,10487808,10636288,10488832,10639360,10491904,10640384,10492928,1003520,28672,66048,66304,68096,68352,229376,0,0,0,0,0,265728,265728,265728,12288,59392,6144,8200,16392,1024,20552,67072,40976,40960,351744,33024,6033408,236544,34880,5216,21632,16256,16256,16256,0,4294967295,0,0,7688,1049336022,3584,344064,458752,573440,401408,516096,630784,1433600,100352,125440,150528,175616,6971392,6979584,6987776,6975488,6983680,6991872,7049216,7069696,7071744,7073792,7075840,852992,853120,870912
.long 0,128,57344,172032,3186688,3272704,10781696,10929152,10780672,10928128,10785792,10933248,10784768,10932224,1204224,28672,65792,65536,67840,67584,229376,0,0,0,0,0,265728,265728,265728,24576,69632,12288,8208,16400,1024,20560,66568,40992,41472,437760,33280,6180864,243712,34944,5312,21760,16256,16256,0,0,4294967295,0,0,13832,1049336022,3584,688128,802816,917504,745472,860160,974848,1490944,200704,225792,250880,275968,6995968,7004160,7012352,7000064,7008256,7016448,7053312,7077888,7079936,7081984,7084032,802816,802944,881664
.long 114688,114816,57344,172032,3274752,3188736,10931200,10783744,10930176,10782720,10935296,10787840,10934272,10786816,1404928,28672,66304,66048,68352,68096,229376,0,0,0,0,0,351744,437760,523776,36864,79872,18432,8216,16408,1024,20568,67080,41008,41472,523776,33536,6328320,250880,35008,5408,21888,0,0,0,0,4294967295,0,0,19976,1049336022,3584,1032192,1146880,1261568,1089536,1204224,1318912,1548288,301056,326144,351232,376320,7020544,7028736,7036928,7024640,7032832,7041024,7057408,7086080,7088128,7090176,7092224,852992,853120,892416
.long 1024,1152,57344,172032,278528,364544,5799936,5947392,5800960,5948416,5804032,5951488,5805056,5952512,1024,28672,81920,82176,83968,84224,229376,0,0,0,0,0,269312,269312,269312,0,49152,0,4224,12416,32,20608,81920,33024,32768,269312,32768,5890048,458752,36864,6144,22528,16256,16256,16256,0,4294967295,0,0,1544,1049336022,3584,0,114688,229376,57344,172032,286720,1376256,0,25088,50176,75264,8126464,8134656,8142848,8130560,8138752,8146944,8224768,8241152,8243200,8245248,8247296,1024,1152,516608
.long 115712,115840,57344,172032,366592,280576,5949440,5801984,5950464,5803008,5953536,5806080,5954560,5807104,201728,28672,82432,82688,84480,84736,229376,0,0,0,0,0,269312,269312,269312,12288,59392,6144,4232,12424,32,20616,82432,33040,32768,355328,33024,6037504,465920,36928,6240,22656,16256,16256,16256,0,4294967295,0,0,7688,1049336022,3584,344064,458752,573440,401408,516096,630784,1433600,100352,125440,150528,175616,8151040,8159232,8167424,8155136,8163328,8171520,8228864,8249344,8251392,8253440,8255488,51200,51328,527360
.long 1024,1152,57344,172032,450560,536576,6095872,6243328,6094848,6242304,6099968,6247424,6098944,6246400,402432,28672,82176,81920,84224,83968,229376,0,0,0,0,0,269312,269312,269312,24576,69632,12288,4240,12432,32,20624,81928,33056,33280,441344,33280,6184960,473088,36992,6336,22784,16256,16256,0,0,4294967295,0,0,13832,1049336022,3584,688128,802816,917504,745472,860160,974848,1490944,200704,225792,250880,275968,8175616,8183808,8192000,8179712,8187904,8196096,8232960,8257536,8259584,8261632,8263680,1024,1152,538112
.long 115712,115840,57344,172032,538624,452608,6245376,6097920,6244352,6096896,6249472,6102016,6248448,6100992,603136,28672,82688,82432,84736,84480,229376,0,0,0,0,0,355328,441344,527360,36864,79872,18432,4248,12440,32,20632,82440,33072,33280,527360,33536,6332416,480256,37056,6432,22912,0,0,0,0,4294967295,0,0,19976,1049336022,3584,1032192,1146880,1261568,1089536,1204224,1318912,1548288,301056,326144,351232,376320,8200192,8208384,8216576,8204288,8212480,8220672,8237056,8265728,8267776,8269824,8271872,51200,51328,548864
.long 1024,1152,57344,172032,3031040,3117056,10518528,10665984,10519552,10667008,10522624,10670080,10523648,10671104,803840,28672,81920,82176,83968,84224,229376,0,0,0,0,0,272896,272896,272896,0,49152,0,8320,16512,1056,20672,82944,41216,40960,272896,32768,5894144,688128,38912,7168,23552,16256,16256,16256,0,4294967295,0,0,1544,1049336022,3584,0,114688,229376,57344,172032,286720,1376256,0,25088,50176,75264,9306112,9314304,9322496,9310208,9318400,9326592,9404416,9420800,9422848,9424896,9426944,803840,803968,860672
.long 115712,115840,57344,172032,3119104,3033088,10668032,10520576,10669056,10521600,10672128,10524672,10673152,10525696,1004544,28672,82432,82688,84480,84736,229376,0,0,0,0,0,272896,272896,272896,12288,59392,6144,8328,16520,1056,20680,83456,41232,40960,358912,33024,6041600,695296,38976,7264,23680,16256,16256,16256,0,4294967295,0,0,7688,1049336022,3584,344064,458752,573440,401408,516096,630784,1433600,100352,125440,150528,175616,9330688,9338880,9347072,9334784,9342976,9351168,9408512,9428992,9431040,9433088,9435136,854016,854144,871424
.long 1024,1152,57344,172032,3203072,3289088,10814464,10961920,10813440,10960896,10818560,10966016,10817536,10964992,1205248,28672,82176,81920,84224,83968,229376,0,0,0,0,0,272896,272896,272896,24576,69632,12288,8336,16528,1056,20688,82952,41248,41472,444928,33280,6189056,702464,39040,7360,23808,16256,16256,0,0,4294967295,0,0,13832,1049336022,3584,688128,802816,917504,745472,860160,974848,1490944,200704,225792,250880,275968,9355264,9363456,9371648,9359360,9367552,9375744,9412608,9437184,9439232,9441280,9443328,803840,803968,882176
.long 115712,115840,57344,172032,3291136,3205120,10963968,10816512,10962944,10815488,10968064,10820608,10967040,10819584,1405952,28672,82688,82432,84736,84480,229376,0,0,0,0,0,358912,444928,530944,36864,79872,18432,8344,16536,1056,20696,83464,41264,41472,530944,33536,6336512,709632,39104,7456,23936,0,0,0,0,4294967295,0,0,19976,1049336022,3584,1032192,1146880,1261568,1089536,1204224,1318912,1548288,301056,326144,351232,376320,9379840,9388032,9396224,9383936,9392128,9400320,9416704,9445376,9447424,9449472,9451520,854016,854144,892928
.long 2048,2176,57344,172032,294912,380928,5832704,5980160,5833728,5981184,5836800,5984256,5837824,5985280,2048,28672,98304,98560,100352,100608,229376,0,0,0,0,0,276480,276480,276480,0,49152,0,4352,12544,64,20736,98304,33280,32768,276480,32768,5898240,917504,40960,8192,24576,16256,16256,16256,0,4294967295,0,0,1544,1065353216,3584,0,114688,229376,57344,172032,286720,1376256,0,25088,50176,75264,10485760,10493952,10502144,10489856,10498048,10506240,10584064,10600448,10602496,10604544,10606592,2048,2176,517120
.long 116736,116864,57344,172032,382976,296960,5982208,5834752,5983232,5835776,5986304,5838848,5987328,5839872,202752,28672,98816,99072,100864,101120,229376,0,0,0,0,0,276480,276480,276480,12288,59392,6144,4360,12552,64,20744,98816,33296,32768,362496,33024,6045696,924672,41024,8288,24704,16256,16256,16256,0,4294967295,0,0,7688,1065353216,3584,344064,458752,573440,401408,516096,630784,1433600,100352,125440,150528,175616,10510336,10518528,10526720,10514432,10522624,10530816,10588160,10608640,10610688,10612736,10614784,52224,52352,527872
.long 2048,2176,57344,172032,466944,552960,6128640,6276096,6127616,6275072,6132736,6280192,6131712,6279168,403456,28672,98560,98304,100608,100352,229376,0,0,0,0,0,276480,276480,276480,24576,69632,12288,4368,12560,64,20752,98312,33312,33280,448512,33280,6193152,931840,41088,8384,24832,16256,16256,0,0,4294967295,0,0,13832,1065353216,3584,688128,802816,917504,745472,860160,974848,1490944,200704,225792,250880,275968,10534912,10543104,10551296,10539008,10547200,10555392,10592256,10616832,10618880,10620928,10622976,2048,2176,538624
.long 116736,116864,57344,172032,555008,468992,6278144,6130688,6277120,6129664,6282240,6134784,6281216,6133760,604160,28672,99072,98816,101120,100864,229376,0,0,0,0,0,362496,448512,534528,36864,79872,18432,4376,12568,64,20760,98824,33328,33280,534528,33536,6340608,939008,41152,8480,24960,0,0,0,0,4294967295,0,0,19976,1065353216,3584,1032192,1146880,1261568,1089536,1204224,1318912,1548288,301056,326144,351232,376320,10559488,10567680,10575872,10563584,10571776,10579968,10596352,10625024,10627072,10629120,10631168,52224,52352,549376
.long 2048,2176,57344,172032,3047424,3133440,10551296,10698752,10552320,10699776,10555392,10702848,10556416,10703872,804864,28672,98304,98560,100352,100608,229376,0,0,0,0,0,280064,280064,280064,0,49152,0,8448,16640,1088,20800,99328,41472,40960,280064,32768,5902336,1146880,43008,9216,25600,16256,16256,16256,0,4294967295,0,0,1544,1065353216,3584,0,114688,229376,57344,172032,286720,1376256,0,25088,50176,75264,11665408,11673600,11681792,11669504,11677696,11685888,11763712,11780096,11782144,11784192,11786240,804864,804992,861184
.long 116736,116864,57344,172032,3135488,3049472,10700800,10553344,10701824,10554368,10704896,10557440,10705920,10558464,1005568,28672,98816,99072,100864,101120,229376,0,0,0,0,0,280064,280064,280064,12288,59392,6144,8456,16648,1088,20808,99840,41488,40960,366080,33024,6049792,1154048,43072,9312,25728,16256,16256,16256,0,4294967295,0,0,7688,1065353216,3584,344064,458752,573440,401408,516096,630784,1433600,100352,125440,150528,175616,11689984,11698176,11706368,11694080,11702272,11710464,11767808,11788288,11790336,11792384,11794432,855040,855168,871936
.long 2048,2176,57344,172032,3219456,3305472,10847232,10994688,10846208,10993664,10851328,10998784,10850304,10997760,1206272,28672,98560,98304,100608,100352,229376,0,0,0,0,0,280064,280064,280064,24576,69632,12288,8464,16656,1088,20816,99336,41504,41472,452096,33280,6197248,1161216,43136,9408,25856,16256,16256,0,0,4294967295,0,0,13832,1065353216,3584,688128,802816,917504,745472,860160,974848,1490944,200704,225792,250880,275968,11714560,11722752,11730944,11718656,11726848,11735040,11771904,11796480,11798528,11800576,11802624,804864,804992,882688
.long 116736,116864,57344,172032,3307520,3221504,10996736,10849280,10995712,10848256,11000832,10853376,10999808,10852352,1406976,28672,99072,98816,101120,100864,229376,0,0,0,0,0,366080,452096,538112,36864,79872,18432,8472,16664,1088,20824,99848,41520,41472,538112,33536,6344704,1168384,43200,9504,25984,0,0,0,0,4294967295,0,0,19976,1065353216,3584,1032192,1146880,1261568,1089536,1204224,1318912,1548288,301056,326144,351232,376320,11739136,11747328,11755520,11743232,11751424,11759616,11776000,11804672,11806720,11808768,11810816,855040,855168,893440
.long 2048,3072,43008,129024,311296,397312,327680,413696,329728,415744,5865472,6012928,5866496,6013952,2048,21504,180224,180736,114688,114944,172032,0,0,0,0,0,283648,283648,283648,0,49152,0,2048,12672,96,20864,180224,33536,32768,283648,32768,5906432,1376256,45056,10240,26624,16256,16256,16256,0,4294967295,0,0,1544,1065353216,2688,0,114688,229376,57344,172032,286720,1376256,0,25088,50176,75264,12845056,12853248,12861440,12849152,12857344,12865536,12943360,12959744,12961792,12963840,12965888,2048,3072,517632
.long 88064,117760,43008,129024,399360,313344,417792,331776,419840,333824,6014976,5867520,6016000,5868544,152576,21504,182272,182784,115200,115456,172032,0,0,0,0,0,283648,283648,283648,12288,59392,6144,2056,12680,96,20872,180736,33552,32768,369664,33024,6053888,1383424,45120,10336,26752,16256,16256,16256,0,4294967295,0,0,7688,1065353216,2688,344064,458752,573440,401408,516096,630784,1433600,100352,125440,150528,175616,12869632,12877824,12886016,12873728,12881920,12890112,12947456,12967936,12969984,12972032,12974080,39680,53248,528384
.long 2176,3072,43008,129024,483328,569344,501760,587776,499712,585728,6161408,6308864,6160384,6307840,303104,21504,180736,180224,114944,114688,172032,0,0,0,0,0,283648,283648,283648,24576,69632,12288,2064,12688,96,20880,180232,33568,33280,455680,33280,6201344,1390592,45184,10432,26880,16256,16256,0,0,4294967295,0,0,13832,1065353216,2688,688128,802816,917504,745472,860160,974848,1490944,200704,225792,250880,275968,12894208,12902400,12910592,12898304,12906496,12914688,12951552,12976128,12978176,12980224,12982272,2176,3072,539136
.long 88192,117760,43008,129024,571392,485376,591872,505856,589824,503808,6310912,6163456,6309888,6162432,453632,21504,182784,182272,115456,115200,172032,0,0,0,0,0,369664,455680,541696,36864,79872,18432,2072,12696,96,20888,180744,33584,33280,541696,33536,6348800,1397760,45248,10528,27008,0,0,0,0,4294967295,0,0,19976,1065353216,2688,1032192,1146880,1261568,1089536,1204224,1318912,1548288,301056,326144,351232,376320,12918784,12926976,12935168,12922880,12931072,12939264,12955648,12984320,12986368,12988416,12990464,39808,53248,549888
.long 2048,3072,43008,129024,3063808,3149824,3080192,3166208,3082240,3168256,10584064,10731520,10585088,10732544,604160,21504,180224,180736,114688,114944,172032,0,0,0,0,0,287232,287232,287232,0,49152,0,3072,16768,1120,20928,181248,41728,40960,287232,32768,5910528,1605632,47104,11264,27648,16256,16256,16256,0,4294967295,0,0,1544,1065353216,2688,0,114688,229376,57344,172032,286720,1376256,0,25088,50176,75264,14024704,14032896,14041088,14028800,14036992,14045184,14123008,14139392,14141440,14143488,14145536,604160,805888,861696
.long 88064,117760,43008,129024,3151872,3065856,3170304,3084288,3172352,3086336,10733568,10586112,10734592,10587136,754688,21504,182272,182784,115200,115456,172032,0,0,0,0,0,287232,287232,287232,12288,59392,6144,3080,16776,1120,20936,181760,41744,40960,373248,33024,6057984,1612800,47168,11360,27776,16256,16256,16256,0,4294967295,0,0,7688,1065353216,2688,344064,458752,573440,401408,516096,630784,1433600,100352,125440,150528,175616,14049280,14057472,14065664,14053376,14061568,14069760,14127104,14147584,14149632,14151680,14153728,641792,856064,872448
.long 2176,3072,43008,129024,3235840,3321856,3254272,3340288,3252224,3338240,10880000,11027456,10878976,11026432,905216,21504,180736,180224,114944,114688,172032,0,0,0,0,0,287232,287232,287232,24576,69632,12288,3088,16784,1120,20944,181256,41760,41472,459264,33280,6205440,1619968,47232,11456,27904,16256,16256,0,0,4294967295,0,0,13832,1065353216,2688,688128,802816,917504,745472,860160,974848,1490944,200704,225792,250880,275968,14073856,14082048,14090240,14077952,14086144,14094336,14131200,14155776,14157824,14159872,14161920,604288,805888,883200
.long 88192,117760,43008,129024,3323904,3237888,3344384,3258368,3342336,3256320,11029504,10882048,11028480,10881024,1055744,21504,182784,182272,115456,115200,172032,0,0,0,0,0,373248,459264,545280,36864,79872,18432,3096,16792,1120,20952,181768,41776,41472,545280,33536,6352896,1627136,47296,11552,28032,0,0,0,0,4294967295,0,0,19976,1065353216,2688,1032192,1146880,1261568,1089536,1204224,1318912,1548288,301056,326144,351232,376320,14098432,14106624,14114816,14102528,14110720,14118912,14135296,14163968,14166016,14168064,14170112,641920,856064,893952
.long 0,128,57344,172032,606208,692224,6356992,6504448,6358016,6505472,6361088,6508544,6362112,6509568,0,28672,65536,65792,67584,67840,229376,0,0,0,0,0,263680,263680,263680,0,49152,0,4608,12800,128,20512,122880,33792,33792,263680,32768,5883904,128,32768,4096,20480,16256,16256,16256,0,0,4294967295,1,0,1049336022,3584,128,114816,229504,57472,172160,286848,1376384,128,25216,50304,75392,5767168,5775360,5783552,5771264,5779456,5787648,5865472,5881856,5883904,5885952,5888000,100352,100480,559104
.long 114688,114816,57344,172032,694272,608256,6506496,6359040,6507520,6360064,6510592,6363136,6511616,6364160,200704,28672,66048,66304,68096,68352,229376,0,0,0,0,0,263680,263680,263680,12288,59392,6144,4616,12808,128,20520,123392,33808,33792,349696,33024,6031360,7296,32832,4192,20608,16256,16256,16256,0,0,4294967295,1,6144,1049336022,3584,344192,458880,573568,401536,516224,630912,1433728,100480,125568,150656,175744,5791744,5799936,5808128,5795840,5804032,5812224,5869568,5890048,5892096,5894144,5896192,150528,150656,569856
.long 0,128,57344,172032,778240,864256,6652928,6800384,6651904,6799360,6657024,6804480,6656000,6803456,401408,28672,65792,65536,67840,67584,229376,0,0,0,0,0,263680,263680,263680,24576,69632,12288,4624,12816,128,20528,122888,33824,34304,435712,33280,6178816,14464,32896,4288,20736,16256,16256,0,0,0,4294967295,1,12288,1049336022,3584,688256,802944,917632,745600,860288,974976,1491072,200832,225920,251008,276096,5816320,5824512,5832704,5820416,5828608,5836800,5873664,5898240,5900288,5902336,5904384,100352,100480,580608
.long 114688,114816,57344,172032,866304,780288,6802432,6654976,6801408,6653952,6806528,6659072,6805504,6658048,602112,28672,66304,66048,68352,68096,229376,0,0,0,0,0,349696,435712,521728,36864,79872,18432,4632,12824,128,20536,123400,33840,34304,521728,33536,6326272,21632,32960,4384,20864,0,0,0,0,0,4294967295,1,18432,1049336022,3584,1032320,1147008,1261696,1089664,1204352,1319040,1548416,301184,326272,351360,376448,5840896,5849088,5857280,5844992,5853184,5861376,5877760,5906432,5908480,5910528,5912576,150528,150656,591360
.long 0,128,57344,172032,3358720,3444736,11075584,11223040,11076608,11224064,11079680,11227136,11080704,11228160,802816,28672,65536,65792,67584,67840,229376,0,0,0,0,0,267264,267264,267264,0,49152,0,8704,16896,1152,20576,123904,41984,41984,267264,32768,5888000,229504,34816,5120,21504,16256,16256,16256,0,0,4294967295,1,0,1049336022,3584,128,114816,229504,57472,172160,286848,1376384,128,25216,50304,75392,6946816,6955008,6963200,6950912,6959104,6967296,7045120,7061504,7063552,7065600,7067648,903168,903296,903168
.long 114688,114816,57344,172032,3446784,3360768,11225088,11077632,11226112,11078656,11229184,11081728,11230208,11082752,1003520,28672,66048,66304,68096,68352,229376,0,0,0,0,0,267264,267264,267264,12288,59392,6144,8712,16904,1152,20584,124416,42000,41984,353280,33024,6035456,236672,34880,5216,21632,16256,16256,16256,0,0,4294967295,1,6144,1049336022,3584,344192,458880,573568,401536,516224,630912,1433728,100480,125568,150656,175744,6971392,6979584,6987776,6975488,6983680,6991872,7049216,7069696,7071744,7073792,7075840,953344,953472,913920
.long 0,128,57344,172032,3530752,3616768,11371520,11518976,11370496,11517952,11375616,11523072,11374592,11522048,1204224,28672,65792,65536,67840,67584,229376,0,0,0,0,0,267264,267264,267264,24576,69632,12288,8720,16912,1152,20592,123912,42016,42496,439296,33280,6182912,243840,34944,5312,21760,16256,16256,0,0,0,4294967295,1,12288,1049336022,3584,688256,802944,917632,745600,860288,974976,1491072,200832,225920,251008,276096,6995968,7004160,7012352,7000064,7008256,7016448,7053312,7077888,7079936,7081984,7084032,903168,903296,924672
.long 114688,114816,57344,172032,3618816,3532800,11521024,11373568,11520000,11372544,11525120,11377664,11524096,11376640,1404928,28672,66304,66048,68352,68096,229376,0,0,0,0,0,353280,439296,525312,36864,79872,18432,8728,16920,1152,20600,124424,42032,42496,525312,33536,6330368,251008,35008,5408,21888,0,0,0,0,0,4294967295,1,18432,1049336022,3584,1032320,1147008,1261696,1089664,1204352,1319040,1548416,301184,326272,351360,376448,7020544,7028736,7036928,7024640,7032832,7041024,7057408,7086080,7088128,7090176,7092224,953344,953472,935424
.long 1024,1152,57344,172032,622592,708608,6389760,6537216,6390784,6538240,6393856,6541312,6394880,6542336,1024,28672,81920,82176,83968,84224,229376,0,0,0,0,0,270848,270848,270848,0,49152,0,4736,12928,160,20640,139264,34048,33792,270848,32768,5892096,458880,36864,6144,22528,16256,16256,16256,0,0,4294967295,1,0,1049336022,3584,128,114816,229504,57472,172160,286848,1376384,128,25216,50304,75392,8126464,8134656,8142848,8130560,8138752,8146944,8224768,8241152,8243200,8245248,8247296,101376,101504,559616
.long 115712,115840,57344,172032,710656,624640,6539264,6391808,6540288,6392832,6543360,6395904,6544384,6396928,201728,28672,82432,82688,84480,84736,229376,0,0,0,0,0,270848,270848,270848,12288,59392,6144,4744,12936,160,20648,139776,34064,33792,356864,33024,6039552,466048,36928,6240,22656,16256,16256,16256,0,0,4294967295,1,6144,1049336022,3584,344192,458880,573568,401536,516224,630912,1433728,100480,125568,150656,175744,8151040,8159232,8167424,8155136,8163328,8171520,8228864,8249344,8251392,8253440,8255488,151552,151680,570368
.long 1024,1152,57344,172032,794624,880640,6685696,6833152,6684672,6832128,6689792,6837248,6688768,6836224,402432,28672,82176,81920,84224,83968,229376,0,0,0,0,0,270848,270848,270848,24576,69632,12288,4752,12944,160,20656,139272,34080,34304,442880,33280,6187008,473216,36992,6336,22784,16256,16256,0,0,0,4294967295,1,12288,1049336022,3584,688256,802944,917632,745600,860288,974976,1491072,200832,225920,251008,276096,8175616,8183808,8192000,8179712,8187904,8196096,8232960,8257536,8259584,8261632,8263680,101376,101504,581120
.long 115712,115840,57344,172032,882688,796672,6835200,6687744,6834176,6686720,6839296,6691840,6838272,6690816,603136,28672,82688,82432,84736,84480,229376,0,0,0,0,0,356864,442880,528896,36864,79872,18432,4760,12952,160,20664,139784,34096,34304,528896,33536,6334464,480384,37056,6432,22912,0,0,0,0,0,4294967295,1,18432,1049336022,3584,1032320,1147008,1261696,1089664,1204352,1319040,1548416,301184,326272,351360,376448,8200192,8208384,8216576,8204288,8212480,8220672,8237056,8265728,8267776,8269824,8271872,151552,151680,591872
.long 1024,1152,57344,172032,3375104,3461120,11108352,11255808,11109376,11256832,11112448,11259904,11113472,11260928,803840,28672,81920,82176,83968,84224,229376,0,0,0,0,0,274432,274432,274432,0,49152,0,8832,17024,1184,20704,140288,42240,41984,274432,32768,5896192,688256,38912,7168,23552,16256,16256,16256,0,0,4294967295,1,0,1049336022,3584,128,114816,229504,57472,172160,286848,1376384,128,25216,50304,75392,9306112,9314304,9322496,9310208,9318400,9326592,9404416,9420800,9422848,9424896,9426944,904192,904320,903680
.long 115712,115840,57344,172032,3463168,3377152,11257856,11110400,11258880,11111424,11261952,11114496,11262976,11115520,1004544,28672,82432,82688,84480,84736,229376,0,0,0,0,0,274432,274432,274432,12288,59392,6144,8840,17032,1184,20712,140800,42256,41984,360448,33024,6043648,695424,38976,7264,23680,16256,16256,16256,0,0,4294967295,1,6144,1049336022,3584,344192,458880,573568,401536,516224,630912,1433728,100480,125568,150656,175744,9330688,9338880,9347072,9334784,9342976,9351168,9408512,9428992,9431040,9433088,9435136,954368,954496,914432
.long 1024,1152,57344,172032,3547136,3633152,11404288,11551744,11403264,11550720,11408384,11555840,11407360,11554816,1205248,28672,82176,81920,84224,83968,229376,0,0,0,0,0,274432,274432,274432,24576,69632,12288,8848,17040,1184,20720,140296,42272,42496,446464,33280,6191104,702592,39040,7360,23808,16256,16256,0,0,0,4294967295,1,12288,1049336022,3584,688256,802944,917632,745600,860288,974976,1491072,200832,225920,251008,276096,9355264,9363456,9371648,9359360,9367552,9375744,9412608,9437184,9439232,9441280,9443328,904192,904320,925184
.long 115712,115840,57344,172032,3635200,3549184,11553792,11406336,11552768,11405312,11557888,11410432,11556864,11409408,1405952,28672,82688,82432,84736,84480,229376,0,0,0,0,0,360448,446464,532480,36864,79872,18432,8856,17048,1184,20728,140808,42288,42496,532480,33536,6338560,709760,39104,7456,23936,0,0,0,0,0,4294967295,1,18432,1049336022,3584,1032320,1147008,1261696,1089664,1204352,1319040,1548416,301184,326272,351360,376448,9379840,9388032,9396224,9383936,9392128,9400320,9416704,9445376,9447424,9449472,9451520,954368,954496,935936
.long 2048,2176,57344,172032,638976,724992,6422528,6569984,6423552,6571008,6426624,6574080,6427648,6575104,2048,28672,98304,98560,100352,100608,229376,0,0,0,0,0,278016,278016,278016,0,49152,0,4864,13056,192,20768,155648,34304,33792,278016,32768,5900288,917632,40960,8192,24576,16256,16256,16256,0,0,4294967295,1,0,1065353216,3584,128,114816,229504,57472,172160,286848,1376384,128,25216,50304,75392,10485760,10493952,10502144,10489856,10498048,10506240,10584064,10600448,10602496,10604544,10606592,102400,102528,560128
.long 116736,116864,57344,172032,727040,641024,6572032,6424576,6573056,6425600,6576128,6428672,6577152,6429696,202752,28672,98816,99072,100864,101120,229376,0,0,0,0,0,278016,278016,278016,12288,59392,6144,4872,13064,192,20776,156160,34320,33792,364032,33024,6047744,924800,41024,8288,24704,16256,16256,16256,0,0,4294967295,1,6144,1065353216,3584,344192,458880,573568,401536,516224,630912,1433728,100480,125568,150656,175744,10510336,10518528,10526720,10514432,10522624,10530816,10588160,10608640,10610688,10612736,10614784,152576,152704,570880
.long 2048,2176,57344,172032,811008,897024,6718464,6865920,6717440,6864896,6722560,6870016,6721536,6868992,403456,28672,98560,98304,100608,100352,229376,0,0,0,0,0,278016,278016,278016,24576,69632,12288,4880,13072,192,20784,155656,34336,34304,450048,33280,6195200,931968,41088,8384,24832,16256,16256,0,0,0,4294967295,1,12288,1065353216,3584,688256,802944,917632,745600,860288,974976,1491072,200832,225920,251008,276096,10534912,10543104,10551296,10539008,10547200,10555392,10592256,10616832,10618880,10620928,10622976,102400,102528,581632
.long 116736,116864,57344,172032,899072,813056,6867968,6720512,6866944,6719488,6872064,6724608,6871040,6723584,604160,28672,99072,98816,101120,100864,229376,0,0,0,0,0,364032,450048,536064,36864,79872,18432,4888,13080,192,20792,156168,34352,34304,536064,33536,6342656,939136,41152,8480,24960,0,0,0,0,0,4294967295,1,18432,1065353216,3584,1032320,1147008,1261696,1089664,1204352,1319040,1548416,301184,326272,351360,376448,10559488,10567680,10575872,10563584,10571776,10579968,10596352,10625024,10627072,10629120,10631168,152576,152704,592384
.long 2048,2176,57344,172032,3391488,3477504,11141120,11288576,11142144,11289600,11145216,11292672,11146240,11293696,804864,28672,98304,98560,100352,100608,229376,0,0,0,0,0,281600,281600,281600,0,49152,0,8960,17152,1216,20832,156672,42496,41984,281600,32768,5904384,1147008,43008,9216,25600,16256,16256,16256,0,0,4294967295,1,0,1065353216,3584,128,114816,229504,57472,172160,286848,1376384,128,25216,50304,75392,11665408,11673600,11681792,11669504,11677696,11685888,11763712,11780096,11782144,11784192,11786240,905216,905344,904192
.long 116736,116864,57344,172032,3479552,3393536,11290624,11143168,11291648,11144192,11294720,11147264,11295744,11148288,1005568,28672,98816,99072,100864,101120,229376,0,0,0,0,0,281600,281600,281600,12288,59392,6144,8968,17160,1216,20840,157184,42512,41984,367616,33024,6051840,1154176,43072,9312,25728,16256,16256,16256,0,0,4294967295,1,6144,1065353216,3584,344192,458880,573568,401536,516224,630912,1433728,100480,125568,150656,175744,11689984,11698176,11706368,11694080,11702272,11710464,11767808,11788288,11790336,11792384,11794432,955392,955520,914944
.long 2048,2176,57344,172032,3563520,3649536,11437056,11584512,11436032,11583488,11441152,11588608,11440128,11587584,1206272,28672,98560,98304,100608,100352,229376,0,0,0,0,0,281600,281600,281600,24576,69632,12288,8976,17168,1216,20848,156680,42528,42496,453632,33280,6199296,1161344,43136,9408,25856,16256,16256,0,0,0,4294967295,1,12288,1065353216,3584,688256,802944,917632,745600,860288,974976,1491072,200832,225920,251008,276096,11714560,11722752,11730944,11718656,11726848,11735040,11771904,11796480,11798528,11800576,11802624,905216,905344,925696
.long 116736,116864,57344,172032,3651584,3565568,11586560,11439104,11585536,11438080,11590656,11443200,11589632,11442176,1406976,28672,99072,98816,101120,100864,229376,0,0,0,0,0,367616,453632,539648,36864,79872,18432,8984,17176,1216,20856,157192,42544,42496,539648,33536,6346752,1168512,43200,9504,25984,0,0,0,0,0,4294967295,1,18432,1065353216,3584,1032320,1147008,1261696,1089664,1204352,1319040,1548416,301184,326272,351360,376448,11739136,11747328,11755520,11743232,11751424,11759616,11776000,11804672,11806720,11808768,11810816,955392,955520,936448
.long 2048,3072,43008,129024,655360,741376,671744,757760,673792,759808,6455296,6602752,6456320,6603776,2176,21504,180224,180736,114688,114944,172032,0,0,0,0,0,285184,285184,285184,0,49152,0,2176,13184,224,20896,182272,34560,33792,285184,32768,5908480,1376384,45056,10240,26624,16256,16256,16256,0,0,4294967295,1,0,1065353216,2688,128,114816,229504,57472,172160,286848,1376384,128,25216,50304,75392,12845056,12853248,12861440,12849152,12857344,12865536,12943360,12959744,12961792,12963840,12965888,77312,103424,560640
.long 88064,117760,43008,129024,743424,657408,761856,675840,763904,677888,6604800,6457344,6605824,6458368,152704,21504,182272,182784,115200,115456,172032,0,0,0,0,0,285184,285184,285184,12288,59392,6144,2184,13192,224,20904,182784,34576,33792,371200,33024,6055936,1383552,45120,10336,26752,16256,16256,16256,0,0,4294967295,1,6144,1065353216,2688,344192,458880,573568,401536,516224,630912,1433728,100480,125568,150656,175744,12869632,12877824,12886016,12873728,12881920,12890112,12947456,12967936,12969984,12972032,12974080,114944,153600,571392
.long 2176,3072,43008,129024,827392,913408,845824,931840,843776,929792,6751232,6898688,6750208,6897664,303232,21504,180736,180224,114944,114688,172032,0,0,0,0,0,285184,285184,285184,24576,69632,12288,2192,13200,224,20912,182280,34592,34304,457216,33280,6203392,1390720,45184,10432,26880,16256,16256,0,0,0,4294967295,1,12288,1065353216,2688,688256,802944,917632,745600,860288,974976,1491072,200832,225920,251008,276096,12894208,12902400,12910592,12898304,12906496,12914688,12951552,12976128,12978176,12980224,12982272,77440,103424,582144
.long 88192,117760,43008,129024,915456,829440,935936,849920,933888,847872,6900736,6753280,6899712,6752256,453760,21504,182784,182272,115456,115200,172032,0,0,0,0,0,371200,457216,543232,36864,79872,18432,2200,13208,224,20920,182792,34608,34304,543232,33536,6350848,1397888,45248,10528,27008,0,0,0,0,0,4294967295,1,18432,1065353216,2688,1032320,1147008,1261696,1089664,1204352,1319040,1548416,301184,326272,351360,376448,12918784,12926976,12935168,12922880,12931072,12939264,12955648,12984320,12986368,12988416,12990464,115072,153600,592896
.long 2048,3072,43008,129024,3407872,3493888,3424256,3510272,3426304,3512320,11173888,11321344,11174912,11322368,604288,21504,180224,180736,114688,114944,172032,0,0,0,0,0,288768,288768,288768,0,49152,0,3200,17280,1248,20960,183296,42752,41984,288768,32768,5912576,1605760,47104,11264,27648,16256,16256,16256,0,0,4294967295,1,0,1065353216,2688,128,114816,229504,57472,172160,286848,1376384,128,25216,50304,75392,14024704,14032896,14041088,14028800,14036992,14045184,14123008,14139392,14141440,14143488,14145536,679424,906240,904704
.long 88064,117760,43008,129024,3495936,3409920,3514368,3428352,3516416,3430400,11323392,11175936,11324416,11176960,754816,21504,182272,182784,115200,115456,172032,0,0,0,0,0,288768,288768,288768,12288,59392,6144,3208,17288,1248,20968,183808,42768,41984,374784,33024,6060032,1612928,47168,11360,27776,16256,16256,16256,0,0,4294967295,1,6144,1065353216,2688,344192,458880,573568,401536,516224,630912,1433728,100480,125568,150656,175744,14049280,14057472,14065664,14053376,14061568,14069760,14127104,14147584,14149632,14151680,14153728,717056,956416,915456
.long 2176,3072,43008,129024,3579904,3665920,3598336,3684352,3596288,3682304,11469824,11617280,11468800,11616256,905344,21504,180736,180224,114944,114688,172032,0,0,0,0,0,288768,288768,288768,24576,69632,12288,3216,17296,1248,20976,183304,42784,42496,460800,33280,6207488,1620096,47232,11456,27904,16256,16256,0,0,0,4294967295,1,12288,1065353216,2688,688256,802944,917632,745600,860288,974976,1491072,200832,225920,251008,276096,14073856,14082048,14090240,14077952,14086144,14094336,14131200,14155776,14157824,14159872,14161920,679552,906240,926208
.long 88192,117760,43008,129024,3667968,3581952,3688448,3602432,3686400,3600384,11619328,11471872,11618304,11470848,1055872,21504,182784,182272,115456,115200,172032,0,0,0,0,0,374784,460800,546816,36864,79872,18432,3224,17304,1248,20984,183816,42800,42496,546816,33536,6354944,1627264,47296,11552,28032,0,0,0,0,0,4294967295,1,18432,1065353216,2688,1032320,1147008,1261696,1089664,1204352,1319040,1548416,301184,326272,351360,376448,14098432,14106624,14114816,14102528,14110720,14118912,14135296,14163968,14166016,14168064,14170112,717184,956416,936960
.long 0,128,57344,172032,950272,1036288,6946816,7094272,6947840,7095296,6950912,7098368,6951936,7099392,128,28672,65536,65792,67584,67840,229376,0,0,0,0,0,262144,262144,262144,0,49152,0,5120,13312,256,20992,67584,34816,34816,606208,33792,6471680,256,32768,4096,20480,16256,16256,16256,1,4294967295,0,0,1544,1049336022,3584,256,114944,229632,57600,172288,286976,1376512,256,25344,50432,75520,5767168,5775360,5783552,5771264,5779456,5787648,5865472,5881856,5883904,5885952,5888000,200704,200832,602112
.long 114688,114816,57344,172032,1038336,952320,7096320,6948864,7097344,6949888,7100416,6952960,7101440,6953984,200832,28672,66048,66304,68096,68352,229376,0,0,0,0,0,262144,262144,348160,12288,59392,6144,5128,13320,256,21000,68096,34832,34816,692224,34048,6619136,7424,32832,4192,20608,16256,0,0,1,4294967295,0,0,7688,1049336022,3584,344320,459008,573696,401664,516352,631040,1433856,100608,125696,150784,175872,5791744,5799936,5808128,5795840,5804032,5812224,5869568,5890048,5892096,5894144,5896192,250880,251008,612864
.long 0,128,57344,172032,1122304,1208320,7242752,7390208,7241728,7389184,7246848,7394304,7245824,7393280,401536,28672,65792,65536,67840,67584,229376,0,0,0,0,0,434176,520192,606208,24576,69632,12288,5136,13328,256,21008,67592,34848,35328,778240,34304,6766592,14592,32896,4288,20736,0,0,0,1,4294967295,0,0,13832,1049336022,3584,688384,803072,917760,745728,860416,975104,1491200,200960,226048,251136,276224,5816320,5824512,5832704,5820416,5828608,5836800,5873664,5898240,5900288,5902336,5904384,200704,200832,623616
.long 114688,114816,57344,172032,1210368,1124352,7392256,7244800,7391232,7243776,7396352,7248896,7395328,7247872,602240,28672,66304,66048,68352,68096,229376,0,0,0,0,0,692224,778240,864256,36864,79872,18432,5144,13336,256,21016,68104,34864,35328,864256,34560,6914048,21760,32960,4384,20864,0,0,0,1,4294967295,0,0,19976,1049336022,3584,1032448,1147136,1261824,1089792,1204480,1319168,1548544,301312,326400,351488,376576,5840896,5849088,5857280,5844992,5853184,5861376,5877760,5906432,5908480,5910528,5912576,250880,251008,634368
.long 0,128,57344,172032,3702784,3788800,11665408,11812864,11666432,11813888,11669504,11816960,11670528,11817984,802944,28672,65536,65792,67584,67840,229376,0,0,0,0,0,265728,265728,265728,0,49152,0,9216,17408,1280,21056,68608,43008,43008,609792,33792,6475776,229632,34816,5120,21504,16256,16256,16256,1,4294967295,0,0,1544,1049336022,3584,256,114944,229632,57600,172288,286976,1376512,256,25344,50432,75520,6946816,6955008,6963200,6950912,6959104,6967296,7045120,7061504,7063552,7065600,7067648,1003520,1003648,946176
.long 114688,114816,57344,172032,3790848,3704832,11814912,11667456,11815936,11668480,11819008,11671552,11820032,11672576,1003648,28672,66048,66304,68096,68352,229376,0,0,0,0,0,265728,265728,351744,12288,59392,6144,9224,17416,1280,21064,69120,43024,43008,695808,34048,6623232,236800,34880,5216,21632,16256,0,0,1,4294967295,0,0,7688,1049336022,3584,344320,459008,573696,401664,516352,631040,1433856,100608,125696,150784,175872,6971392,6979584,6987776,6975488,6983680,6991872,7049216,7069696,7071744,7073792,7075840,1053696,1053824,956928
.long 0,128,57344,172032,3874816,3960832,11961344,12108800,11960320,12107776,11965440,12112896,11964416,12111872,1204352,28672,65792,65536,67840,67584,229376,0,0,0,0,0,437760,523776,609792,24576,69632,12288,9232,17424,1280,21072,68616,43040,43520,781824,34304,6770688,243968,34944,5312,21760,0,0,0,1,4294967295,0,0,13832,1049336022,3584,688384,803072,917760,745728,860416,975104,1491200,200960,226048,251136,276224,6995968,7004160,7012352,7000064,7008256,7016448,7053312,7077888,7079936,7081984,7084032,1003520,1003648,967680
.long 114688,114816,57344,172032,3962880,3876864,12110848,11963392,12109824,11962368,12114944,11967488,12113920,11966464,1405056,28672,66304,66048,68352,68096,229376,0,0,0,0,0,695808,781824,867840,36864,79872,18432,9240,17432,1280,21080,69128,43056,43520,867840,34560,6918144,251136,35008,5408,21888,0,0,0,1,4294967295,0,0,19976,1049336022,3584,1032448,1147136,1261824,1089792,1204480,1319168,1548544,301312,326400,351488,376576,7020544,7028736,7036928,7024640,7032832,7041024,7057408,7086080,7088128,7090176,7092224,1053696,1053824,978432
.long 1024,1152,57344,172032,966656,1052672,6979584,7127040,6980608,7128064,6983680,7131136,6984704,7132160,1152,28672,81920,82176,83968,84224,229376,0,0,0,0,0,269312,269312,269312,0,49152,0,5248,13440,288,21120,83968,35072,34816,613376,33792,6479872,459008,36864,6144,22528,16256,16256,16256,1,4294967295,0,0,1544,1049336022,3584,256,114944,229632,57600,172288,286976,1376512,256,25344,50432,75520,8126464,8134656,8142848,8130560,8138752,8146944,8224768,8241152,8243200,8245248,8247296,201728,201856,602624
.long 115712,115840,57344,172032,1054720,968704,7129088,6981632,7130112,6982656,7133184,6985728,7134208,6986752,201856,28672,82432,82688,84480,84736,229376,0,0,0,0,0,269312,269312,355328,12288,59392,6144,5256,13448,288,21128,84480,35088,34816,699392,34048,6627328,466176,36928,6240,22656,16256,0,0,1,4294967295,0,0,7688,1049336022,3584,344320,459008,573696,401664,516352,631040,1433856,100608,125696,150784,175872,8151040,8159232,8167424,8155136,8163328,8171520,8228864,8249344,8251392,8253440,8255488,251904,252032,613376
.long 1024,1152,57344,172032,1138688,1224704,7275520,7422976,7274496,7421952,7279616,7427072,7278592,7426048,402560,28672,82176,81920,84224,83968,229376,0,0,0,0,0,441344,527360,613376,24576,69632,12288,5264,13456,288,21136,83976,35104,35328,785408,34304,6774784,473344,36992,6336,22784,0,0,0,1,4294967295,0,0,13832,1049336022,3584,688384,803072,917760,745728,860416,975104,1491200,200960,226048,251136,276224,8175616,8183808,8192000,8179712,8187904,8196096,8232960,8257536,8259584,8261632,8263680,201728,201856,624128
.long 115712,115840,57344,172032,1226752,1140736,7425024,7277568,7424000,7276544,7429120,7281664,7428096,7280640,603264,28672,82688,82432,84736,84480,229376,0,0,0,0,0,699392,785408,871424,36864,79872,18432,5272,13464,288,21144,84488,35120,35328,871424,34560,6922240,480512,37056,6432,22912,0,0,0,1,4294967295,0,0,19976,1049336022,3584,1032448,1147136,1261824,1089792,1204480,1319168,1548544,301312,326400,351488,376576,8200192,8208384,8216576,8204288,8212480,8220672,8237056,8265728,8267776,8269824,8271872,251904,252032,634880
.long 1024,1152,57344,172032,3719168,3805184,11698176,11845632,11699200,11846656,11702272,11849728,11703296,11850752,803968,28672,81920,82176,83968,84224,229376,0,0,0,0,0,272896,272896,272896,0,49152,0,9344,17536,1312,21184,84992,43264,43008,616960,33792,6483968,688384,38912,7168,23552,16256,16256,16256,1,4294967295,0,0,1544,1049336022,3584,256,114944,229632,57600,172288,286976,1376512,256,25344,50432,75520,9306112,9314304,9322496,9310208,9318400,9326592,9404416,9420800,9422848,9424896,9426944,1004544,1004672,946688
.long 115712,115840,57344,172032,3807232,3721216,11847680,11700224,11848704,11701248,11851776,11704320,11852800,11705344,1004672,28672,82432,82688,84480,84736,229376,0,0,0,0,0,272896,272896,358912,12288,59392,6144,9352,17544,1312,21192,85504,43280,43008,702976,34048,6631424,695552,38976,7264,23680,16256,0,0,1,4294967295,0,0,7688,1049336022,3584,344320,459008,573696,401664,516352,631040,1433856,100608,125696,150784,175872,9330688,9338880,9347072,9334784,9342976,9351168,9408512,9428992,9431040,9433088,9435136,1054720,1054848,957440
.long 1024,1152,57344,172032,3891200,3977216,11994112,12141568,11993088,12140544,11998208,12145664,11997184,12144640,1205376,28672,82176,81920,84224,83968,229376,0,0,0,0,0,444928,530944,616960,24576,69632,12288,9360,17552,1312,21200,85000,43296,43520,788992,34304,6778880,702720,39040,7360,23808,0,0,0,1,4294967295,0,0,13832,1049336022,3584,688384,803072,917760,745728,860416,975104,1491200,200960,226048,251136,276224,9355264,9363456,9371648,9359360,9367552,9375744,9412608,9437184,9439232,9441280,9443328,1004544,1004672,968192
.long 115712,115840,57344,172032,3979264,3893248,12143616,11996160,12142592,11995136,12147712,12000256,12146688,11999232,1406080,28672,82688,82432,84736,84480,229376,0,0,0,0,0,702976,788992,875008,36864,79872,18432,9368,17560,1312,21208,85512,43312,43520,875008,34560,6926336,709888,39104,7456,23936,0,0,0,1,4294967295,0,0,19976,1049336022,3584,1032448,1147136,1261824,1089792,1204480,1319168,1548544,301312,326400,351488,376576,9379840,9388032,9396224,9383936,9392128,9400320,9416704,9445376,9447424,9449472,9451520,1054720,1054848,978944
.long 2048,2176,57344,172032,983040,1069056,7012352,7159808,7013376,7160832,7016448,7163904,7017472,7164928,2176,28672,98304,98560,100352,100608,229376,0,0,0,0,0,276480,276480,276480,0,49152,0,5376,13568,320,21248,100352,35328,34816,620544,33792,6488064,917760,40960,8192,24576,16256,16256,16256,1,4294967295,0,0,1544,1065353216,3584,256,114944,229632,57600,172288,286976,1376512,256,25344,50432,75520,10485760,10493952,10502144,10489856,10498048,10506240,10584064,10600448,10602496,10604544,10606592,202752,202880,603136
.long 116736,116864,57344,172032,1071104,985088,7161856,7014400,7162880,7015424,7165952,7018496,7166976,7019520,202880,28672,98816,99072,100864,101120,229376,0,0,0,0,0,276480,276480,362496,12288,59392,6144,5384,13576,320,21256,100864,35344,34816,706560,34048,6635520,924928,41024,8288,24704,16256,0,0,1,4294967295,0,0,7688,1065353216,3584,344320,459008,573696,401664,516352,631040,1433856,100608,125696,150784,175872,10510336,10518528,10526720,10514432,10522624,10530816,10588160,10608640,10610688,10612736,10614784,252928,253056,613888
.long 2048,2176,57344,172032,1155072,1241088,7308288,7455744,7307264,7454720,7312384,7459840,7311360,7458816,403584,28672,98560,98304,100608,100352,229376,0,0,0,0,0,448512,534528,620544,24576,69632,12288,5392,13584,320,21264,100360,35360,35328,792576,34304,6782976,932096,41088,8384,24832,0,0,0,1,4294967295,0,0,13832,1065353216,3584,688384,803072,917760,745728,860416,975104,1491200,200960,226048,251136,276224,10534912,10543104,10551296,10539008,10547200,10555392,10592256,10616832,10618880,10620928,10622976,202752,202880,624640
.long 116736,116864,57344,172032,1243136,1157120,7457792,7310336,7456768,7309312,7461888,7314432,7460864,7313408,604288,28672,99072,98816,101120,100864,229376,0,0,0,0,0,706560,792576,878592,36864,79872,18432,5400,13592,320,21272,100872,35376,35328,878592,34560,6930432,939264,41152,8480,24960,0,0,0,1,4294967295,0,0,19976,1065353216,3584,1032448,1147136,1261824,1089792,1204480,1319168,1548544,301312,326400,351488,376576,10559488,10567680,10575872,10563584,10571776,10579968,10596352,10625024,10627072,10629120,10631168,252928,253056,635392
.long 2048,2176,57344,172032,3735552,3821568,11730944,11878400,11731968,11879424,11735040,11882496,11736064,11883520,804992,28672,98304,98560,100352,100608,229376,0,0,0,0,0,280064,280064,280064,0,49152,0,9472,17664,1344,21312,101376,43520,43008,624128,33792,6492160,1147136,43008,9216,25600,16256,16256,16256,1,4294967295,0,0,1544,1065353216,3584,256,114944,229632,57600,172288,286976,1376512,256,25344,50432,75520,11665408,11673600,11681792,11669504,11677696,11685888,11763712,11780096,11782144,11784192,11786240,1005568,1005696,947200
.long 116736,116864,57344,172032,3823616,3737600,11880448,11732992,11881472,11734016,11884544,11737088,11885568,11738112,1005696,28672,98816,99072,100864,101120,229376,0,0,0,0,0,280064,280064,366080,12288,59392,6144,9480,17672,1344,21320,101888,43536,43008,710144,34048,6639616,1154304,43072,9312,25728,16256,0,0,1,4294967295,0,0,7688,1065353216,3584,344320,459008,573696,401664,516352,631040,1433856,100608,125696,150784,175872,11689984,11698176,11706368,11694080,11702272,11710464,11767808,11788288,11790336,11792384,11794432,1055744,1055872,957952
.long 2048,2176,57344,172032,3907584,3993600,12026880,12174336,12025856,12173312,12030976,12178432,12029952,12177408,1206400,28672,98560,98304,100608,100352,229376,0,0,0,0,0,452096,538112,624128,24576,69632,12288,9488,17680,1344,21328,101384,43552,43520,796160,34304,6787072,1161472,43136,9408,25856,0,0,0,1,4294967295,0,0,13832,1065353216,3584,688384,803072,917760,745728,860416,975104,1491200,200960,226048,251136,276224,11714560,11722752,11730944,11718656,11726848,11735040,11771904,11796480,11798528,11800576,11802624,1005568,1005696,968704
.long 116736,116864,57344,172032,3995648,3909632,12176384,12028928,12175360,12027904,12180480,12033024,12179456,12032000,1407104,28672,99072,98816,101120,100864,229376,0,0,0,0,0,710144,796160,882176,36864,79872,18432,9496,17688,1344,21336,101896,43568,43520,882176,34560,6934528,1168640,43200,9504,25984,0,0,0,1,4294967295,0,0,19976,1065353216,3584,1032448,1147136,1261824,1089792,1204480,1319168,1548544,301312,326400,351488,376576,11739136,11747328,11755520,11743232,11751424,11759616,11776000,11804672,11806720,11808768,11810816,1055744,1055872,979456
.long 2048,3072,43008,129024,999424,1085440,1015808,1101824,1017856,1103872,7045120,7192576,7046144,7193600,3072,28672,180224,180736,114688,114944,172032,0,0,0,0,0,283648,283648,283648,0,49152,0,2304,13696,352,21376,114688,35584,34816,627712,33792,6496256,1376512,45056,10240,26624,16256,16256,16256,1,4294967295,0,0,1544,1065353216,2688,256,114944,229632,57600,172288,286976,1376512,256,25344,50432,75520,12845056,12853248,12861440,12849152,12857344,12865536,12943360,12959744,12961792,12963840,12965888,152576,203776,603648
.long 88064,117760,43008,129024,1087488,1001472,1105920,1019904,1107968,1021952,7194624,7047168,7195648,7048192,203776,28672,182272,182784,115200,115456,172032,0,0,0,0,0,283648,283648,369664,12288,59392,6144,2312,13704,352,21384,115200,35600,34816,713728,34048,6643712,1383680,45120,10336,26752,16256,0,0,1,4294967295,0,0,7688,1065353216,2688,344320,459008,573696,401664,516352,631040,1433856,100608,125696,150784,175872,12869632,12877824,12886016,12873728,12881920,12890112,12947456,12967936,12969984,12972032,12974080,190208,253952,614400
.long 2176,3072,43008,129024,1171456,1257472,1189888,1275904,1187840,1273856,7341056,7488512,7340032,7487488,404480,28672,180736,180224,114944,114688,172032,0,0,0,0,0,455680,541696,627712,24576,69632,12288,2320,13712,352,21392,114696,35616,35328,799744,34304,6791168,1390848,45184,10432,26880,0,0,0,1,4294967295,0,0,13832,1065353216,2688,688384,803072,917760,745728,860416,975104,1491200,200960,226048,251136,276224,12894208,12902400,12910592,12898304,12906496,12914688,12951552,12976128,12978176,12980224,12982272,152704,203776,625152
.long 88192,117760,43008,129024,1259520,1173504,1280000,1193984,1277952,1191936,7490560,7343104,7489536,7342080,605184,28672,182784,182272,115456,115200,172032,0,0,0,0,0,713728,799744,885760,36864,79872,18432,2328,13720,352,21400,115208,35632,35328,885760,34560,6938624,1398016,45248,10528,27008,0,0,0,1,4294967295,0,0,19976,1065353216,2688,1032448,1147136,1261824,1089792,1204480,1319168,1548544,301312,326400,351488,376576,12918784,12926976,12935168,12922880,12931072,12939264,12955648,12984320,12986368,12988416,12990464,190336,253952,635904
.long 2048,3072,43008,129024,3751936,3837952,3768320,3854336,3770368,3856384,11763712,11911168,11764736,11912192,805888,28672,180224,180736,114688,114944,172032,0,0,0,0,0,287232,287232,287232,0,49152,0,3328,17792,1376,21440,115712,43776,43008,631296,33792,6500352,1605888,47104,11264,27648,16256,16256,16256,1,4294967295,0,0,1544,1065353216,2688,256,114944,229632,57600,172288,286976,1376512,256,25344,50432,75520,14024704,14032896,14041088,14028800,14036992,14045184,14123008,14139392,14141440,14143488,14145536,754688,1006592,947712
.long 88064,117760,43008,129024,3840000,3753984,3858432,3772416,3860480,3774464,11913216,11765760,11914240,11766784,1006592,28672,182272,182784,115200,115456,172032,0,0,0,0,0,287232,287232,373248,12288,59392,6144,3336,17800,1376,21448,116224,43792,43008,717312,34048,6647808,1613056,47168,11360,27776,16256,0,0,1,4294967295,0,0,7688,1065353216,2688,344320,459008,573696,401664,516352,631040,1433856,100608,125696,150784,175872,14049280,14057472,14065664,14053376,14061568,14069760,14127104,14147584,14149632,14151680,14153728,792320,1056768,958464
.long 2176,3072,43008,129024,3923968,4009984,3942400,4028416,3940352,4026368,12059648,12207104,12058624,12206080,1207296,28672,180736,180224,114944,114688,172032,0,0,0,0,0,459264,545280,631296,24576,69632,12288,3344,17808,1376,21456,115720,43808,43520,803328,34304,6795264,1620224,47232,11456,27904,0,0,0,1,4294967295,0,0,13832,1065353216,2688,688384,803072,917760,745728,860416,975104,1491200,200960,226048,251136,276224,14073856,14082048,14090240,14077952,14086144,14094336,14131200,14155776,14157824,14159872,14161920,754816,1006592,969216
.long 88192,117760,43008,129024,4012032,3926016,4032512,3946496,4030464,3944448,12209152,12061696,12208128,12060672,1408000,28672,182784,182272,115456,115200,172032,0,0,0,0,0,717312,803328,889344,36864,79872,18432,3352,17816,1376,21464,116232,43824,43520,889344,34560,6942720,1627392,47296,11552,28032,0,0,0,1,4294967295,0,0,19976,1065353216,2688,1032448,1147136,1261824,1089792,1204480,1319168,1548544,301312,326400,351488,376576,14098432,14106624,14114816,14102528,14110720,14118912,14135296,14163968,14166016,14168064,14170112,792448,1056768,979968
.long 0,128,57344,172032,1294336,1380352,7536640,7684096,7537664,7685120,7540736,7688192,7541760,7689216,128,28672,65536,65792,67584,67840,229376,0,0,0,0,0,263680,263680,263680,0,49152,0,5632,13824,384,21024,124928,35840,35840,607744,33792,6473728,384,32768,4096,20480,16256,16256,16256,1,0,4294967295,1,0,1049336022,3584,384,115072,229760,57728,172416,287104,1376640,384,25472,50560,75648,5767168,5775360,5783552,5771264,5779456,5787648,5865472,5881856,5883904,5885952,5888000,301056,301184,645120
.long 114688,114816,57344,172032,1382400,1296384,7686144,7538688,7687168,7539712,7690240,7542784,7691264,7543808,200832,28672,66048,66304,68096,68352,229376,0,0,0,0,0,263680,263680,349696,12288,59392,6144,5640,13832,384,21032,125440,35856,35840,693760,34048,6621184,7552,32832,4192,20608,16256,0,0,1,0,4294967295,1,6144,1049336022,3584,344448,459136,573824,401792,516480,631168,1433984,100736,125824,150912,176000,5791744,5799936,5808128,5795840,5804032,5812224,5869568,5890048,5892096,5894144,5896192,351232,351360,655872
.long 0,128,57344,172032,1466368,1552384,7832576,7980032,7831552,7979008,7836672,7984128,7835648,7983104,401536,28672,65792,65536,67840,67584,229376,0,0,0,0,0,435712,521728,607744,24576,69632,12288,5648,13840,384,21040,124936,35872,36352,779776,34304,6768640,14720,32896,4288,20736,0,0,0,1,0,4294967295,1,12288,1049336022,3584,688512,803200,917888,745856,860544,975232,1491328,201088,226176,251264,276352,5816320,5824512,5832704,5820416,5828608,5836800,5873664,5898240,5900288,5902336,5904384,301056,301184,666624
.long 114688,114816,57344,172032,1554432,1468416,7982080,7834624,7981056,7833600,7986176,7838720,7985152,7837696,602240,28672,66304,66048,68352,68096,229376,0,0,0,0,0,693760,779776,865792,36864,79872,18432,5656,13848,384,21048,125448,35888,36352,865792,34560,6916096,21888,32960,4384,20864,0,0,0,1,0,4294967295,1,18432,1049336022,3584,1032576,1147264,1261952,1089920,1204608,1319296,1548672,301440,326528,351616,376704,5840896,5849088,5857280,5844992,5853184,5861376,5877760,5906432,5908480,5910528,5912576,351232,351360,677376
.long 0,128,57344,172032,4046848,4132864,12255232,12402688,12256256,12403712,12259328,12406784,12260352,12407808,802944,28672,65536,65792,67584,67840,229376,0,0,0,0,0,267264,267264,267264,0,49152,0,9728,17920,1408,21088,125952,44032,44032,611328,33792,6477824,229760,34816,5120,21504,16256,16256,16256,1,0,4294967295,1,0,1049336022,3584,384,115072,229760,57728,172416,287104,1376640,384,25472,50560,75648,6946816,6955008,6963200,6950912,6959104,6967296,7045120,7061504,7063552,7065600,7067648,1103872,1104000,989184
.long 114688,114816,57344,172032,4134912,4048896,12404736,12257280,12405760,12258304,12408832,12261376,12409856,12262400,1003648,28672,66048,66304,68096,68352,229376,0,0,0,0,0,267264,267264,353280,12288,59392,6144,9736,17928,1408,21096,126464,44048,44032,697344,34048,6625280,236928,34880,5216,21632,16256,0,0,1,0,4294967295,1,6144,1049336022,3584,344448,459136,573824,401792,516480,631168,1433984,100736,125824,150912,176000,6971392,6979584,6987776,6975488,6983680,6991872,7049216,7069696,7071744,7073792,7075840,1154048,1154176,999936
.long 0,128,57344,172032,4218880,4304896,12551168,12698624,12550144,12697600,12555264,12702720,12554240,12701696,1204352,28672,65792,65536,67840,67584,229376,0,0,0,0,0,439296,525312,611328,24576,69632,12288,9744,17936,1408,21104,125960,44064,44544,783360,34304,6772736,244096,34944,5312,21760,0,0,0,1,0,4294967295,1,12288,1049336022,3584,688512,803200,917888,745856,860544,975232,1491328,201088,226176,251264,276352,6995968,7004160,7012352,7000064,7008256,7016448,7053312,7077888,7079936,7081984,7084032,1103872,1104000,1010688
.long 114688,114816,57344,172032,4306944,4220928,12700672,12553216,12699648,12552192,12704768,12557312,12703744,12556288,1405056,28672,66304,66048,68352,68096,229376,0,0,0,0,0,697344,783360,869376,36864,79872,18432,9752,17944,1408,21112,126472,44080,44544,869376,34560,6920192,251264,35008,5408,21888,0,0,0,1,0,4294967295,1,18432,1049336022,3584,1032576,1147264,1261952,1089920,1204608,1319296,1548672,301440,326528,351616,376704,7020544,7028736,7036928,7024640,7032832,7041024,7057408,7086080,7088128,7090176,7092224,1154048,1154176,1021440
.long 1024,1152,57344,172032,1310720,1396736,7569408,7716864,7570432,7717888,7573504,7720960,7574528,7721984,1152,28672,81920,82176,83968,84224,229376,0,0,0,0,0,270848,270848,270848,0,49152,0,5760,13952,416,21152,141312,36096,35840,614912,33792,6481920,459136,36864,6144,22528,16256,16256,16256,1,0,4294967295,1,0,1049336022,3584,384,115072,229760,57728,172416,287104,1376640,384,25472,50560,75648,8126464,8134656,8142848,8130560,8138752,8146944,8224768,8241152,8243200,8245248,8247296,302080,302208,645632
.long 115712,115840,57344,172032,1398784,1312768,7718912,7571456,7719936,7572480,7723008,7575552,7724032,7576576,201856,28672,82432,82688,84480,84736,229376,0,0,0,0,0,270848,270848,356864,12288,59392,6144,5768,13960,416,21160,141824,36112,35840,700928,34048,6629376,466304,36928,6240,22656,16256,0,0,1,0,4294967295,1,6144,1049336022,3584,344448,459136,573824,401792,516480,631168,1433984,100736,125824,150912,176000,8151040,8159232,8167424,8155136,8163328,8171520,8228864,8249344,8251392,8253440,8255488,352256,352384,656384
.long 1024,1152,57344,172032,1482752,1568768,7865344,8012800,7864320,8011776,7869440,8016896,7868416,8015872,402560,28672,82176,81920,84224,83968,229376,0,0,0,0,0,442880,528896,614912,24576,69632,12288,5776,13968,416,21168,141320,36128,36352,786944,34304,6776832,473472,36992,6336,22784,0,0,0,1,0,4294967295,1,12288,1049336022,3584,688512,803200,917888,745856,860544,975232,1491328,201088,226176,251264,276352,8175616,8183808,8192000,8179712,8187904,8196096,8232960,8257536,8259584,8261632,8263680,302080,302208,667136
.long 115712,115840,57344,172032,1570816,1484800,8014848,7867392,8013824,7866368,8018944,7871488,8017920,7870464,603264,28672,82688,82432,84736,84480,229376,0,0,0,0,0,700928,786944,872960,36864,79872,18432,5784,13976,416,21176,141832,36144,36352,872960,34560,6924288,480640,37056,6432,22912,0,0,0,1,0,4294967295,1,18432,1049336022,3584,1032576,1147264,1261952,1089920,1204608,1319296,1548672,301440,326528,351616,376704,8200192,8208384,8216576,8204288,8212480,8220672,8237056,8265728,8267776,8269824,8271872,352256,352384,677888
.long 1024,1152,57344,172032,4063232,4149248,12288000,12435456,12289024,12436480,12292096,12439552,12293120,12440576,803968,28672,81920,82176,83968,84224,229376,0,0,0,0,0,274432,274432,274432,0,49152,0,9856,18048,1440,21216,142336,44288,44032,618496,33792,6486016,688512,38912,7168,23552,16256,16256,16256,1,0,4294967295,1,0,1049336022,3584,384,115072,229760,57728,172416,287104,1376640,384,25472,50560,75648,9306112,9314304,9322496,9310208,9318400,9326592,9404416,9420800,9422848,9424896,9426944,1104896,1105024,989696
.long 115712,115840,57344,172032,4151296,4065280,12437504,12290048,12438528,12291072,12441600,12294144,12442624,12295168,1004672,28672,82432,82688,84480,84736,229376,0,0,0,0,0,274432,274432,360448,12288,59392,6144,9864,18056,1440,21224,142848,44304,44032,704512,34048,6633472,695680,38976,7264,23680,16256,0,0,1,0,4294967295,1,6144,1049336022,3584,344448,459136,573824,401792,516480,631168,1433984,100736,125824,150912,176000,9330688,9338880,9347072,9334784,9342976,9351168,9408512,9428992,9431040,9433088,9435136,1155072,1155200,1000448
.long 1024,1152,57344,172032,4235264,4321280,12583936,12731392,12582912,12730368,12588032,12735488,12587008,12734464,1205376,28672,82176,81920,84224,83968,229376,0,0,0,0,0,446464,532480,618496,24576,69632,12288,9872,18064,1440,21232,142344,44320,44544,790528,34304,6780928,702848,39040,7360,23808,0,0,0,1,0,4294967295,1,12288,1049336022,3584,688512,803200,917888,745856,860544,975232,1491328,201088,226176,251264,276352,9355264,9363456,9371648,9359360,9367552,9375744,9412608,9437184,9439232,9441280,9443328,1104896,1105024,1011200
.long 115712,115840,57344,172032,4323328,4237312,12733440,12585984,12732416,12584960,12737536,12590080,12736512,12589056,1406080,28672,82688,82432,84736,84480,229376,0,0,0,0,0,704512,790528,876544,36864,79872,18432,9880,18072,1440,21240,142856,44336,44544,876544,34560,6928384,710016,39104,7456,23936,0,0,0,1,0,4294967295,1,18432,1049336022,3584,1032576,1147264,1261952,1089920,1204608,1319296,1548672,301440,326528,351616,376704,9379840,9388032,9396224,9383936,9392128,9400320,9416704,9445376,9447424,9449472,9451520,1155072,1155200,1021952
.long 2048,2176,57344,172032,1327104,1413120,7602176,7749632,7603200,7750656,7606272,7753728,7607296,7754752,2176,28672,98304,98560,100352,100608,229376,0,0,0,0,0,278016,278016,278016,0,49152,0,5888,14080,448,21280,157696,36352,35840,622080,33792,6490112,917888,40960,8192,24576,16256,16256,16256,1,0,4294967295,1,0,1065353216,3584,384,115072,229760,57728,172416,287104,1376640,384,25472,50560,75648,10485760,10493952,10502144,10489856,10498048,10506240,10584064,10600448,10602496,10604544,10606592,303104,303232,646144
.long 116736,116864,57344,172032,1415168,1329152,7751680,7604224,7752704,7605248,7755776,7608320,7756800,7609344,202880,28672,98816,99072,100864,101120,229376,0,0,0,0,0,278016,278016,364032,12288,59392,6144,5896,14088,448,21288,158208,36368,35840,708096,34048,6637568,925056,41024,8288,24704,16256,0,0,1,0,4294967295,1,6144,1065353216,3584,344448,459136,573824,401792,516480,631168,1433984,100736,125824,150912,176000,10510336,10518528,10526720,10514432,10522624,10530816,10588160,10608640,10610688,10612736,10614784,353280,353408,656896
.long 2048,2176,57344,172032,1499136,1585152,7898112,8045568,7897088,8044544,7902208,8049664,7901184,8048640,403584,28672,98560,98304,100608,100352,229376,0,0,0,0,0,450048,536064,622080,24576,69632,12288,5904,14096,448,21296,157704,36384,36352,794112,34304,6785024,932224,41088,8384,24832,0,0,0,1,0,4294967295,1,12288,1065353216,3584,688512,803200,917888,745856,860544,975232,1491328,201088,226176,251264,276352,10534912,10543104,10551296,10539008,10547200,10555392,10592256,10616832,10618880,10620928,10622976,303104,303232,667648
.long 116736,116864,57344,172032,1587200,1501184,8047616,7900160,8046592,7899136,8051712,7904256,8050688,7903232,604288,28672,99072,98816,101120,100864,229376,0,0,0,0,0,708096,794112,880128,36864,79872,18432,5912,14104,448,21304,158216,36400,36352,880128,34560,6932480,939392,41152,8480,24960,0,0,0,1,0,4294967295,1,18432,1065353216,3584,1032576,1147264,1261952,1089920,1204608,1319296,1548672,301440,326528,351616,376704,10559488,10567680,10575872,10563584,10571776,10579968,10596352,10625024,10627072,10629120,10631168,353280,353408,678400
.long 2048,2176,57344,172032,4079616,4165632,12320768,12468224,12321792,12469248,12324864,12472320,12325888,12473344,804992,28672,98304,98560,100352,100608,229376,0,0,0,0,0,281600,281600,281600,0,49152,0,9984,18176,1472,21344,158720,44544,44032,625664,33792,6494208,1147264,43008,9216,25600,16256,16256,16256,1,0,4294967295,1,0,1065353216,3584,384,115072,229760,57728,172416,287104,1376640,384,25472,50560,75648,11665408,11673600,11681792,11669504,11677696,11685888,11763712,11780096,11782144,11784192,11786240,1105920,1106048,990208
.long 116736,116864,57344,172032,4167680,4081664,12470272,12322816,12471296,12323840,12474368,12326912,12475392,12327936,1005696,28672,98816,99072,100864,101120,229376,0,0,0,0,0,281600,281600,367616,12288,59392,6144,9992,18184,1472,21352,159232,44560,44032,711680,34048,6641664,1154432,43072,9312,25728,16256,0,0,1,0,4294967295,1,6144,1065353216,3584,344448,459136,573824,401792,516480,631168,1433984,100736,125824,150912,176000,11689984,11698176,11706368,11694080,11702272,11710464,11767808,11788288,11790336,11792384,11794432,1156096,1156224,1000960
.long 2048,2176,57344,172032,4251648,4337664,12616704,12764160,12615680,12763136,12620800,12768256,12619776,12767232,1206400,28672,98560,98304,100608,100352,229376,0,0,0,0,0,453632,539648,625664,24576,69632,12288,10000,18192,1472,21360,158728,44576,44544,797696,34304,6789120,1161600,43136,9408,25856,0,0,0,1,0,4294967295,1,12288,1065353216,3584,688512,803200,917888,745856,860544,975232,1491328,201088,226176,251264,276352,11714560,11722752,11730944,11718656,11726848,11735040,11771904,11796480,11798528,11800576,11802624,1105920,1106048,1011712
.long 116736,116864,57344,172032,4339712,4253696,12766208,12618752,12765184,12617728,12770304,12622848,12769280,12621824,1407104,28672,99072,98816,101120,100864,229376,0,0,0,0,0,711680,797696,883712,36864,79872,18432,10008,18200,1472,21368,159240,44592,44544,883712,34560,6936576,1168768,43200,9504,25984,0,0,0,1,0,4294967295,1,18432,1065353216,3584,1032576,1147264,1261952,1089920,1204608,1319296,1548672,301440,326528,351616,376704,11739136,11747328,11755520,11743232,11751424,11759616,11776000,11804672,11806720,11808768,11810816,1156096,1156224,1022464
.long 2048,3072,43008,129024,1343488,1429504,1359872,1445888,1361920,1447936,7634944,7782400,7635968,7783424,3072,28672,180224,180736,114688,114944,172032,0,0,0,0,0,285184,285184,285184,0,49152,0,2432,14208,480,21408,172032,36608,35840,629248,33792,6498304,1376640,45056,10240,26624,16256,16256,16256,1,0,4294967295,1,0,1065353216,2688,384,115072,229760,57728,172416,287104,1376640,384,25472,50560,75648,12845056,12853248,12861440,12849152,12857344,12865536,12943360,12959744,12961792,12963840,12965888,227840,304128,646656
.long 88064,117760,43008,129024,1431552,1345536,1449984,1363968,1452032,1366016,7784448,7636992,7785472,7638016,203776,28672,182272,182784,115200,115456,172032,0,0,0,0,0,285184,285184,371200,12288,59392,6144,2440,14216,480,21416,172544,36624,35840,715264,34048,6645760,1383808,45120,10336,26752,16256,0,0,1,0,4294967295,1,6144,1065353216,2688,344448,459136,573824,401792,516480,631168,1433984,100736,125824,150912,176000,12869632,12877824,12886016,12873728,12881920,12890112,12947456,12967936,12969984,12972032,12974080,265472,354304,657408
.long 2176,3072,43008,129024,1515520,1601536,1533952,1619968,1531904,1617920,7930880,8078336,7929856,8077312,404480,28672,180736,180224,114944,114688,172032,0,0,0,0,0,457216,543232,629248,24576,69632,12288,2448,14224,480,21424,172040,36640,36352,801280,34304,6793216,1390976,45184,10432,26880,0,0,0,1,0,4294967295,1,12288,1065353216,2688,688512,803200,917888,745856,860544,975232,1491328,201088,226176,251264,276352,12894208,12902400,12910592,12898304,12906496,12914688,12951552,12976128,12978176,12980224,12982272,227968,304128,668160
.long 88192,117760,43008,129024,1603584,1517568,1624064,1538048,1622016,1536000,8080384,7932928,8079360,7931904,605184,28672,182784,182272,115456,115200,172032,0,0,0,0,0,715264,801280,887296,36864,79872,18432,2456,14232,480,21432,172552,36656,36352,887296,34560,6940672,1398144,45248,10528,27008,0,0,0,1,0,4294967295,1,18432,1065353216,2688,1032576,1147264,1261952,1089920,1204608,1319296,1548672,301440,326528,351616,376704,12918784,12926976,12935168,12922880,12931072,12939264,12955648,12984320,12986368,12988416,12990464,265600,354304,678912
.long 2048,3072,43008,129024,4096000,4182016,4112384,4198400,4114432,4200448,12353536,12500992,12354560,12502016,805888,28672,180224,180736,114688,114944,172032,0,0,0,0,0,288768,288768,288768,0,49152,0,3456,18304,1504,21472,173056,44800,44032,632832,33792,6502400,1606016,47104,11264,27648,16256,16256,16256,1,0,4294967295,1,0,1065353216,2688,384,115072,229760,57728,172416,287104,1376640,384,25472,50560,75648,14024704,14032896,14041088,14028800,14036992,14045184,14123008,14139392,14141440,14143488,14145536,829952,1106944,990720
.long 88064,117760,43008,129024,4184064,4098048,4202496,4116480,4204544,4118528,12503040,12355584,12504064,12356608,1006592,28672,182272,182784,115200,115456,172032,0,0,0,0,0,288768,288768,374784,12288,59392,6144,3464,18312,1504,21480,173568,44816,44032,718848,34048,6649856,1613184,47168,11360,27776,16256,0,0,1,0,4294967295,1,6144,1065353216,2688,344448,459136,573824,401792,516480,631168,1433984,100736,125824,150912,176000,14049280,14057472,14065664,14053376,14061568,14069760,14127104,14147584,14149632,14151680,14153728,867584,1157120,1001472
.long 2176,3072,43008,129024,4268032,4354048,4286464,4372480,4284416,4370432,12649472,12796928,12648448,12795904,1207296,28672,180736,180224,114944,114688,172032,0,0,0,0,0,460800,546816,632832,24576,69632,12288,3472,18320,1504,21488,173064,44832,44544,804864,34304,6797312,1620352,47232,11456,27904,0,0,0,1,0,4294967295,1,12288,1065353216,2688,688512,803200,917888,745856,860544,975232,1491328,201088,226176,251264,276352,14073856,14082048,14090240,14077952,14086144,14094336,14131200,14155776,14157824,14159872,14161920,830080,1106944,1012224
.long 88192,117760,43008,129024,4356096,4270080,4376576,4290560,4374528,4288512,12798976,12651520,12797952,12650496,1408000,28672,182784,182272,115456,115200,172032,0,0,0,0,0,718848,804864,890880,36864,79872,18432,3480,18328,1504,21496,173576,44848,44544,890880,34560,6944768,1627520,47296,11552,28032,0,0,0,1,0,4294967295,1,18432,1065353216,2688,1032576,1147264,1261952,1089920,1204608,1319296,1548672,301440,326528,351616,376704,14098432,14106624,14114816,14102528,14110720,14118912,14135296,14163968,14166016,14168064,14170112,867712,1157120,1022976
.long 0,128,57344,172032,1638400,1724416,8126464,8273920,8127488,8274944,8130560,8278016,8131584,8279040,802816,28672,65536,65792,67584,67840,229376,0,0,0,0,0,262144,348160,434176,0,49152,0,6144,14336,512,21504,66560,36864,36864,950272,34816,7061504,512,32768,4096,20480,0,0,0,2,4294967295,0,0,1544,1049336022,3584,512,115200,229888,57856,172544,287232,1376768,512,25600,50688,75776,5767168,5775360,5783552,5771264,5779456,5787648,5865472,5881856,5883904,5885952,5888000,401408,401536,688128
.long 114688,114816,57344,172032,1726464,1640448,8275968,8128512,8276992,8129536,8280064,8132608,8281088,8133632,1003520,28672,66048,66304,68096,68352,229376,0,0,0,0,0,520192,606208,692224,12288,59392,6144,6152,14344,512,21512,67072,36880,36864,1036288,35072,7208960,7680,32832,4192,20608,0,0,0,2,4294967295,0,0,7688,1049336022,3584,344576,459264,573952,401920,516608,631296,1434112,100864,125952,151040,176128,5791744,5799936,5808128,5795840,5804032,5812224,5869568,5890048,5892096,5894144,5896192,451584,451712,698880
.long 0,128,57344,172032,1810432,1896448,8422400,8569856,8421376,8568832,8426496,8573952,8425472,8572928,1204224,28672,65792,65536,67840,67584,229376,0,0,0,0,0,778240,864256,950272,24576,69632,12288,6160,14352,512,21520,66568,36896,37376,1122304,35328,7356416,14848,32896,4288,20736,0,0,0,2,4294967295,0,0,13832,1049336022,3584,688640,803328,918016,745984,860672,975360,1491456,201216,226304,251392,276480,5816320,5824512,5832704,5820416,5828608,5836800,5873664,5898240,5900288,5902336,5904384,401408,401536,709632
.long 114688,114816,57344,172032,1898496,1812480,8571904,8424448,8570880,8423424,8576000,8428544,8574976,8427520,1404928,28672,66304,66048,68352,68096,229376,0,0,0,0,0,1036288,1122304,1208320,36864,79872,18432,6168,14360,512,21528,67080,36912,37376,1208320,35584,7503872,22016,32960,4384,20864,0,0,0,2,4294967295,0,0,19976,1049336022,3584,1032704,1147392,1262080,1090048,1204736,1319424,1548800,301568,326656,351744,376832,5840896,5849088,5857280,5844992,5853184,5861376,5877760,5906432,5908480,5910528,5912576,451584,451712,720384
.long 0,128,57344,172032,4390912,4476928,12845056,12992512,12846080,12993536,12849152,12996608,12850176,12997632,0,28672,65536,65792,67584,67840,229376,0,0,0,0,0,265728,351744,437760,0,49152,0,10240,18432,1536,21568,65536,45056,45056,953856,34816,7065600,229888,34816,5120,21504,0,0,0,2,4294967295,0,0,1544,1049336022,3584,512,115200,229888,57856,172544,287232,1376768,512,25600,50688,75776,6946816,6955008,6963200,6950912,6959104,6967296,7045120,7061504,7063552,7065600,7067648,1204224,1204352,1032192
.long 114688,114816,57344,172032,4478976,4392960,12994560,12847104,12995584,12848128,12998656,12851200,12999680,12852224,200704,28672,66048,66304,68096,68352,229376,0,0,0,0,0,523776,609792,695808,12288,59392,6144,10248,18440,1536,21576,66048,45072,45056,1039872,35072,7213056,237056,34880,5216,21632,0,0,0,2,4294967295,0,0,7688,1049336022,3584,344576,459264,573952,401920,516608,631296,1434112,100864,125952,151040,176128,6971392,6979584,6987776,6975488,6983680,6991872,7049216,7069696,7071744,7073792,7075840,1254400,1254528,1042944
.long 0,128,57344,172032,4562944,4648960,13140992,13288448,13139968,13287424,13145088,13292544,13144064,13291520,401408,28672,65792,65536,67840,67584,229376,0,0,0,0,0,781824,867840,953856,24576,69632,12288,10256,18448,1536,21584,65544,45088,45568,1125888,35328,7360512,244224,34944,5312,21760,0,0,0,2,4294967295,0,0,13832,1049336022,3584,688640,803328,918016,745984,860672,975360,1491456,201216,226304,251392,276480,6995968,7004160,7012352,7000064,7008256,7016448,7053312,7077888,7079936,7081984,7084032,1204224,1204352,1053696
.long 114688,114816,57344,172032,4651008,4564992,13290496,13143040,13289472,13142016,13294592,13147136,13293568,13146112,602112,28672,66304,66048,68352,68096,229376,0,0,0,0,0,1039872,1125888,1211904,36864,79872,18432,10264,18456,1536,21592,66056,45104,45568,1211904,35584,7507968,251392,35008,5408,21888,0,0,0,2,4294967295,0,0,19976,1049336022,3584,1032704,1147392,1262080,1090048,1204736,1319424,1548800,301568,326656,351744,376832,7020544,7028736,7036928,7024640,7032832,7041024,7057408,7086080,7088128,7090176,7092224,1254400,1254528,1064448
.long 1024,1152,57344,172032,1654784,1740800,8159232,8306688,8160256,8307712,8163328,8310784,8164352,8311808,803840,28672,81920,82176,83968,84224,229376,0,0,0,0,0,269312,355328,441344,0,49152,0,6272,14464,544,21632,82944,37120,36864,957440,34816,7069696,459264,36864,6144,22528,0,0,0,2,4294967295,0,0,1544,1049336022,3584,512,115200,229888,57856,172544,287232,1376768,512,25600,50688,75776,8126464,8134656,8142848,8130560,8138752,8146944,8224768,8241152,8243200,8245248,8247296,402432,402560,688640
.long 115712,115840,57344,172032,1742848,1656832,8308736,8161280,8309760,8162304,8312832,8165376,8313856,8166400,1004544,28672,82432,82688,84480,84736,229376,0,0,0,0,0,527360,613376,699392,12288,59392,6144,6280,14472,544,21640,83456,37136,36864,1043456,35072,7217152,466432,36928,6240,22656,0,0,0,2,4294967295,0,0,7688,1049336022,3584,344576,459264,573952,401920,516608,631296,1434112,100864,125952,151040,176128,8151040,8159232,8167424,8155136,8163328,8171520,8228864,8249344,8251392,8253440,8255488,452608,452736,699392
.long 1024,1152,57344,172032,1826816,1912832,8455168,8602624,8454144,8601600,8459264,8606720,8458240,8605696,1205248,28672,82176,81920,84224,83968,229376,0,0,0,0,0,785408,871424,957440,24576,69632,12288,6288,14480,544,21648,82952,37152,37376,1129472,35328,7364608,473600,36992,6336,22784,0,0,0,2,4294967295,0,0,13832,1049336022,3584,688640,803328,918016,745984,860672,975360,1491456,201216,226304,251392,276480,8175616,8183808,8192000,8179712,8187904,8196096,8232960,8257536,8259584,8261632,8263680,402432,402560,710144
.long 115712,115840,57344,172032,1914880,1828864,8604672,8457216,8603648,8456192,8608768,8461312,8607744,8460288,1405952,28672,82688,82432,84736,84480,229376,0,0,0,0,0,1043456,1129472,1215488,36864,79872,18432,6296,14488,544,21656,83464,37168,37376,1215488,35584,7512064,480768,37056,6432,22912,0,0,0,2,4294967295,0,0,19976,1049336022,3584,1032704,1147392,1262080,1090048,1204736,1319424,1548800,301568,326656,351744,376832,8200192,8208384,8216576,8204288,8212480,8220672,8237056,8265728,8267776,8269824,8271872,452608,452736,720896
.long 1024,1152,57344,172032,4407296,4493312,12877824,13025280,12878848,13026304,12881920,13029376,12882944,13030400,1024,28672,81920,82176,83968,84224,229376,0,0,0,0,0,272896,358912,444928,0,49152,0,10368,18560,1568,21696,81920,45312,45056,961024,34816,7073792,688640,38912,7168,23552,0,0,0,2,4294967295,0,0,1544,1049336022,3584,512,115200,229888,57856,172544,287232,1376768,512,25600,50688,75776,9306112,9314304,9322496,9310208,9318400,9326592,9404416,9420800,9422848,9424896,9426944,1205248,1205376,1032704
.long 115712,115840,57344,172032,4495360,4409344,13027328,12879872,13028352,12880896,13031424,12883968,13032448,12884992,201728,28672,82432,82688,84480,84736,229376,0,0,0,0,0,530944,616960,702976,12288,59392,6144,10376,18568,1568,21704,82432,45328,45056,1047040,35072,7221248,695808,38976,7264,23680,0,0,0,2,4294967295,0,0,7688,1049336022,3584,344576,459264,573952,401920,516608,631296,1434112,100864,125952,151040,176128,9330688,9338880,9347072,9334784,9342976,9351168,9408512,9428992,9431040,9433088,9435136,1255424,1255552,1043456
.long 1024,1152,57344,172032,4579328,4665344,13173760,13321216,13172736,13320192,13177856,13325312,13176832,13324288,402432,28672,82176,81920,84224,83968,229376,0,0,0,0,0,788992,875008,961024,24576,69632,12288,10384,18576,1568,21712,81928,45344,45568,1133056,35328,7368704,702976,39040,7360,23808,0,0,0,2,4294967295,0,0,13832,1049336022,3584,688640,803328,918016,745984,860672,975360,1491456,201216,226304,251392,276480,9355264,9363456,9371648,9359360,9367552,9375744,9412608,9437184,9439232,9441280,9443328,1205248,1205376,1054208
.long 115712,115840,57344,172032,4667392,4581376,13323264,13175808,13322240,13174784,13327360,13179904,13326336,13178880,603136,28672,82688,82432,84736,84480,229376,0,0,0,0,0,1047040,1133056,1219072,36864,79872,18432,10392,18584,1568,21720,82440,45360,45568,1219072,35584,7516160,710144,39104,7456,23936,0,0,0,2,4294967295,0,0,19976,1049336022,3584,1032704,1147392,1262080,1090048,1204736,1319424,1548800,301568,326656,351744,376832,9379840,9388032,9396224,9383936,9392128,9400320,9416704,9445376,9447424,9449472,9451520,1255424,1255552,1064960
.long 2048,2176,57344,172032,1671168,1757184,8192000,8339456,8193024,8340480,8196096,8343552,8197120,8344576,804864,28672,98304,98560,100352,100608,229376,0,0,0,0,0,276480,362496,448512,0,49152,0,6400,14592,576,21760,99328,37376,36864,964608,34816,7077888,918016,40960,8192,24576,0,0,0,2,4294967295,0,0,1544,1065353216,3584,512,115200,229888,57856,172544,287232,1376768,512,25600,50688,75776,10485760,10493952,10502144,10489856,10498048,10506240,10584064,10600448,10602496,10604544,10606592,403456,403584,689152
.long 116736,116864,57344,172032,1759232,1673216,8341504,8194048,8342528,8195072,8345600,8198144,8346624,8199168,1005568,28672,98816,99072,100864,101120,229376,0,0,0,0,0,534528,620544,706560,12288,59392,6144,6408,14600,576,21768,99840,37392,36864,1050624,35072,7225344,925184,41024,8288,24704,0,0,0,2,4294967295,0,0,7688,1065353216,3584,344576,459264,573952,401920,516608,631296,1434112,100864,125952,151040,176128,10510336,10518528,10526720,10514432,10522624,10530816,10588160,10608640,10610688,10612736,10614784,453632,453760,699904
.long 2048,2176,57344,172032,1843200,1929216,8487936,8635392,8486912,8634368,8492032,8639488,8491008,8638464,1206272,28672,98560,98304,100608,100352,229376,0,0,0,0,0,792576,878592,964608,24576,69632,12288,6416,14608,576,21776,99336,37408,37376,1136640,35328,7372800,932352,41088,8384,24832,0,0,0,2,4294967295,0,0,13832,1065353216,3584,688640,803328,918016,745984,860672,975360,1491456,201216,226304,251392,276480,10534912,10543104,10551296,10539008,10547200,10555392,10592256,10616832,10618880,10620928,10622976,403456,403584,710656
.long 116736,116864,57344,172032,1931264,1845248,8637440,8489984,8636416,8488960,8641536,8494080,8640512,8493056,1406976,28672,99072,98816,101120,100864,229376,0,0,0,0,0,1050624,1136640,1222656,36864,79872,18432,6424,14616,576,21784,99848,37424,37376,1222656,35584,7520256,939520,41152,8480,24960,0,0,0,2,4294967295,0,0,19976,1065353216,3584,1032704,1147392,1262080,1090048,1204736,1319424,1548800,301568,326656,351744,376832,10559488,10567680,10575872,10563584,10571776,10579968,10596352,10625024,10627072,10629120,10631168,453632,453760,721408
.long 2048,2176,57344,172032,4423680,4509696,12910592,13058048,12911616,13059072,12914688,13062144,12915712,13063168,2048,28672,98304,98560,100352,100608,229376,0,0,0,0,0,280064,366080,452096,0,49152,0,10496,18688,1600,21824,98304,45568,45056,968192,34816,7081984,1147392,43008,9216,25600,0,0,0,2,4294967295,0,0,1544,1065353216,3584,512,115200,229888,57856,172544,287232,1376768,512,25600,50688,75776,11665408,11673600,11681792,11669504,11677696,11685888,11763712,11780096,11782144,11784192,11786240,1206272,1206400,1033216
.long 116736,116864,57344,172032,4511744,4425728,13060096,12912640,13061120,12913664,13064192,12916736,13065216,12917760,202752,28672,98816,99072,100864,101120,229376,0,0,0,0,0,538112,624128,710144,12288,59392,6144,10504,18696,1600,21832,98816,45584,45056,1054208,35072,7229440,1154560,43072,9312,25728,0,0,0,2,4294967295,0,0,7688,1065353216,3584,344576,459264,573952,401920,516608,631296,1434112,100864,125952,151040,176128,11689984,11698176,11706368,11694080,11702272,11710464,11767808,11788288,11790336,11792384,11794432,1256448,1256576,1043968
.long 2048,2176,57344,172032,4595712,4681728,13206528,13353984,13205504,13352960,13210624,13358080,13209600,13357056,403456,28672,98560,98304,100608,100352,229376,0,0,0,0,0,796160,882176,968192,24576,69632,12288,10512,18704,1600,21840,98312,45600,45568,1140224,35328,7376896,1161728,43136,9408,25856,0,0,0,2,4294967295,0,0,13832,1065353216,3584,688640,803328,918016,745984,860672,975360,1491456,201216,226304,251392,276480,11714560,11722752,11730944,11718656,11726848,11735040,11771904,11796480,11798528,11800576,11802624,1206272,1206400,1054720
.long 116736,116864,57344,172032,4683776,4597760,13356032,13208576,13355008,13207552,13360128,13212672,13359104,13211648,604160,28672,99072,98816,101120,100864,229376,0,0,0,0,0,1054208,1140224,1226240,36864,79872,18432,10520,18712,1600,21848,98824,45616,45568,1226240,35584,7524352,1168896,43200,9504,25984,0,0,0,2,4294967295,0,0,19976,1065353216,3584,1032704,1147392,1262080,1090048,1204736,1319424,1548800,301568,326656,351744,376832,11739136,11747328,11755520,11743232,11751424,11759616,11776000,11804672,11806720,11808768,11810816,1256448,1256576,1065472
.long 2048,3072,43008,129024,1687552,1773568,1703936,1789952,1705984,1792000,8224768,8372224,8225792,8373248,604160,21504,180224,180736,114688,114944,172032,0,0,0,0,0,283648,369664,455680,0,49152,0,2560,14720,608,21888,181248,37632,36864,971776,34816,7086080,1376768,45056,10240,26624,0,0,0,2,4294967295,0,0,1544,1065353216,2688,512,115200,229888,57856,172544,287232,1376768,512,25600,50688,75776,12845056,12853248,12861440,12849152,12857344,12865536,12943360,12959744,12961792,12963840,12965888,303104,404480,689664
.long 88064,117760,43008,129024,1775616,1689600,1794048,1708032,1796096,1710080,8374272,8226816,8375296,8227840,754688,21504,182272,182784,115200,115456,172032,0,0,0,0,0,541696,627712,713728,12288,59392,6144,2568,14728,608,21896,181760,37648,36864,1057792,35072,7233536,1383936,45120,10336,26752,0,0,0,2,4294967295,0,0,7688,1065353216,2688,344576,459264,573952,401920,516608,631296,1434112,100864,125952,151040,176128,12869632,12877824,12886016,12873728,12881920,12890112,12947456,12967936,12969984,12972032,12974080,340736,454656,700416
.long 2176,3072,43008,129024,1859584,1945600,1878016,1964032,1875968,1961984,8520704,8668160,8519680,8667136,905216,21504,180736,180224,114944,114688,172032,0,0,0,0,0,799744,885760,971776,24576,69632,12288,2576,14736,608,21904,181256,37664,37376,1143808,35328,7380992,1391104,45184,10432,26880,0,0,0,2,4294967295,0,0,13832,1065353216,2688,688640,803328,918016,745984,860672,975360,1491456,201216,226304,251392,276480,12894208,12902400,12910592,12898304,12906496,12914688,12951552,12976128,12978176,12980224,12982272,303232,404480,711168
.long 88192,117760,43008,129024,1947648,1861632,1968128,1882112,1966080,1880064,8670208,8522752,8669184,8521728,1055744,21504,182784,182272,115456,115200,172032,0,0,0,0,0,1057792,1143808,1229824,36864,79872,18432,2584,14744,608,21912,181768,37680,37376,1229824,35584,7528448,1398272,45248,10528,27008,0,0,0,2,4294967295,0,0,19976,1065353216,2688,1032704,1147392,1262080,1090048,1204736,1319424,1548800,301568,326656,351744,376832,12918784,12926976,12935168,12922880,12931072,12939264,12955648,12984320,12986368,12988416,12990464,340864,454656,721920
.long 2048,3072,43008,129024,4440064,4526080,4456448,4542464,4458496,4544512,12943360,13090816,12944384,13091840,2048,21504,180224,180736,114688,114944,172032,0,0,0,0,0,287232,373248,459264,0,49152,0,3584,18816,1632,21952,180224,45824,45056,975360,34816,7090176,1606144,47104,11264,27648,0,0,0,2,4294967295,0,0,1544,1065353216,2688,512,115200,229888,57856,172544,287232,1376768,512,25600,50688,75776,14024704,14032896,14041088,14028800,14036992,14045184,14123008,14139392,14141440,14143488,14145536,905216,1207296,1033728
.long 88064,117760,43008,129024,4528128,4442112,4546560,4460544,4548608,4462592,13092864,12945408,13093888,12946432,152576,21504,182272,182784,115200,115456,172032,0,0,0,0,0,545280,631296,717312,12288,59392,6144,3592,18824,1632,21960,180736,45840,45056,1061376,35072,7237632,1613312,47168,11360,27776,0,0,0,2,4294967295,0,0,7688,1065353216,2688,344576,459264,573952,401920,516608,631296,1434112,100864,125952,151040,176128,14049280,14057472,14065664,14053376,14061568,14069760,14127104,14147584,14149632,14151680,14153728,942848,1257472,1044480
.long 2176,3072,43008,129024,4612096,4698112,4630528,4716544,4628480,4714496,13239296,13386752,13238272,13385728,303104,21504,180736,180224,114944,114688,172032,0,0,0,0,0,803328,889344,975360,24576,69632,12288,3600,18832,1632,21968,180232,45856,45568,1147392,35328,7385088,1620480,47232,11456,27904,0,0,0,2,4294967295,0,0,13832,1065353216,2688,688640,803328,918016,745984,860672,975360,1491456,201216,226304,251392,276480,14073856,14082048,14090240,14077952,14086144,14094336,14131200,14155776,14157824,14159872,14161920,905344,1207296,1055232
.long 88192,117760,43008,129024,4700160,4614144,4720640,4634624,4718592,4632576,13388800,13241344,13387776,13240320,453632,21504,182784,182272,115456,115200,172032,0,0,0,0,0,1061376,1147392,1233408,36864,79872,18432,3608,18840,1632,21976,180744,45872,45568,1233408,35584,7532544,1627648,47296,11552,28032,0,0,0,2,4294967295,0,0,19976,1065353216,2688,1032704,1147392,1262080,1090048,1204736,1319424,1548800,301568,326656,351744,376832,14098432,14106624,14114816,14102528,14110720,14118912,14135296,14163968,14166016,14168064,14170112,942976,1257472,1065984
.long 0,128,57344,172032,1982464,2068480,8716288,8863744,8717312,8864768,8720384,8867840,8721408,8868864,802816,28672,65536,65792,67584,67840,229376,0,0,0,0,0,263680,349696,435712,0,49152,0,6656,14848,640,21536,123904,37888,37888,951808,34816,7063552,640,32768,4096,20480,0,0,0,2,0,4294967295,1,0,1049336022,3584,640,115328,230016,57984,172672,287360,1376896,640,25728,50816,75904,5767168,5775360,5783552,5771264,5779456,5787648,5865472,5881856,5883904,5885952,5888000,501760,501888,731136
.long 114688,114816,57344,172032,2070528,1984512,8865792,8718336,8866816,8719360,8869888,8722432,8870912,8723456,1003520,28672,66048,66304,68096,68352,229376,0,0,0,0,0,521728,607744,693760,12288,59392,6144,6664,14856,640,21544,124416,37904,37888,1037824,35072,7211008,7808,32832,4192,20608,0,0,0,2,0,4294967295,1,6144,1049336022,3584,344704,459392,574080,402048,516736,631424,1434240,100992,126080,151168,176256,5791744,5799936,5808128,5795840,5804032,5812224,5869568,5890048,5892096,5894144,5896192,551936,552064,741888
.long 0,128,57344,172032,2154496,2240512,9012224,9159680,9011200,9158656,9016320,9163776,9015296,9162752,1204224,28672,65792,65536,67840,67584,229376,0,0,0,0,0,779776,865792,951808,24576,69632,12288,6672,14864,640,21552,123912,37920,38400,1123840,35328,7358464,14976,32896,4288,20736,0,0,0,2,0,4294967295,1,12288,1049336022,3584,688768,803456,918144,746112,860800,975488,1491584,201344,226432,251520,276608,5816320,5824512,5832704,5820416,5828608,5836800,5873664,5898240,5900288,5902336,5904384,501760,501888,752640
.long 114688,114816,57344,172032,2242560,2156544,9161728,9014272,9160704,9013248,9165824,9018368,9164800,9017344,1404928,28672,66304,66048,68352,68096,229376,0,0,0,0,0,1037824,1123840,1209856,36864,79872,18432,6680,14872,640,21560,124424,37936,38400,1209856,35584,7505920,22144,32960,4384,20864,0,0,0,2,0,4294967295,1,18432,1049336022,3584,1032832,1147520,1262208,1090176,1204864,1319552,1548928,301696,326784,351872,376960,5840896,5849088,5857280,5844992,5853184,5861376,5877760,5906432,5908480,5910528,5912576,551936,552064,763392
.long 0,128,57344,172032,4734976,4820992,13434880,13582336,13435904,13583360,13438976,13586432,13440000,13587456,0,28672,65536,65792,67584,67840,229376,0,0,0,0,0,267264,353280,439296,0,49152,0,10752,18944,1664,21600,122880,46080,46080,955392,34816,7067648,230016,34816,5120,21504,0,0,0,2,0,4294967295,1,0,1049336022,3584,640,115328,230016,57984,172672,287360,1376896,640,25728,50816,75904,6946816,6955008,6963200,6950912,6959104,6967296,7045120,7061504,7063552,7065600,7067648,1304576,1304704,1075200
.long 114688,114816,57344,172032,4823040,4737024,13584384,13436928,13585408,13437952,13588480,13441024,13589504,13442048,200704,28672,66048,66304,68096,68352,229376,0,0,0,0,0,525312,611328,697344,12288,59392,6144,10760,18952,1664,21608,123392,46096,46080,1041408,35072,7215104,237184,34880,5216,21632,0,0,0,2,0,4294967295,1,6144,1049336022,3584,344704,459392,574080,402048,516736,631424,1434240,100992,126080,151168,176256,6971392,6979584,6987776,6975488,6983680,6991872,7049216,7069696,7071744,7073792,7075840,1354752,1354880,1085952
.long 0,128,57344,172032,4907008,4993024,13730816,13878272,13729792,13877248,13734912,13882368,13733888,13881344,401408,28672,65792,65536,67840,67584,229376,0,0,0,0,0,783360,869376,955392,24576,69632,12288,10768,18960,1664,21616,122888,46112,46592,1127424,35328,7362560,244352,34944,5312,21760,0,0,0,2,0,4294967295,1,12288,1049336022,3584,688768,803456,918144,746112,860800,975488,1491584,201344,226432,251520,276608,6995968,7004160,7012352,7000064,7008256,7016448,7053312,7077888,7079936,7081984,7084032,1304576,1304704,1096704
.long 114688,114816,57344,172032,4995072,4909056,13880320,13732864,13879296,13731840,13884416,13736960,13883392,13735936,602112,28672,66304,66048,68352,68096,229376,0,0,0,0,0,1041408,1127424,1213440,36864,79872,18432,10776,18968,1664,21624,123400,46128,46592,1213440,35584,7510016,251520,35008,5408,21888,0,0,0,2,0,4294967295,1,18432,1049336022,3584,1032832,1147520,1262208,1090176,1204864,1319552,1548928,301696,326784,351872,376960,7020544,7028736,7036928,7024640,7032832,7041024,7057408,7086080,7088128,7090176,7092224,1354752,1354880,1107456
.long 1024,1152,57344,172032,1998848,2084864,8749056,8896512,8750080,8897536,8753152,8900608,8754176,8901632,803840,28672,81920,82176,83968,84224,229376,0,0,0,0,0,270848,356864,442880,0,49152,0,6784,14976,672,21664,140288,38144,37888,958976,34816,7071744,459392,36864,6144,22528,0,0,0,2,0,4294967295,1,0,1049336022,3584,640,115328,230016,57984,172672,287360,1376896,640,25728,50816,75904,8126464,8134656,8142848,8130560,8138752,8146944,8224768,8241152,8243200,8245248,8247296,502784,502912,731648
.long 115712,115840,57344,172032,2086912,2000896,8898560,8751104,8899584,8752128,8902656,8755200,8903680,8756224,1004544,28672,82432,82688,84480,84736,229376,0,0,0,0,0,528896,614912,700928,12288,59392,6144,6792,14984,672,21672,140800,38160,37888,1044992,35072,7219200,466560,36928,6240,22656,0,0,0,2,0,4294967295,1,6144,1049336022,3584,344704,459392,574080,402048,516736,631424,1434240,100992,126080,151168,176256,8151040,8159232,8167424,8155136,8163328,8171520,8228864,8249344,8251392,8253440,8255488,552960,553088,742400
.long 1024,1152,57344,172032,2170880,2256896,9044992,9192448,9043968,9191424,9049088,9196544,9048064,9195520,1205248,28672,82176,81920,84224,83968,229376,0,0,0,0,0,786944,872960,958976,24576,69632,12288,6800,14992,672,21680,140296,38176,38400,1131008,35328,7366656,473728,36992,6336,22784,0,0,0,2,0,4294967295,1,12288,1049336022,3584,688768,803456,918144,746112,860800,975488,1491584,201344,226432,251520,276608,8175616,8183808,8192000,8179712,8187904,8196096,8232960,8257536,8259584,8261632,8263680,502784,502912,753152
.long 115712,115840,57344,172032,2258944,2172928,9194496,9047040,9193472,9046016,9198592,9051136,9197568,9050112,1405952,28672,82688,82432,84736,84480,229376,0,0,0,0,0,1044992,1131008,1217024,36864,79872,18432,6808,15000,672,21688,140808,38192,38400,1217024,35584,7514112,480896,37056,6432,22912,0,0,0,2,0,4294967295,1,18432,1049336022,3584,1032832,1147520,1262208,1090176,1204864,1319552,1548928,301696,326784,351872,376960,8200192,8208384,8216576,8204288,8212480,8220672,8237056,8265728,8267776,8269824,8271872,552960,553088,763904
.long 1024,1152,57344,172032,4751360,4837376,13467648,13615104,13468672,13616128,13471744,13619200,13472768,13620224,1024,28672,81920,82176,83968,84224,229376,0,0,0,0,0,274432,360448,446464,0,49152,0,10880,19072,1696,21728,139264,46336,46080,962560,34816,7075840,688768,38912,7168,23552,0,0,0,2,0,4294967295,1,0,1049336022,3584,640,115328,230016,57984,172672,287360,1376896,640,25728,50816,75904,9306112,9314304,9322496,9310208,9318400,9326592,9404416,9420800,9422848,9424896,9426944,1305600,1305728,1075712
.long 115712,115840,57344,172032,4839424,4753408,13617152,13469696,13618176,13470720,13621248,13473792,13622272,13474816,201728,28672,82432,82688,84480,84736,229376,0,0,0,0,0,532480,618496,704512,12288,59392,6144,10888,19080,1696,21736,139776,46352,46080,1048576,35072,7223296,695936,38976,7264,23680,0,0,0,2,0,4294967295,1,6144,1049336022,3584,344704,459392,574080,402048,516736,631424,1434240,100992,126080,151168,176256,9330688,9338880,9347072,9334784,9342976,9351168,9408512,9428992,9431040,9433088,9435136,1355776,1355904,1086464
.long 1024,1152,57344,172032,4923392,5009408,13763584,13911040,13762560,13910016,13767680,13915136,13766656,13914112,402432,28672,82176,81920,84224,83968,229376,0,0,0,0,0,790528,876544,962560,24576,69632,12288,10896,19088,1696,21744,139272,46368,46592,1134592,35328,7370752,703104,39040,7360,23808,0,0,0,2,0,4294967295,1,12288,1049336022,3584,688768,803456,918144,746112,860800,975488,1491584,201344,226432,251520,276608,9355264,9363456,9371648,9359360,9367552,9375744,9412608,9437184,9439232,9441280,9443328,1305600,1305728,1097216
.long 115712,115840,57344,172032,5011456,4925440,13913088,13765632,13912064,13764608,13917184,13769728,13916160,13768704,603136,28672,82688,82432,84736,84480,229376,0,0,0,0,0,1048576,1134592,1220608,36864,79872,18432,10904,19096,1696,21752,139784,46384,46592,1220608,35584,7518208,710272,39104,7456,23936,0,0,0,2,0,4294967295,1,18432,1049336022,3584,1032832,1147520,1262208,1090176,1204864,1319552,1548928,301696,326784,351872,376960,9379840,9388032,9396224,9383936,9392128,9400320,9416704,9445376,9447424,9449472,9451520,1355776,1355904,1107968
.long 2048,2176,57344,172032,2015232,2101248,8781824,8929280,8782848,8930304,8785920,8933376,8786944,8934400,804864,28672,98304,98560,100352,100608,229376,0,0,0,0,0,278016,364032,450048,0,49152,0,6912,15104,704,21792,156672,38400,37888,966144,34816,7079936,918144,40960,8192,24576,0,0,0,2,0,4294967295,1,0,1065353216,3584,640,115328,230016,57984,172672,287360,1376896,640,25728,50816,75904,10485760,10493952,10502144,10489856,10498048,10506240,10584064,10600448,10602496,10604544,10606592,503808,503936,732160
.long 116736,116864,57344,172032,2103296,2017280,8931328,8783872,8932352,8784896,8935424,8787968,8936448,8788992,1005568,28672,98816,99072,100864,101120,229376,0,0,0,0,0,536064,622080,708096,12288,59392,6144,6920,15112,704,21800,157184,38416,37888,1052160,35072,7227392,925312,41024,8288,24704,0,0,0,2,0,4294967295,1,6144,1065353216,3584,344704,459392,574080,402048,516736,631424,1434240,100992,126080,151168,176256,10510336,10518528,10526720,10514432,10522624,10530816,10588160,10608640,10610688,10612736,10614784,553984,554112,742912
.long 2048,2176,57344,172032,2187264,2273280,9077760,9225216,9076736,9224192,9081856,9229312,9080832,9228288,1206272,28672,98560,98304,100608,100352,229376,0,0,0,0,0,794112,880128,966144,24576,69632,12288,6928,15120,704,21808,156680,38432,38400,1138176,35328,7374848,932480,41088,8384,24832,0,0,0,2,0,4294967295,1,12288,1065353216,3584,688768,803456,918144,746112,860800,975488,1491584,201344,226432,251520,276608,10534912,10543104,10551296,10539008,10547200,10555392,10592256,10616832,10618880,10620928,10622976,503808,503936,753664
.long 116736,116864,57344,172032,2275328,2189312,9227264,9079808,9226240,9078784,9231360,9083904,9230336,9082880,1406976,28672,99072,98816,101120,100864,229376,0,0,0,0,0,1052160,1138176,1224192,36864,79872,18432,6936,15128,704,21816,157192,38448,38400,1224192,35584,7522304,939648,41152,8480,24960,0,0,0,2,0,4294967295,1,18432,1065353216,3584,1032832,1147520,1262208,1090176,1204864,1319552,1548928,301696,326784,351872,376960,10559488,10567680,10575872,10563584,10571776,10579968,10596352,10625024,10627072,10629120,10631168,553984,554112,764416
.long 2048,2176,57344,172032,4767744,4853760,13500416,13647872,13501440,13648896,13504512,13651968,13505536,13652992,2048,28672,98304,98560,100352,100608,229376,0,0,0,0,0,281600,367616,453632,0,49152,0,11008,19200,1728,21856,155648,46592,46080,969728,34816,7084032,1147520,43008,9216,25600,0,0,0,2,0,4294967295,1,0,1065353216,3584,640,115328,230016,57984,172672,287360,1376896,640,25728,50816,75904,11665408,11673600,11681792,11669504,11677696,11685888,11763712,11780096,11782144,11784192,11786240,1306624,1306752,1076224
.long 116736,116864,57344,172032,4855808,4769792,13649920,13502464,13650944,13503488,13654016,13506560,13655040,13507584,202752,28672,98816,99072,100864,101120,229376,0,0,0,0,0,539648,625664,711680,12288,59392,6144,11016,19208,1728,21864,156160,46608,46080,1055744,35072,7231488,1154688,43072,9312,25728,0,0,0,2,0,4294967295,1,6144,1065353216,3584,344704,459392,574080,402048,516736,631424,1434240,100992,126080,151168,176256,11689984,11698176,11706368,11694080,11702272,11710464,11767808,11788288,11790336,11792384,11794432,1356800,1356928,1086976
.long 2048,2176,57344,172032,4939776,5025792,13796352,13943808,13795328,13942784,13800448,13947904,13799424,13946880,403456,28672,98560,98304,100608,100352,229376,0,0,0,0,0,797696,883712,969728,24576,69632,12288,11024,19216,1728,21872,155656,46624,46592,1141760,35328,7378944,1161856,43136,9408,25856,0,0,0,2,0,4294967295,1,12288,1065353216,3584,688768,803456,918144,746112,860800,975488,1491584,201344,226432,251520,276608,11714560,11722752,11730944,11718656,11726848,11735040,11771904,11796480,11798528,11800576,11802624,1306624,1306752,1097728
.long 116736,116864,57344,172032,5027840,4941824,13945856,13798400,13944832,13797376,13949952,13802496,13948928,13801472,604160,28672,99072,98816,101120,100864,229376,0,0,0,0,0,1055744,1141760,1227776,36864,79872,18432,11032,19224,1728,21880,156168,46640,46592,1227776,35584,7526400,1169024,43200,9504,25984,0,0,0,2,0,4294967295,1,18432,1065353216,3584,1032832,1147520,1262208,1090176,1204864,1319552,1548928,301696,326784,351872,376960,11739136,11747328,11755520,11743232,11751424,11759616,11776000,11804672,11806720,11808768,11810816,1356800,1356928,1108480
.long 2048,3072,43008,129024,2031616,2117632,2048000,2134016,2050048,2136064,8814592,8962048,8815616,8963072,604288,21504,180224,180736,114688,114944,172032,0,0,0,0,0,285184,371200,457216,0,49152,0,2688,15232,736,21920,183296,38656,37888,973312,34816,7088128,1376896,45056,10240,26624,0,0,0,2,0,4294967295,1,0,1065353216,2688,640,115328,230016,57984,172672,287360,1376896,640,25728,50816,75904,12845056,12853248,12861440,12849152,12857344,12865536,12943360,12959744,12961792,12963840,12965888,378368,504832,732672
.long 88064,117760,43008,129024,2119680,2033664,2138112,2052096,2140160,2054144,8964096,8816640,8965120,8817664,754816,21504,182272,182784,115200,115456,172032,0,0,0,0,0,543232,629248,715264,12288,59392,6144,2696,15240,736,21928,183808,38672,37888,1059328,35072,7235584,1384064,45120,10336,26752,0,0,0,2,0,4294967295,1,6144,1065353216,2688,344704,459392,574080,402048,516736,631424,1434240,100992,126080,151168,176256,12869632,12877824,12886016,12873728,12881920,12890112,12947456,12967936,12969984,12972032,12974080,416000,555008,743424
.long 2176,3072,43008,129024,2203648,2289664,2222080,2308096,2220032,2306048,9110528,9257984,9109504,9256960,905344,21504,180736,180224,114944,114688,172032,0,0,0,0,0,801280,887296,973312,24576,69632,12288,2704,15248,736,21936,183304,38688,38400,1145344,35328,7383040,1391232,45184,10432,26880,0,0,0,2,0,4294967295,1,12288,1065353216,2688,688768,803456,918144,746112,860800,975488,1491584,201344,226432,251520,276608,12894208,12902400,12910592,12898304,12906496,12914688,12951552,12976128,12978176,12980224,12982272,378496,504832,754176
.long 88192,117760,43008,129024,2291712,2205696,2312192,2226176,2310144,2224128,9260032,9112576,9259008,9111552,1055872,21504,182784,182272,115456,115200,172032,0,0,0,0,0,1059328,1145344,1231360,36864,79872,18432,2712,15256,736,21944,183816,38704,38400,1231360,35584,7530496,1398400,45248,10528,27008,0,0,0,2,0,4294967295,1,18432,1065353216,2688,1032832,1147520,1262208,1090176,1204864,1319552,1548928,301696,326784,351872,376960,12918784,12926976,12935168,12922880,12931072,12939264,12955648,12984320,12986368,12988416,12990464,416128,555008,764928
.long 2048,3072,43008,129024,4784128,4870144,4800512,4886528,4802560,4888576,13533184,13680640,13534208,13681664,2176,21504,180224,180736,114688,114944,172032,0,0,0,0,0,288768,374784,460800,0,49152,0,3712,19328,1760,21984,182272,46848,46080,976896,34816,7092224,1606272,47104,11264,27648,0,0,0,2,0,4294967295,1,0,1065353216,2688,640,115328,230016,57984,172672,287360,1376896,640,25728,50816,75904,14024704,14032896,14041088,14028800,14036992,14045184,14123008,14139392,14141440,14143488,14145536,980480,1307648,1076736
.long 88064,117760,43008,129024,4872192,4786176,4890624,4804608,4892672,4806656,13682688,13535232,13683712,13536256,152704,21504,182272,182784,115200,115456,172032,0,0,0,0,0,546816,632832,718848,12288,59392,6144,3720,19336,1760,21992,182784,46864,46080,1062912,35072,7239680,1613440,47168,11360,27776,0,0,0,2,0,4294967295,1,6144,1065353216,2688,344704,459392,574080,402048,516736,631424,1434240,100992,126080,151168,176256,14049280,14057472,14065664,14053376,14061568,14069760,14127104,14147584,14149632,14151680,14153728,1018112,1357824,1087488
.long 2176,3072,43008,129024,4956160,5042176,4974592,5060608,4972544,5058560,13829120,13976576,13828096,13975552,303232,21504,180736,180224,114944,114688,172032,0,0,0,0,0,804864,890880,976896,24576,69632,12288,3728,19344,1760,22000,182280,46880,46592,1148928,35328,7387136,1620608,47232,11456,27904,0,0,0,2,0,4294967295,1,12288,1065353216,2688,688768,803456,918144,746112,860800,975488,1491584,201344,226432,251520,276608,14073856,14082048,14090240,14077952,14086144,14094336,14131200,14155776,14157824,14159872,14161920,980608,1307648,1098240
.long 88192,117760,43008,129024,5044224,4958208,5064704,4978688,5062656,4976640,13978624,13831168,13977600,13830144,453760,21504,182784,182272,115456,115200,172032,0,0,0,0,0,1062912,1148928,1234944,36864,79872,18432,3736,19352,1760,22008,182792,46896,46592,1234944,35584,7534592,1627776,47296,11552,28032,0,0,0,2,0,4294967295,1,18432,1065353216,2688,1032832,1147520,1262208,1090176,1204864,1319552,1548928,301696,326784,351872,376960,14098432,14106624,14114816,14102528,14110720,14118912,14135296,14163968,14166016,14168064,14170112,1018240,1357824,1108992
.long 0,128,57344,172032,2326528,2412544,9306112,9453568,9307136,9454592,9310208,9457664,9311232,9458688,802944,28672,65536,65792,67584,67840,229376,0,0,0,0,0,606208,692224,778240,0,49152,0,7168,15360,768,22016,68608,38912,38912,1294336,35840,7651328,768,32768,4096,20480,0,0,0,3,4294967295,0,0,1544,1049336022,3584,768,115456,230144,58112,172800,287488,1377024,768,25856,50944,76032,5767168,5775360,5783552,5771264,5779456,5787648,5865472,5881856,5883904,5885952,5888000,602112,602240,774144
.long 114688,114816,57344,172032,2414592,2328576,9455616,9308160,9456640,9309184,9459712,9312256,9460736,9313280,1003648,28672,66048,66304,68096,68352,229376,0,0,0,0,0,864256,950272,1036288,12288,59392,6144,7176,15368,768,22024,69120,38928,38912,1380352,36096,7798784,7936,32832,4192,20608,0,0,0,3,4294967295,0,0,7688,1049336022,3584,344832,459520,574208,402176,516864,631552,1434368,101120,126208,151296,176384,5791744,5799936,5808128,5795840,5804032,5812224,5869568,5890048,5892096,5894144,5896192,652288,652416,784896
.long 0,128,57344,172032,2498560,2584576,9602048,9749504,9601024,9748480,9606144,9753600,9605120,9752576,1204352,28672,65792,65536,67840,67584,229376,0,0,0,0,0,1122304,1208320,1294336,24576,69632,12288,7184,15376,768,22032,68616,38944,39424,1466368,36352,7946240,15104,32896,4288,20736,0,0,0,3,4294967295,0,0,13832,1049336022,3584,688896,803584,918272,746240,860928,975616,1491712,201472,226560,251648,276736,5816320,5824512,5832704,5820416,5828608,5836800,5873664,5898240,5900288,5902336,5904384,602112,602240,795648
.long 114688,114816,57344,172032,2586624,2500608,9751552,9604096,9750528,9603072,9755648,9608192,9754624,9607168,1405056,28672,66304,66048,68352,68096,229376,0,0,0,0,0,1380352,1466368,1552384,36864,79872,18432,7192,15384,768,22040,69128,38960,39424,1552384,36608,8093696,22272,32960,4384,20864,0,0,0,3,4294967295,0,0,19976,1049336022,3584,1032960,1147648,1262336,1090304,1204992,1319680,1549056,301824,326912,352000,377088,5840896,5849088,5857280,5844992,5853184,5861376,5877760,5906432,5908480,5910528,5912576,652288,652416,806400
.long 0,128,57344,172032,5079040,5165056,14024704,14172160,14025728,14173184,14028800,14176256,14029824,14177280,128,28672,65536,65792,67584,67840,229376,0,0,0,0,0,609792,695808,781824,0,49152,0,11264,19456,1792,22080,67584,47104,47104,1297920,35840,7655424,230144,34816,5120,21504,0,0,0,3,4294967295,0,0,1544,1049336022,3584,768,115456,230144,58112,172800,287488,1377024,768,25856,50944,76032,6946816,6955008,6963200,6950912,6959104,6967296,7045120,7061504,7063552,7065600,7067648,1404928,1405056,1118208
.long 114688,114816,57344,172032,5167104,5081088,14174208,14026752,14175232,14027776,14178304,14030848,14179328,14031872,200832,28672,66048,66304,68096,68352,229376,0,0,0,0,0,867840,953856,1039872,12288,59392,6144,11272,19464,1792,22088,68096,47120,47104,1383936,36096,7802880,237312,34880,5216,21632,0,0,0,3,4294967295,0,0,7688,1049336022,3584,344832,459520,574208,402176,516864,631552,1434368,101120,126208,151296,176384,6971392,6979584,6987776,6975488,6983680,6991872,7049216,7069696,7071744,7073792,7075840,1455104,1455232,1128960
.long 0,128,57344,172032,5251072,5337088,14320640,14468096,14319616,14467072,14324736,14472192,14323712,14471168,401536,28672,65792,65536,67840,67584,229376,0,0,0,0,0,1125888,1211904,1297920,24576,69632,12288,11280,19472,1792,22096,67592,47136,47616,1469952,36352,7950336,244480,34944,5312,21760,0,0,0,3,4294967295,0,0,13832,1049336022,3584,688896,803584,918272,746240,860928,975616,1491712,201472,226560,251648,276736,6995968,7004160,7012352,7000064,7008256,7016448,7053312,7077888,7079936,7081984,7084032,1404928,1405056,1139712
.long 114688,114816,57344,172032,5339136,5253120,14470144,14322688,14469120,14321664,14474240,14326784,14473216,14325760,602240,28672,66304,66048,68352,68096,229376,0,0,0,0,0,1383936,1469952,1555968,36864,79872,18432,11288,19480,1792,22104,68104,47152,47616,1555968,36608,8097792,251648,35008,5408,21888,0,0,0,3,4294967295,0,0,19976,1049336022,3584,1032960,1147648,1262336,1090304,1204992,1319680,1549056,301824,326912,352000,377088,7020544,7028736,7036928,7024640,7032832,7041024,7057408,7086080,7088128,7090176,7092224,1455104,1455232,1150464
.long 1024,1152,57344,172032,2342912,2428928,9338880,9486336,9339904,9487360,9342976,9490432,9344000,9491456,803968,28672,81920,82176,83968,84224,229376,0,0,0,0,0,613376,699392,785408,0,49152,0,7296,15488,800,22144,84992,39168,38912,1301504,35840,7659520,459520,36864,6144,22528,0,0,0,3,4294967295,0,0,1544,1049336022,3584,768,115456,230144,58112,172800,287488,1377024,768,25856,50944,76032,8126464,8134656,8142848,8130560,8138752,8146944,8224768,8241152,8243200,8245248,8247296,603136,603264,774656
.long 115712,115840,57344,172032,2430976,2344960,9488384,9340928,9489408,9341952,9492480,9345024,9493504,9346048,1004672,28672,82432,82688,84480,84736,229376,0,0,0,0,0,871424,957440,1043456,12288,59392,6144,7304,15496,800,22152,85504,39184,38912,1387520,36096,7806976,466688,36928,6240,22656,0,0,0,3,4294967295,0,0,7688,1049336022,3584,344832,459520,574208,402176,516864,631552,1434368,101120,126208,151296,176384,8151040,8159232,8167424,8155136,8163328,8171520,8228864,8249344,8251392,8253440,8255488,653312,653440,785408
.long 1024,1152,57344,172032,2514944,2600960,9634816,9782272,9633792,9781248,9638912,9786368,9637888,9785344,1205376,28672,82176,81920,84224,83968,229376,0,0,0,0,0,1129472,1215488,1301504,24576,69632,12288,7312,15504,800,22160,85000,39200,39424,1473536,36352,7954432,473856,36992,6336,22784,0,0,0,3,4294967295,0,0,13832,1049336022,3584,688896,803584,918272,746240,860928,975616,1491712,201472,226560,251648,276736,8175616,8183808,8192000,8179712,8187904,8196096,8232960,8257536,8259584,8261632,8263680,603136,603264,796160
.long 115712,115840,57344,172032,2603008,2516992,9784320,9636864,9783296,9635840,9788416,9640960,9787392,9639936,1406080,28672,82688,82432,84736,84480,229376,0,0,0,0,0,1387520,1473536,1559552,36864,79872,18432,7320,15512,800,22168,85512,39216,39424,1559552,36608,8101888,481024,37056,6432,22912,0,0,0,3,4294967295,0,0,19976,1049336022,3584,1032960,1147648,1262336,1090304,1204992,1319680,1549056,301824,326912,352000,377088,8200192,8208384,8216576,8204288,8212480,8220672,8237056,8265728,8267776,8269824,8271872,653312,653440,806912
.long 1024,1152,57344,172032,5095424,5181440,14057472,14204928,14058496,14205952,14061568,14209024,14062592,14210048,1152,28672,81920,82176,83968,84224,229376,0,0,0,0,0,616960,702976,788992,0,49152,0,11392,19584,1824,22208,83968,47360,47104,1305088,35840,7663616,688896,38912,7168,23552,0,0,0,3,4294967295,0,0,1544,1049336022,3584,768,115456,230144,58112,172800,287488,1377024,768,25856,50944,76032,9306112,9314304,9322496,9310208,9318400,9326592,9404416,9420800,9422848,9424896,9426944,1405952,1406080,1118720
.long 115712,115840,57344,172032,5183488,5097472,14206976,14059520,14208000,14060544,14211072,14063616,14212096,14064640,201856,28672,82432,82688,84480,84736,229376,0,0,0,0,0,875008,961024,1047040,12288,59392,6144,11400,19592,1824,22216,84480,47376,47104,1391104,36096,7811072,696064,38976,7264,23680,0,0,0,3,4294967295,0,0,7688,1049336022,3584,344832,459520,574208,402176,516864,631552,1434368,101120,126208,151296,176384,9330688,9338880,9347072,9334784,9342976,9351168,9408512,9428992,9431040,9433088,9435136,1456128,1456256,1129472
.long 1024,1152,57344,172032,5267456,5353472,14353408,14500864,14352384,14499840,14357504,14504960,14356480,14503936,402560,28672,82176,81920,84224,83968,229376,0,0,0,0,0,1133056,1219072,1305088,24576,69632,12288,11408,19600,1824,22224,83976,47392,47616,1477120,36352,7958528,703232,39040,7360,23808,0,0,0,3,4294967295,0,0,13832,1049336022,3584,688896,803584,918272,746240,860928,975616,1491712,201472,226560,251648,276736,9355264,9363456,9371648,9359360,9367552,9375744,9412608,9437184,9439232,9441280,9443328,1405952,1406080,1140224
.long 115712,115840,57344,172032,5355520,5269504,14502912,14355456,14501888,14354432,14507008,14359552,14505984,14358528,603264,28672,82688,82432,84736,84480,229376,0,0,0,0,0,1391104,1477120,1563136,36864,79872,18432,11416,19608,1824,22232,84488,47408,47616,1563136,36608,8105984,710400,39104,7456,23936,0,0,0,3,4294967295,0,0,19976,1049336022,3584,1032960,1147648,1262336,1090304,1204992,1319680,1549056,301824,326912,352000,377088,9379840,9388032,9396224,9383936,9392128,9400320,9416704,9445376,9447424,9449472,9451520,1456128,1456256,1150976
.long 2048,2176,57344,172032,2359296,2445312,9371648,9519104,9372672,9520128,9375744,9523200,9376768,9524224,804992,28672,98304,98560,100352,100608,229376,0,0,0,0,0,620544,706560,792576,0,49152,0,7424,15616,832,22272,101376,39424,38912,1308672,35840,7667712,918272,40960,8192,24576,0,0,0,3,4294967295,0,0,1544,1065353216,3584,768,115456,230144,58112,172800,287488,1377024,768,25856,50944,76032,10485760,10493952,10502144,10489856,10498048,10506240,10584064,10600448,10602496,10604544,10606592,604160,604288,775168
.long 116736,116864,57344,172032,2447360,2361344,9521152,9373696,9522176,9374720,9525248,9377792,9526272,9378816,1005696,28672,98816,99072,100864,101120,229376,0,0,0,0,0,878592,964608,1050624,12288,59392,6144,7432,15624,832,22280,101888,39440,38912,1394688,36096,7815168,925440,41024,8288,24704,0,0,0,3,4294967295,0,0,7688,1065353216,3584,344832,459520,574208,402176,516864,631552,1434368,101120,126208,151296,176384,10510336,10518528,10526720,10514432,10522624,10530816,10588160,10608640,10610688,10612736,10614784,654336,654464,785920
.long 2048,2176,57344,172032,2531328,2617344,9667584,9815040,9666560,9814016,9671680,9819136,9670656,9818112,1206400,28672,98560,98304,100608,100352,229376,0,0,0,0,0,1136640,1222656,1308672,24576,69632,12288,7440,15632,832,22288,101384,39456,39424,1480704,36352,7962624,932608,41088,8384,24832,0,0,0,3,4294967295,0,0,13832,1065353216,3584,688896,803584,918272,746240,860928,975616,1491712,201472,226560,251648,276736,10534912,10543104,10551296,10539008,10547200,10555392,10592256,10616832,10618880,10620928,10622976,604160,604288,796672
.long 116736,116864,57344,172032,2619392,2533376,9817088,9669632,9816064,9668608,9821184,9673728,9820160,9672704,1407104,28672,99072,98816,101120,100864,229376,0,0,0,0,0,1394688,1480704,1566720,36864,79872,18432,7448,15640,832,22296,101896,39472,39424,1566720,36608,8110080,939776,41152,8480,24960,0,0,0,3,4294967295,0,0,19976,1065353216,3584,1032960,1147648,1262336,1090304,1204992,1319680,1549056,301824,326912,352000,377088,10559488,10567680,10575872,10563584,10571776,10579968,10596352,10625024,10627072,10629120,10631168,654336,654464,807424
.long 2048,2176,57344,172032,5111808,5197824,14090240,14237696,14091264,14238720,14094336,14241792,14095360,14242816,2176,28672,98304,98560,100352,100608,229376,0,0,0,0,0,624128,710144,796160,0,49152,0,11520,19712,1856,22336,100352,47616,47104,1312256,35840,7671808,1147648,43008,9216,25600,0,0,0,3,4294967295,0,0,1544,1065353216,3584,768,115456,230144,58112,172800,287488,1377024,768,25856,50944,76032,11665408,11673600,11681792,11669504,11677696,11685888,11763712,11780096,11782144,11784192,11786240,1406976,1407104,1119232
.long 116736,116864,57344,172032,5199872,5113856,14239744,14092288,14240768,14093312,14243840,14096384,14244864,14097408,202880,28672,98816,99072,100864,101120,229376,0,0,0,0,0,882176,968192,1054208,12288,59392,6144,11528,19720,1856,22344,100864,47632,47104,1398272,36096,7819264,1154816,43072,9312,25728,0,0,0,3,4294967295,0,0,7688,1065353216,3584,344832,459520,574208,402176,516864,631552,1434368,101120,126208,151296,176384,11689984,11698176,11706368,11694080,11702272,11710464,11767808,11788288,11790336,11792384,11794432,1457152,1457280,1129984
.long 2048,2176,57344,172032,5283840,5369856,14386176,14533632,14385152,14532608,14390272,14537728,14389248,14536704,403584,28672,98560,98304,100608,100352,229376,0,0,0,0,0,1140224,1226240,1312256,24576,69632,12288,11536,19728,1856,22352,100360,47648,47616,1484288,36352,7966720,1161984,43136,9408,25856,0,0,0,3,4294967295,0,0,13832,1065353216,3584,688896,803584,918272,746240,860928,975616,1491712,201472,226560,251648,276736,11714560,11722752,11730944,11718656,11726848,11735040,11771904,11796480,11798528,11800576,11802624,1406976,1407104,1140736
.long 116736,116864,57344,172032,5371904,5285888,14535680,14388224,14534656,14387200,14539776,14392320,14538752,14391296,604288,28672,99072,98816,101120,100864,229376,0,0,0,0,0,1398272,1484288,1570304,36864,79872,18432,11544,19736,1856,22360,100872,47664,47616,1570304,36608,8114176,1169152,43200,9504,25984,0,0,0,3,4294967295,0,0,19976,1065353216,3584,1032960,1147648,1262336,1090304,1204992,1319680,1549056,301824,326912,352000,377088,11739136,11747328,11755520,11743232,11751424,11759616,11776000,11804672,11806720,11808768,11810816,1457152,1457280,1151488
.long 2048,3072,43008,129024,2375680,2461696,2392064,2478080,2394112,2480128,9404416,9551872,9405440,9552896,805888,28672,180224,180736,114688,114944,172032,0,0,0,0,0,627712,713728,799744,0,49152,0,2816,15744,864,22400,115712,39680,38912,1315840,35840,7675904,1377024,45056,10240,26624,0,0,0,3,4294967295,0,0,1544,1065353216,2688,768,115456,230144,58112,172800,287488,1377024,768,25856,50944,76032,12845056,12853248,12861440,12849152,12857344,12865536,12943360,12959744,12961792,12963840,12965888,453632,605184,775680
.long 88064,117760,43008,129024,2463744,2377728,2482176,2396160,2484224,2398208,9553920,9406464,9554944,9407488,1006592,28672,182272,182784,115200,115456,172032,0,0,0,0,0,885760,971776,1057792,12288,59392,6144,2824,15752,864,22408,116224,39696,38912,1401856,36096,7823360,1384192,45120,10336,26752,0,0,0,3,4294967295,0,0,7688,1065353216,2688,344832,459520,574208,402176,516864,631552,1434368,101120,126208,151296,176384,12869632,12877824,12886016,12873728,12881920,12890112,12947456,12967936,12969984,12972032,12974080,491264,655360,786432
.long 2176,3072,43008,129024,2547712,2633728,2566144,2652160,2564096,2650112,9700352,9847808,9699328,9846784,1207296,28672,180736,180224,114944,114688,172032,0,0,0,0,0,1143808,1229824,1315840,24576,69632,12288,2832,15760,864,22416,115720,39712,39424,1487872,36352,7970816,1391360,45184,10432,26880,0,0,0,3,4294967295,0,0,13832,1065353216,2688,688896,803584,918272,746240,860928,975616,1491712,201472,226560,251648,276736,12894208,12902400,12910592,12898304,12906496,12914688,12951552,12976128,12978176,12980224,12982272,453760,605184,797184
.long 88192,117760,43008,129024,2635776,2549760,2656256,2570240,2654208,2568192,9849856,9702400,9848832,9701376,1408000,28672,182784,182272,115456,115200,172032,0,0,0,0,0,1401856,1487872,1573888,36864,79872,18432,2840,15768,864,22424,116232,39728,39424,1573888,36608,8118272,1398528,45248,10528,27008,0,0,0,3,4294967295,0,0,19976,1065353216,2688,1032960,1147648,1262336,1090304,1204992,1319680,1549056,301824,326912,352000,377088,12918784,12926976,12935168,12922880,12931072,12939264,12955648,12984320,12986368,12988416,12990464,491392,655360,807936
.long 2048,3072,43008,129024,5128192,5214208,5144576,5230592,5146624,5232640,14123008,14270464,14124032,14271488,3072,28672,180224,180736,114688,114944,172032,0,0,0,0,0,631296,717312,803328,0,49152,0,3840,19840,1888,22464,114688,47872,47104,1319424,35840,7680000,1606400,47104,11264,27648,0,0,0,3,4294967295,0,0,1544,1065353216,2688,768,115456,230144,58112,172800,287488,1377024,768,25856,50944,76032,14024704,14032896,14041088,14028800,14036992,14045184,14123008,14139392,14141440,14143488,14145536,1055744,1408000,1119744
.long 88064,117760,43008,129024,5216256,5130240,5234688,5148672,5236736,5150720,14272512,14125056,14273536,14126080,203776,28672,182272,182784,115200,115456,172032,0,0,0,0,0,889344,975360,1061376,12288,59392,6144,3848,19848,1888,22472,115200,47888,47104,1405440,36096,7827456,1613568,47168,11360,27776,0,0,0,3,4294967295,0,0,7688,1065353216,2688,344832,459520,574208,402176,516864,631552,1434368,101120,126208,151296,176384,14049280,14057472,14065664,14053376,14061568,14069760,14127104,14147584,14149632,14151680,14153728,1093376,1458176,1130496
.long 2176,3072,43008,129024,5300224,5386240,5318656,5404672,5316608,5402624,14418944,14566400,14417920,14565376,404480,28672,180736,180224,114944,114688,172032,0,0,0,0,0,1147392,1233408,1319424,24576,69632,12288,3856,19856,1888,22480,114696,47904,47616,1491456,36352,7974912,1620736,47232,11456,27904,0,0,0,3,4294967295,0,0,13832,1065353216,2688,688896,803584,918272,746240,860928,975616,1491712,201472,226560,251648,276736,14073856,14082048,14090240,14077952,14086144,14094336,14131200,14155776,14157824,14159872,14161920,1055872,1408000,1141248
.long 88192,117760,43008,129024,5388288,5302272,5408768,5322752,5406720,5320704,14568448,14420992,14567424,14419968,605184,28672,182784,182272,115456,115200,172032,0,0,0,0,0,1405440,1491456,1577472,36864,79872,18432,3864,19864,1888,22488,115208,47920,47616,1577472,36608,8122368,1627904,47296,11552,28032,0,0,0,3,4294967295,0,0,19976,1065353216,2688,1032960,1147648,1262336,1090304,1204992,1319680,1549056,301824,326912,352000,377088,14098432,14106624,14114816,14102528,14110720,14118912,14135296,14163968,14166016,14168064,14170112,1093504,1458176,1152000
.long 0,128,57344,172032,2670592,2756608,9895936,10043392,9896960,10044416,9900032,10047488,9901056,10048512,802944,28672,65536,65792,67584,67840,229376,0,0,0,0,0,607744,693760,779776,0,49152,0,7680,15872,896,22048,125952,39936,39936,1295872,35840,7653376,57344,33280,4112,20496,0,0,0,3,0,4294967295,1,0,1049336022,3584,0,114688,229376,57344,172032,286720,1376256,0,25088,50176,75264,6062080,6070272,6078464,6066176,6074368,6082560,6160384,6176768,6178816,6180864,6182912,702464,702592,817152
.long 114688,114816,57344,172032,2758656,2672640,10045440,9897984,10046464,9899008,10049536,9902080,10050560,9903104,1003648,28672,66048,66304,68096,68352,229376,0,0,0,0,0,865792,951808,1037824,12288,59392,6144,7688,15880,896,22056,126464,39952,39936,1381888,36096,7800832,64512,33344,4208,20624,0,0,0,3,0,4294967295,1,6144,1049336022,3584,344064,458752,573440,401408,516096,630784,1433600,100352,125440,150528,175616,6086656,6094848,6103040,6090752,6098944,6107136,6164480,6184960,6187008,6189056,6191104,752640,752768,827904
.long 0,128,57344,172032,2842624,2928640,10191872,10339328,10190848,10338304,10195968,10343424,10194944,10342400,1204352,28672,65792,65536,67840,67584,229376,0,0,0,0,0,1123840,1209856,1295872,24576,69632,12288,7696,15888,896,22064,125960,39968,40448,1467904,36352,7948288,71680,33408,4304,20752,0,0,0,3,0,4294967295,1,12288,1049336022,3584,688128,802816,917504,745472,860160,974848,1490944,200704,225792,250880,275968,6111232,6119424,6127616,6115328,6123520,6131712,6168576,6193152,6195200,6197248,6199296,702464,702592,838656
.long 114688,114816,57344,172032,2930688,2844672,10341376,10193920,10340352,10192896,10345472,10198016,10344448,10196992,1405056,28672,66304,66048,68352,68096,229376,0,0,0,0,0,1381888,1467904,1553920,36864,79872,18432,7704,15896,896,22072,126472,39984,40448,1553920,36608,8095744,78848,33472,4400,20880,0,0,0,3,0,4294967295,1,18432,1049336022,3584,1032192,1146880,1261568,1089536,1204224,1318912,1548288,301056,326144,351232,376320,6135808,6144000,6152192,6139904,6148096,6156288,6172672,6201344,6203392,6205440,6207488,752640,752768,849408
.long 0,128,57344,172032,5423104,5509120,14614528,14761984,14615552,14763008,14618624,14766080,14619648,14767104,128,28672,65536,65792,67584,67840,229376,0,0,0,0,0,611328,697344,783360,0,49152,0,11776,19968,1920,22112,124928,48128,48128,1299456,35840,7657472,286720,35328,5136,21520,0,0,0,3,0,4294967295,1,0,1049336022,3584,0,114688,229376,57344,172032,286720,1376256,0,25088,50176,75264,7241728,7249920,7258112,7245824,7254016,7262208,7340032,7356416,7358464,7360512,7362560,1505280,1505408,1161216
.long 114688,114816,57344,172032,5511168,5425152,14764032,14616576,14765056,14617600,14768128,14620672,14769152,14621696,200832,28672,66048,66304,68096,68352,229376,0,0,0,0,0,869376,955392,1041408,12288,59392,6144,11784,19976,1920,22120,125440,48144,48128,1385472,36096,7804928,293888,35392,5232,21648,0,0,0,3,0,4294967295,1,6144,1049336022,3584,344064,458752,573440,401408,516096,630784,1433600,100352,125440,150528,175616,7266304,7274496,7282688,7270400,7278592,7286784,7344128,7364608,7366656,7368704,7370752,1555456,1555584,1171968
.long 0,128,57344,172032,5595136,5681152,14910464,15057920,14909440,15056896,14914560,15062016,14913536,15060992,401536,28672,65792,65536,67840,67584,229376,0,0,0,0,0,1127424,1213440,1299456,24576,69632,12288,11792,19984,1920,22128,124936,48160,48640,1471488,36352,7952384,301056,35456,5328,21776,0,0,0,3,0,4294967295,1,12288,1049336022,3584,688128,802816,917504,745472,860160,974848,1490944,200704,225792,250880,275968,7290880,7299072,7307264,7294976,7303168,7311360,7348224,7372800,7374848,7376896,7378944,1505280,1505408,1182720
.long 114688,114816,57344,172032,5683200,5597184,15059968,14912512,15058944,14911488,15064064,14916608,15063040,14915584,602240,28672,66304,66048,68352,68096,229376,0,0,0,0,0,1385472,1471488,1557504,36864,79872,18432,11800,19992,1920,22136,125448,48176,48640,1557504,36608,8099840,308224,35520,5424,21904,0,0,0,3,0,4294967295,1,18432,1049336022,3584,1032192,1146880,1261568,1089536,1204224,1318912,1548288,301056,326144,351232,376320,7315456,7323648,7331840,7319552,7327744,7335936,7352320,7380992,7383040,7385088,7387136,1555456,1555584,1193472
.long 1024,1152,57344,172032,2686976,2772992,9928704,10076160,9929728,10077184,9932800,10080256,9933824,10081280,803968,28672,81920,82176,83968,84224,229376,0,0,0,0,0,614912,700928,786944,0,49152,0,7808,16000,928,22176,142336,40192,39936,1303040,35840,7661568,516096,37376,6160,22544,0,0,0,3,0,4294967295,1,0,1049336022,3584,0,114688,229376,57344,172032,286720,1376256,0,25088,50176,75264,8421376,8429568,8437760,8425472,8433664,8441856,8519680,8536064,8538112,8540160,8542208,703488,703616,817664
.long 115712,115840,57344,172032,2775040,2689024,10078208,9930752,10079232,9931776,10082304,9934848,10083328,9935872,1004672,28672,82432,82688,84480,84736,229376,0,0,0,0,0,872960,958976,1044992,12288,59392,6144,7816,16008,928,22184,142848,40208,39936,1389056,36096,7809024,523264,37440,6256,22672,0,0,0,3,0,4294967295,1,6144,1049336022,3584,344064,458752,573440,401408,516096,630784,1433600,100352,125440,150528,175616,8445952,8454144,8462336,8450048,8458240,8466432,8523776,8544256,8546304,8548352,8550400,753664,753792,828416
.long 1024,1152,57344,172032,2859008,2945024,10224640,10372096,10223616,10371072,10228736,10376192,10227712,10375168,1205376,28672,82176,81920,84224,83968,229376,0,0,0,0,0,1131008,1217024,1303040,24576,69632,12288,7824,16016,928,22192,142344,40224,40448,1475072,36352,7956480,530432,37504,6352,22800,0,0,0,3,0,4294967295,1,12288,1049336022,3584,688128,802816,917504,745472,860160,974848,1490944,200704,225792,250880,275968,8470528,8478720,8486912,8474624,8482816,8491008,8527872,8552448,8554496,8556544,8558592,703488,703616,839168
.long 115712,115840,57344,172032,2947072,2861056,10374144,10226688,10373120,10225664,10378240,10230784,10377216,10229760,1406080,28672,82688,82432,84736,84480,229376,0,0,0,0,0,1389056,1475072,1561088,36864,79872,18432,7832,16024,928,22200,142856,40240,40448,1561088,36608,8103936,537600,37568,6448,22928,0,0,0,3,0,4294967295,1,18432,1049336022,3584,1032192,1146880,1261568,1089536,1204224,1318912,1548288,301056,326144,351232,376320,8495104,8503296,8511488,8499200,8507392,8515584,8531968,8560640,8562688,8564736,8566784,753664,753792,849920
.long 1024,1152,57344,172032,5439488,5525504,14647296,14794752,14648320,14795776,14651392,14798848,14652416,14799872,1152,28672,81920,82176,83968,84224,229376,0,0,0,0,0,618496,704512,790528,0,49152,0,11904,20096,1952,22240,141312,48384,48128,1306624,35840,7665664,745472,39424,7184,23568,0,0,0,3,0,4294967295,1,0,1049336022,3584,0,114688,229376,57344,172032,286720,1376256,0,25088,50176,75264,9601024,9609216,9617408,9605120,9613312,9621504,9699328,9715712,9717760,9719808,9721856,1506304,1506432,1161728
.long 115712,115840,57344,172032,5527552,5441536,14796800,14649344,14797824,14650368,14800896,14653440,14801920,14654464,201856,28672,82432,82688,84480,84736,229376,0,0,0,0,0,876544,962560,1048576,12288,59392,6144,11912,20104,1952,22248,141824,48400,48128,1392640,36096,7813120,752640,39488,7280,23696,0,0,0,3,0,4294967295,1,6144,1049336022,3584,344064,458752,573440,401408,516096,630784,1433600,100352,125440,150528,175616,9625600,9633792,9641984,9629696,9637888,9646080,9703424,9723904,9725952,9728000,9730048,1556480,1556608,1172480
.long 1024,1152,57344,172032,5611520,5697536,14943232,15090688,14942208,15089664,14947328,15094784,14946304,15093760,402560,28672,82176,81920,84224,83968,229376,0,0,0,0,0,1134592,1220608,1306624,24576,69632,12288,11920,20112,1952,22256,141320,48416,48640,1478656,36352,7960576,759808,39552,7376,23824,0,0,0,3,0,4294967295,1,12288,1049336022,3584,688128,802816,917504,745472,860160,974848,1490944,200704,225792,250880,275968,9650176,9658368,9666560,9654272,9662464,9670656,9707520,9732096,9734144,9736192,9738240,1506304,1506432,1183232
.long 115712,115840,57344,172032,5699584,5613568,15092736,14945280,15091712,14944256,15096832,14949376,15095808,14948352,603264,28672,82688,82432,84736,84480,229376,0,0,0,0,0,1392640,1478656,1564672,36864,79872,18432,11928,20120,1952,22264,141832,48432,48640,1564672,36608,8108032,766976,39616,7472,23952,0,0,0,3,0,4294967295,1,18432,1049336022,3584,1032192,1146880,1261568,1089536,1204224,1318912,1548288,301056,326144,351232,376320,9674752,9682944,9691136,9678848,9687040,9695232,9711616,9740288,9742336,9744384,9746432,1556480,1556608,1193984
.long 2048,2176,57344,172032,2703360,2789376,9961472,10108928,9962496,10109952,9965568,10113024,9966592,10114048,804992,28672,98304,98560,100352,100608,229376,0,0,0,0,0,622080,708096,794112,0,49152,0,7936,16128,960,22304,158720,40448,39936,1310208,35840,7669760,974848,41472,8208,24592,0,0,0,3,0,4294967295,1,0,1065353216,3584,0,114688,229376,57344,172032,286720,1376256,0,25088,50176,75264,10780672,10788864,10797056,10784768,10792960,10801152,10878976,10895360,10897408,10899456,10901504,704512,704640,818176
.long 116736,116864,57344,172032,2791424,2705408,10110976,9963520,10112000,9964544,10115072,9967616,10116096,9968640,1005696,28672,98816,99072,100864,101120,229376,0,0,0,0,0,880128,966144,1052160,12288,59392,6144,7944,16136,960,22312,159232,40464,39936,1396224,36096,7817216,982016,41536,8304,24720,0,0,0,3,0,4294967295,1,6144,1065353216,3584,344064,458752,573440,401408,516096,630784,1433600,100352,125440,150528,175616,10805248,10813440,10821632,10809344,10817536,10825728,10883072,10903552,10905600,10907648,10909696,754688,754816,828928
.long 2048,2176,57344,172032,2875392,2961408,10257408,10404864,10256384,10403840,10261504,10408960,10260480,10407936,1206400,28672,98560,98304,100608,100352,229376,0,0,0,0,0,1138176,1224192,1310208,24576,69632,12288,7952,16144,960,22320,158728,40480,40448,1482240,36352,7964672,989184,41600,8400,24848,0,0,0,3,0,4294967295,1,12288,1065353216,3584,688128,802816,917504,745472,860160,974848,1490944,200704,225792,250880,275968,10829824,10838016,10846208,10833920,10842112,10850304,10887168,10911744,10913792,10915840,10917888,704512,704640,839680
.long 116736,116864,57344,172032,2963456,2877440,10406912,10259456,10405888,10258432,10411008,10263552,10409984,10262528,1407104,28672,99072,98816,101120,100864,229376,0,0,0,0,0,1396224,1482240,1568256,36864,79872,18432,7960,16152,960,22328,159240,40496,40448,1568256,36608,8112128,996352,41664,8496,24976,0,0,0,3,0,4294967295,1,18432,1065353216,3584,1032192,1146880,1261568,1089536,1204224,1318912,1548288,301056,326144,351232,376320,10854400,10862592,10870784,10858496,10866688,10874880,10891264,10919936,10921984,10924032,10926080,754688,754816,850432
.long 2048,2176,57344,172032,5455872,5541888,14680064,14827520,14681088,14828544,14684160,14831616,14685184,14832640,2176,28672,98304,98560,100352,100608,229376,0,0,0,0,0,625664,711680,797696,0,49152,0,12032,20224,1984,22368,157696,48640,48128,1313792,35840,7673856,1204224,43520,9232,25616,0,0,0,3,0,4294967295,1,0,1065353216,3584,0,114688,229376,57344,172032,286720,1376256,0,25088,50176,75264,11960320,11968512,11976704,11964416,11972608,11980800,12058624,12075008,12077056,12079104,12081152,1507328,1507456,1162240
.long 116736,116864,57344,172032,5543936,5457920,14829568,14682112,14830592,14683136,14833664,14686208,14834688,14687232,202880,28672,98816,99072,100864,101120,229376,0,0,0,0,0,883712,969728,1055744,12288,59392,6144,12040,20232,1984,22376,158208,48656,48128,1399808,36096,7821312,1211392,43584,9328,25744,0,0,0,3,0,4294967295,1,6144,1065353216,3584,344064,458752,573440,401408,516096,630784,1433600,100352,125440,150528,175616,11984896,11993088,12001280,11988992,11997184,12005376,12062720,12083200,12085248,12087296,12089344,1557504,1557632,1172992
.long 2048,2176,57344,172032,5627904,5713920,14976000,15123456,14974976,15122432,14980096,15127552,14979072,15126528,403584,28672,98560,98304,100608,100352,229376,0,0,0,0,0,1141760,1227776,1313792,24576,69632,12288,12048,20240,1984,22384,157704,48672,48640,1485824,36352,7968768,1218560,43648,9424,25872,0,0,0,3,0,4294967295,1,12288,1065353216,3584,688128,802816,917504,745472,860160,974848,1490944,200704,225792,250880,275968,12009472,12017664,12025856,12013568,12021760,12029952,12066816,12091392,12093440,12095488,12097536,1507328,1507456,1183744
.long 116736,116864,57344,172032,5715968,5629952,15125504,14978048,15124480,14977024,15129600,14982144,15128576,14981120,604288,28672,99072,98816,101120,100864,229376,0,0,0,0,0,1399808,1485824,1571840,36864,79872,18432,12056,20248,1984,22392,158216,48688,48640,1571840,36608,8116224,1225728,43712,9520,26000,0,0,0,3,0,4294967295,1,18432,1065353216,3584,1032192,1146880,1261568,1089536,1204224,1318912,1548288,301056,326144,351232,376320,12034048,12042240,12050432,12038144,12046336,12054528,12070912,12099584,12101632,12103680,12105728,1557504,1557632,1194496
.long 2048,3072,43008,129024,2719744,2805760,2736128,2822144,2738176,2824192,9994240,10141696,9995264,10142720,805888,28672,180224,180736,114688,114944,172032,0,0,0,0,0,629248,715264,801280,0,49152,0,2944,16256,992,22432,173056,40704,39936,1317376,35840,7677952,1433600,45568,10256,26640,0,0,0,3,0,4294967295,1,0,1065353216,2688,0,114688,229376,57344,172032,286720,1376256,0,25088,50176,75264,13139968,13148160,13156352,13144064,13152256,13160448,13238272,13254656,13256704,13258752,13260800,528896,705536,818688
.long 88064,117760,43008,129024,2807808,2721792,2826240,2740224,2828288,2742272,10143744,9996288,10144768,9997312,1006592,28672,182272,182784,115200,115456,172032,0,0,0,0,0,887296,973312,1059328,12288,59392,6144,2952,16264,992,22440,173568,40720,39936,1403392,36096,7825408,1440768,45632,10352,26768,0,0,0,3,0,4294967295,1,6144,1065353216,2688,344064,458752,573440,401408,516096,630784,1433600,100352,125440,150528,175616,13164544,13172736,13180928,13168640,13176832,13185024,13242368,13262848,13264896,13266944,13268992,566528,755712,829440
.long 2176,3072,43008,129024,2891776,2977792,2910208,2996224,2908160,2994176,10290176,10437632,10289152,10436608,1207296,28672,180736,180224,114944,114688,172032,0,0,0,0,0,1145344,1231360,1317376,24576,69632,12288,2960,16272,992,22448,173064,40736,40448,1489408,36352,7972864,1447936,45696,10448,26896,0,0,0,3,0,4294967295,1,12288,1065353216,2688,688128,802816,917504,745472,860160,974848,1490944,200704,225792,250880,275968,13189120,13197312,13205504,13193216,13201408,13209600,13246464,13271040,13273088,13275136,13277184,529024,705536,840192
.long 88192,117760,43008,129024,2979840,2893824,3000320,2914304,2998272,2912256,10439680,10292224,10438656,10291200,1408000,28672,182784,182272,115456,115200,172032,0,0,0,0,0,1403392,1489408,1575424,36864,79872,18432,2968,16280,992,22456,173576,40752,40448,1575424,36608,8120320,1455104,45760,10544,27024,0,0,0,3,0,4294967295,1,18432,1065353216,2688,1032192,1146880,1261568,1089536,1204224,1318912,1548288,301056,326144,351232,376320,13213696,13221888,13230080,13217792,13225984,13234176,13250560,13279232,13281280,13283328,13285376,566656,755712,850944
.long 2048,3072,43008,129024,5472256,5558272,5488640,5574656,5490688,5576704,14712832,14860288,14713856,14861312,3072,28672,180224,180736,114688,114944,172032,0,0,0,0,0,632832,718848,804864,0,49152,0,3968,20352,2016,22496,172032,48896,48128,1320960,35840,7682048,1662976,47616,11280,27664,0,0,0,3,0,4294967295,1,0,1065353216,2688,0,114688,229376,57344,172032,286720,1376256,0,25088,50176,75264,14319616,14327808,14336000,14323712,14331904,14340096,14417920,14434304,14436352,14438400,14440448,1131008,1508352,1162752
.long 88064,117760,43008,129024,5560320,5474304,5578752,5492736,5580800,5494784,14862336,14714880,14863360,14715904,203776,28672,182272,182784,115200,115456,172032,0,0,0,0,0,890880,976896,1062912,12288,59392,6144,3976,20360,2016,22504,172544,48912,48128,1406976,36096,7829504,1670144,47680,11376,27792,0,0,0,3,0,4294967295,1,6144,1065353216,2688,344064,458752,573440,401408,516096,630784,1433600,100352,125440,150528,175616,14344192,14352384,14360576,14348288,14356480,14364672,14422016,14442496,14444544,14446592,14448640,1168640,1558528,1173504
.long 2176,3072,43008,129024,5644288,5730304,5662720,5748736,5660672,5746688,15008768,15156224,15007744,15155200,404480,28672,180736,180224,114944,114688,172032,0,0,0,0,0,1148928,1234944,1320960,24576,69632,12288,3984,20368,2016,22512,172040,48928,48640,1492992,36352,7976960,1677312,47744,11472,27920,0,0,0,3,0,4294967295,1,12288,1065353216,2688,688128,802816,917504,745472,860160,974848,1490944,200704,225792,250880,275968,14368768,14376960,14385152,14372864,14381056,14389248,14426112,14450688,14452736,14454784,14456832,1131136,1508352,1184256
.long 88192,117760,43008,129024,5732352,5646336,5752832,5666816,5750784,5664768,15158272,15010816,15157248,15009792,605184,28672,182784,182272,115456,115200,172032,0,0,0,0,0,1406976,1492992,1579008,36864,79872,18432,3992,20376,2016,22520,172552,48944,48640,1579008,36608,8124416,1684480,47808,11568,28048,0,0,0,3,0,4294967295,1,18432,1065353216,2688,1032192,1146880,1261568,1089536,1204224,1318912,1548288,301056,326144,351232,376320,14393344,14401536,14409728,14397440,14405632,14413824,14430208,14458880,14460928,14462976,14465024,1168768,1558528,1195008
.long 256,384,57344,172032,266240,352256,5775360,5922816,5776384,5923840,5779456,5926912,5780480,5927936,256,28672,69632,69888,71680,71936,229376,0,0,0,0,0,950272,1036288,1122304,0,49152,0,4128,12320,8,22528,69632,32832,32768,1638400,36864,8241152,57472,33280,4112,20496,0,0,0,4,4294967295,0,0,1544,1049336022,3584,128,114816,229504,57472,172160,286848,1376384,128,25216,50304,75392,6062080,6070272,6078464,6066176,6074368,6082560,6160384,6176768,6178816,6180864,6182912,256,384,516224
.long 114944,115072,57344,172032,354304,268288,5924864,5777408,5925888,5778432,5928960,5781504,5929984,5782528,200960,28672,70144,70400,72192,72448,229376,0,0,0,0,0,1208320,1294336,1380352,12288,59392,6144,4136,12328,8,22536,70144,32848,32768,1724416,37120,8388608,64640,33344,4208,20624,0,0,0,4,4294967295,0,0,7688,1049336022,3584,344192,458880,573568,401536,516224,630912,1433728,100480,125568,150656,175744,6086656,6094848,6103040,6090752,6098944,6107136,6164480,6184960,6187008,6189056,6191104,50432,50560,526976
.long 256,384,57344,172032,438272,524288,6071296,6218752,6070272,6217728,6075392,6222848,6074368,6221824,401664,28672,69888,69632,71936,71680,229376,0,0,0,0,0,1466368,1552384,1638400,24576,69632,12288,4144,12336,8,22544,69640,32864,33280,1810432,37376,8536064,71808,33408,4304,20752,0,0,0,4,4294967295,0,0,13832,1049336022,3584,688256,802944,917632,745600,860288,974976,1491072,200832,225920,251008,276096,6111232,6119424,6127616,6115328,6123520,6131712,6168576,6193152,6195200,6197248,6199296,256,384,537728
.long 114944,115072,57344,172032,526336,440320,6220800,6073344,6219776,6072320,6224896,6077440,6223872,6076416,602368,28672,70400,70144,72448,72192,229376,0,0,0,0,0,1724416,1810432,1896448,36864,79872,18432,4152,12344,8,22552,70152,32880,33280,1896448,37632,8683520,78976,33472,4400,20880,0,0,0,4,4294967295,0,0,19976,1049336022,3584,1032320,1147008,1261696,1089664,1204352,1319040,1548416,301184,326272,351360,376448,6135808,6144000,6152192,6139904,6148096,6156288,6172672,6201344,6203392,6205440,6207488,50432,50560,548480
.long 256,384,57344,172032,3018752,3104768,10493952,10641408,10494976,10642432,10498048,10645504,10499072,10646528,803072,28672,69632,69888,71680,71936,229376,0,0,0,0,0,953856,1039872,1125888,0,49152,0,8224,16416,1032,22592,70656,41024,40960,1641984,36864,8245248,286848,35328,5136,21520,0,0,0,4,4294967295,0,0,1544,1049336022,3584,128,114816,229504,57472,172160,286848,1376384,128,25216,50304,75392,7241728,7249920,7258112,7245824,7254016,7262208,7340032,7356416,7358464,7360512,7362560,803072,803200,860288
.long 114944,115072,57344,172032,3106816,3020800,10643456,10496000,10644480,10497024,10647552,10500096,10648576,10501120,1003776,28672,70144,70400,72192,72448,229376,0,0,0,0,0,1211904,1297920,1383936,12288,59392,6144,8232,16424,1032,22600,71168,41040,40960,1728000,37120,8392704,294016,35392,5232,21648,0,0,0,4,4294967295,0,0,7688,1049336022,3584,344192,458880,573568,401536,516224,630912,1433728,100480,125568,150656,175744,7266304,7274496,7282688,7270400,7278592,7286784,7344128,7364608,7366656,7368704,7370752,853248,853376,871040
.long 256,384,57344,172032,3190784,3276800,10789888,10937344,10788864,10936320,10793984,10941440,10792960,10940416,1204480,28672,69888,69632,71936,71680,229376,0,0,0,0,0,1469952,1555968,1641984,24576,69632,12288,8240,16432,1032,22608,70664,41056,41472,1814016,37376,8540160,301184,35456,5328,21776,0,0,0,4,4294967295,0,0,13832,1049336022,3584,688256,802944,917632,745600,860288,974976,1491072,200832,225920,251008,276096,7290880,7299072,7307264,7294976,7303168,7311360,7348224,7372800,7374848,7376896,7378944,803072,803200,881792
.long 114944,115072,57344,172032,3278848,3192832,10939392,10791936,10938368,10790912,10943488,10796032,10942464,10795008,1405184,28672,70400,70144,72448,72192,229376,0,0,0,0,0,1728000,1814016,1900032,36864,79872,18432,8248,16440,1032,22616,71176,41072,41472,1900032,37632,8687616,308352,35520,5424,21904,0,0,0,4,4294967295,0,0,19976,1049336022,3584,1032320,1147008,1261696,1089664,1204352,1319040,1548416,301184,326272,351360,376448,7315456,7323648,7331840,7319552,7327744,7335936,7352320,7380992,7383040,7385088,7387136,853248,853376,892544
.long 1280,1408,57344,172032,282624,368640,5808128,5955584,5809152,5956608,5812224,5959680,5813248,5960704,1280,28672,86016,86272,88064,88320,229376,0,0,0,0,0,957440,1043456,1129472,0,49152,0,4256,12448,40,22656,86016,33088,32768,1645568,36864,8249344,516224,37376,6160,22544,0,0,0,4,4294967295,0,0,1544,1049336022,3584,128,114816,229504,57472,172160,286848,1376384,128,25216,50304,75392,8421376,8429568,8437760,8425472,8433664,8441856,8519680,8536064,8538112,8540160,8542208,1280,1408,516736
.long 115968,116096,57344,172032,370688,284672,5957632,5810176,5958656,5811200,5961728,5814272,5962752,5815296,201984,28672,86528,86784,88576,88832,229376,0,0,0,0,0,1215488,1301504,1387520,12288,59392,6144,4264,12456,40,22664,86528,33104,32768,1731584,37120,8396800,523392,37440,6256,22672,0,0,0,4,4294967295,0,0,7688,1049336022,3584,344192,458880,573568,401536,516224,630912,1433728,100480,125568,150656,175744,8445952,8454144,8462336,8450048,8458240,8466432,8523776,8544256,8546304,8548352,8550400,51456,51584,527488
.long 1280,1408,57344,172032,454656,540672,6104064,6251520,6103040,6250496,6108160,6255616,6107136,6254592,402688,28672,86272,86016,88320,88064,229376,0,0,0,0,0,1473536,1559552,1645568,24576,69632,12288,4272,12464,40,22672,86024,33120,33280,1817600,37376,8544256,530560,37504,6352,22800,0,0,0,4,4294967295,0,0,13832,1049336022,3584,688256,802944,917632,745600,860288,974976,1491072,200832,225920,251008,276096,8470528,8478720,8486912,8474624,8482816,8491008,8527872,8552448,8554496,8556544,8558592,1280,1408,538240
.long 115968,116096,57344,172032,542720,456704,6253568,6106112,6252544,6105088,6257664,6110208,6256640,6109184,603392,28672,86784,86528,88832,88576,229376,0,0,0,0,0,1731584,1817600,1903616,36864,79872,18432,4280,12472,40,22680,86536,33136,33280,1903616,37632,8691712,537728,37568,6448,22928,0,0,0,4,4294967295,0,0,19976,1049336022,3584,1032320,1147008,1261696,1089664,1204352,1319040,1548416,301184,326272,351360,376448,8495104,8503296,8511488,8499200,8507392,8515584,8531968,8560640,8562688,8564736,8566784,51456,51584,548992
.long 1280,1408,57344,172032,3035136,3121152,10526720,10674176,10527744,10675200,10530816,10678272,10531840,10679296,804096,28672,86016,86272,88064,88320,229376,0,0,0,0,0,961024,1047040,1133056,0,49152,0,8352,16544,1064,22720,87040,41280,40960,1649152,36864,8253440,745600,39424,7184,23568,0,0,0,4,4294967295,0,0,1544,1049336022,3584,128,114816,229504,57472,172160,286848,1376384,128,25216,50304,75392,9601024,9609216,9617408,9605120,9613312,9621504,9699328,9715712,9717760,9719808,9721856,804096,804224,860800
.long 115968,116096,57344,172032,3123200,3037184,10676224,10528768,10677248,10529792,10680320,10532864,10681344,10533888,1004800,28672,86528,86784,88576,88832,229376,0,0,0,0,0,1219072,1305088,1391104,12288,59392,6144,8360,16552,1064,22728,87552,41296,40960,1735168,37120,8400896,752768,39488,7280,23696,0,0,0,4,4294967295,0,0,7688,1049336022,3584,344192,458880,573568,401536,516224,630912,1433728,100480,125568,150656,175744,9625600,9633792,9641984,9629696,9637888,9646080,9703424,9723904,9725952,9728000,9730048,854272,854400,871552
.long 1280,1408,57344,172032,3207168,3293184,10822656,10970112,10821632,10969088,10826752,10974208,10825728,10973184,1205504,28672,86272,86016,88320,88064,229376,0,0,0,0,0,1477120,1563136,1649152,24576,69632,12288,8368,16560,1064,22736,87048,41312,41472,1821184,37376,8548352,759936,39552,7376,23824,0,0,0,4,4294967295,0,0,13832,1049336022,3584,688256,802944,917632,745600,860288,974976,1491072,200832,225920,251008,276096,9650176,9658368,9666560,9654272,9662464,9670656,9707520,9732096,9734144,9736192,9738240,804096,804224,882304
.long 115968,116096,57344,172032,3295232,3209216,10972160,10824704,10971136,10823680,10976256,10828800,10975232,10827776,1406208,28672,86784,86528,88832,88576,229376,0,0,0,0,0,1735168,1821184,1907200,36864,79872,18432,8376,16568,1064,22744,87560,41328,41472,1907200,37632,8695808,767104,39616,7472,23952,0,0,0,4,4294967295,0,0,19976,1049336022,3584,1032320,1147008,1261696,1089664,1204352,1319040,1548416,301184,326272,351360,376448,9674752,9682944,9691136,9678848,9687040,9695232,9711616,9740288,9742336,9744384,9746432,854272,854400,893056
.long 2304,2432,57344,172032,299008,385024,5840896,5988352,5841920,5989376,5844992,5992448,5846016,5993472,2304,28672,102400,102656,104448,104704,229376,0,0,0,0,0,964608,1050624,1136640,0,49152,0,4384,12576,72,22784,102400,33344,32768,1652736,36864,8257536,974976,41472,8208,24592,0,0,0,4,4294967295,0,0,1544,1065353216,3584,128,114816,229504,57472,172160,286848,1376384,128,25216,50304,75392,10780672,10788864,10797056,10784768,10792960,10801152,10878976,10895360,10897408,10899456,10901504,2304,2432,517248
.long 116992,117120,57344,172032,387072,301056,5990400,5842944,5991424,5843968,5994496,5847040,5995520,5848064,203008,28672,102912,103168,104960,105216,229376,0,0,0,0,0,1222656,1308672,1394688,12288,59392,6144,4392,12584,72,22792,102912,33360,32768,1738752,37120,8404992,982144,41536,8304,24720,0,0,0,4,4294967295,0,0,7688,1065353216,3584,344192,458880,573568,401536,516224,630912,1433728,100480,125568,150656,175744,10805248,10813440,10821632,10809344,10817536,10825728,10883072,10903552,10905600,10907648,10909696,52480,52608,528000
.long 2304,2432,57344,172032,471040,557056,6136832,6284288,6135808,6283264,6140928,6288384,6139904,6287360,403712,28672,102656,102400,104704,104448,229376,0,0,0,0,0,1480704,1566720,1652736,24576,69632,12288,4400,12592,72,22800,102408,33376,33280,1824768,37376,8552448,989312,41600,8400,24848,0,0,0,4,4294967295,0,0,13832,1065353216,3584,688256,802944,917632,745600,860288,974976,1491072,200832,225920,251008,276096,10829824,10838016,10846208,10833920,10842112,10850304,10887168,10911744,10913792,10915840,10917888,2304,2432,538752
.long 116992,117120,57344,172032,559104,473088,6286336,6138880,6285312,6137856,6290432,6142976,6289408,6141952,604416,28672,103168,102912,105216,104960,229376,0,0,0,0,0,1738752,1824768,1910784,36864,79872,18432,4408,12600,72,22808,102920,33392,33280,1910784,37632,8699904,996480,41664,8496,24976,0,0,0,4,4294967295,0,0,19976,1065353216,3584,1032320,1147008,1261696,1089664,1204352,1319040,1548416,301184,326272,351360,376448,10854400,10862592,10870784,10858496,10866688,10874880,10891264,10919936,10921984,10924032,10926080,52480,52608,549504
.long 2304,2432,57344,172032,3051520,3137536,10559488,10706944,10560512,10707968,10563584,10711040,10564608,10712064,805120,28672,102400,102656,104448,104704,229376,0,0,0,0,0,968192,1054208,1140224,0,49152,0,8480,16672,1096,22848,103424,41536,40960,1656320,36864,8261632,1204352,43520,9232,25616,0,0,0,4,4294967295,0,0,1544,1065353216,3584,128,114816,229504,57472,172160,286848,1376384,128,25216,50304,75392,11960320,11968512,11976704,11964416,11972608,11980800,12058624,12075008,12077056,12079104,12081152,805120,805248,861312
.long 116992,117120,57344,172032,3139584,3053568,10708992,10561536,10710016,10562560,10713088,10565632,10714112,10566656,1005824,28672,102912,103168,104960,105216,229376,0,0,0,0,0,1226240,1312256,1398272,12288,59392,6144,8488,16680,1096,22856,103936,41552,40960,1742336,37120,8409088,1211520,43584,9328,25744,0,0,0,4,4294967295,0,0,7688,1065353216,3584,344192,458880,573568,401536,516224,630912,1433728,100480,125568,150656,175744,11984896,11993088,12001280,11988992,11997184,12005376,12062720,12083200,12085248,12087296,12089344,855296,855424,872064
.long 2304,2432,57344,172032,3223552,3309568,10855424,11002880,10854400,11001856,10859520,11006976,10858496,11005952,1206528,28672,102656,102400,104704,104448,229376,0,0,0,0,0,1484288,1570304,1656320,24576,69632,12288,8496,16688,1096,22864,103432,41568,41472,1828352,37376,8556544,1218688,43648,9424,25872,0,0,0,4,4294967295,0,0,13832,1065353216,3584,688256,802944,917632,745600,860288,974976,1491072,200832,225920,251008,276096,12009472,12017664,12025856,12013568,12021760,12029952,12066816,12091392,12093440,12095488,12097536,805120,805248,882816
.long 116992,117120,57344,172032,3311616,3225600,11004928,10857472,11003904,10856448,11009024,10861568,11008000,10860544,1407232,28672,103168,102912,105216,104960,229376,0,0,0,0,0,1742336,1828352,1914368,36864,79872,18432,8504,16696,1096,22872,103944,41584,41472,1914368,37632,8704000,1225856,43712,9520,26000,0,0,0,4,4294967295,0,0,19976,1065353216,3584,1032320,1147008,1261696,1089664,1204352,1319040,1548416,301184,326272,351360,376448,12034048,12042240,12050432,12038144,12046336,12054528,12070912,12099584,12101632,12103680,12105728,855296,855424,893568
.long 2304,3200,43008,129024,315392,401408,335872,421888,337920,423936,5869568,6017024,5870592,6018048,2304,21504,184320,184832,116736,116992,172032,0,0,0,0,0,971776,1057792,1143808,0,49152,0,2080,12704,104,22912,184320,33600,32768,1659904,36864,8265728,1433728,45568,10256,26640,0,0,0,4,4294967295,0,0,1544,1065353216,2688,128,114816,229504,57472,172160,286848,1376384,128,25216,50304,75392,13139968,13148160,13156352,13144064,13152256,13160448,13238272,13254656,13256704,13258752,13260800,2304,3200,517760
.long 88320,117888,43008,129024,403456,317440,425984,339968,428032,342016,6019072,5871616,6020096,5872640,152832,21504,186368,186880,117248,117504,172032,0,0,0,0,0,1229824,1315840,1401856,12288,59392,6144,2088,12712,104,22920,184832,33616,32768,1745920,37120,8413184,1440896,45632,10352,26768,0,0,0,4,4294967295,0,0,7688,1065353216,2688,344192,458880,573568,401536,516224,630912,1433728,100480,125568,150656,175744,13164544,13172736,13180928,13168640,13176832,13185024,13242368,13262848,13264896,13266944,13268992,39936,53376,528512
.long 2432,3200,43008,129024,487424,573440,509952,595968,507904,593920,6165504,6312960,6164480,6311936,303360,21504,184832,184320,116992,116736,172032,0,0,0,0,0,1487872,1573888,1659904,24576,69632,12288,2096,12720,104,22928,184328,33632,33280,1831936,37376,8560640,1448064,45696,10448,26896,0,0,0,4,4294967295,0,0,13832,1065353216,2688,688256,802944,917632,745600,860288,974976,1491072,200832,225920,251008,276096,13189120,13197312,13205504,13193216,13201408,13209600,13246464,13271040,13273088,13275136,13277184,2432,3200,539264
.long 88448,117888,43008,129024,575488,489472,600064,514048,598016,512000,6315008,6167552,6313984,6166528,453888,21504,186880,186368,117504,117248,172032,0,0,0,0,0,1745920,1831936,1917952,36864,79872,18432,2104,12728,104,22936,184840,33648,33280,1917952,37632,8708096,1455232,45760,10544,27024,0,0,0,4,4294967295,0,0,19976,1065353216,2688,1032320,1147008,1261696,1089664,1204352,1319040,1548416,301184,326272,351360,376448,13213696,13221888,13230080,13217792,13225984,13234176,13250560,13279232,13281280,13283328,13285376,40064,53376,550016
.long 2304,3200,43008,129024,3067904,3153920,3088384,3174400,3090432,3176448,10588160,10735616,10589184,10736640,604416,21504,184320,184832,116736,116992,172032,0,0,0,0,0,975360,1061376,1147392,0,49152,0,3104,16800,1128,22976,185344,41792,40960,1663488,36864,8269824,1663104,47616,11280,27664,0,0,0,4,4294967295,0,0,1544,1065353216,2688,128,114816,229504,57472,172160,286848,1376384,128,25216,50304,75392,14319616,14327808,14336000,14323712,14331904,14340096,14417920,14434304,14436352,14438400,14440448,604416,806016,861824
.long 88320,117888,43008,129024,3155968,3069952,3178496,3092480,3180544,3094528,10737664,10590208,10738688,10591232,754944,21504,186368,186880,117248,117504,172032,0,0,0,0,0,1233408,1319424,1405440,12288,59392,6144,3112,16808,1128,22984,185856,41808,40960,1749504,37120,8417280,1670272,47680,11376,27792,0,0,0,4,4294967295,0,0,7688,1065353216,2688,344192,458880,573568,401536,516224,630912,1433728,100480,125568,150656,175744,14344192,14352384,14360576,14348288,14356480,14364672,14422016,14442496,14444544,14446592,14448640,642048,856192,872576
.long 2432,3200,43008,129024,3239936,3325952,3262464,3348480,3260416,3346432,10884096,11031552,10883072,11030528,905472,21504,184832,184320,116992,116736,172032,0,0,0,0,0,1491456,1577472,1663488,24576,69632,12288,3120,16816,1128,22992,185352,41824,41472,1835520,37376,8564736,1677440,47744,11472,27920,0,0,0,4,4294967295,0,0,13832,1065353216,2688,688256,802944,917632,745600,860288,974976,1491072,200832,225920,251008,276096,14368768,14376960,14385152,14372864,14381056,14389248,14426112,14450688,14452736,14454784,14456832,604544,806016,883328
.long 88448,117888,43008,129024,3328000,3241984,3352576,3266560,3350528,3264512,11033600,10886144,11032576,10885120,1056000,21504,186880,186368,117504,117248,172032,0,0,0,0,0,1749504,1835520,1921536,36864,79872,18432,3128,16824,1128,23000,185864,41840,41472,1921536,37632,8712192,1684608,47808,11568,28048,0,0,0,4,4294967295,0,0,19976,1065353216,2688,1032320,1147008,1261696,1089664,1204352,1319040,1548416,301184,326272,351360,376448,14393344,14401536,14409728,14397440,14405632,14413824,14430208,14458880,14460928,14462976,14465024,642176,856192,894080
.long 256,384,57344,172032,610304,696320,6365184,6512640,6366208,6513664,6369280,6516736,6370304,6517760,256,28672,69632,69888,71680,71936,229376,0,0,0,0,0,951808,1037824,1123840,0,49152,0,4640,12832,136,22560,126976,33856,33792,1639936,36864,8243200,57600,33280,4112,20496,0,0,0,4,0,4294967295,1,0,1049336022,3584,256,114944,229632,57600,172288,286976,1376512,256,25344,50432,75520,6062080,6070272,6078464,6066176,6074368,6082560,6160384,6176768,6178816,6180864,6182912,100608,100736,559232
.long 114944,115072,57344,172032,698368,612352,6514688,6367232,6515712,6368256,6518784,6371328,6519808,6372352,200960,28672,70144,70400,72192,72448,229376,0,0,0,0,0,1209856,1295872,1381888,12288,59392,6144,4648,12840,136,22568,127488,33872,33792,1725952,37120,8390656,64768,33344,4208,20624,0,0,0,4,0,4294967295,1,6144,1049336022,3584,344320,459008,573696,401664,516352,631040,1433856,100608,125696,150784,175872,6086656,6094848,6103040,6090752,6098944,6107136,6164480,6184960,6187008,6189056,6191104,150784,150912,569984
.long 256,384,57344,172032,782336,868352,6661120,6808576,6660096,6807552,6665216,6812672,6664192,6811648,401664,28672,69888,69632,71936,71680,229376,0,0,0,0,0,1467904,1553920,1639936,24576,69632,12288,4656,12848,136,22576,126984,33888,34304,1811968,37376,8538112,71936,33408,4304,20752,0,0,0,4,0,4294967295,1,12288,1049336022,3584,688384,803072,917760,745728,860416,975104,1491200,200960,226048,251136,276224,6111232,6119424,6127616,6115328,6123520,6131712,6168576,6193152,6195200,6197248,6199296,100608,100736,580736
.long 114944,115072,57344,172032,870400,784384,6810624,6663168,6809600,6662144,6814720,6667264,6813696,6666240,602368,28672,70400,70144,72448,72192,229376,0,0,0,0,0,1725952,1811968,1897984,36864,79872,18432,4664,12856,136,22584,127496,33904,34304,1897984,37632,8685568,79104,33472,4400,20880,0,0,0,4,0,4294967295,1,18432,1049336022,3584,1032448,1147136,1261824,1089792,1204480,1319168,1548544,301312,326400,351488,376576,6135808,6144000,6152192,6139904,6148096,6156288,6172672,6201344,6203392,6205440,6207488,150784,150912,591488
.long 256,384,57344,172032,3362816,3448832,11083776,11231232,11084800,11232256,11087872,11235328,11088896,11236352,803072,28672,69632,69888,71680,71936,229376,0,0,0,0,0,955392,1041408,1127424,0,49152,0,8736,16928,1160,22624,128000,42048,41984,1643520,36864,8247296,286976,35328,5136,21520,0,0,0,4,0,4294967295,1,0,1049336022,3584,256,114944,229632,57600,172288,286976,1376512,256,25344,50432,75520,7241728,7249920,7258112,7245824,7254016,7262208,7340032,7356416,7358464,7360512,7362560,903424,903552,903296
.long 114944,115072,57344,172032,3450880,3364864,11233280,11085824,11234304,11086848,11237376,11089920,11238400,11090944,1003776,28672,70144,70400,72192,72448,229376,0,0,0,0,0,1213440,1299456,1385472,12288,59392,6144,8744,16936,1160,22632,128512,42064,41984,1729536,37120,8394752,294144,35392,5232,21648,0,0,0,4,0,4294967295,1,6144,1049336022,3584,344320,459008,573696,401664,516352,631040,1433856,100608,125696,150784,175872,7266304,7274496,7282688,7270400,7278592,7286784,7344128,7364608,7366656,7368704,7370752,953600,953728,914048
.long 256,384,57344,172032,3534848,3620864,11379712,11527168,11378688,11526144,11383808,11531264,11382784,11530240,1204480,28672,69888,69632,71936,71680,229376,0,0,0,0,0,1471488,1557504,1643520,24576,69632,12288,8752,16944,1160,22640,128008,42080,42496,1815552,37376,8542208,301312,35456,5328,21776,0,0,0,4,0,4294967295,1,12288,1049336022,3584,688384,803072,917760,745728,860416,975104,1491200,200960,226048,251136,276224,7290880,7299072,7307264,7294976,7303168,7311360,7348224,7372800,7374848,7376896,7378944,903424,903552,924800
.long 114944,115072,57344,172032,3622912,3536896,11529216,11381760,11528192,11380736,11533312,11385856,11532288,11384832,1405184,28672,70400,70144,72448,72192,229376,0,0,0,0,0,1729536,1815552,1901568,36864,79872,18432,8760,16952,1160,22648,128520,42096,42496,1901568,37632,8689664,308480,35520,5424,21904,0,0,0,4,0,4294967295,1,18432,1049336022,3584,1032448,1147136,1261824,1089792,1204480,1319168,1548544,301312,326400,351488,376576,7315456,7323648,7331840,7319552,7327744,7335936,7352320,7380992,7383040,7385088,7387136,953600,953728,935552
.long 1280,1408,57344,172032,626688,712704,6397952,6545408,6398976,6546432,6402048,6549504,6403072,6550528,1280,28672,86016,86272,88064,88320,229376,0,0,0,0,0,958976,1044992,1131008,0,49152,0,4768,12960,168,22688,143360,34112,33792,1647104,36864,8251392,516352,37376,6160,22544,0,0,0,4,0,4294967295,1,0,1049336022,3584,256,114944,229632,57600,172288,286976,1376512,256,25344,50432,75520,8421376,8429568,8437760,8425472,8433664,8441856,8519680,8536064,8538112,8540160,8542208,101632,101760,559744
.long 115968,116096,57344,172032,714752,628736,6547456,6400000,6548480,6401024,6551552,6404096,6552576,6405120,201984,28672,86528,86784,88576,88832,229376,0,0,0,0,0,1217024,1303040,1389056,12288,59392,6144,4776,12968,168,22696,143872,34128,33792,1733120,37120,8398848,523520,37440,6256,22672,0,0,0,4,0,4294967295,1,6144,1049336022,3584,344320,459008,573696,401664,516352,631040,1433856,100608,125696,150784,175872,8445952,8454144,8462336,8450048,8458240,8466432,8523776,8544256,8546304,8548352,8550400,151808,151936,570496
.long 1280,1408,57344,172032,798720,884736,6693888,6841344,6692864,6840320,6697984,6845440,6696960,6844416,402688,28672,86272,86016,88320,88064,229376,0,0,0,0,0,1475072,1561088,1647104,24576,69632,12288,4784,12976,168,22704,143368,34144,34304,1819136,37376,8546304,530688,37504,6352,22800,0,0,0,4,0,4294967295,1,12288,1049336022,3584,688384,803072,917760,745728,860416,975104,1491200,200960,226048,251136,276224,8470528,8478720,8486912,8474624,8482816,8491008,8527872,8552448,8554496,8556544,8558592,101632,101760,581248
.long 115968,116096,57344,172032,886784,800768,6843392,6695936,6842368,6694912,6847488,6700032,6846464,6699008,603392,28672,86784,86528,88832,88576,229376,0,0,0,0,0,1733120,1819136,1905152,36864,79872,18432,4792,12984,168,22712,143880,34160,34304,1905152,37632,8693760,537856,37568,6448,22928,0,0,0,4,0,4294967295,1,18432,1049336022,3584,1032448,1147136,1261824,1089792,1204480,1319168,1548544,301312,326400,351488,376576,8495104,8503296,8511488,8499200,8507392,8515584,8531968,8560640,8562688,8564736,8566784,151808,151936,592000
.long 1280,1408,57344,172032,3379200,3465216,11116544,11264000,11117568,11265024,11120640,11268096,11121664,11269120,804096,28672,86016,86272,88064,88320,229376,0,0,0,0,0,962560,1048576,1134592,0,49152,0,8864,17056,1192,22752,144384,42304,41984,1650688,36864,8255488,745728,39424,7184,23568,0,0,0,4,0,4294967295,1,0,1049336022,3584,256,114944,229632,57600,172288,286976,1376512,256,25344,50432,75520,9601024,9609216,9617408,9605120,9613312,9621504,9699328,9715712,9717760,9719808,9721856,904448,904576,903808
.long 115968,116096,57344,172032,3467264,3381248,11266048,11118592,11267072,11119616,11270144,11122688,11271168,11123712,1004800,28672,86528,86784,88576,88832,229376,0,0,0,0,0,1220608,1306624,1392640,12288,59392,6144,8872,17064,1192,22760,144896,42320,41984,1736704,37120,8402944,752896,39488,7280,23696,0,0,0,4,0,4294967295,1,6144,1049336022,3584,344320,459008,573696,401664,516352,631040,1433856,100608,125696,150784,175872,9625600,9633792,9641984,9629696,9637888,9646080,9703424,9723904,9725952,9728000,9730048,954624,954752,914560
.long 1280,1408,57344,172032,3551232,3637248,11412480,11559936,11411456,11558912,11416576,11564032,11415552,11563008,1205504,28672,86272,86016,88320,88064,229376,0,0,0,0,0,1478656,1564672,1650688,24576,69632,12288,8880,17072,1192,22768,144392,42336,42496,1822720,37376,8550400,760064,39552,7376,23824,0,0,0,4,0,4294967295,1,12288,1049336022,3584,688384,803072,917760,745728,860416,975104,1491200,200960,226048,251136,276224,9650176,9658368,9666560,9654272,9662464,9670656,9707520,9732096,9734144,9736192,9738240,904448,904576,925312
.long 115968,116096,57344,172032,3639296,3553280,11561984,11414528,11560960,11413504,11566080,11418624,11565056,11417600,1406208,28672,86784,86528,88832,88576,229376,0,0,0,0,0,1736704,1822720,1908736,36864,79872,18432,8888,17080,1192,22776,144904,42352,42496,1908736,37632,8697856,767232,39616,7472,23952,0,0,0,4,0,4294967295,1,18432,1049336022,3584,1032448,1147136,1261824,1089792,1204480,1319168,1548544,301312,326400,351488,376576,9674752,9682944,9691136,9678848,9687040,9695232,9711616,9740288,9742336,9744384,9746432,954624,954752,936064
.long 2304,2432,57344,172032,643072,729088,6430720,6578176,6431744,6579200,6434816,6582272,6435840,6583296,2304,28672,102400,102656,104448,104704,229376,0,0,0,0,0,966144,1052160,1138176,0,49152,0,4896,13088,200,22816,159744,34368,33792,1654272,36864,8259584,975104,41472,8208,24592,0,0,0,4,0,4294967295,1,0,1065353216,3584,256,114944,229632,57600,172288,286976,1376512,256,25344,50432,75520,10780672,10788864,10797056,10784768,10792960,10801152,10878976,10895360,10897408,10899456,10901504,102656,102784,560256
.long 116992,117120,57344,172032,731136,645120,6580224,6432768,6581248,6433792,6584320,6436864,6585344,6437888,203008,28672,102912,103168,104960,105216,229376,0,0,0,0,0,1224192,1310208,1396224,12288,59392,6144,4904,13096,200,22824,160256,34384,33792,1740288,37120,8407040,982272,41536,8304,24720,0,0,0,4,0,4294967295,1,6144,1065353216,3584,344320,459008,573696,401664,516352,631040,1433856,100608,125696,150784,175872,10805248,10813440,10821632,10809344,10817536,10825728,10883072,10903552,10905600,10907648,10909696,152832,152960,571008
.long 2304,2432,57344,172032,815104,901120,6726656,6874112,6725632,6873088,6730752,6878208,6729728,6877184,403712,28672,102656,102400,104704,104448,229376,0,0,0,0,0,1482240,1568256,1654272,24576,69632,12288,4912,13104,200,22832,159752,34400,34304,1826304,37376,8554496,989440,41600,8400,24848,0,0,0,4,0,4294967295,1,12288,1065353216,3584,688384,803072,917760,745728,860416,975104,1491200,200960,226048,251136,276224,10829824,10838016,10846208,10833920,10842112,10850304,10887168,10911744,10913792,10915840,10917888,102656,102784,581760
.long 116992,117120,57344,172032,903168,817152,6876160,6728704,6875136,6727680,6880256,6732800,6879232,6731776,604416,28672,103168,102912,105216,104960,229376,0,0,0,0,0,1740288,1826304,1912320,36864,79872,18432,4920,13112,200,22840,160264,34416,34304,1912320,37632,8701952,996608,41664,8496,24976,0,0,0,4,0,4294967295,1,18432,1065353216,3584,1032448,1147136,1261824,1089792,1204480,1319168,1548544,301312,326400,351488,376576,10854400,10862592,10870784,10858496,10866688,10874880,10891264,10919936,10921984,10924032,10926080,152832,152960,592512
.long 2304,2432,57344,172032,3395584,3481600,11149312,11296768,11150336,11297792,11153408,11300864,11154432,11301888,805120,28672,102400,102656,104448,104704,229376,0,0,0,0,0,969728,1055744,1141760,0,49152,0,8992,17184,1224,22880,160768,42560,41984,1657856,36864,8263680,1204480,43520,9232,25616,0,0,0,4,0,4294967295,1,0,1065353216,3584,256,114944,229632,57600,172288,286976,1376512,256,25344,50432,75520,11960320,11968512,11976704,11964416,11972608,11980800,12058624,12075008,12077056,12079104,12081152,905472,905600,904320
.long 116992,117120,57344,172032,3483648,3397632,11298816,11151360,11299840,11152384,11302912,11155456,11303936,11156480,1005824,28672,102912,103168,104960,105216,229376,0,0,0,0,0,1227776,1313792,1399808,12288,59392,6144,9000,17192,1224,22888,161280,42576,41984,1743872,37120,8411136,1211648,43584,9328,25744,0,0,0,4,0,4294967295,1,6144,1065353216,3584,344320,459008,573696,401664,516352,631040,1433856,100608,125696,150784,175872,11984896,11993088,12001280,11988992,11997184,12005376,12062720,12083200,12085248,12087296,12089344,955648,955776,915072
.long 2304,2432,57344,172032,3567616,3653632,11445248,11592704,11444224,11591680,11449344,11596800,11448320,11595776,1206528,28672,102656,102400,104704,104448,229376,0,0,0,0,0,1485824,1571840,1657856,24576,69632,12288,9008,17200,1224,22896,160776,42592,42496,1829888,37376,8558592,1218816,43648,9424,25872,0,0,0,4,0,4294967295,1,12288,1065353216,3584,688384,803072,917760,745728,860416,975104,1491200,200960,226048,251136,276224,12009472,12017664,12025856,12013568,12021760,12029952,12066816,12091392,12093440,12095488,12097536,905472,905600,925824
.long 116992,117120,57344,172032,3655680,3569664,11594752,11447296,11593728,11446272,11598848,11451392,11597824,11450368,1407232,28672,103168,102912,105216,104960,229376,0,0,0,0,0,1743872,1829888,1915904,36864,79872,18432,9016,17208,1224,22904,161288,42608,42496,1915904,37632,8706048,1225984,43712,9520,26000,0,0,0,4,0,4294967295,1,18432,1065353216,3584,1032448,1147136,1261824,1089792,1204480,1319168,1548544,301312,326400,351488,376576,12034048,12042240,12050432,12038144,12046336,12054528,12070912,12099584,12101632,12103680,12105728,955648,955776,936576
.long 2304,3200,43008,129024,659456,745472,679936,765952,681984,768000,6459392,6606848,6460416,6607872,2432,21504,184320,184832,116736,116992,172032,0,0,0,0,0,973312,1059328,1145344,0,49152,0,2208,13216,232,22944,186368,34624,33792,1661440,36864,8267776,1433856,45568,10256,26640,0,0,0,4,0,4294967295,1,0,1065353216,2688,256,114944,229632,57600,172288,286976,1376512,256,25344,50432,75520,13139968,13148160,13156352,13144064,13152256,13160448,13238272,13254656,13256704,13258752,13260800,77568,103552,560768
.long 88320,117888,43008,129024,747520,661504,770048,684032,772096,686080,6608896,6461440,6609920,6462464,152960,21504,186368,186880,117248,117504,172032,0,0,0,0,0,1231360,1317376,1403392,12288,59392,6144,2216,13224,232,22952,186880,34640,33792,1747456,37120,8415232,1441024,45632,10352,26768,0,0,0,4,0,4294967295,1,6144,1065353216,2688,344320,459008,573696,401664,516352,631040,1433856,100608,125696,150784,175872,13164544,13172736,13180928,13168640,13176832,13185024,13242368,13262848,13264896,13266944,13268992,115200,153728,571520
.long 2432,3200,43008,129024,831488,917504,854016,940032,851968,937984,6755328,6902784,6754304,6901760,303488,21504,184832,184320,116992,116736,172032,0,0,0,0,0,1489408,1575424,1661440,24576,69632,12288,2224,13232,232,22960,186376,34656,34304,1833472,37376,8562688,1448192,45696,10448,26896,0,0,0,4,0,4294967295,1,12288,1065353216,2688,688384,803072,917760,745728,860416,975104,1491200,200960,226048,251136,276224,13189120,13197312,13205504,13193216,13201408,13209600,13246464,13271040,13273088,13275136,13277184,77696,103552,582272
.long 88448,117888,43008,129024,919552,833536,944128,858112,942080,856064,6904832,6757376,6903808,6756352,454016,21504,186880,186368,117504,117248,172032,0,0,0,0,0,1747456,1833472,1919488,36864,79872,18432,2232,13240,232,22968,186888,34672,34304,1919488,37632,8710144,1455360,45760,10544,27024,0,0,0,4,0,4294967295,1,18432,1065353216,2688,1032448,1147136,1261824,1089792,1204480,1319168,1548544,301312,326400,351488,376576,13213696,13221888,13230080,13217792,13225984,13234176,13250560,13279232,13281280,13283328,13285376,115328,153728,593024
.long 2304,3200,43008,129024,3411968,3497984,3432448,3518464,3434496,3520512,11177984,11325440,11179008,11326464,604544,21504,184320,184832,116736,116992,172032,0,0,0,0,0,976896,1062912,1148928,0,49152,0,3232,17312,1256,23008,187392,42816,41984,1665024,36864,8271872,1663232,47616,11280,27664,0,0,0,4,0,4294967295,1,0,1065353216,2688,256,114944,229632,57600,172288,286976,1376512,256,25344,50432,75520,14319616,14327808,14336000,14323712,14331904,14340096,14417920,14434304,14436352,14438400,14440448,679680,906368,904832
.long 88320,117888,43008,129024,3500032,3414016,3522560,3436544,3524608,3438592,11327488,11180032,11328512,11181056,755072,21504,186368,186880,117248,117504,172032,0,0,0,0,0,1234944,1320960,1406976,12288,59392,6144,3240,17320,1256,23016,187904,42832,41984,1751040,37120,8419328,1670400,47680,11376,27792,0,0,0,4,0,4294967295,1,6144,1065353216,2688,344320,459008,573696,401664,516352,631040,1433856,100608,125696,150784,175872,14344192,14352384,14360576,14348288,14356480,14364672,14422016,14442496,14444544,14446592,14448640,717312,956544,915584
.long 2432,3200,43008,129024,3584000,3670016,3606528,3692544,3604480,3690496,11473920,11621376,11472896,11620352,905600,21504,184832,184320,116992,116736,172032,0,0,0,0,0,1492992,1579008,1665024,24576,69632,12288,3248,17328,1256,23024,187400,42848,42496,1837056,37376,8566784,1677568,47744,11472,27920,0,0,0,4,0,4294967295,1,12288,1065353216,2688,688384,803072,917760,745728,860416,975104,1491200,200960,226048,251136,276224,14368768,14376960,14385152,14372864,14381056,14389248,14426112,14450688,14452736,14454784,14456832,679808,906368,926336
.long 88448,117888,43008,129024,3672064,3586048,3696640,3610624,3694592,3608576,11623424,11475968,11622400,11474944,1056128,21504,186880,186368,117504,117248,172032,0,0,0,0,0,1751040,1837056,1923072,36864,79872,18432,3256,17336,1256,23032,187912,42864,42496,1923072,37632,8714240,1684736,47808,11568,28048,0,0,0,4,0,4294967295,1,18432,1065353216,2688,1032448,1147136,1261824,1089792,1204480,1319168,1548544,301312,326400,351488,376576,14393344,14401536,14409728,14397440,14405632,14413824,14430208,14458880,14460928,14462976,14465024,717440,956544,937088
.long 256,384,57344,172032,954368,1040384,6955008,7102464,6956032,7103488,6959104,7106560,6960128,7107584,384,28672,69632,69888,71680,71936,229376,0,0,0,0,0,1294336,1380352,1466368,0,49152,0,5152,13344,264,23040,71680,34880,34816,1982464,37888,8830976,57728,33280,4112,20496,0,0,0,5,4294967295,0,0,1544,1049336022,3584,384,115072,229760,57728,172416,287104,1376640,384,25472,50560,75648,6062080,6070272,6078464,6066176,6074368,6082560,6160384,6176768,6178816,6180864,6182912,200960,201088,602240
.long 114944,115072,57344,172032,1042432,956416,7104512,6957056,7105536,6958080,7108608,6961152,7109632,6962176,201088,28672,70144,70400,72192,72448,229376,0,0,0,0,0,1552384,1638400,1724416,12288,59392,6144,5160,13352,264,23048,72192,34896,34816,2068480,38144,8978432,64896,33344,4208,20624,0,0,0,5,4294967295,0,0,7688,1049336022,3584,344448,459136,573824,401792,516480,631168,1433984,100736,125824,150912,176000,6086656,6094848,6103040,6090752,6098944,6107136,6164480,6184960,6187008,6189056,6191104,251136,251264,612992
.long 256,384,57344,172032,1126400,1212416,7250944,7398400,7249920,7397376,7255040,7402496,7254016,7401472,401792,28672,69888,69632,71936,71680,229376,0,0,0,0,0,1810432,1896448,1982464,24576,69632,12288,5168,13360,264,23056,71688,34912,35328,2154496,38400,9125888,72064,33408,4304,20752,0,0,0,5,4294967295,0,0,13832,1049336022,3584,688512,803200,917888,745856,860544,975232,1491328,201088,226176,251264,276352,6111232,6119424,6127616,6115328,6123520,6131712,6168576,6193152,6195200,6197248,6199296,200960,201088,623744
.long 114944,115072,57344,172032,1214464,1128448,7400448,7252992,7399424,7251968,7404544,7257088,7403520,7256064,602496,28672,70400,70144,72448,72192,229376,0,0,0,0,0,2068480,2154496,2240512,36864,79872,18432,5176,13368,264,23064,72200,34928,35328,2240512,38656,9273344,79232,33472,4400,20880,0,0,0,5,4294967295,0,0,19976,1049336022,3584,1032576,1147264,1261952,1089920,1204608,1319296,1548672,301440,326528,351616,376704,6135808,6144000,6152192,6139904,6148096,6156288,6172672,6201344,6203392,6205440,6207488,251136,251264,634496
.long 256,384,57344,172032,3706880,3792896,11673600,11821056,11674624,11822080,11677696,11825152,11678720,11826176,803200,28672,69632,69888,71680,71936,229376,0,0,0,0,0,1297920,1383936,1469952,0,49152,0,9248,17440,1288,23104,72704,43072,43008,1986048,37888,8835072,287104,35328,5136,21520,0,0,0,5,4294967295,0,0,1544,1049336022,3584,384,115072,229760,57728,172416,287104,1376640,384,25472,50560,75648,7241728,7249920,7258112,7245824,7254016,7262208,7340032,7356416,7358464,7360512,7362560,1003776,1003904,946304
.long 114944,115072,57344,172032,3794944,3708928,11823104,11675648,11824128,11676672,11827200,11679744,11828224,11680768,1003904,28672,70144,70400,72192,72448,229376,0,0,0,0,0,1555968,1641984,1728000,12288,59392,6144,9256,17448,1288,23112,73216,43088,43008,2072064,38144,8982528,294272,35392,5232,21648,0,0,0,5,4294967295,0,0,7688,1049336022,3584,344448,459136,573824,401792,516480,631168,1433984,100736,125824,150912,176000,7266304,7274496,7282688,7270400,7278592,7286784,7344128,7364608,7366656,7368704,7370752,1053952,1054080,957056
.long 256,384,57344,172032,3878912,3964928,11969536,12116992,11968512,12115968,11973632,12121088,11972608,12120064,1204608,28672,69888,69632,71936,71680,229376,0,0,0,0,0,1814016,1900032,1986048,24576,69632,12288,9264,17456,1288,23120,72712,43104,43520,2158080,38400,9129984,301440,35456,5328,21776,0,0,0,5,4294967295,0,0,13832,1049336022,3584,688512,803200,917888,745856,860544,975232,1491328,201088,226176,251264,276352,7290880,7299072,7307264,7294976,7303168,7311360,7348224,7372800,7374848,7376896,7378944,1003776,1003904,967808
.long 114944,115072,57344,172032,3966976,3880960,12119040,11971584,12118016,11970560,12123136,11975680,12122112,11974656,1405312,28672,70400,70144,72448,72192,229376,0,0,0,0,0,2072064,2158080,2244096,36864,79872,18432,9272,17464,1288,23128,73224,43120,43520,2244096,38656,9277440,308608,35520,5424,21904,0,0,0,5,4294967295,0,0,19976,1049336022,3584,1032576,1147264,1261952,1089920,1204608,1319296,1548672,301440,326528,351616,376704,7315456,7323648,7331840,7319552,7327744,7335936,7352320,7380992,7383040,7385088,7387136,1053952,1054080,978560
.long 1280,1408,57344,172032,970752,1056768,6987776,7135232,6988800,7136256,6991872,7139328,6992896,7140352,1408,28672,86016,86272,88064,88320,229376,0,0,0,0,0,1301504,1387520,1473536,0,49152,0,5280,13472,296,23168,88064,35136,34816,1989632,37888,8839168,516480,37376,6160,22544,0,0,0,5,4294967295,0,0,1544,1049336022,3584,384,115072,229760,57728,172416,287104,1376640,384,25472,50560,75648,8421376,8429568,8437760,8425472,8433664,8441856,8519680,8536064,8538112,8540160,8542208,201984,202112,602752
.long 115968,116096,57344,172032,1058816,972800,7137280,6989824,7138304,6990848,7141376,6993920,7142400,6994944,202112,28672,86528,86784,88576,88832,229376,0,0,0,0,0,1559552,1645568,1731584,12288,59392,6144,5288,13480,296,23176,88576,35152,34816,2075648,38144,8986624,523648,37440,6256,22672,0,0,0,5,4294967295,0,0,7688,1049336022,3584,344448,459136,573824,401792,516480,631168,1433984,100736,125824,150912,176000,8445952,8454144,8462336,8450048,8458240,8466432,8523776,8544256,8546304,8548352,8550400,252160,252288,613504
.long 1280,1408,57344,172032,1142784,1228800,7283712,7431168,7282688,7430144,7287808,7435264,7286784,7434240,402816,28672,86272,86016,88320,88064,229376,0,0,0,0,0,1817600,1903616,1989632,24576,69632,12288,5296,13488,296,23184,88072,35168,35328,2161664,38400,9134080,530816,37504,6352,22800,0,0,0,5,4294967295,0,0,13832,1049336022,3584,688512,803200,917888,745856,860544,975232,1491328,201088,226176,251264,276352,8470528,8478720,8486912,8474624,8482816,8491008,8527872,8552448,8554496,8556544,8558592,201984,202112,624256
.long 115968,116096,57344,172032,1230848,1144832,7433216,7285760,7432192,7284736,7437312,7289856,7436288,7288832,603520,28672,86784,86528,88832,88576,229376,0,0,0,0,0,2075648,2161664,2247680,36864,79872,18432,5304,13496,296,23192,88584,35184,35328,2247680,38656,9281536,537984,37568,6448,22928,0,0,0,5,4294967295,0,0,19976,1049336022,3584,1032576,1147264,1261952,1089920,1204608,1319296,1548672,301440,326528,351616,376704,8495104,8503296,8511488,8499200,8507392,8515584,8531968,8560640,8562688,8564736,8566784,252160,252288,635008
.long 1280,1408,57344,172032,3723264,3809280,11706368,11853824,11707392,11854848,11710464,11857920,11711488,11858944,804224,28672,86016,86272,88064,88320,229376,0,0,0,0,0,1305088,1391104,1477120,0,49152,0,9376,17568,1320,23232,89088,43328,43008,1993216,37888,8843264,745856,39424,7184,23568,0,0,0,5,4294967295,0,0,1544,1049336022,3584,384,115072,229760,57728,172416,287104,1376640,384,25472,50560,75648,9601024,9609216,9617408,9605120,9613312,9621504,9699328,9715712,9717760,9719808,9721856,1004800,1004928,946816
.long 115968,116096,57344,172032,3811328,3725312,11855872,11708416,11856896,11709440,11859968,11712512,11860992,11713536,1004928,28672,86528,86784,88576,88832,229376,0,0,0,0,0,1563136,1649152,1735168,12288,59392,6144,9384,17576,1320,23240,89600,43344,43008,2079232,38144,8990720,753024,39488,7280,23696,0,0,0,5,4294967295,0,0,7688,1049336022,3584,344448,459136,573824,401792,516480,631168,1433984,100736,125824,150912,176000,9625600,9633792,9641984,9629696,9637888,9646080,9703424,9723904,9725952,9728000,9730048,1054976,1055104,957568
.long 1280,1408,57344,172032,3895296,3981312,12002304,12149760,12001280,12148736,12006400,12153856,12005376,12152832,1205632,28672,86272,86016,88320,88064,229376,0,0,0,0,0,1821184,1907200,1993216,24576,69632,12288,9392,17584,1320,23248,89096,43360,43520,2165248,38400,9138176,760192,39552,7376,23824,0,0,0,5,4294967295,0,0,13832,1049336022,3584,688512,803200,917888,745856,860544,975232,1491328,201088,226176,251264,276352,9650176,9658368,9666560,9654272,9662464,9670656,9707520,9732096,9734144,9736192,9738240,1004800,1004928,968320
.long 115968,116096,57344,172032,3983360,3897344,12151808,12004352,12150784,12003328,12155904,12008448,12154880,12007424,1406336,28672,86784,86528,88832,88576,229376,0,0,0,0,0,2079232,2165248,2251264,36864,79872,18432,9400,17592,1320,23256,89608,43376,43520,2251264,38656,9285632,767360,39616,7472,23952,0,0,0,5,4294967295,0,0,19976,1049336022,3584,1032576,1147264,1261952,1089920,1204608,1319296,1548672,301440,326528,351616,376704,9674752,9682944,9691136,9678848,9687040,9695232,9711616,9740288,9742336,9744384,9746432,1054976,1055104,979072
.long 2304,2432,57344,172032,987136,1073152,7020544,7168000,7021568,7169024,7024640,7172096,7025664,7173120,2432,28672,102400,102656,104448,104704,229376,0,0,0,0,0,1308672,1394688,1480704,0,49152,0,5408,13600,328,23296,104448,35392,34816,1996800,37888,8847360,975232,41472,8208,24592,0,0,0,5,4294967295,0,0,1544,1065353216,3584,384,115072,229760,57728,172416,287104,1376640,384,25472,50560,75648,10780672,10788864,10797056,10784768,10792960,10801152,10878976,10895360,10897408,10899456,10901504,203008,203136,603264
.long 116992,117120,57344,172032,1075200,989184,7170048,7022592,7171072,7023616,7174144,7026688,7175168,7027712,203136,28672,102912,103168,104960,105216,229376,0,0,0,0,0,1566720,1652736,1738752,12288,59392,6144,5416,13608,328,23304,104960,35408,34816,2082816,38144,8994816,982400,41536,8304,24720,0,0,0,5,4294967295,0,0,7688,1065353216,3584,344448,459136,573824,401792,516480,631168,1433984,100736,125824,150912,176000,10805248,10813440,10821632,10809344,10817536,10825728,10883072,10903552,10905600,10907648,10909696,253184,253312,614016
.long 2304,2432,57344,172032,1159168,1245184,7316480,7463936,7315456,7462912,7320576,7468032,7319552,7467008,403840,28672,102656,102400,104704,104448,229376,0,0,0,0,0,1824768,1910784,1996800,24576,69632,12288,5424,13616,328,23312,104456,35424,35328,2168832,38400,9142272,989568,41600,8400,24848,0,0,0,5,4294967295,0,0,13832,1065353216,3584,688512,803200,917888,745856,860544,975232,1491328,201088,226176,251264,276352,10829824,10838016,10846208,10833920,10842112,10850304,10887168,10911744,10913792,10915840,10917888,203008,203136,624768
.long 116992,117120,57344,172032,1247232,1161216,7465984,7318528,7464960,7317504,7470080,7322624,7469056,7321600,604544,28672,103168,102912,105216,104960,229376,0,0,0,0,0,2082816,2168832,2254848,36864,79872,18432,5432,13624,328,23320,104968,35440,35328,2254848,38656,9289728,996736,41664,8496,24976,0,0,0,5,4294967295,0,0,19976,1065353216,3584,1032576,1147264,1261952,1089920,1204608,1319296,1548672,301440,326528,351616,376704,10854400,10862592,10870784,10858496,10866688,10874880,10891264,10919936,10921984,10924032,10926080,253184,253312,635520
.long 2304,2432,57344,172032,3739648,3825664,11739136,11886592,11740160,11887616,11743232,11890688,11744256,11891712,805248,28672,102400,102656,104448,104704,229376,0,0,0,0,0,1312256,1398272,1484288,0,49152,0,9504,17696,1352,23360,105472,43584,43008,2000384,37888,8851456,1204608,43520,9232,25616,0,0,0,5,4294967295,0,0,1544,1065353216,3584,384,115072,229760,57728,172416,287104,1376640,384,25472,50560,75648,11960320,11968512,11976704,11964416,11972608,11980800,12058624,12075008,12077056,12079104,12081152,1005824,1005952,947328
.long 116992,117120,57344,172032,3827712,3741696,11888640,11741184,11889664,11742208,11892736,11745280,11893760,11746304,1005952,28672,102912,103168,104960,105216,229376,0,0,0,0,0,1570304,1656320,1742336,12288,59392,6144,9512,17704,1352,23368,105984,43600,43008,2086400,38144,8998912,1211776,43584,9328,25744,0,0,0,5,4294967295,0,0,7688,1065353216,3584,344448,459136,573824,401792,516480,631168,1433984,100736,125824,150912,176000,11984896,11993088,12001280,11988992,11997184,12005376,12062720,12083200,12085248,12087296,12089344,1056000,1056128,958080
.long 2304,2432,57344,172032,3911680,3997696,12035072,12182528,12034048,12181504,12039168,12186624,12038144,12185600,1206656,28672,102656,102400,104704,104448,229376,0,0,0,0,0,1828352,1914368,2000384,24576,69632,12288,9520,17712,1352,23376,105480,43616,43520,2172416,38400,9146368,1218944,43648,9424,25872,0,0,0,5,4294967295,0,0,13832,1065353216,3584,688512,803200,917888,745856,860544,975232,1491328,201088,226176,251264,276352,12009472,12017664,12025856,12013568,12021760,12029952,12066816,12091392,12093440,12095488,12097536,1005824,1005952,968832
.long 116992,117120,57344,172032,3999744,3913728,12184576,12037120,12183552,12036096,12188672,12041216,12187648,12040192,1407360,28672,103168,102912,105216,104960,229376,0,0,0,0,0,2086400,2172416,2258432,36864,79872,18432,9528,17720,1352,23384,105992,43632,43520,2258432,38656,9293824,1226112,43712,9520,26000,0,0,0,5,4294967295,0,0,19976,1065353216,3584,1032576,1147264,1261952,1089920,1204608,1319296,1548672,301440,326528,351616,376704,12034048,12042240,12050432,12038144,12046336,12054528,12070912,12099584,12101632,12103680,12105728,1056000,1056128,979584
.long 2304,3200,43008,129024,1003520,1089536,1024000,1110016,1026048,1112064,7049216,7196672,7050240,7197696,3200,28672,184320,184832,116736,116992,172032,0,0,0,0,0,1315840,1401856,1487872,0,49152,0,2336,13728,360,23424,116736,35648,34816,2003968,37888,8855552,1433984,45568,10256,26640,0,0,0,5,4294967295,0,0,1544,1065353216,2688,384,115072,229760,57728,172416,287104,1376640,384,25472,50560,75648,13139968,13148160,13156352,13144064,13152256,13160448,13238272,13254656,13256704,13258752,13260800,152832,203904,603776
.long 88320,117888,43008,129024,1091584,1005568,1114112,1028096,1116160,1030144,7198720,7051264,7199744,7052288,203904,28672,186368,186880,117248,117504,172032,0,0,0,0,0,1573888,1659904,1745920,12288,59392,6144,2344,13736,360,23432,117248,35664,34816,2089984,38144,9003008,1441152,45632,10352,26768,0,0,0,5,4294967295,0,0,7688,1065353216,2688,344448,459136,573824,401792,516480,631168,1433984,100736,125824,150912,176000,13164544,13172736,13180928,13168640,13176832,13185024,13242368,13262848,13264896,13266944,13268992,190464,254080,614528
.long 2432,3200,43008,129024,1175552,1261568,1198080,1284096,1196032,1282048,7345152,7492608,7344128,7491584,404608,28672,184832,184320,116992,116736,172032,0,0,0,0,0,1831936,1917952,2003968,24576,69632,12288,2352,13744,360,23440,116744,35680,35328,2176000,38400,9150464,1448320,45696,10448,26896,0,0,0,5,4294967295,0,0,13832,1065353216,2688,688512,803200,917888,745856,860544,975232,1491328,201088,226176,251264,276352,13189120,13197312,13205504,13193216,13201408,13209600,13246464,13271040,13273088,13275136,13277184,152960,203904,625280
.long 88448,117888,43008,129024,1263616,1177600,1288192,1202176,1286144,1200128,7494656,7347200,7493632,7346176,605312,28672,186880,186368,117504,117248,172032,0,0,0,0,0,2089984,2176000,2262016,36864,79872,18432,2360,13752,360,23448,117256,35696,35328,2262016,38656,9297920,1455488,45760,10544,27024,0,0,0,5,4294967295,0,0,19976,1065353216,2688,1032576,1147264,1261952,1089920,1204608,1319296,1548672,301440,326528,351616,376704,13213696,13221888,13230080,13217792,13225984,13234176,13250560,13279232,13281280,13283328,13285376,190592,254080,636032
.long 2304,3200,43008,129024,3756032,3842048,3776512,3862528,3778560,3864576,11767808,11915264,11768832,11916288,806016,28672,184320,184832,116736,116992,172032,0,0,0,0,0,1319424,1405440,1491456,0,49152,0,3360,17824,1384,23488,117760,43840,43008,2007552,37888,8859648,1663360,47616,11280,27664,0,0,0,5,4294967295,0,0,1544,1065353216,2688,384,115072,229760,57728,172416,287104,1376640,384,25472,50560,75648,14319616,14327808,14336000,14323712,14331904,14340096,14417920,14434304,14436352,14438400,14440448,754944,1006720,947840
.long 88320,117888,43008,129024,3844096,3758080,3866624,3780608,3868672,3782656,11917312,11769856,11918336,11770880,1006720,28672,186368,186880,117248,117504,172032,0,0,0,0,0,1577472,1663488,1749504,12288,59392,6144,3368,17832,1384,23496,118272,43856,43008,2093568,38144,9007104,1670528,47680,11376,27792,0,0,0,5,4294967295,0,0,7688,1065353216,2688,344448,459136,573824,401792,516480,631168,1433984,100736,125824,150912,176000,14344192,14352384,14360576,14348288,14356480,14364672,14422016,14442496,14444544,14446592,14448640,792576,1056896,958592
.long 2432,3200,43008,129024,3928064,4014080,3950592,4036608,3948544,4034560,12063744,12211200,12062720,12210176,1207424,28672,184832,184320,116992,116736,172032,0,0,0,0,0,1835520,1921536,2007552,24576,69632,12288,3376,17840,1384,23504,117768,43872,43520,2179584,38400,9154560,1677696,47744,11472,27920,0,0,0,5,4294967295,0,0,13832,1065353216,2688,688512,803200,917888,745856,860544,975232,1491328,201088,226176,251264,276352,14368768,14376960,14385152,14372864,14381056,14389248,14426112,14450688,14452736,14454784,14456832,755072,1006720,969344
.long 88448,117888,43008,129024,4016128,3930112,4040704,3954688,4038656,3952640,12213248,12065792,12212224,12064768,1408128,28672,186880,186368,117504,117248,172032,0,0,0,0,0,2093568,2179584,2265600,36864,79872,18432,3384,17848,1384,23512,118280,43888,43520,2265600,38656,9302016,1684864,47808,11568,28048,0,0,0,5,4294967295,0,0,19976,1065353216,2688,1032576,1147264,1261952,1089920,1204608,1319296,1548672,301440,326528,351616,376704,14393344,14401536,14409728,14397440,14405632,14413824,14430208,14458880,14460928,14462976,14465024,792704,1056896,980096
.long 256,384,57344,172032,1298432,1384448,7544832,7692288,7545856,7693312,7548928,7696384,7549952,7697408,384,28672,69632,69888,71680,71936,229376,0,0,0,0,0,1295872,1381888,1467904,0,49152,0,5664,13856,392,23072,129024,35904,35840,1984000,37888,8833024,57856,33280,4112,20496,0,0,0,5,0,4294967295,1,0,1049336022,3584,512,115200,229888,57856,172544,287232,1376768,512,25600,50688,75776,6062080,6070272,6078464,6066176,6074368,6082560,6160384,6176768,6178816,6180864,6182912,301312,301440,645248
.long 114944,115072,57344,172032,1386496,1300480,7694336,7546880,7695360,7547904,7698432,7550976,7699456,7552000,201088,28672,70144,70400,72192,72448,229376,0,0,0,0,0,1553920,1639936,1725952,12288,59392,6144,5672,13864,392,23080,129536,35920,35840,2070016,38144,8980480,65024,33344,4208,20624,0,0,0,5,0,4294967295,1,6144,1049336022,3584,344576,459264,573952,401920,516608,631296,1434112,100864,125952,151040,176128,6086656,6094848,6103040,6090752,6098944,6107136,6164480,6184960,6187008,6189056,6191104,351488,351616,656000
.long 256,384,57344,172032,1470464,1556480,7840768,7988224,7839744,7987200,7844864,7992320,7843840,7991296,401792,28672,69888,69632,71936,71680,229376,0,0,0,0,0,1811968,1897984,1984000,24576,69632,12288,5680,13872,392,23088,129032,35936,36352,2156032,38400,9127936,72192,33408,4304,20752,0,0,0,5,0,4294967295,1,12288,1049336022,3584,688640,803328,918016,745984,860672,975360,1491456,201216,226304,251392,276480,6111232,6119424,6127616,6115328,6123520,6131712,6168576,6193152,6195200,6197248,6199296,301312,301440,666752
.long 114944,115072,57344,172032,1558528,1472512,7990272,7842816,7989248,7841792,7994368,7846912,7993344,7845888,602496,28672,70400,70144,72448,72192,229376,0,0,0,0,0,2070016,2156032,2242048,36864,79872,18432,5688,13880,392,23096,129544,35952,36352,2242048,38656,9275392,79360,33472,4400,20880,0,0,0,5,0,4294967295,1,18432,1049336022,3584,1032704,1147392,1262080,1090048,1204736,1319424,1548800,301568,326656,351744,376832,6135808,6144000,6152192,6139904,6148096,6156288,6172672,6201344,6203392,6205440,6207488,351488,351616,677504
.long 256,384,57344,172032,4050944,4136960,12263424,12410880,12264448,12411904,12267520,12414976,12268544,12416000,803200,28672,69632,69888,71680,71936,229376,0,0,0,0,0,1299456,1385472,1471488,0,49152,0,9760,17952,1416,23136,130048,44096,44032,1987584,37888,8837120,287232,35328,5136,21520,0,0,0,5,0,4294967295,1,0,1049336022,3584,512,115200,229888,57856,172544,287232,1376768,512,25600,50688,75776,7241728,7249920,7258112,7245824,7254016,7262208,7340032,7356416,7358464,7360512,7362560,1104128,1104256,989312
.long 114944,115072,57344,172032,4139008,4052992,12412928,12265472,12413952,12266496,12417024,12269568,12418048,12270592,1003904,28672,70144,70400,72192,72448,229376,0,0,0,0,0,1557504,1643520,1729536,12288,59392,6144,9768,17960,1416,23144,130560,44112,44032,2073600,38144,8984576,294400,35392,5232,21648,0,0,0,5,0,4294967295,1,6144,1049336022,3584,344576,459264,573952,401920,516608,631296,1434112,100864,125952,151040,176128,7266304,7274496,7282688,7270400,7278592,7286784,7344128,7364608,7366656,7368704,7370752,1154304,1154432,1000064
.long 256,384,57344,172032,4222976,4308992,12559360,12706816,12558336,12705792,12563456,12710912,12562432,12709888,1204608,28672,69888,69632,71936,71680,229376,0,0,0,0,0,1815552,1901568,1987584,24576,69632,12288,9776,17968,1416,23152,130056,44128,44544,2159616,38400,9132032,301568,35456,5328,21776,0,0,0,5,0,4294967295,1,12288,1049336022,3584,688640,803328,918016,745984,860672,975360,1491456,201216,226304,251392,276480,7290880,7299072,7307264,7294976,7303168,7311360,7348224,7372800,7374848,7376896,7378944,1104128,1104256,1010816
.long 114944,115072,57344,172032,4311040,4225024,12708864,12561408,12707840,12560384,12712960,12565504,12711936,12564480,1405312,28672,70400,70144,72448,72192,229376,0,0,0,0,0,2073600,2159616,2245632,36864,79872,18432,9784,17976,1416,23160,130568,44144,44544,2245632,38656,9279488,308736,35520,5424,21904,0,0,0,5,0,4294967295,1,18432,1049336022,3584,1032704,1147392,1262080,1090048,1204736,1319424,1548800,301568,326656,351744,376832,7315456,7323648,7331840,7319552,7327744,7335936,7352320,7380992,7383040,7385088,7387136,1154304,1154432,1021568
.long 1280,1408,57344,172032,1314816,1400832,7577600,7725056,7578624,7726080,7581696,7729152,7582720,7730176,1408,28672,86016,86272,88064,88320,229376,0,0,0,0,0,1303040,1389056,1475072,0,49152,0,5792,13984,424,23200,145408,36160,35840,1991168,37888,8841216,516608,37376,6160,22544,0,0,0,5,0,4294967295,1,0,1049336022,3584,512,115200,229888,57856,172544,287232,1376768,512,25600,50688,75776,8421376,8429568,8437760,8425472,8433664,8441856,8519680,8536064,8538112,8540160,8542208,302336,302464,645760
.long 115968,116096,57344,172032,1402880,1316864,7727104,7579648,7728128,7580672,7731200,7583744,7732224,7584768,202112,28672,86528,86784,88576,88832,229376,0,0,0,0,0,1561088,1647104,1733120,12288,59392,6144,5800,13992,424,23208,145920,36176,35840,2077184,38144,8988672,523776,37440,6256,22672,0,0,0,5,0,4294967295,1,6144,1049336022,3584,344576,459264,573952,401920,516608,631296,1434112,100864,125952,151040,176128,8445952,8454144,8462336,8450048,8458240,8466432,8523776,8544256,8546304,8548352,8550400,352512,352640,656512
.long 1280,1408,57344,172032,1486848,1572864,7873536,8020992,7872512,8019968,7877632,8025088,7876608,8024064,402816,28672,86272,86016,88320,88064,229376,0,0,0,0,0,1819136,1905152,1991168,24576,69632,12288,5808,14000,424,23216,145416,36192,36352,2163200,38400,9136128,530944,37504,6352,22800,0,0,0,5,0,4294967295,1,12288,1049336022,3584,688640,803328,918016,745984,860672,975360,1491456,201216,226304,251392,276480,8470528,8478720,8486912,8474624,8482816,8491008,8527872,8552448,8554496,8556544,8558592,302336,302464,667264
.long 115968,116096,57344,172032,1574912,1488896,8023040,7875584,8022016,7874560,8027136,7879680,8026112,7878656,603520,28672,86784,86528,88832,88576,229376,0,0,0,0,0,2077184,2163200,2249216,36864,79872,18432,5816,14008,424,23224,145928,36208,36352,2249216,38656,9283584,538112,37568,6448,22928,0,0,0,5,0,4294967295,1,18432,1049336022,3584,1032704,1147392,1262080,1090048,1204736,1319424,1548800,301568,326656,351744,376832,8495104,8503296,8511488,8499200,8507392,8515584,8531968,8560640,8562688,8564736,8566784,352512,352640,678016
.long 1280,1408,57344,172032,4067328,4153344,12296192,12443648,12297216,12444672,12300288,12447744,12301312,12448768,804224,28672,86016,86272,88064,88320,229376,0,0,0,0,0,1306624,1392640,1478656,0,49152,0,9888,18080,1448,23264,146432,44352,44032,1994752,37888,8845312,745984,39424,7184,23568,0,0,0,5,0,4294967295,1,0,1049336022,3584,512,115200,229888,57856,172544,287232,1376768,512,25600,50688,75776,9601024,9609216,9617408,9605120,9613312,9621504,9699328,9715712,9717760,9719808,9721856,1105152,1105280,989824
.long 115968,116096,57344,172032,4155392,4069376,12445696,12298240,12446720,12299264,12449792,12302336,12450816,12303360,1004928,28672,86528,86784,88576,88832,229376,0,0,0,0,0,1564672,1650688,1736704,12288,59392,6144,9896,18088,1448,23272,146944,44368,44032,2080768,38144,8992768,753152,39488,7280,23696,0,0,0,5,0,4294967295,1,6144,1049336022,3584,344576,459264,573952,401920,516608,631296,1434112,100864,125952,151040,176128,9625600,9633792,9641984,9629696,9637888,9646080,9703424,9723904,9725952,9728000,9730048,1155328,1155456,1000576
.long 1280,1408,57344,172032,4239360,4325376,12592128,12739584,12591104,12738560,12596224,12743680,12595200,12742656,1205632,28672,86272,86016,88320,88064,229376,0,0,0,0,0,1822720,1908736,1994752,24576,69632,12288,9904,18096,1448,23280,146440,44384,44544,2166784,38400,9140224,760320,39552,7376,23824,0,0,0,5,0,4294967295,1,12288,1049336022,3584,688640,803328,918016,745984,860672,975360,1491456,201216,226304,251392,276480,9650176,9658368,9666560,9654272,9662464,9670656,9707520,9732096,9734144,9736192,9738240,1105152,1105280,1011328
.long 115968,116096,57344,172032,4327424,4241408,12741632,12594176,12740608,12593152,12745728,12598272,12744704,12597248,1406336,28672,86784,86528,88832,88576,229376,0,0,0,0,0,2080768,2166784,2252800,36864,79872,18432,9912,18104,1448,23288,146952,44400,44544,2252800,38656,9287680,767488,39616,7472,23952,0,0,0,5,0,4294967295,1,18432,1049336022,3584,1032704,1147392,1262080,1090048,1204736,1319424,1548800,301568,326656,351744,376832,9674752,9682944,9691136,9678848,9687040,9695232,9711616,9740288,9742336,9744384,9746432,1155328,1155456,1022080
.long 2304,2432,57344,172032,1331200,1417216,7610368,7757824,7611392,7758848,7614464,7761920,7615488,7762944,2432,28672,102400,102656,104448,104704,229376,0,0,0,0,0,1310208,1396224,1482240,0,49152,0,5920,14112,456,23328,161792,36416,35840,1998336,37888,8849408,975360,41472,8208,24592,0,0,0,5,0,4294967295,1,0,1065353216,3584,512,115200,229888,57856,172544,287232,1376768,512,25600,50688,75776,10780672,10788864,10797056,10784768,10792960,10801152,10878976,10895360,10897408,10899456,10901504,303360,303488,646272
.long 116992,117120,57344,172032,1419264,1333248,7759872,7612416,7760896,7613440,7763968,7616512,7764992,7617536,203136,28672,102912,103168,104960,105216,229376,0,0,0,0,0,1568256,1654272,1740288,12288,59392,6144,5928,14120,456,23336,162304,36432,35840,2084352,38144,8996864,982528,41536,8304,24720,0,0,0,5,0,4294967295,1,6144,1065353216,3584,344576,459264,573952,401920,516608,631296,1434112,100864,125952,151040,176128,10805248,10813440,10821632,10809344,10817536,10825728,10883072,10903552,10905600,10907648,10909696,353536,353664,657024
.long 2304,2432,57344,172032,1503232,1589248,7906304,8053760,7905280,8052736,7910400,8057856,7909376,8056832,403840,28672,102656,102400,104704,104448,229376,0,0,0,0,0,1826304,1912320,1998336,24576,69632,12288,5936,14128,456,23344,161800,36448,36352,2170368,38400,9144320,989696,41600,8400,24848,0,0,0,5,0,4294967295,1,12288,1065353216,3584,688640,803328,918016,745984,860672,975360,1491456,201216,226304,251392,276480,10829824,10838016,10846208,10833920,10842112,10850304,10887168,10911744,10913792,10915840,10917888,303360,303488,667776
.long 116992,117120,57344,172032,1591296,1505280,8055808,7908352,8054784,7907328,8059904,7912448,8058880,7911424,604544,28672,103168,102912,105216,104960,229376,0,0,0,0,0,2084352,2170368,2256384,36864,79872,18432,5944,14136,456,23352,162312,36464,36352,2256384,38656,9291776,996864,41664,8496,24976,0,0,0,5,0,4294967295,1,18432,1065353216,3584,1032704,1147392,1262080,1090048,1204736,1319424,1548800,301568,326656,351744,376832,10854400,10862592,10870784,10858496,10866688,10874880,10891264,10919936,10921984,10924032,10926080,353536,353664,678528
.long 2304,2432,57344,172032,4083712,4169728,12328960,12476416,12329984,12477440,12333056,12480512,12334080,12481536,805248,28672,102400,102656,104448,104704,229376,0,0,0,0,0,1313792,1399808,1485824,0,49152,0,10016,18208,1480,23392,162816,44608,44032,2001920,37888,8853504,1204736,43520,9232,25616,0,0,0,5,0,4294967295,1,0,1065353216,3584,512,115200,229888,57856,172544,287232,1376768,512,25600,50688,75776,11960320,11968512,11976704,11964416,11972608,11980800,12058624,12075008,12077056,12079104,12081152,1106176,1106304,990336
.long 116992,117120,57344,172032,4171776,4085760,12478464,12331008,12479488,12332032,12482560,12335104,12483584,12336128,1005952,28672,102912,103168,104960,105216,229376,0,0,0,0,0,1571840,1657856,1743872,12288,59392,6144,10024,18216,1480,23400,163328,44624,44032,2087936,38144,9000960,1211904,43584,9328,25744,0,0,0,5,0,4294967295,1,6144,1065353216,3584,344576,459264,573952,401920,516608,631296,1434112,100864,125952,151040,176128,11984896,11993088,12001280,11988992,11997184,12005376,12062720,12083200,12085248,12087296,12089344,1156352,1156480,1001088
.long 2304,2432,57344,172032,4255744,4341760,12624896,12772352,12623872,12771328,12628992,12776448,12627968,12775424,1206656,28672,102656,102400,104704,104448,229376,0,0,0,0,0,1829888,1915904,2001920,24576,69632,12288,10032,18224,1480,23408,162824,44640,44544,2173952,38400,9148416,1219072,43648,9424,25872,0,0,0,5,0,4294967295,1,12288,1065353216,3584,688640,803328,918016,745984,860672,975360,1491456,201216,226304,251392,276480,12009472,12017664,12025856,12013568,12021760,12029952,12066816,12091392,12093440,12095488,12097536,1106176,1106304,1011840
.long 116992,117120,57344,172032,4343808,4257792,12774400,12626944,12773376,12625920,12778496,12631040,12777472,12630016,1407360,28672,103168,102912,105216,104960,229376,0,0,0,0,0,2087936,2173952,2259968,36864,79872,18432,10040,18232,1480,23416,163336,44656,44544,2259968,38656,9295872,1226240,43712,9520,26000,0,0,0,5,0,4294967295,1,18432,1065353216,3584,1032704,1147392,1262080,1090048,1204736,1319424,1548800,301568,326656,351744,376832,12034048,12042240,12050432,12038144,12046336,12054528,12070912,12099584,12101632,12103680,12105728,1156352,1156480,1022592
.long 2304,3200,43008,129024,1347584,1433600,1368064,1454080,1370112,1456128,7639040,7786496,7640064,7787520,3200,28672,184320,184832,116736,116992,172032,0,0,0,0,0,1317376,1403392,1489408,0,49152,0,2464,14240,488,23456,174080,36672,35840,2005504,37888,8857600,1434112,45568,10256,26640,0,0,0,5,0,4294967295,1,0,1065353216,2688,512,115200,229888,57856,172544,287232,1376768,512,25600,50688,75776,13139968,13148160,13156352,13144064,13152256,13160448,13238272,13254656,13256704,13258752,13260800,228096,304256,646784
.long 88320,117888,43008,129024,1435648,1349632,1458176,1372160,1460224,1374208,7788544,7641088,7789568,7642112,203904,28672,186368,186880,117248,117504,172032,0,0,0,0,0,1575424,1661440,1747456,12288,59392,6144,2472,14248,488,23464,174592,36688,35840,2091520,38144,9005056,1441280,45632,10352,26768,0,0,0,5,0,4294967295,1,6144,1065353216,2688,344576,459264,573952,401920,516608,631296,1434112,100864,125952,151040,176128,13164544,13172736,13180928,13168640,13176832,13185024,13242368,13262848,13264896,13266944,13268992,265728,354432,657536
.long 2432,3200,43008,129024,1519616,1605632,1542144,1628160,1540096,1626112,7934976,8082432,7933952,8081408,404608,28672,184832,184320,116992,116736,172032,0,0,0,0,0,1833472,1919488,2005504,24576,69632,12288,2480,14256,488,23472,174088,36704,36352,2177536,38400,9152512,1448448,45696,10448,26896,0,0,0,5,0,4294967295,1,12288,1065353216,2688,688640,803328,918016,745984,860672,975360,1491456,201216,226304,251392,276480,13189120,13197312,13205504,13193216,13201408,13209600,13246464,13271040,13273088,13275136,13277184,228224,304256,668288
.long 88448,117888,43008,129024,1607680,1521664,1632256,1546240,1630208,1544192,8084480,7937024,8083456,7936000,605312,28672,186880,186368,117504,117248,172032,0,0,0,0,0,2091520,2177536,2263552,36864,79872,18432,2488,14264,488,23480,174600,36720,36352,2263552,38656,9299968,1455616,45760,10544,27024,0,0,0,5,0,4294967295,1,18432,1065353216,2688,1032704,1147392,1262080,1090048,1204736,1319424,1548800,301568,326656,351744,376832,13213696,13221888,13230080,13217792,13225984,13234176,13250560,13279232,13281280,13283328,13285376,265856,354432,679040
.long 2304,3200,43008,129024,4100096,4186112,4120576,4206592,4122624,4208640,12357632,12505088,12358656,12506112,806016,28672,184320,184832,116736,116992,172032,0,0,0,0,0,1320960,1406976,1492992,0,49152,0,3488,18336,1512,23520,175104,44864,44032,2009088,37888,8861696,1663488,47616,11280,27664,0,0,0,5,0,4294967295,1,0,1065353216,2688,512,115200,229888,57856,172544,287232,1376768,512,25600,50688,75776,14319616,14327808,14336000,14323712,14331904,14340096,14417920,14434304,14436352,14438400,14440448,830208,1107072,990848
.long 88320,117888,43008,129024,4188160,4102144,4210688,4124672,4212736,4126720,12507136,12359680,12508160,12360704,1006720,28672,186368,186880,117248,117504,172032,0,0,0,0,0,1579008,1665024,1751040,12288,59392,6144,3496,18344,1512,23528,175616,44880,44032,2095104,38144,9009152,1670656,47680,11376,27792,0,0,0,5,0,4294967295,1,6144,1065353216,2688,344576,459264,573952,401920,516608,631296,1434112,100864,125952,151040,176128,14344192,14352384,14360576,14348288,14356480,14364672,14422016,14442496,14444544,14446592,14448640,867840,1157248,1001600
.long 2432,3200,43008,129024,4272128,4358144,4294656,4380672,4292608,4378624,12653568,12801024,12652544,12800000,1207424,28672,184832,184320,116992,116736,172032,0,0,0,0,0,1837056,1923072,2009088,24576,69632,12288,3504,18352,1512,23536,175112,44896,44544,2181120,38400,9156608,1677824,47744,11472,27920,0,0,0,5,0,4294967295,1,12288,1065353216,2688,688640,803328,918016,745984,860672,975360,1491456,201216,226304,251392,276480,14368768,14376960,14385152,14372864,14381056,14389248,14426112,14450688,14452736,14454784,14456832,830336,1107072,1012352
.long 88448,117888,43008,129024,4360192,4274176,4384768,4298752,4382720,4296704,12803072,12655616,12802048,12654592,1408128,28672,186880,186368,117504,117248,172032,0,0,0,0,0,2095104,2181120,2267136,36864,79872,18432,3512,18360,1512,23544,175624,44912,44544,2267136,38656,9304064,1684992,47808,11568,28048,0,0,0,5,0,4294967295,1,18432,1065353216,2688,1032704,1147392,1262080,1090048,1204736,1319424,1548800,301568,326656,351744,376832,14393344,14401536,14409728,14397440,14405632,14413824,14430208,14458880,14460928,14462976,14465024,867968,1157248,1023104
.long 256,384,57344,172032,1642496,1728512,8134656,8282112,8135680,8283136,8138752,8286208,8139776,8287232,803072,28672,69632,69888,71680,71936,229376,0,0,0,0,0,1638400,1724416,1810432,0,49152,0,6176,14368,520,23552,70656,36928,36864,2326528,38912,9420800,57984,33280,4112,20496,0,0,0,6,4294967295,0,0,1544,1049336022,3584,640,115328,230016,57984,172672,287360,1376896,640,25728,50816,75904,6062080,6070272,6078464,6066176,6074368,6082560,6160384,6176768,6178816,6180864,6182912,401664,401792,688256
.long 114944,115072,57344,172032,1730560,1644544,8284160,8136704,8285184,8137728,8288256,8140800,8289280,8141824,1003776,28672,70144,70400,72192,72448,229376,0,0,0,0,0,1896448,1982464,2068480,12288,59392,6144,6184,14376,520,23560,71168,36944,36864,2412544,39168,9568256,65152,33344,4208,20624,0,0,0,6,4294967295,0,0,7688,1049336022,3584,344704,459392,574080,402048,516736,631424,1434240,100992,126080,151168,176256,6086656,6094848,6103040,6090752,6098944,6107136,6164480,6184960,6187008,6189056,6191104,451840,451968,699008
.long 256,384,57344,172032,1814528,1900544,8430592,8578048,8429568,8577024,8434688,8582144,8433664,8581120,1204480,28672,69888,69632,71936,71680,229376,0,0,0,0,0,2154496,2240512,2326528,24576,69632,12288,6192,14384,520,23568,70664,36960,37376,2498560,39424,9715712,72320,33408,4304,20752,0,0,0,6,4294967295,0,0,13832,1049336022,3584,688768,803456,918144,746112,860800,975488,1491584,201344,226432,251520,276608,6111232,6119424,6127616,6115328,6123520,6131712,6168576,6193152,6195200,6197248,6199296,401664,401792,709760
.long 114944,115072,57344,172032,1902592,1816576,8580096,8432640,8579072,8431616,8584192,8436736,8583168,8435712,1405184,28672,70400,70144,72448,72192,229376,0,0,0,0,0,2412544,2498560,2584576,36864,79872,18432,6200,14392,520,23576,71176,36976,37376,2584576,39680,9863168,79488,33472,4400,20880,0,0,0,6,4294967295,0,0,19976,1049336022,3584,1032832,1147520,1262208,1090176,1204864,1319552,1548928,301696,326784,351872,376960,6135808,6144000,6152192,6139904,6148096,6156288,6172672,6201344,6203392,6205440,6207488,451840,451968,720512
.long 256,384,57344,172032,4395008,4481024,12853248,13000704,12854272,13001728,12857344,13004800,12858368,13005824,256,28672,69632,69888,71680,71936,229376,0,0,0,0,0,1641984,1728000,1814016,0,49152,0,10272,18464,1544,23616,69632,45120,45056,2330112,38912,9424896,287360,35328,5136,21520,0,0,0,6,4294967295,0,0,1544,1049336022,3584,640,115328,230016,57984,172672,287360,1376896,640,25728,50816,75904,7241728,7249920,7258112,7245824,7254016,7262208,7340032,7356416,7358464,7360512,7362560,1204480,1204608,1032320
.long 114944,115072,57344,172032,4483072,4397056,13002752,12855296,13003776,12856320,13006848,12859392,13007872,12860416,200960,28672,70144,70400,72192,72448,229376,0,0,0,0,0,1900032,1986048,2072064,12288,59392,6144,10280,18472,1544,23624,70144,45136,45056,2416128,39168,9572352,294528,35392,5232,21648,0,0,0,6,4294967295,0,0,7688,1049336022,3584,344704,459392,574080,402048,516736,631424,1434240,100992,126080,151168,176256,7266304,7274496,7282688,7270400,7278592,7286784,7344128,7364608,7366656,7368704,7370752,1254656,1254784,1043072
.long 256,384,57344,172032,4567040,4653056,13149184,13296640,13148160,13295616,13153280,13300736,13152256,13299712,401664,28672,69888,69632,71936,71680,229376,0,0,0,0,0,2158080,2244096,2330112,24576,69632,12288,10288,18480,1544,23632,69640,45152,45568,2502144,39424,9719808,301696,35456,5328,21776,0,0,0,6,4294967295,0,0,13832,1049336022,3584,688768,803456,918144,746112,860800,975488,1491584,201344,226432,251520,276608,7290880,7299072,7307264,7294976,7303168,7311360,7348224,7372800,7374848,7376896,7378944,1204480,1204608,1053824
.long 114944,115072,57344,172032,4655104,4569088,13298688,13151232,13297664,13150208,13302784,13155328,13301760,13154304,602368,28672,70400,70144,72448,72192,229376,0,0,0,0,0,2416128,2502144,2588160,36864,79872,18432,10296,18488,1544,23640,70152,45168,45568,2588160,39680,9867264,308864,35520,5424,21904,0,0,0,6,4294967295,0,0,19976,1049336022,3584,1032832,1147520,1262208,1090176,1204864,1319552,1548928,301696,326784,351872,376960,7315456,7323648,7331840,7319552,7327744,7335936,7352320,7380992,7383040,7385088,7387136,1254656,1254784,1064576
.long 1280,1408,57344,172032,1658880,1744896,8167424,8314880,8168448,8315904,8171520,8318976,8172544,8320000,804096,28672,86016,86272,88064,88320,229376,0,0,0,0,0,1645568,1731584,1817600,0,49152,0,6304,14496,552,23680,87040,37184,36864,2333696,38912,9428992,516736,37376,6160,22544,0,0,0,6,4294967295,0,0,1544,1049336022,3584,640,115328,230016,57984,172672,287360,1376896,640,25728,50816,75904,8421376,8429568,8437760,8425472,8433664,8441856,8519680,8536064,8538112,8540160,8542208,402688,402816,688768
.long 115968,116096,57344,172032,1746944,1660928,8316928,8169472,8317952,8170496,8321024,8173568,8322048,8174592,1004800,28672,86528,86784,88576,88832,229376,0,0,0,0,0,1903616,1989632,2075648,12288,59392,6144,6312,14504,552,23688,87552,37200,36864,2419712,39168,9576448,523904,37440,6256,22672,0,0,0,6,4294967295,0,0,7688,1049336022,3584,344704,459392,574080,402048,516736,631424,1434240,100992,126080,151168,176256,8445952,8454144,8462336,8450048,8458240,8466432,8523776,8544256,8546304,8548352,8550400,452864,452992,699520
.long 1280,1408,57344,172032,1830912,1916928,8463360,8610816,8462336,8609792,8467456,8614912,8466432,8613888,1205504,28672,86272,86016,88320,88064,229376,0,0,0,0,0,2161664,2247680,2333696,24576,69632,12288,6320,14512,552,23696,87048,37216,37376,2505728,39424,9723904,531072,37504,6352,22800,0,0,0,6,4294967295,0,0,13832,1049336022,3584,688768,803456,918144,746112,860800,975488,1491584,201344,226432,251520,276608,8470528,8478720,8486912,8474624,8482816,8491008,8527872,8552448,8554496,8556544,8558592,402688,402816,710272
.long 115968,116096,57344,172032,1918976,1832960,8612864,8465408,8611840,8464384,8616960,8469504,8615936,8468480,1406208,28672,86784,86528,88832,88576,229376,0,0,0,0,0,2419712,2505728,2591744,36864,79872,18432,6328,14520,552,23704,87560,37232,37376,2591744,39680,9871360,538240,37568,6448,22928,0,0,0,6,4294967295,0,0,19976,1049336022,3584,1032832,1147520,1262208,1090176,1204864,1319552,1548928,301696,326784,351872,376960,8495104,8503296,8511488,8499200,8507392,8515584,8531968,8560640,8562688,8564736,8566784,452864,452992,721024
.long 1280,1408,57344,172032,4411392,4497408,12886016,13033472,12887040,13034496,12890112,13037568,12891136,13038592,1280,28672,86016,86272,88064,88320,229376,0,0,0,0,0,1649152,1735168,1821184,0,49152,0,10400,18592,1576,23744,86016,45376,45056,2337280,38912,9433088,746112,39424,7184,23568,0,0,0,6,4294967295,0,0,1544,1049336022,3584,640,115328,230016,57984,172672,287360,1376896,640,25728,50816,75904,9601024,9609216,9617408,9605120,9613312,9621504,9699328,9715712,9717760,9719808,9721856,1205504,1205632,1032832
.long 115968,116096,57344,172032,4499456,4413440,13035520,12888064,13036544,12889088,13039616,12892160,13040640,12893184,201984,28672,86528,86784,88576,88832,229376,0,0,0,0,0,1907200,1993216,2079232,12288,59392,6144,10408,18600,1576,23752,86528,45392,45056,2423296,39168,9580544,753280,39488,7280,23696,0,0,0,6,4294967295,0,0,7688,1049336022,3584,344704,459392,574080,402048,516736,631424,1434240,100992,126080,151168,176256,9625600,9633792,9641984,9629696,9637888,9646080,9703424,9723904,9725952,9728000,9730048,1255680,1255808,1043584
.long 1280,1408,57344,172032,4583424,4669440,13181952,13329408,13180928,13328384,13186048,13333504,13185024,13332480,402688,28672,86272,86016,88320,88064,229376,0,0,0,0,0,2165248,2251264,2337280,24576,69632,12288,10416,18608,1576,23760,86024,45408,45568,2509312,39424,9728000,760448,39552,7376,23824,0,0,0,6,4294967295,0,0,13832,1049336022,3584,688768,803456,918144,746112,860800,975488,1491584,201344,226432,251520,276608,9650176,9658368,9666560,9654272,9662464,9670656,9707520,9732096,9734144,9736192,9738240,1205504,1205632,1054336
.long 115968,116096,57344,172032,4671488,4585472,13331456,13184000,13330432,13182976,13335552,13188096,13334528,13187072,603392,28672,86784,86528,88832,88576,229376,0,0,0,0,0,2423296,2509312,2595328,36864,79872,18432,10424,18616,1576,23768,86536,45424,45568,2595328,39680,9875456,767616,39616,7472,23952,0,0,0,6,4294967295,0,0,19976,1049336022,3584,1032832,1147520,1262208,1090176,1204864,1319552,1548928,301696,326784,351872,376960,9674752,9682944,9691136,9678848,9687040,9695232,9711616,9740288,9742336,9744384,9746432,1255680,1255808,1065088
.long 2304,2432,57344,172032,1675264,1761280,8200192,8347648,8201216,8348672,8204288,8351744,8205312,8352768,805120,28672,102400,102656,104448,104704,229376,0,0,0,0,0,1652736,1738752,1824768,0,49152,0,6432,14624,584,23808,103424,37440,36864,2340864,38912,9437184,975488,41472,8208,24592,0,0,0,6,4294967295,0,0,1544,1065353216,3584,640,115328,230016,57984,172672,287360,1376896,640,25728,50816,75904,10780672,10788864,10797056,10784768,10792960,10801152,10878976,10895360,10897408,10899456,10901504,403712,403840,689280
.long 116992,117120,57344,172032,1763328,1677312,8349696,8202240,8350720,8203264,8353792,8206336,8354816,8207360,1005824,28672,102912,103168,104960,105216,229376,0,0,0,0,0,1910784,1996800,2082816,12288,59392,6144,6440,14632,584,23816,103936,37456,36864,2426880,39168,9584640,982656,41536,8304,24720,0,0,0,6,4294967295,0,0,7688,1065353216,3584,344704,459392,574080,402048,516736,631424,1434240,100992,126080,151168,176256,10805248,10813440,10821632,10809344,10817536,10825728,10883072,10903552,10905600,10907648,10909696,453888,454016,700032
.long 2304,2432,57344,172032,1847296,1933312,8496128,8643584,8495104,8642560,8500224,8647680,8499200,8646656,1206528,28672,102656,102400,104704,104448,229376,0,0,0,0,0,2168832,2254848,2340864,24576,69632,12288,6448,14640,584,23824,103432,37472,37376,2512896,39424,9732096,989824,41600,8400,24848,0,0,0,6,4294967295,0,0,13832,1065353216,3584,688768,803456,918144,746112,860800,975488,1491584,201344,226432,251520,276608,10829824,10838016,10846208,10833920,10842112,10850304,10887168,10911744,10913792,10915840,10917888,403712,403840,710784
.long 116992,117120,57344,172032,1935360,1849344,8645632,8498176,8644608,8497152,8649728,8502272,8648704,8501248,1407232,28672,103168,102912,105216,104960,229376,0,0,0,0,0,2426880,2512896,2598912,36864,79872,18432,6456,14648,584,23832,103944,37488,37376,2598912,39680,9879552,996992,41664,8496,24976,0,0,0,6,4294967295,0,0,19976,1065353216,3584,1032832,1147520,1262208,1090176,1204864,1319552,1548928,301696,326784,351872,376960,10854400,10862592,10870784,10858496,10866688,10874880,10891264,10919936,10921984,10924032,10926080,453888,454016,721536
.long 2304,2432,57344,172032,4427776,4513792,12918784,13066240,12919808,13067264,12922880,13070336,12923904,13071360,2304,28672,102400,102656,104448,104704,229376,0,0,0,0,0,1656320,1742336,1828352,0,49152,0,10528,18720,1608,23872,102400,45632,45056,2344448,38912,9441280,1204864,43520,9232,25616,0,0,0,6,4294967295,0,0,1544,1065353216,3584,640,115328,230016,57984,172672,287360,1376896,640,25728,50816,75904,11960320,11968512,11976704,11964416,11972608,11980800,12058624,12075008,12077056,12079104,12081152,1206528,1206656,1033344
.long 116992,117120,57344,172032,4515840,4429824,13068288,12920832,13069312,12921856,13072384,12924928,13073408,12925952,203008,28672,102912,103168,104960,105216,229376,0,0,0,0,0,1914368,2000384,2086400,12288,59392,6144,10536,18728,1608,23880,102912,45648,45056,2430464,39168,9588736,1212032,43584,9328,25744,0,0,0,6,4294967295,0,0,7688,1065353216,3584,344704,459392,574080,402048,516736,631424,1434240,100992,126080,151168,176256,11984896,11993088,12001280,11988992,11997184,12005376,12062720,12083200,12085248,12087296,12089344,1256704,1256832,1044096
.long 2304,2432,57344,172032,4599808,4685824,13214720,13362176,13213696,13361152,13218816,13366272,13217792,13365248,403712,28672,102656,102400,104704,104448,229376,0,0,0,0,0,2172416,2258432,2344448,24576,69632,12288,10544,18736,1608,23888,102408,45664,45568,2516480,39424,9736192,1219200,43648,9424,25872,0,0,0,6,4294967295,0,0,13832,1065353216,3584,688768,803456,918144,746112,860800,975488,1491584,201344,226432,251520,276608,12009472,12017664,12025856,12013568,12021760,12029952,12066816,12091392,12093440,12095488,12097536,1206528,1206656,1054848
.long 116992,117120,57344,172032,4687872,4601856,13364224,13216768,13363200,13215744,13368320,13220864,13367296,13219840,604416,28672,103168,102912,105216,104960,229376,0,0,0,0,0,2430464,2516480,2602496,36864,79872,18432,10552,18744,1608,23896,102920,45680,45568,2602496,39680,9883648,1226368,43712,9520,26000,0,0,0,6,4294967295,0,0,19976,1065353216,3584,1032832,1147520,1262208,1090176,1204864,1319552,1548928,301696,326784,351872,376960,12034048,12042240,12050432,12038144,12046336,12054528,12070912,12099584,12101632,12103680,12105728,1256704,1256832,1065600
.long 2304,3200,43008,129024,1691648,1777664,1712128,1798144,1714176,1800192,8228864,8376320,8229888,8377344,604416,21504,184320,184832,116736,116992,172032,0,0,0,0,0,1659904,1745920,1831936,0,49152,0,2592,14752,616,23936,185344,37696,36864,2348032,38912,9445376,1434240,45568,10256,26640,0,0,0,6,4294967295,0,0,1544,1065353216,2688,640,115328,230016,57984,172672,287360,1376896,640,25728,50816,75904,13139968,13148160,13156352,13144064,13152256,13160448,13238272,13254656,13256704,13258752,13260800,303360,404608,689792
.long 88320,117888,43008,129024,1779712,1693696,1802240,1716224,1804288,1718272,8378368,8230912,8379392,8231936,754944,21504,186368,186880,117248,117504,172032,0,0,0,0,0,1917952,2003968,2089984,12288,59392,6144,2600,14760,616,23944,185856,37712,36864,2434048,39168,9592832,1441408,45632,10352,26768,0,0,0,6,4294967295,0,0,7688,1065353216,2688,344704,459392,574080,402048,516736,631424,1434240,100992,126080,151168,176256,13164544,13172736,13180928,13168640,13176832,13185024,13242368,13262848,13264896,13266944,13268992,340992,454784,700544
.long 2432,3200,43008,129024,1863680,1949696,1886208,1972224,1884160,1970176,8524800,8672256,8523776,8671232,905472,21504,184832,184320,116992,116736,172032,0,0,0,0,0,2176000,2262016,2348032,24576,69632,12288,2608,14768,616,23952,185352,37728,37376,2520064,39424,9740288,1448576,45696,10448,26896,0,0,0,6,4294967295,0,0,13832,1065353216,2688,688768,803456,918144,746112,860800,975488,1491584,201344,226432,251520,276608,13189120,13197312,13205504,13193216,13201408,13209600,13246464,13271040,13273088,13275136,13277184,303488,404608,711296
.long 88448,117888,43008,129024,1951744,1865728,1976320,1890304,1974272,1888256,8674304,8526848,8673280,8525824,1056000,21504,186880,186368,117504,117248,172032,0,0,0,0,0,2434048,2520064,2606080,36864,79872,18432,2616,14776,616,23960,185864,37744,37376,2606080,39680,9887744,1455744,45760,10544,27024,0,0,0,6,4294967295,0,0,19976,1065353216,2688,1032832,1147520,1262208,1090176,1204864,1319552,1548928,301696,326784,351872,376960,13213696,13221888,13230080,13217792,13225984,13234176,13250560,13279232,13281280,13283328,13285376,341120,454784,722048
.long 2304,3200,43008,129024,4444160,4530176,4464640,4550656,4466688,4552704,12947456,13094912,12948480,13095936,2304,21504,184320,184832,116736,116992,172032,0,0,0,0,0,1663488,1749504,1835520,0,49152,0,3616,18848,1640,24000,184320,45888,45056,2351616,38912,9449472,1663616,47616,11280,27664,0,0,0,6,4294967295,0,0,1544,1065353216,2688,640,115328,230016,57984,172672,287360,1376896,640,25728,50816,75904,14319616,14327808,14336000,14323712,14331904,14340096,14417920,14434304,14436352,14438400,14440448,905472,1207424,1033856
.long 88320,117888,43008,129024,4532224,4446208,4554752,4468736,4556800,4470784,13096960,12949504,13097984,12950528,152832,21504,186368,186880,117248,117504,172032,0,0,0,0,0,1921536,2007552,2093568,12288,59392,6144,3624,18856,1640,24008,184832,45904,45056,2437632,39168,9596928,1670784,47680,11376,27792,0,0,0,6,4294967295,0,0,7688,1065353216,2688,344704,459392,574080,402048,516736,631424,1434240,100992,126080,151168,176256,14344192,14352384,14360576,14348288,14356480,14364672,14422016,14442496,14444544,14446592,14448640,943104,1257600,1044608
.long 2432,3200,43008,129024,4616192,4702208,4638720,4724736,4636672,4722688,13243392,13390848,13242368,13389824,303360,21504,184832,184320,116992,116736,172032,0,0,0,0,0,2179584,2265600,2351616,24576,69632,12288,3632,18864,1640,24016,184328,45920,45568,2523648,39424,9744384,1677952,47744,11472,27920,0,0,0,6,4294967295,0,0,13832,1065353216,2688,688768,803456,918144,746112,860800,975488,1491584,201344,226432,251520,276608,14368768,14376960,14385152,14372864,14381056,14389248,14426112,14450688,14452736,14454784,14456832,905600,1207424,1055360
.long 88448,117888,43008,129024,4704256,4618240,4728832,4642816,4726784,4640768,13392896,13245440,13391872,13244416,453888,21504,186880,186368,117504,117248,172032,0,0,0,0,0,2437632,2523648,2609664,36864,79872,18432,3640,18872,1640,24024,184840,45936,45568,2609664,39680,9891840,1685120,47808,11568,28048,0,0,0,6,4294967295,0,0,19976,1065353216,2688,1032832,1147520,1262208,1090176,1204864,1319552,1548928,301696,326784,351872,376960,14393344,14401536,14409728,14397440,14405632,14413824,14430208,14458880,14460928,14462976,14465024,943232,1257600,1066112
.long 256,384,57344,172032,1986560,2072576,8724480,8871936,8725504,8872960,8728576,8876032,8729600,8877056,803072,28672,69632,69888,71680,71936,229376,0,0,0,0,0,1639936,1725952,1811968,0,49152,0,6688,14880,648,23584,128000,37952,37888,2328064,38912,9422848,58112,33280,4112,20496,0,0,0,6,0,4294967295,1,0,1049336022,3584,768,115456,230144,58112,172800,287488,1377024,768,25856,50944,76032,6062080,6070272,6078464,6066176,6074368,6082560,6160384,6176768,6178816,6180864,6182912,502016,502144,731264
.long 114944,115072,57344,172032,2074624,1988608,8873984,8726528,8875008,8727552,8878080,8730624,8879104,8731648,1003776,28672,70144,70400,72192,72448,229376,0,0,0,0,0,1897984,1984000,2070016,12288,59392,6144,6696,14888,648,23592,128512,37968,37888,2414080,39168,9570304,65280,33344,4208,20624,0,0,0,6,0,4294967295,1,6144,1049336022,3584,344832,459520,574208,402176,516864,631552,1434368,101120,126208,151296,176384,6086656,6094848,6103040,6090752,6098944,6107136,6164480,6184960,6187008,6189056,6191104,552192,552320,742016
.long 256,384,57344,172032,2158592,2244608,9020416,9167872,9019392,9166848,9024512,9171968,9023488,9170944,1204480,28672,69888,69632,71936,71680,229376,0,0,0,0,0,2156032,2242048,2328064,24576,69632,12288,6704,14896,648,23600,128008,37984,38400,2500096,39424,9717760,72448,33408,4304,20752,0,0,0,6,0,4294967295,1,12288,1049336022,3584,688896,803584,918272,746240,860928,975616,1491712,201472,226560,251648,276736,6111232,6119424,6127616,6115328,6123520,6131712,6168576,6193152,6195200,6197248,6199296,502016,502144,752768
.long 114944,115072,57344,172032,2246656,2160640,9169920,9022464,9168896,9021440,9174016,9026560,9172992,9025536,1405184,28672,70400,70144,72448,72192,229376,0,0,0,0,0,2414080,2500096,2586112,36864,79872,18432,6712,14904,648,23608,128520,38000,38400,2586112,39680,9865216,79616,33472,4400,20880,0,0,0,6,0,4294967295,1,18432,1049336022,3584,1032960,1147648,1262336,1090304,1204992,1319680,1549056,301824,326912,352000,377088,6135808,6144000,6152192,6139904,6148096,6156288,6172672,6201344,6203392,6205440,6207488,552192,552320,763520
.long 256,384,57344,172032,4739072,4825088,13443072,13590528,13444096,13591552,13447168,13594624,13448192,13595648,256,28672,69632,69888,71680,71936,229376,0,0,0,0,0,1643520,1729536,1815552,0,49152,0,10784,18976,1672,23648,126976,46144,46080,2331648,38912,9426944,287488,35328,5136,21520,0,0,0,6,0,4294967295,1,0,1049336022,3584,768,115456,230144,58112,172800,287488,1377024,768,25856,50944,76032,7241728,7249920,7258112,7245824,7254016,7262208,7340032,7356416,7358464,7360512,7362560,1304832,1304960,1075328
.long 114944,115072,57344,172032,4827136,4741120,13592576,13445120,13593600,13446144,13596672,13449216,13597696,13450240,200960,28672,70144,70400,72192,72448,229376,0,0,0,0,0,1901568,1987584,2073600,12288,59392,6144,10792,18984,1672,23656,127488,46160,46080,2417664,39168,9574400,294656,35392,5232,21648,0,0,0,6,0,4294967295,1,6144,1049336022,3584,344832,459520,574208,402176,516864,631552,1434368,101120,126208,151296,176384,7266304,7274496,7282688,7270400,7278592,7286784,7344128,7364608,7366656,7368704,7370752,1355008,1355136,1086080
.long 256,384,57344,172032,4911104,4997120,13739008,13886464,13737984,13885440,13743104,13890560,13742080,13889536,401664,28672,69888,69632,71936,71680,229376,0,0,0,0,0,2159616,2245632,2331648,24576,69632,12288,10800,18992,1672,23664,126984,46176,46592,2503680,39424,9721856,301824,35456,5328,21776,0,0,0,6,0,4294967295,1,12288,1049336022,3584,688896,803584,918272,746240,860928,975616,1491712,201472,226560,251648,276736,7290880,7299072,7307264,7294976,7303168,7311360,7348224,7372800,7374848,7376896,7378944,1304832,1304960,1096832
.long 114944,115072,57344,172032,4999168,4913152,13888512,13741056,13887488,13740032,13892608,13745152,13891584,13744128,602368,28672,70400,70144,72448,72192,229376,0,0,0,0,0,2417664,2503680,2589696,36864,79872,18432,10808,19000,1672,23672,127496,46192,46592,2589696,39680,9869312,308992,35520,5424,21904,0,0,0,6,0,4294967295,1,18432,1049336022,3584,1032960,1147648,1262336,1090304,1204992,1319680,1549056,301824,326912,352000,377088,7315456,7323648,7331840,7319552,7327744,7335936,7352320,7380992,7383040,7385088,7387136,1355008,1355136,1107584
.long 1280,1408,57344,172032,2002944,2088960,8757248,8904704,8758272,8905728,8761344,8908800,8762368,8909824,804096,28672,86016,86272,88064,88320,229376,0,0,0,0,0,1647104,1733120,1819136,0,49152,0,6816,15008,680,23712,144384,38208,37888,2335232,38912,9431040,516864,37376,6160,22544,0,0,0,6,0,4294967295,1,0,1049336022,3584,768,115456,230144,58112,172800,287488,1377024,768,25856,50944,76032,8421376,8429568,8437760,8425472,8433664,8441856,8519680,8536064,8538112,8540160,8542208,503040,503168,731776
.long 115968,116096,57344,172032,2091008,2004992,8906752,8759296,8907776,8760320,8910848,8763392,8911872,8764416,1004800,28672,86528,86784,88576,88832,229376,0,0,0,0,0,1905152,1991168,2077184,12288,59392,6144,6824,15016,680,23720,144896,38224,37888,2421248,39168,9578496,524032,37440,6256,22672,0,0,0,6,0,4294967295,1,6144,1049336022,3584,344832,459520,574208,402176,516864,631552,1434368,101120,126208,151296,176384,8445952,8454144,8462336,8450048,8458240,8466432,8523776,8544256,8546304,8548352,8550400,553216,553344,742528
.long 1280,1408,57344,172032,2174976,2260992,9053184,9200640,9052160,9199616,9057280,9204736,9056256,9203712,1205504,28672,86272,86016,88320,88064,229376,0,0,0,0,0,2163200,2249216,2335232,24576,69632,12288,6832,15024,680,23728,144392,38240,38400,2507264,39424,9725952,531200,37504,6352,22800,0,0,0,6,0,4294967295,1,12288,1049336022,3584,688896,803584,918272,746240,860928,975616,1491712,201472,226560,251648,276736,8470528,8478720,8486912,8474624,8482816,8491008,8527872,8552448,8554496,8556544,8558592,503040,503168,753280
.long 115968,116096,57344,172032,2263040,2177024,9202688,9055232,9201664,9054208,9206784,9059328,9205760,9058304,1406208,28672,86784,86528,88832,88576,229376,0,0,0,0,0,2421248,2507264,2593280,36864,79872,18432,6840,15032,680,23736,144904,38256,38400,2593280,39680,9873408,538368,37568,6448,22928,0,0,0,6,0,4294967295,1,18432,1049336022,3584,1032960,1147648,1262336,1090304,1204992,1319680,1549056,301824,326912,352000,377088,8495104,8503296,8511488,8499200,8507392,8515584,8531968,8560640,8562688,8564736,8566784,553216,553344,764032
.long 1280,1408,57344,172032,4755456,4841472,13475840,13623296,13476864,13624320,13479936,13627392,13480960,13628416,1280,28672,86016,86272,88064,88320,229376,0,0,0,0,0,1650688,1736704,1822720,0,49152,0,10912,19104,1704,23776,143360,46400,46080,2338816,38912,9435136,746240,39424,7184,23568,0,0,0,6,0,4294967295,1,0,1049336022,3584,768,115456,230144,58112,172800,287488,1377024,768,25856,50944,76032,9601024,9609216,9617408,9605120,9613312,9621504,9699328,9715712,9717760,9719808,9721856,1305856,1305984,1075840
.long 115968,116096,57344,172032,4843520,4757504,13625344,13477888,13626368,13478912,13629440,13481984,13630464,13483008,201984,28672,86528,86784,88576,88832,229376,0,0,0,0,0,1908736,1994752,2080768,12288,59392,6144,10920,19112,1704,23784,143872,46416,46080,2424832,39168,9582592,753408,39488,7280,23696,0,0,0,6,0,4294967295,1,6144,1049336022,3584,344832,459520,574208,402176,516864,631552,1434368,101120,126208,151296,176384,9625600,9633792,9641984,9629696,9637888,9646080,9703424,9723904,9725952,9728000,9730048,1356032,1356160,1086592
.long 1280,1408,57344,172032,4927488,5013504,13771776,13919232,13770752,13918208,13775872,13923328,13774848,13922304,402688,28672,86272,86016,88320,88064,229376,0,0,0,0,0,2166784,2252800,2338816,24576,69632,12288,10928,19120,1704,23792,143368,46432,46592,2510848,39424,9730048,760576,39552,7376,23824,0,0,0,6,0,4294967295,1,12288,1049336022,3584,688896,803584,918272,746240,860928,975616,1491712,201472,226560,251648,276736,9650176,9658368,9666560,9654272,9662464,9670656,9707520,9732096,9734144,9736192,9738240,1305856,1305984,1097344
.long 115968,116096,57344,172032,5015552,4929536,13921280,13773824,13920256,13772800,13925376,13777920,13924352,13776896,603392,28672,86784,86528,88832,88576,229376,0,0,0,0,0,2424832,2510848,2596864,36864,79872,18432,10936,19128,1704,23800,143880,46448,46592,2596864,39680,9877504,767744,39616,7472,23952,0,0,0,6,0,4294967295,1,18432,1049336022,3584,1032960,1147648,1262336,1090304,1204992,1319680,1549056,301824,326912,352000,377088,9674752,9682944,9691136,9678848,9687040,9695232,9711616,9740288,9742336,9744384,9746432,1356032,1356160,1108096
.long 2304,2432,57344,172032,2019328,2105344,8790016,8937472,8791040,8938496,8794112,8941568,8795136,8942592,805120,28672,102400,102656,104448,104704,229376,0,0,0,0,0,1654272,1740288,1826304,0,49152,0,6944,15136,712,23840,160768,38464,37888,2342400,38912,9439232,975616,41472,8208,24592,0,0,0,6,0,4294967295,1,0,1065353216,3584,768,115456,230144,58112,172800,287488,1377024,768,25856,50944,76032,10780672,10788864,10797056,10784768,10792960,10801152,10878976,10895360,10897408,10899456,10901504,504064,504192,732288
.long 116992,117120,57344,172032,2107392,2021376,8939520,8792064,8940544,8793088,8943616,8796160,8944640,8797184,1005824,28672,102912,103168,104960,105216,229376,0,0,0,0,0,1912320,1998336,2084352,12288,59392,6144,6952,15144,712,23848,161280,38480,37888,2428416,39168,9586688,982784,41536,8304,24720,0,0,0,6,0,4294967295,1,6144,1065353216,3584,344832,459520,574208,402176,516864,631552,1434368,101120,126208,151296,176384,10805248,10813440,10821632,10809344,10817536,10825728,10883072,10903552,10905600,10907648,10909696,554240,554368,743040
.long 2304,2432,57344,172032,2191360,2277376,9085952,9233408,9084928,9232384,9090048,9237504,9089024,9236480,1206528,28672,102656,102400,104704,104448,229376,0,0,0,0,0,2170368,2256384,2342400,24576,69632,12288,6960,15152,712,23856,160776,38496,38400,2514432,39424,9734144,989952,41600,8400,24848,0,0,0,6,0,4294967295,1,12288,1065353216,3584,688896,803584,918272,746240,860928,975616,1491712,201472,226560,251648,276736,10829824,10838016,10846208,10833920,10842112,10850304,10887168,10911744,10913792,10915840,10917888,504064,504192,753792
.long 116992,117120,57344,172032,2279424,2193408,9235456,9088000,9234432,9086976,9239552,9092096,9238528,9091072,1407232,28672,103168,102912,105216,104960,229376,0,0,0,0,0,2428416,2514432,2600448,36864,79872,18432,6968,15160,712,23864,161288,38512,38400,2600448,39680,9881600,997120,41664,8496,24976,0,0,0,6,0,4294967295,1,18432,1065353216,3584,1032960,1147648,1262336,1090304,1204992,1319680,1549056,301824,326912,352000,377088,10854400,10862592,10870784,10858496,10866688,10874880,10891264,10919936,10921984,10924032,10926080,554240,554368,764544
.long 2304,2432,57344,172032,4771840,4857856,13508608,13656064,13509632,13657088,13512704,13660160,13513728,13661184,2304,28672,102400,102656,104448,104704,229376,0,0,0,0,0,1657856,1743872,1829888,0,49152,0,11040,19232,1736,23904,159744,46656,46080,2345984,38912,9443328,1204992,43520,9232,25616,0,0,0,6,0,4294967295,1,0,1065353216,3584,768,115456,230144,58112,172800,287488,1377024,768,25856,50944,76032,11960320,11968512,11976704,11964416,11972608,11980800,12058624,12075008,12077056,12079104,12081152,1306880,1307008,1076352
.long 116992,117120,57344,172032,4859904,4773888,13658112,13510656,13659136,13511680,13662208,13514752,13663232,13515776,203008,28672,102912,103168,104960,105216,229376,0,0,0,0,0,1915904,2001920,2087936,12288,59392,6144,11048,19240,1736,23912,160256,46672,46080,2432000,39168,9590784,1212160,43584,9328,25744,0,0,0,6,0,4294967295,1,6144,1065353216,3584,344832,459520,574208,402176,516864,631552,1434368,101120,126208,151296,176384,11984896,11993088,12001280,11988992,11997184,12005376,12062720,12083200,12085248,12087296,12089344,1357056,1357184,1087104
.long 2304,2432,57344,172032,4943872,5029888,13804544,13952000,13803520,13950976,13808640,13956096,13807616,13955072,403712,28672,102656,102400,104704,104448,229376,0,0,0,0,0,2173952,2259968,2345984,24576,69632,12288,11056,19248,1736,23920,159752,46688,46592,2518016,39424,9738240,1219328,43648,9424,25872,0,0,0,6,0,4294967295,1,12288,1065353216,3584,688896,803584,918272,746240,860928,975616,1491712,201472,226560,251648,276736,12009472,12017664,12025856,12013568,12021760,12029952,12066816,12091392,12093440,12095488,12097536,1306880,1307008,1097856
.long 116992,117120,57344,172032,5031936,4945920,13954048,13806592,13953024,13805568,13958144,13810688,13957120,13809664,604416,28672,103168,102912,105216,104960,229376,0,0,0,0,0,2432000,2518016,2604032,36864,79872,18432,11064,19256,1736,23928,160264,46704,46592,2604032,39680,9885696,1226496,43712,9520,26000,0,0,0,6,0,4294967295,1,18432,1065353216,3584,1032960,1147648,1262336,1090304,1204992,1319680,1549056,301824,326912,352000,377088,12034048,12042240,12050432,12038144,12046336,12054528,12070912,12099584,12101632,12103680,12105728,1357056,1357184,1108608
.long 2304,3200,43008,129024,2035712,2121728,2056192,2142208,2058240,2144256,8818688,8966144,8819712,8967168,604544,21504,184320,184832,116736,116992,172032,0,0,0,0,0,1661440,1747456,1833472,0,49152,0,2720,15264,744,23968,187392,38720,37888,2349568,38912,9447424,1434368,45568,10256,26640,0,0,0,6,0,4294967295,1,0,1065353216,2688,768,115456,230144,58112,172800,287488,1377024,768,25856,50944,76032,13139968,13148160,13156352,13144064,13152256,13160448,13238272,13254656,13256704,13258752,13260800,378624,504960,732800
.long 88320,117888,43008,129024,2123776,2037760,2146304,2060288,2148352,2062336,8968192,8820736,8969216,8821760,755072,21504,186368,186880,117248,117504,172032,0,0,0,0,0,1919488,2005504,2091520,12288,59392,6144,2728,15272,744,23976,187904,38736,37888,2435584,39168,9594880,1441536,45632,10352,26768,0,0,0,6,0,4294967295,1,6144,1065353216,2688,344832,459520,574208,402176,516864,631552,1434368,101120,126208,151296,176384,13164544,13172736,13180928,13168640,13176832,13185024,13242368,13262848,13264896,13266944,13268992,416256,555136,743552
.long 2432,3200,43008,129024,2207744,2293760,2230272,2316288,2228224,2314240,9114624,9262080,9113600,9261056,905600,21504,184832,184320,116992,116736,172032,0,0,0,0,0,2177536,2263552,2349568,24576,69632,12288,2736,15280,744,23984,187400,38752,38400,2521600,39424,9742336,1448704,45696,10448,26896,0,0,0,6,0,4294967295,1,12288,1065353216,2688,688896,803584,918272,746240,860928,975616,1491712,201472,226560,251648,276736,13189120,13197312,13205504,13193216,13201408,13209600,13246464,13271040,13273088,13275136,13277184,378752,504960,754304
.long 88448,117888,43008,129024,2295808,2209792,2320384,2234368,2318336,2232320,9264128,9116672,9263104,9115648,1056128,21504,186880,186368,117504,117248,172032,0,0,0,0,0,2435584,2521600,2607616,36864,79872,18432,2744,15288,744,23992,187912,38768,38400,2607616,39680,9889792,1455872,45760,10544,27024,0,0,0,6,0,4294967295,1,18432,1065353216,2688,1032960,1147648,1262336,1090304,1204992,1319680,1549056,301824,326912,352000,377088,13213696,13221888,13230080,13217792,13225984,13234176,13250560,13279232,13281280,13283328,13285376,416384,555136,765056
.long 2304,3200,43008,129024,4788224,4874240,4808704,4894720,4810752,4896768,13537280,13684736,13538304,13685760,2432,21504,184320,184832,116736,116992,172032,0,0,0,0,0,1665024,1751040,1837056,0,49152,0,3744,19360,1768,24032,186368,46912,46080,2353152,38912,9451520,1663744,47616,11280,27664,0,0,0,6,0,4294967295,1,0,1065353216,2688,768,115456,230144,58112,172800,287488,1377024,768,25856,50944,76032,14319616,14327808,14336000,14323712,14331904,14340096,14417920,14434304,14436352,14438400,14440448,980736,1307776,1076864
.long 88320,117888,43008,129024,4876288,4790272,4898816,4812800,4900864,4814848,13686784,13539328,13687808,13540352,152960,21504,186368,186880,117248,117504,172032,0,0,0,0,0,1923072,2009088,2095104,12288,59392,6144,3752,19368,1768,24040,186880,46928,46080,2439168,39168,9598976,1670912,47680,11376,27792,0,0,0,6,0,4294967295,1,6144,1065353216,2688,344832,459520,574208,402176,516864,631552,1434368,101120,126208,151296,176384,14344192,14352384,14360576,14348288,14356480,14364672,14422016,14442496,14444544,14446592,14448640,1018368,1357952,1087616
.long 2432,3200,43008,129024,4960256,5046272,4982784,5068800,4980736,5066752,13833216,13980672,13832192,13979648,303488,21504,184832,184320,116992,116736,172032,0,0,0,0,0,2181120,2267136,2353152,24576,69632,12288,3760,19376,1768,24048,186376,46944,46592,2525184,39424,9746432,1678080,47744,11472,27920,0,0,0,6,0,4294967295,1,12288,1065353216,2688,688896,803584,918272,746240,860928,975616,1491712,201472,226560,251648,276736,14368768,14376960,14385152,14372864,14381056,14389248,14426112,14450688,14452736,14454784,14456832,980864,1307776,1098368
.long 88448,117888,43008,129024,5048320,4962304,5072896,4986880,5070848,4984832,13982720,13835264,13981696,13834240,454016,21504,186880,186368,117504,117248,172032,0,0,0,0,0,2439168,2525184,2611200,36864,79872,18432,3768,19384,1768,24056,186888,46960,46592,2611200,39680,9893888,1685248,47808,11568,28048,0,0,0,6,0,4294967295,1,18432,1065353216,2688,1032960,1147648,1262336,1090304,1204992,1319680,1549056,301824,326912,352000,377088,14393344,14401536,14409728,14397440,14405632,14413824,14430208,14458880,14460928,14462976,14465024,1018496,1357952,1109120
.long 256,384,57344,172032,2330624,2416640,9314304,9461760,9315328,9462784,9318400,9465856,9319424,9466880,803200,28672,69632,69888,71680,71936,229376,0,0,0,0,0,1982464,2068480,2154496,0,49152,0,7200,15392,776,24064,72704,38976,38912,2670592,39936,10010624,114688,33792,4608,20992,0,0,0,7,4294967295,0,0,1544,1049336022,3584,0,114688,229376,57344,172032,286720,1376256,0,25088,50176,75264,6356992,6365184,6373376,6361088,6369280,6377472,6455296,6471680,6473728,6475776,6477824,602368,602496,774272
.long 114944,115072,57344,172032,2418688,2332672,9463808,9316352,9464832,9317376,9467904,9320448,9468928,9321472,1003904,28672,70144,70400,72192,72448,229376,0,0,0,0,0,2240512,2326528,2412544,12288,59392,6144,7208,15400,776,24072,73216,38992,38912,2756608,40192,10158080,121856,33856,4704,21120,0,0,0,7,4294967295,0,0,7688,1049336022,3584,344064,458752,573440,401408,516096,630784,1433600,100352,125440,150528,175616,6381568,6389760,6397952,6385664,6393856,6402048,6459392,6479872,6481920,6483968,6486016,652544,652672,785024
.long 256,384,57344,172032,2502656,2588672,9610240,9757696,9609216,9756672,9614336,9761792,9613312,9760768,1204608,28672,69888,69632,71936,71680,229376,0,0,0,0,0,2498560,2584576,2670592,24576,69632,12288,7216,15408,776,24080,72712,39008,39424,2842624,40448,10305536,129024,33920,4800,21248,0,0,0,7,4294967295,0,0,13832,1049336022,3584,688128,802816,917504,745472,860160,974848,1490944,200704,225792,250880,275968,6406144,6414336,6422528,6410240,6418432,6426624,6463488,6488064,6490112,6492160,6494208,602368,602496,795776
.long 114944,115072,57344,172032,2590720,2504704,9759744,9612288,9758720,9611264,9763840,9616384,9762816,9615360,1405312,28672,70400,70144,72448,72192,229376,0,0,0,0,0,2756608,2842624,2928640,36864,79872,18432,7224,15416,776,24088,73224,39024,39424,2928640,40704,10452992,136192,33984,4896,21376,0,0,0,7,4294967295,0,0,19976,1049336022,3584,1032192,1146880,1261568,1089536,1204224,1318912,1548288,301056,326144,351232,376320,6430720,6438912,6447104,6434816,6443008,6451200,6467584,6496256,6498304,6500352,6502400,652544,652672,806528
.long 256,384,57344,172032,5083136,5169152,14032896,14180352,14033920,14181376,14036992,14184448,14038016,14185472,384,28672,69632,69888,71680,71936,229376,0,0,0,0,0,1986048,2072064,2158080,0,49152,0,11296,19488,1800,24128,71680,47168,47104,2674176,39936,10014720,344064,35840,5632,22016,0,0,0,7,4294967295,0,0,1544,1049336022,3584,0,114688,229376,57344,172032,286720,1376256,0,25088,50176,75264,7536640,7544832,7553024,7540736,7548928,7557120,7634944,7651328,7653376,7655424,7657472,1405184,1405312,1118336
.long 114944,115072,57344,172032,5171200,5085184,14182400,14034944,14183424,14035968,14186496,14039040,14187520,14040064,201088,28672,70144,70400,72192,72448,229376,0,0,0,0,0,2244096,2330112,2416128,12288,59392,6144,11304,19496,1800,24136,72192,47184,47104,2760192,40192,10162176,351232,35904,5728,22144,0,0,0,7,4294967295,0,0,7688,1049336022,3584,344064,458752,573440,401408,516096,630784,1433600,100352,125440,150528,175616,7561216,7569408,7577600,7565312,7573504,7581696,7639040,7659520,7661568,7663616,7665664,1455360,1455488,1129088
.long 256,384,57344,172032,5255168,5341184,14328832,14476288,14327808,14475264,14332928,14480384,14331904,14479360,401792,28672,69888,69632,71936,71680,229376,0,0,0,0,0,2502144,2588160,2674176,24576,69632,12288,11312,19504,1800,24144,71688,47200,47616,2846208,40448,10309632,358400,35968,5824,22272,0,0,0,7,4294967295,0,0,13832,1049336022,3584,688128,802816,917504,745472,860160,974848,1490944,200704,225792,250880,275968,7585792,7593984,7602176,7589888,7598080,7606272,7643136,7667712,7669760,7671808,7673856,1405184,1405312,1139840
.long 114944,115072,57344,172032,5343232,5257216,14478336,14330880,14477312,14329856,14482432,14334976,14481408,14333952,602496,28672,70400,70144,72448,72192,229376,0,0,0,0,0,2760192,2846208,2932224,36864,79872,18432,11320,19512,1800,24152,72200,47216,47616,2932224,40704,10457088,365568,36032,5920,22400,0,0,0,7,4294967295,0,0,19976,1049336022,3584,1032192,1146880,1261568,1089536,1204224,1318912,1548288,301056,326144,351232,376320,7610368,7618560,7626752,7614464,7622656,7630848,7647232,7675904,7677952,7680000,7682048,1455360,1455488,1150592
.long 1280,1408,57344,172032,2347008,2433024,9347072,9494528,9348096,9495552,9351168,9498624,9352192,9499648,804224,28672,86016,86272,88064,88320,229376,0,0,0,0,0,1989632,2075648,2161664,0,49152,0,7328,15520,808,24192,89088,39232,38912,2677760,39936,10018816,573440,37888,6656,23040,0,0,0,7,4294967295,0,0,1544,1049336022,3584,0,114688,229376,57344,172032,286720,1376256,0,25088,50176,75264,8716288,8724480,8732672,8720384,8728576,8736768,8814592,8830976,8833024,8835072,8837120,603392,603520,774784
.long 115968,116096,57344,172032,2435072,2349056,9496576,9349120,9497600,9350144,9500672,9353216,9501696,9354240,1004928,28672,86528,86784,88576,88832,229376,0,0,0,0,0,2247680,2333696,2419712,12288,59392,6144,7336,15528,808,24200,89600,39248,38912,2763776,40192,10166272,580608,37952,6752,23168,0,0,0,7,4294967295,0,0,7688,1049336022,3584,344064,458752,573440,401408,516096,630784,1433600,100352,125440,150528,175616,8740864,8749056,8757248,8744960,8753152,8761344,8818688,8839168,8841216,8843264,8845312,653568,653696,785536
.long 1280,1408,57344,172032,2519040,2605056,9643008,9790464,9641984,9789440,9647104,9794560,9646080,9793536,1205632,28672,86272,86016,88320,88064,229376,0,0,0,0,0,2505728,2591744,2677760,24576,69632,12288,7344,15536,808,24208,89096,39264,39424,2849792,40448,10313728,587776,38016,6848,23296,0,0,0,7,4294967295,0,0,13832,1049336022,3584,688128,802816,917504,745472,860160,974848,1490944,200704,225792,250880,275968,8765440,8773632,8781824,8769536,8777728,8785920,8822784,8847360,8849408,8851456,8853504,603392,603520,796288
.long 115968,116096,57344,172032,2607104,2521088,9792512,9645056,9791488,9644032,9796608,9649152,9795584,9648128,1406336,28672,86784,86528,88832,88576,229376,0,0,0,0,0,2763776,2849792,2935808,36864,79872,18432,7352,15544,808,24216,89608,39280,39424,2935808,40704,10461184,594944,38080,6944,23424,0,0,0,7,4294967295,0,0,19976,1049336022,3584,1032192,1146880,1261568,1089536,1204224,1318912,1548288,301056,326144,351232,376320,8790016,8798208,8806400,8794112,8802304,8810496,8826880,8855552,8857600,8859648,8861696,653568,653696,807040
.long 1280,1408,57344,172032,5099520,5185536,14065664,14213120,14066688,14214144,14069760,14217216,14070784,14218240,1408,28672,86016,86272,88064,88320,229376,0,0,0,0,0,1993216,2079232,2165248,0,49152,0,11424,19616,1832,24256,88064,47424,47104,2681344,39936,10022912,802816,39936,7680,24064,0,0,0,7,4294967295,0,0,1544,1049336022,3584,0,114688,229376,57344,172032,286720,1376256,0,25088,50176,75264,9895936,9904128,9912320,9900032,9908224,9916416,9994240,10010624,10012672,10014720,10016768,1406208,1406336,1118848
.long 115968,116096,57344,172032,5187584,5101568,14215168,14067712,14216192,14068736,14219264,14071808,14220288,14072832,202112,28672,86528,86784,88576,88832,229376,0,0,0,0,0,2251264,2337280,2423296,12288,59392,6144,11432,19624,1832,24264,88576,47440,47104,2767360,40192,10170368,809984,40000,7776,24192,0,0,0,7,4294967295,0,0,7688,1049336022,3584,344064,458752,573440,401408,516096,630784,1433600,100352,125440,150528,175616,9920512,9928704,9936896,9924608,9932800,9940992,9998336,10018816,10020864,10022912,10024960,1456384,1456512,1129600
.long 1280,1408,57344,172032,5271552,5357568,14361600,14509056,14360576,14508032,14365696,14513152,14364672,14512128,402816,28672,86272,86016,88320,88064,229376,0,0,0,0,0,2509312,2595328,2681344,24576,69632,12288,11440,19632,1832,24272,88072,47456,47616,2853376,40448,10317824,817152,40064,7872,24320,0,0,0,7,4294967295,0,0,13832,1049336022,3584,688128,802816,917504,745472,860160,974848,1490944,200704,225792,250880,275968,9945088,9953280,9961472,9949184,9957376,9965568,10002432,10027008,10029056,10031104,10033152,1406208,1406336,1140352
.long 115968,116096,57344,172032,5359616,5273600,14511104,14363648,14510080,14362624,14515200,14367744,14514176,14366720,603520,28672,86784,86528,88832,88576,229376,0,0,0,0,0,2767360,2853376,2939392,36864,79872,18432,11448,19640,1832,24280,88584,47472,47616,2939392,40704,10465280,824320,40128,7968,24448,0,0,0,7,4294967295,0,0,19976,1049336022,3584,1032192,1146880,1261568,1089536,1204224,1318912,1548288,301056,326144,351232,376320,9969664,9977856,9986048,9973760,9981952,9990144,10006528,10035200,10037248,10039296,10041344,1456384,1456512,1151104
.long 2304,2432,57344,172032,2363392,2449408,9379840,9527296,9380864,9528320,9383936,9531392,9384960,9532416,805248,28672,102400,102656,104448,104704,229376,0,0,0,0,0,1996800,2082816,2168832,0,49152,0,7456,15648,840,24320,105472,39488,38912,2684928,39936,10027008,1032192,41984,8704,25088,0,0,0,7,4294967295,0,0,1544,1065353216,3584,0,114688,229376,57344,172032,286720,1376256,0,25088,50176,75264,11075584,11083776,11091968,11079680,11087872,11096064,11173888,11190272,11192320,11194368,11196416,604416,604544,775296
.long 116992,117120,57344,172032,2451456,2365440,9529344,9381888,9530368,9382912,9533440,9385984,9534464,9387008,1005952,28672,102912,103168,104960,105216,229376,0,0,0,0,0,2254848,2340864,2426880,12288,59392,6144,7464,15656,840,24328,105984,39504,38912,2770944,40192,10174464,1039360,42048,8800,25216,0,0,0,7,4294967295,0,0,7688,1065353216,3584,344064,458752,573440,401408,516096,630784,1433600,100352,125440,150528,175616,11100160,11108352,11116544,11104256,11112448,11120640,11177984,11198464,11200512,11202560,11204608,654592,654720,786048
.long 2304,2432,57344,172032,2535424,2621440,9675776,9823232,9674752,9822208,9679872,9827328,9678848,9826304,1206656,28672,102656,102400,104704,104448,229376,0,0,0,0,0,2512896,2598912,2684928,24576,69632,12288,7472,15664,840,24336,105480,39520,39424,2856960,40448,10321920,1046528,42112,8896,25344,0,0,0,7,4294967295,0,0,13832,1065353216,3584,688128,802816,917504,745472,860160,974848,1490944,200704,225792,250880,275968,11124736,11132928,11141120,11128832,11137024,11145216,11182080,11206656,11208704,11210752,11212800,604416,604544,796800
.long 116992,117120,57344,172032,2623488,2537472,9825280,9677824,9824256,9676800,9829376,9681920,9828352,9680896,1407360,28672,103168,102912,105216,104960,229376,0,0,0,0,0,2770944,2856960,2942976,36864,79872,18432,7480,15672,840,24344,105992,39536,39424,2942976,40704,10469376,1053696,42176,8992,25472,0,0,0,7,4294967295,0,0,19976,1065353216,3584,1032192,1146880,1261568,1089536,1204224,1318912,1548288,301056,326144,351232,376320,11149312,11157504,11165696,11153408,11161600,11169792,11186176,11214848,11216896,11218944,11220992,654592,654720,807552
.long 2304,2432,57344,172032,5115904,5201920,14098432,14245888,14099456,14246912,14102528,14249984,14103552,14251008,2432,28672,102400,102656,104448,104704,229376,0,0,0,0,0,2000384,2086400,2172416,0,49152,0,11552,19744,1864,24384,104448,47680,47104,2688512,39936,10031104,1261568,44032,9728,26112,0,0,0,7,4294967295,0,0,1544,1065353216,3584,0,114688,229376,57344,172032,286720,1376256,0,25088,50176,75264,12255232,12263424,12271616,12259328,12267520,12275712,12353536,12369920,12371968,12374016,12376064,1407232,1407360,1119360
.long 116992,117120,57344,172032,5203968,5117952,14247936,14100480,14248960,14101504,14252032,14104576,14253056,14105600,203136,28672,102912,103168,104960,105216,229376,0,0,0,0,0,2258432,2344448,2430464,12288,59392,6144,11560,19752,1864,24392,104960,47696,47104,2774528,40192,10178560,1268736,44096,9824,26240,0,0,0,7,4294967295,0,0,7688,1065353216,3584,344064,458752,573440,401408,516096,630784,1433600,100352,125440,150528,175616,12279808,12288000,12296192,12283904,12292096,12300288,12357632,12378112,12380160,12382208,12384256,1457408,1457536,1130112
.long 2304,2432,57344,172032,5287936,5373952,14394368,14541824,14393344,14540800,14398464,14545920,14397440,14544896,403840,28672,102656,102400,104704,104448,229376,0,0,0,0,0,2516480,2602496,2688512,24576,69632,12288,11568,19760,1864,24400,104456,47712,47616,2860544,40448,10326016,1275904,44160,9920,26368,0,0,0,7,4294967295,0,0,13832,1065353216,3584,688128,802816,917504,745472,860160,974848,1490944,200704,225792,250880,275968,12304384,12312576,12320768,12308480,12316672,12324864,12361728,12386304,12388352,12390400,12392448,1407232,1407360,1140864
.long 116992,117120,57344,172032,5376000,5289984,14543872,14396416,14542848,14395392,14547968,14400512,14546944,14399488,604544,28672,103168,102912,105216,104960,229376,0,0,0,0,0,2774528,2860544,2946560,36864,79872,18432,11576,19768,1864,24408,104968,47728,47616,2946560,40704,10473472,1283072,44224,10016,26496,0,0,0,7,4294967295,0,0,19976,1065353216,3584,1032192,1146880,1261568,1089536,1204224,1318912,1548288,301056,326144,351232,376320,12328960,12337152,12345344,12333056,12341248,12349440,12365824,12394496,12396544,12398592,12400640,1457408,1457536,1151616
.long 2304,3200,43008,129024,2379776,2465792,2400256,2486272,2402304,2488320,9408512,9555968,9409536,9556992,806016,28672,184320,184832,116736,116992,172032,0,0,0,0,0,2003968,2089984,2176000,0,49152,0,2848,15776,872,24448,117760,39744,38912,2692096,39936,10035200,1490944,46080,10752,27136,0,0,0,7,4294967295,0,0,1544,1065353216,2688,0,114688,229376,57344,172032,286720,1376256,0,25088,50176,75264,13434880,13443072,13451264,13438976,13447168,13455360,13533184,13549568,13551616,13553664,13555712,453888,605312,775808
.long 88320,117888,43008,129024,2467840,2381824,2490368,2404352,2492416,2406400,9558016,9410560,9559040,9411584,1006720,28672,186368,186880,117248,117504,172032,0,0,0,0,0,2262016,2348032,2434048,12288,59392,6144,2856,15784,872,24456,118272,39760,38912,2778112,40192,10182656,1498112,46144,10848,27264,0,0,0,7,4294967295,0,0,7688,1065353216,2688,344064,458752,573440,401408,516096,630784,1433600,100352,125440,150528,175616,13459456,13467648,13475840,13463552,13471744,13479936,13537280,13557760,13559808,13561856,13563904,491520,655488,786560
.long 2432,3200,43008,129024,2551808,2637824,2574336,2660352,2572288,2658304,9704448,9851904,9703424,9850880,1207424,28672,184832,184320,116992,116736,172032,0,0,0,0,0,2520064,2606080,2692096,24576,69632,12288,2864,15792,872,24464,117768,39776,39424,2864128,40448,10330112,1505280,46208,10944,27392,0,0,0,7,4294967295,0,0,13832,1065353216,2688,688128,802816,917504,745472,860160,974848,1490944,200704,225792,250880,275968,13484032,13492224,13500416,13488128,13496320,13504512,13541376,13565952,13568000,13570048,13572096,454016,605312,797312
.long 88448,117888,43008,129024,2639872,2553856,2664448,2578432,2662400,2576384,9853952,9706496,9852928,9705472,1408128,28672,186880,186368,117504,117248,172032,0,0,0,0,0,2778112,2864128,2950144,36864,79872,18432,2872,15800,872,24472,118280,39792,39424,2950144,40704,10477568,1512448,46272,11040,27520,0,0,0,7,4294967295,0,0,19976,1065353216,2688,1032192,1146880,1261568,1089536,1204224,1318912,1548288,301056,326144,351232,376320,13508608,13516800,13524992,13512704,13520896,13529088,13545472,13574144,13576192,13578240,13580288,491648,655488,808064
.long 2304,3200,43008,129024,5132288,5218304,5152768,5238784,5154816,5240832,14127104,14274560,14128128,14275584,3200,28672,184320,184832,116736,116992,172032,0,0,0,0,0,2007552,2093568,2179584,0,49152,0,3872,19872,1896,24512,116736,47936,47104,2695680,39936,10039296,1720320,48128,11776,28160,0,0,0,7,4294967295,0,0,1544,1065353216,2688,0,114688,229376,57344,172032,286720,1376256,0,25088,50176,75264,14614528,14622720,14630912,14618624,14626816,14635008,14712832,14729216,14731264,14733312,14735360,1056000,1408128,1119872
.long 88320,117888,43008,129024,5220352,5134336,5242880,5156864,5244928,5158912,14276608,14129152,14277632,14130176,203904,28672,186368,186880,117248,117504,172032,0,0,0,0,0,2265600,2351616,2437632,12288,59392,6144,3880,19880,1896,24520,117248,47952,47104,2781696,40192,10186752,1727488,48192,11872,28288,0,0,0,7,4294967295,0,0,7688,1065353216,2688,344064,458752,573440,401408,516096,630784,1433600,100352,125440,150528,175616,14639104,14647296,14655488,14643200,14651392,14659584,14716928,14737408,14739456,14741504,14743552,1093632,1458304,1130624
.long 2432,3200,43008,129024,5304320,5390336,5326848,5412864,5324800,5410816,14423040,14570496,14422016,14569472,404608,28672,184832,184320,116992,116736,172032,0,0,0,0,0,2523648,2609664,2695680,24576,69632,12288,3888,19888,1896,24528,116744,47968,47616,2867712,40448,10334208,1734656,48256,11968,28416,0,0,0,7,4294967295,0,0,13832,1065353216,2688,688128,802816,917504,745472,860160,974848,1490944,200704,225792,250880,275968,14663680,14671872,14680064,14667776,14675968,14684160,14721024,14745600,14747648,14749696,14751744,1056128,1408128,1141376
.long 88448,117888,43008,129024,5392384,5306368,5416960,5330944,5414912,5328896,14572544,14425088,14571520,14424064,605312,28672,186880,186368,117504,117248,172032,0,0,0,0,0,2781696,2867712,2953728,36864,79872,18432,3896,19896,1896,24536,117256,47984,47616,2953728,40704,10481664,1741824,48320,12064,28544,0,0,0,7,4294967295,0,0,19976,1065353216,2688,1032192,1146880,1261568,1089536,1204224,1318912,1548288,301056,326144,351232,376320,14688256,14696448,14704640,14692352,14700544,14708736,14725120,14753792,14755840,14757888,14759936,1093760,1458304,1152128
.long 256,384,57344,172032,2674688,2760704,9904128,10051584,9905152,10052608,9908224,10055680,9909248,10056704,803200,28672,69632,69888,71680,71936,229376,0,0,0,0,0,1984000,2070016,2156032,0,49152,0,7712,15904,904,24096,130048,40000,39936,2672128,39936,10012672,114816,33792,4608,20992,0,0,0,7,0,4294967295,1,0,1049336022,3584,128,114816,229504,57472,172160,286848,1376384,128,25216,50304,75392,6356992,6365184,6373376,6361088,6369280,6377472,6455296,6471680,6473728,6475776,6477824,702720,702848,817280
.long 114944,115072,57344,172032,2762752,2676736,10053632,9906176,10054656,9907200,10057728,9910272,10058752,9911296,1003904,28672,70144,70400,72192,72448,229376,0,0,0,0,0,2242048,2328064,2414080,12288,59392,6144,7720,15912,904,24104,130560,40016,39936,2758144,40192,10160128,121984,33856,4704,21120,0,0,0,7,0,4294967295,1,6144,1049336022,3584,344192,458880,573568,401536,516224,630912,1433728,100480,125568,150656,175744,6381568,6389760,6397952,6385664,6393856,6402048,6459392,6479872,6481920,6483968,6486016,752896,753024,828032
.long 256,384,57344,172032,2846720,2932736,10200064,10347520,10199040,10346496,10204160,10351616,10203136,10350592,1204608,28672,69888,69632,71936,71680,229376,0,0,0,0,0,2500096,2586112,2672128,24576,69632,12288,7728,15920,904,24112,130056,40032,40448,2844160,40448,10307584,129152,33920,4800,21248,0,0,0,7,0,4294967295,1,12288,1049336022,3584,688256,802944,917632,745600,860288,974976,1491072,200832,225920,251008,276096,6406144,6414336,6422528,6410240,6418432,6426624,6463488,6488064,6490112,6492160,6494208,702720,702848,838784
.long 114944,115072,57344,172032,2934784,2848768,10349568,10202112,10348544,10201088,10353664,10206208,10352640,10205184,1405312,28672,70400,70144,72448,72192,229376,0,0,0,0,0,2758144,2844160,2930176,36864,79872,18432,7736,15928,904,24120,130568,40048,40448,2930176,40704,10455040,136320,33984,4896,21376,0,0,0,7,0,4294967295,1,18432,1049336022,3584,1032320,1147008,1261696,1089664,1204352,1319040,1548416,301184,326272,351360,376448,6430720,6438912,6447104,6434816,6443008,6451200,6467584,6496256,6498304,6500352,6502400,752896,753024,849536
.long 256,384,57344,172032,5427200,5513216,14622720,14770176,14623744,14771200,14626816,14774272,14627840,14775296,384,28672,69632,69888,71680,71936,229376,0,0,0,0,0,1987584,2073600,2159616,0,49152,0,11808,20000,1928,24160,129024,48192,48128,2675712,39936,10016768,344192,35840,5632,22016,0,0,0,7,0,4294967295,1,0,1049336022,3584,128,114816,229504,57472,172160,286848,1376384,128,25216,50304,75392,7536640,7544832,7553024,7540736,7548928,7557120,7634944,7651328,7653376,7655424,7657472,1505536,1505664,1161344
.long 114944,115072,57344,172032,5515264,5429248,14772224,14624768,14773248,14625792,14776320,14628864,14777344,14629888,201088,28672,70144,70400,72192,72448,229376,0,0,0,0,0,2245632,2331648,2417664,12288,59392,6144,11816,20008,1928,24168,129536,48208,48128,2761728,40192,10164224,351360,35904,5728,22144,0,0,0,7,0,4294967295,1,6144,1049336022,3584,344192,458880,573568,401536,516224,630912,1433728,100480,125568,150656,175744,7561216,7569408,7577600,7565312,7573504,7581696,7639040,7659520,7661568,7663616,7665664,1555712,1555840,1172096
.long 256,384,57344,172032,5599232,5685248,14918656,15066112,14917632,15065088,14922752,15070208,14921728,15069184,401792,28672,69888,69632,71936,71680,229376,0,0,0,0,0,2503680,2589696,2675712,24576,69632,12288,11824,20016,1928,24176,129032,48224,48640,2847744,40448,10311680,358528,35968,5824,22272,0,0,0,7,0,4294967295,1,12288,1049336022,3584,688256,802944,917632,745600,860288,974976,1491072,200832,225920,251008,276096,7585792,7593984,7602176,7589888,7598080,7606272,7643136,7667712,7669760,7671808,7673856,1505536,1505664,1182848
.long 114944,115072,57344,172032,5687296,5601280,15068160,14920704,15067136,14919680,15072256,14924800,15071232,14923776,602496,28672,70400,70144,72448,72192,229376,0,0,0,0,0,2761728,2847744,2933760,36864,79872,18432,11832,20024,1928,24184,129544,48240,48640,2933760,40704,10459136,365696,36032,5920,22400,0,0,0,7,0,4294967295,1,18432,1049336022,3584,1032320,1147008,1261696,1089664,1204352,1319040,1548416,301184,326272,351360,376448,7610368,7618560,7626752,7614464,7622656,7630848,7647232,7675904,7677952,7680000,7682048,1555712,1555840,1193600
.long 1280,1408,57344,172032,2691072,2777088,9936896,10084352,9937920,10085376,9940992,10088448,9942016,10089472,804224,28672,86016,86272,88064,88320,229376,0,0,0,0,0,1991168,2077184,2163200,0,49152,0,7840,16032,936,24224,146432,40256,39936,2679296,39936,10020864,573568,37888,6656,23040,0,0,0,7,0,4294967295,1,0,1049336022,3584,128,114816,229504,57472,172160,286848,1376384,128,25216,50304,75392,8716288,8724480,8732672,8720384,8728576,8736768,8814592,8830976,8833024,8835072,8837120,703744,703872,817792
.long 115968,116096,57344,172032,2779136,2693120,10086400,9938944,10087424,9939968,10090496,9943040,10091520,9944064,1004928,28672,86528,86784,88576,88832,229376,0,0,0,0,0,2249216,2335232,2421248,12288,59392,6144,7848,16040,936,24232,146944,40272,39936,2765312,40192,10168320,580736,37952,6752,23168,0,0,0,7,0,4294967295,1,6144,1049336022,3584,344192,458880,573568,401536,516224,630912,1433728,100480,125568,150656,175744,8740864,8749056,8757248,8744960,8753152,8761344,8818688,8839168,8841216,8843264,8845312,753920,754048,828544
.long 1280,1408,57344,172032,2863104,2949120,10232832,10380288,10231808,10379264,10236928,10384384,10235904,10383360,1205632,28672,86272,86016,88320,88064,229376,0,0,0,0,0,2507264,2593280,2679296,24576,69632,12288,7856,16048,936,24240,146440,40288,40448,2851328,40448,10315776,587904,38016,6848,23296,0,0,0,7,0,4294967295,1,12288,1049336022,3584,688256,802944,917632,745600,860288,974976,1491072,200832,225920,251008,276096,8765440,8773632,8781824,8769536,8777728,8785920,8822784,8847360,8849408,8851456,8853504,703744,703872,839296
.long 115968,116096,57344,172032,2951168,2865152,10382336,10234880,10381312,10233856,10386432,10238976,10385408,10237952,1406336,28672,86784,86528,88832,88576,229376,0,0,0,0,0,2765312,2851328,2937344,36864,79872,18432,7864,16056,936,24248,146952,40304,40448,2937344,40704,10463232,595072,38080,6944,23424,0,0,0,7,0,4294967295,1,18432,1049336022,3584,1032320,1147008,1261696,1089664,1204352,1319040,1548416,301184,326272,351360,376448,8790016,8798208,8806400,8794112,8802304,8810496,8826880,8855552,8857600,8859648,8861696,753920,754048,850048
.long 1280,1408,57344,172032,5443584,5529600,14655488,14802944,14656512,14803968,14659584,14807040,14660608,14808064,1408,28672,86016,86272,88064,88320,229376,0,0,0,0,0,1994752,2080768,2166784,0,49152,0,11936,20128,1960,24288,145408,48448,48128,2682880,39936,10024960,802944,39936,7680,24064,0,0,0,7,0,4294967295,1,0,1049336022,3584,128,114816,229504,57472,172160,286848,1376384,128,25216,50304,75392,9895936,9904128,9912320,9900032,9908224,9916416,9994240,10010624,10012672,10014720,10016768,1506560,1506688,1161856
.long 115968,116096,57344,172032,5531648,5445632,14804992,14657536,14806016,14658560,14809088,14661632,14810112,14662656,202112,28672,86528,86784,88576,88832,229376,0,0,0,0,0,2252800,2338816,2424832,12288,59392,6144,11944,20136,1960,24296,145920,48464,48128,2768896,40192,10172416,810112,40000,7776,24192,0,0,0,7,0,4294967295,1,6144,1049336022,3584,344192,458880,573568,401536,516224,630912,1433728,100480,125568,150656,175744,9920512,9928704,9936896,9924608,9932800,9940992,9998336,10018816,10020864,10022912,10024960,1556736,1556864,1172608
.long 1280,1408,57344,172032,5615616,5701632,14951424,15098880,14950400,15097856,14955520,15102976,14954496,15101952,402816,28672,86272,86016,88320,88064,229376,0,0,0,0,0,2510848,2596864,2682880,24576,69632,12288,11952,20144,1960,24304,145416,48480,48640,2854912,40448,10319872,817280,40064,7872,24320,0,0,0,7,0,4294967295,1,12288,1049336022,3584,688256,802944,917632,745600,860288,974976,1491072,200832,225920,251008,276096,9945088,9953280,9961472,9949184,9957376,9965568,10002432,10027008,10029056,10031104,10033152,1506560,1506688,1183360
.long 115968,116096,57344,172032,5703680,5617664,15100928,14953472,15099904,14952448,15105024,14957568,15104000,14956544,603520,28672,86784,86528,88832,88576,229376,0,0,0,0,0,2768896,2854912,2940928,36864,79872,18432,11960,20152,1960,24312,145928,48496,48640,2940928,40704,10467328,824448,40128,7968,24448,0,0,0,7,0,4294967295,1,18432,1049336022,3584,1032320,1147008,1261696,1089664,1204352,1319040,1548416,301184,326272,351360,376448,9969664,9977856,9986048,9973760,9981952,9990144,10006528,10035200,10037248,10039296,10041344,1556736,1556864,1194112
.long 2304,2432,57344,172032,2707456,2793472,9969664,10117120,9970688,10118144,9973760,10121216,9974784,10122240,805248,28672,102400,102656,104448,104704,229376,0,0,0,0,0,1998336,2084352,2170368,0,49152,0,7968,16160,968,24352,162816,40512,39936,2686464,39936,10029056,1032320,41984,8704,25088,0,0,0,7,0,4294967295,1,0,1065353216,3584,128,114816,229504,57472,172160,286848,1376384,128,25216,50304,75392,11075584,11083776,11091968,11079680,11087872,11096064,11173888,11190272,11192320,11194368,11196416,704768,704896,818304
.long 116992,117120,57344,172032,2795520,2709504,10119168,9971712,10120192,9972736,10123264,9975808,10124288,9976832,1005952,28672,102912,103168,104960,105216,229376,0,0,0,0,0,2256384,2342400,2428416,12288,59392,6144,7976,16168,968,24360,163328,40528,39936,2772480,40192,10176512,1039488,42048,8800,25216,0,0,0,7,0,4294967295,1,6144,1065353216,3584,344192,458880,573568,401536,516224,630912,1433728,100480,125568,150656,175744,11100160,11108352,11116544,11104256,11112448,11120640,11177984,11198464,11200512,11202560,11204608,754944,755072,829056
.long 2304,2432,57344,172032,2879488,2965504,10265600,10413056,10264576,10412032,10269696,10417152,10268672,10416128,1206656,28672,102656,102400,104704,104448,229376,0,0,0,0,0,2514432,2600448,2686464,24576,69632,12288,7984,16176,968,24368,162824,40544,40448,2858496,40448,10323968,1046656,42112,8896,25344,0,0,0,7,0,4294967295,1,12288,1065353216,3584,688256,802944,917632,745600,860288,974976,1491072,200832,225920,251008,276096,11124736,11132928,11141120,11128832,11137024,11145216,11182080,11206656,11208704,11210752,11212800,704768,704896,839808
.long 116992,117120,57344,172032,2967552,2881536,10415104,10267648,10414080,10266624,10419200,10271744,10418176,10270720,1407360,28672,103168,102912,105216,104960,229376,0,0,0,0,0,2772480,2858496,2944512,36864,79872,18432,7992,16184,968,24376,163336,40560,40448,2944512,40704,10471424,1053824,42176,8992,25472,0,0,0,7,0,4294967295,1,18432,1065353216,3584,1032320,1147008,1261696,1089664,1204352,1319040,1548416,301184,326272,351360,376448,11149312,11157504,11165696,11153408,11161600,11169792,11186176,11214848,11216896,11218944,11220992,754944,755072,850560
.long 2304,2432,57344,172032,5459968,5545984,14688256,14835712,14689280,14836736,14692352,14839808,14693376,14840832,2432,28672,102400,102656,104448,104704,229376,0,0,0,0,0,2001920,2087936,2173952,0,49152,0,12064,20256,1992,24416,161792,48704,48128,2690048,39936,10033152,1261696,44032,9728,26112,0,0,0,7,0,4294967295,1,0,1065353216,3584,128,114816,229504,57472,172160,286848,1376384,128,25216,50304,75392,12255232,12263424,12271616,12259328,12267520,12275712,12353536,12369920,12371968,12374016,12376064,1507584,1507712,1162368
.long 116992,117120,57344,172032,5548032,5462016,14837760,14690304,14838784,14691328,14841856,14694400,14842880,14695424,203136,28672,102912,103168,104960,105216,229376,0,0,0,0,0,2259968,2345984,2432000,12288,59392,6144,12072,20264,1992,24424,162304,48720,48128,2776064,40192,10180608,1268864,44096,9824,26240,0,0,0,7,0,4294967295,1,6144,1065353216,3584,344192,458880,573568,401536,516224,630912,1433728,100480,125568,150656,175744,12279808,12288000,12296192,12283904,12292096,12300288,12357632,12378112,12380160,12382208,12384256,1557760,1557888,1173120
.long 2304,2432,57344,172032,5632000,5718016,14984192,15131648,14983168,15130624,14988288,15135744,14987264,15134720,403840,28672,102656,102400,104704,104448,229376,0,0,0,0,0,2518016,2604032,2690048,24576,69632,12288,12080,20272,1992,24432,161800,48736,48640,2862080,40448,10328064,1276032,44160,9920,26368,0,0,0,7,0,4294967295,1,12288,1065353216,3584,688256,802944,917632,745600,860288,974976,1491072,200832,225920,251008,276096,12304384,12312576,12320768,12308480,12316672,12324864,12361728,12386304,12388352,12390400,12392448,1507584,1507712,1183872
.long 116992,117120,57344,172032,5720064,5634048,15133696,14986240,15132672,14985216,15137792,14990336,15136768,14989312,604544,28672,103168,102912,105216,104960,229376,0,0,0,0,0,2776064,2862080,2948096,36864,79872,18432,12088,20280,1992,24440,162312,48752,48640,2948096,40704,10475520,1283200,44224,10016,26496,0,0,0,7,0,4294967295,1,18432,1065353216,3584,1032320,1147008,1261696,1089664,1204352,1319040,1548416,301184,326272,351360,376448,12328960,12337152,12345344,12333056,12341248,12349440,12365824,12394496,12396544,12398592,12400640,1557760,1557888,1194624
.long 2304,3200,43008,129024,2723840,2809856,2744320,2830336,2746368,2832384,9998336,10145792,9999360,10146816,806016,28672,184320,184832,116736,116992,172032,0,0,0,0,0,2005504,2091520,2177536,0,49152,0,2976,16288,1000,24480,175104,40768,39936,2693632,39936,10037248,1491072,46080,10752,27136,0,0,0,7,0,4294967295,1,0,1065353216,2688,128,114816,229504,57472,172160,286848,1376384,128,25216,50304,75392,13434880,13443072,13451264,13438976,13447168,13455360,13533184,13549568,13551616,13553664,13555712,529152,705664,818816
.long 88320,117888,43008,129024,2811904,2725888,2834432,2748416,2836480,2750464,10147840,10000384,10148864,10001408,1006720,28672,186368,186880,117248,117504,172032,0,0,0,0,0,2263552,2349568,2435584,12288,59392,6144,2984,16296,1000,24488,175616,40784,39936,2779648,40192,10184704,1498240,46144,10848,27264,0,0,0,7,0,4294967295,1,6144,1065353216,2688,344192,458880,573568,401536,516224,630912,1433728,100480,125568,150656,175744,13459456,13467648,13475840,13463552,13471744,13479936,13537280,13557760,13559808,13561856,13563904,566784,755840,829568
.long 2432,3200,43008,129024,2895872,2981888,2918400,3004416,2916352,3002368,10294272,10441728,10293248,10440704,1207424,28672,184832,184320,116992,116736,172032,0,0,0,0,0,2521600,2607616,2693632,24576,69632,12288,2992,16304,1000,24496,175112,40800,40448,2865664,40448,10332160,1505408,46208,10944,27392,0,0,0,7,0,4294967295,1,12288,1065353216,2688,688256,802944,917632,745600,860288,974976,1491072,200832,225920,251008,276096,13484032,13492224,13500416,13488128,13496320,13504512,13541376,13565952,13568000,13570048,13572096,529280,705664,840320
.long 88448,117888,43008,129024,2983936,2897920,3008512,2922496,3006464,2920448,10443776,10296320,10442752,10295296,1408128,28672,186880,186368,117504,117248,172032,0,0,0,0,0,2779648,2865664,2951680,36864,79872,18432,3000,16312,1000,24504,175624,40816,40448,2951680,40704,10479616,1512576,46272,11040,27520,0,0,0,7,0,4294967295,1,18432,1065353216,2688,1032320,1147008,1261696,1089664,1204352,1319040,1548416,301184,326272,351360,376448,13508608,13516800,13524992,13512704,13520896,13529088,13545472,13574144,13576192,13578240,13580288,566912,755840,851072
.long 2304,3200,43008,129024,5476352,5562368,5496832,5582848,5498880,5584896,14716928,14864384,14717952,14865408,3200,28672,184320,184832,116736,116992,172032,0,0,0,0,0,2009088,2095104,2181120,0,49152,0,4000,20384,2024,24544,174080,48960,48128,2697216,39936,10041344,1720448,48128,11776,28160,0,0,0,7,0,4294967295,1,0,1065353216,2688,128,114816,229504,57472,172160,286848,1376384,128,25216,50304,75392,14614528,14622720,14630912,14618624,14626816,14635008,14712832,14729216,14731264,14733312,14735360,1131264,1508480,1162880
.long 88320,117888,43008,129024,5564416,5478400,5586944,5500928,5588992,5502976,14866432,14718976,14867456,14720000,203904,28672,186368,186880,117248,117504,172032,0,0,0,0,0,2267136,2353152,2439168,12288,59392,6144,4008,20392,2024,24552,174592,48976,48128,2783232,40192,10188800,1727616,48192,11872,28288,0,0,0,7,0,4294967295,1,6144,1065353216,2688,344192,458880,573568,401536,516224,630912,1433728,100480,125568,150656,175744,14639104,14647296,14655488,14643200,14651392,14659584,14716928,14737408,14739456,14741504,14743552,1168896,1558656,1173632
.long 2432,3200,43008,129024,5648384,5734400,5670912,5756928,5668864,5754880,15012864,15160320,15011840,15159296,404608,28672,184832,184320,116992,116736,172032,0,0,0,0,0,2525184,2611200,2697216,24576,69632,12288,4016,20400,2024,24560,174088,48992,48640,2869248,40448,10336256,1734784,48256,11968,28416,0,0,0,7,0,4294967295,1,12288,1065353216,2688,688256,802944,917632,745600,860288,974976,1491072,200832,225920,251008,276096,14663680,14671872,14680064,14667776,14675968,14684160,14721024,14745600,14747648,14749696,14751744,1131392,1508480,1184384
.long 88448,117888,43008,129024,5736448,5650432,5761024,5675008,5758976,5672960,15162368,15014912,15161344,15013888,605312,28672,186880,186368,117504,117248,172032,0,0,0,0,0,2783232,2869248,2955264,36864,79872,18432,4024,20408,2024,24568,174600,49008,48640,2955264,40704,10483712,1741952,48320,12064,28544,0,0,0,7,0,4294967295,1,18432,1065353216,2688,1032320,1147008,1261696,1089664,1204352,1319040,1548416,301184,326272,351360,376448,14688256,14696448,14704640,14692352,14700544,14708736,14725120,14753792,14755840,14757888,14759936,1169024,1558656,1195136
.long 512,640,57344,172032,270336,356352,5783552,5931008,5784576,5932032,5787648,5935104,5788672,5936128,512,28672,73728,73984,75776,76032,229376,0,0,0,0,0,2326528,2412544,2498560,0,49152,0,4160,12352,16,24576,73728,32896,32768,3014656,40960,10600448,114944,33792,4608,20992,0,0,0,8,4294967295,0,0,1544,1049336022,3584,256,114944,229632,57600,172288,286976,1376512,256,25344,50432,75520,6356992,6365184,6373376,6361088,6369280,6377472,6455296,6471680,6473728,6475776,6477824,512,640,516352
.long 115200,115328,57344,172032,358400,272384,5933056,5785600,5934080,5786624,5937152,5789696,5938176,5790720,201216,28672,74240,74496,76288,76544,229376,0,0,0,0,0,2584576,2670592,2756608,12288,59392,6144,4168,12360,16,24584,74240,32912,32768,3100672,41216,10747904,122112,33856,4704,21120,0,0,0,8,4294967295,0,0,7688,1049336022,3584,344320,459008,573696,401664,516352,631040,1433856,100608,125696,150784,175872,6381568,6389760,6397952,6385664,6393856,6402048,6459392,6479872,6481920,6483968,6486016,50688,50816,527104
.long 512,640,57344,172032,442368,528384,6079488,6226944,6078464,6225920,6083584,6231040,6082560,6230016,401920,28672,73984,73728,76032,75776,229376,0,0,0,0,0,2842624,2928640,3014656,24576,69632,12288,4176,12368,16,24592,73736,32928,33280,3186688,41472,10895360,129280,33920,4800,21248,0,0,0,8,4294967295,0,0,13832,1049336022,3584,688384,803072,917760,745728,860416,975104,1491200,200960,226048,251136,276224,6406144,6414336,6422528,6410240,6418432,6426624,6463488,6488064,6490112,6492160,6494208,512,640,537856
.long 115200,115328,57344,172032,530432,444416,6228992,6081536,6227968,6080512,6233088,6085632,6232064,6084608,602624,28672,74496,74240,76544,76288,229376,0,0,0,0,0,3100672,3186688,3272704,36864,79872,18432,4184,12376,16,24600,74248,32944,33280,3272704,41728,11042816,136448,33984,4896,21376,0,0,0,8,4294967295,0,0,19976,1049336022,3584,1032448,1147136,1261824,1089792,1204480,1319168,1548544,301312,326400,351488,376576,6430720,6438912,6447104,6434816,6443008,6451200,6467584,6496256,6498304,6500352,6502400,50688,50816,548608
.long 512,640,57344,172032,3022848,3108864,10502144,10649600,10503168,10650624,10506240,10653696,10507264,10654720,803328,28672,73728,73984,75776,76032,229376,0,0,0,0,0,2330112,2416128,2502144,0,49152,0,8256,16448,1040,24640,74752,41088,40960,3018240,40960,10604544,344320,35840,5632,22016,0,0,0,8,4294967295,0,0,1544,1049336022,3584,256,114944,229632,57600,172288,286976,1376512,256,25344,50432,75520,7536640,7544832,7553024,7540736,7548928,7557120,7634944,7651328,7653376,7655424,7657472,803328,803456,860416
.long 115200,115328,57344,172032,3110912,3024896,10651648,10504192,10652672,10505216,10655744,10508288,10656768,10509312,1004032,28672,74240,74496,76288,76544,229376,0,0,0,0,0,2588160,2674176,2760192,12288,59392,6144,8264,16456,1040,24648,75264,41104,40960,3104256,41216,10752000,351488,35904,5728,22144,0,0,0,8,4294967295,0,0,7688,1049336022,3584,344320,459008,573696,401664,516352,631040,1433856,100608,125696,150784,175872,7561216,7569408,7577600,7565312,7573504,7581696,7639040,7659520,7661568,7663616,7665664,853504,853632,871168
.long 512,640,57344,172032,3194880,3280896,10798080,10945536,10797056,10944512,10802176,10949632,10801152,10948608,1204736,28672,73984,73728,76032,75776,229376,0,0,0,0,0,2846208,2932224,3018240,24576,69632,12288,8272,16464,1040,24656,74760,41120,41472,3190272,41472,10899456,358656,35968,5824,22272,0,0,0,8,4294967295,0,0,13832,1049336022,3584,688384,803072,917760,745728,860416,975104,1491200,200960,226048,251136,276224,7585792,7593984,7602176,7589888,7598080,7606272,7643136,7667712,7669760,7671808,7673856,803328,803456,881920
.long 115200,115328,57344,172032,3282944,3196928,10947584,10800128,10946560,10799104,10951680,10804224,10950656,10803200,1405440,28672,74496,74240,76544,76288,229376,0,0,0,0,0,3104256,3190272,3276288,36864,79872,18432,8280,16472,1040,24664,75272,41136,41472,3276288,41728,11046912,365824,36032,5920,22400,0,0,0,8,4294967295,0,0,19976,1049336022,3584,1032448,1147136,1261824,1089792,1204480,1319168,1548544,301312,326400,351488,376576,7610368,7618560,7626752,7614464,7622656,7630848,7647232,7675904,7677952,7680000,7682048,853504,853632,892672
.long 1536,1664,57344,172032,286720,372736,5816320,5963776,5817344,5964800,5820416,5967872,5821440,5968896,1536,28672,90112,90368,92160,92416,229376,0,0,0,0,0,2333696,2419712,2505728,0,49152,0,4288,12480,48,24704,90112,33152,32768,3021824,40960,10608640,573696,37888,6656,23040,0,0,0,8,4294967295,0,0,1544,1049336022,3584,256,114944,229632,57600,172288,286976,1376512,256,25344,50432,75520,8716288,8724480,8732672,8720384,8728576,8736768,8814592,8830976,8833024,8835072,8837120,1536,1664,516864
.long 116224,116352,57344,172032,374784,288768,5965824,5818368,5966848,5819392,5969920,5822464,5970944,5823488,202240,28672,90624,90880,92672,92928,229376,0,0,0,0,0,2591744,2677760,2763776,12288,59392,6144,4296,12488,48,24712,90624,33168,32768,3107840,41216,10756096,580864,37952,6752,23168,0,0,0,8,4294967295,0,0,7688,1049336022,3584,344320,459008,573696,401664,516352,631040,1433856,100608,125696,150784,175872,8740864,8749056,8757248,8744960,8753152,8761344,8818688,8839168,8841216,8843264,8845312,51712,51840,527616
.long 1536,1664,57344,172032,458752,544768,6112256,6259712,6111232,6258688,6116352,6263808,6115328,6262784,402944,28672,90368,90112,92416,92160,229376,0,0,0,0,0,2849792,2935808,3021824,24576,69632,12288,4304,12496,48,24720,90120,33184,33280,3193856,41472,10903552,588032,38016,6848,23296,0,0,0,8,4294967295,0,0,13832,1049336022,3584,688384,803072,917760,745728,860416,975104,1491200,200960,226048,251136,276224,8765440,8773632,8781824,8769536,8777728,8785920,8822784,8847360,8849408,8851456,8853504,1536,1664,538368
.long 116224,116352,57344,172032,546816,460800,6261760,6114304,6260736,6113280,6265856,6118400,6264832,6117376,603648,28672,90880,90624,92928,92672,229376,0,0,0,0,0,3107840,3193856,3279872,36864,79872,18432,4312,12504,48,24728,90632,33200,33280,3279872,41728,11051008,595200,38080,6944,23424,0,0,0,8,4294967295,0,0,19976,1049336022,3584,1032448,1147136,1261824,1089792,1204480,1319168,1548544,301312,326400,351488,376576,8790016,8798208,8806400,8794112,8802304,8810496,8826880,8855552,8857600,8859648,8861696,51712,51840,549120
.long 1536,1664,57344,172032,3039232,3125248,10534912,10682368,10535936,10683392,10539008,10686464,10540032,10687488,804352,28672,90112,90368,92160,92416,229376,0,0,0,0,0,2337280,2423296,2509312,0,49152,0,8384,16576,1072,24768,91136,41344,40960,3025408,40960,10612736,803072,39936,7680,24064,0,0,0,8,4294967295,0,0,1544,1049336022,3584,256,114944,229632,57600,172288,286976,1376512,256,25344,50432,75520,9895936,9904128,9912320,9900032,9908224,9916416,9994240,10010624,10012672,10014720,10016768,804352,804480,860928
.long 116224,116352,57344,172032,3127296,3041280,10684416,10536960,10685440,10537984,10688512,10541056,10689536,10542080,1005056,28672,90624,90880,92672,92928,229376,0,0,0,0,0,2595328,2681344,2767360,12288,59392,6144,8392,16584,1072,24776,91648,41360,40960,3111424,41216,10760192,810240,40000,7776,24192,0,0,0,8,4294967295,0,0,7688,1049336022,3584,344320,459008,573696,401664,516352,631040,1433856,100608,125696,150784,175872,9920512,9928704,9936896,9924608,9932800,9940992,9998336,10018816,10020864,10022912,10024960,854528,854656,871680
.long 1536,1664,57344,172032,3211264,3297280,10830848,10978304,10829824,10977280,10834944,10982400,10833920,10981376,1205760,28672,90368,90112,92416,92160,229376,0,0,0,0,0,2853376,2939392,3025408,24576,69632,12288,8400,16592,1072,24784,91144,41376,41472,3197440,41472,10907648,817408,40064,7872,24320,0,0,0,8,4294967295,0,0,13832,1049336022,3584,688384,803072,917760,745728,860416,975104,1491200,200960,226048,251136,276224,9945088,9953280,9961472,9949184,9957376,9965568,10002432,10027008,10029056,10031104,10033152,804352,804480,882432
.long 116224,116352,57344,172032,3299328,3213312,10980352,10832896,10979328,10831872,10984448,10836992,10983424,10835968,1406464,28672,90880,90624,92928,92672,229376,0,0,0,0,0,3111424,3197440,3283456,36864,79872,18432,8408,16600,1072,24792,91656,41392,41472,3283456,41728,11055104,824576,40128,7968,24448,0,0,0,8,4294967295,0,0,19976,1049336022,3584,1032448,1147136,1261824,1089792,1204480,1319168,1548544,301312,326400,351488,376576,9969664,9977856,9986048,9973760,9981952,9990144,10006528,10035200,10037248,10039296,10041344,854528,854656,893184
.long 2560,2688,57344,172032,303104,389120,5849088,5996544,5850112,5997568,5853184,6000640,5854208,6001664,2560,28672,106496,106752,108544,108800,229376,0,0,0,0,0,2340864,2426880,2512896,0,49152,0,4416,12608,80,24832,106496,33408,32768,3028992,40960,10616832,1032448,41984,8704,25088,0,0,0,8,4294967295,0,0,1544,1065353216,3584,256,114944,229632,57600,172288,286976,1376512,256,25344,50432,75520,11075584,11083776,11091968,11079680,11087872,11096064,11173888,11190272,11192320,11194368,11196416,2560,2688,517376
.long 117248,117376,57344,172032,391168,305152,5998592,5851136,5999616,5852160,6002688,5855232,6003712,5856256,203264,28672,107008,107264,109056,109312,229376,0,0,0,0,0,2598912,2684928,2770944,12288,59392,6144,4424,12616,80,24840,107008,33424,32768,3115008,41216,10764288,1039616,42048,8800,25216,0,0,0,8,4294967295,0,0,7688,1065353216,3584,344320,459008,573696,401664,516352,631040,1433856,100608,125696,150784,175872,11100160,11108352,11116544,11104256,11112448,11120640,11177984,11198464,11200512,11202560,11204608,52736,52864,528128
.long 2560,2688,57344,172032,475136,561152,6145024,6292480,6144000,6291456,6149120,6296576,6148096,6295552,403968,28672,106752,106496,108800,108544,229376,0,0,0,0,0,2856960,2942976,3028992,24576,69632,12288,4432,12624,80,24848,106504,33440,33280,3201024,41472,10911744,1046784,42112,8896,25344,0,0,0,8,4294967295,0,0,13832,1065353216,3584,688384,803072,917760,745728,860416,975104,1491200,200960,226048,251136,276224,11124736,11132928,11141120,11128832,11137024,11145216,11182080,11206656,11208704,11210752,11212800,2560,2688,538880
.long 117248,117376,57344,172032,563200,477184,6294528,6147072,6293504,6146048,6298624,6151168,6297600,6150144,604672,28672,107264,107008,109312,109056,229376,0,0,0,0,0,3115008,3201024,3287040,36864,79872,18432,4440,12632,80,24856,107016,33456,33280,3287040,41728,11059200,1053952,42176,8992,25472,0,0,0,8,4294967295,0,0,19976,1065353216,3584,1032448,1147136,1261824,1089792,1204480,1319168,1548544,301312,326400,351488,376576,11149312,11157504,11165696,11153408,11161600,11169792,11186176,11214848,11216896,11218944,11220992,52736,52864,549632
.long 2560,2688,57344,172032,3055616,3141632,10567680,10715136,10568704,10716160,10571776,10719232,10572800,10720256,805376,28672,106496,106752,108544,108800,229376,0,0,0,0,0,2344448,2430464,2516480,0,49152,0,8512,16704,1104,24896,107520,41600,40960,3032576,40960,10620928,1261824,44032,9728,26112,0,0,0,8,4294967295,0,0,1544,1065353216,3584,256,114944,229632,57600,172288,286976,1376512,256,25344,50432,75520,12255232,12263424,12271616,12259328,12267520,12275712,12353536,12369920,12371968,12374016,12376064,805376,805504,861440
.long 117248,117376,57344,172032,3143680,3057664,10717184,10569728,10718208,10570752,10721280,10573824,10722304,10574848,1006080,28672,107008,107264,109056,109312,229376,0,0,0,0,0,2602496,2688512,2774528,12288,59392,6144,8520,16712,1104,24904,108032,41616,40960,3118592,41216,10768384,1268992,44096,9824,26240,0,0,0,8,4294967295,0,0,7688,1065353216,3584,344320,459008,573696,401664,516352,631040,1433856,100608,125696,150784,175872,12279808,12288000,12296192,12283904,12292096,12300288,12357632,12378112,12380160,12382208,12384256,855552,855680,872192
.long 2560,2688,57344,172032,3227648,3313664,10863616,11011072,10862592,11010048,10867712,11015168,10866688,11014144,1206784,28672,106752,106496,108800,108544,229376,0,0,0,0,0,2860544,2946560,3032576,24576,69632,12288,8528,16720,1104,24912,107528,41632,41472,3204608,41472,10915840,1276160,44160,9920,26368,0,0,0,8,4294967295,0,0,13832,1065353216,3584,688384,803072,917760,745728,860416,975104,1491200,200960,226048,251136,276224,12304384,12312576,12320768,12308480,12316672,12324864,12361728,12386304,12388352,12390400,12392448,805376,805504,882944
.long 117248,117376,57344,172032,3315712,3229696,11013120,10865664,11012096,10864640,11017216,10869760,11016192,10868736,1407488,28672,107264,107008,109312,109056,229376,0,0,0,0,0,3118592,3204608,3290624,36864,79872,18432,8536,16728,1104,24920,108040,41648,41472,3290624,41728,11063296,1283328,44224,10016,26496,0,0,0,8,4294967295,0,0,19976,1065353216,3584,1032448,1147136,1261824,1089792,1204480,1319168,1548544,301312,326400,351488,376576,12328960,12337152,12345344,12333056,12341248,12349440,12365824,12394496,12396544,12398592,12400640,855552,855680,893696
.long 2560,3328,43008,129024,319488,405504,344064,430080,346112,432128,5873664,6021120,5874688,6022144,2560,21504,188416,188928,118784,119040,172032,0,0,0,0,0,2348032,2434048,2520064,0,49152,0,2112,12736,112,24960,188416,33664,32768,3036160,40960,10625024,1491200,46080,10752,27136,0,0,0,8,4294967295,0,0,1544,1065353216,2688,256,114944,229632,57600,172288,286976,1376512,256,25344,50432,75520,13434880,13443072,13451264,13438976,13447168,13455360,13533184,13549568,13551616,13553664,13555712,2560,3328,517888
.long 88576,118016,43008,129024,407552,321536,1073741824,1073741824,1073741824,1073741824,6023168,5875712,6024192,5876736,153088,21504,188416,188928,119296,119552,172032,0,0,0,0,0,2606080,2692096,2778112,12288,59392,6144,2120,12744,112,24968,188928,33680,32768,3122176,41216,10772480,1498368,46144,10848,27264,0,0,0,8,4294967295,0,0,7688,1065353216,2688,344320,459008,573696,401664,516352,631040,1433856,100608,125696,150784,175872,13459456,13467648,13475840,13463552,13471744,13479936,13537280,13557760,13559808,13561856,13563904,40192,53504,528640
.long 2560,3328,43008,129024,491520,577536,518144,604160,516096,602112,6169600,6317056,6168576,6316032,303616,21504,188928,188416,119040,118784,172032,0,0,0,0,0,2864128,2950144,3036160,24576,69632,12288,2128,12752,112,24976,188424,33696,33280,3208192,41472,10919936,1505536,46208,10944,27392,0,0,0,8,4294967295,0,0,13832,1065353216,2688,688384,803072,917760,745728,860416,975104,1491200,200960,226048,251136,276224,13484032,13492224,13500416,13488128,13496320,13504512,13541376,13565952,13568000,13570048,13572096,2560,3328,539392
.long 88576,118016,43008,129024,579584,493568,1073741824,1073741824,1073741824,1073741824,6319104,6171648,6318080,6170624,454144,21504,188928,188416,119552,119296,172032,0,0,0,0,0,3122176,3208192,3294208,36864,79872,18432,2136,12760,112,24984,188936,33712,33280,3294208,41728,11067392,1512704,46272,11040,27520,0,0,0,8,4294967295,0,0,19976,1065353216,2688,1032448,1147136,1261824,1089792,1204480,1319168,1548544,301312,326400,351488,376576,13508608,13516800,13524992,13512704,13520896,13529088,13545472,13574144,13576192,13578240,13580288,40192,53504,550144
.long 2560,3328,43008,129024,3072000,3158016,3096576,3182592,3098624,3184640,10592256,10739712,10593280,10740736,604672,21504,188416,188928,118784,119040,172032,0,0,0,0,0,2351616,2437632,2523648,0,49152,0,3136,16832,1136,25024,189440,41856,40960,3039744,40960,10629120,1720576,48128,11776,28160,0,0,0,8,4294967295,0,0,1544,1065353216,2688,256,114944,229632,57600,172288,286976,1376512,256,25344,50432,75520,14614528,14622720,14630912,14618624,14626816,14635008,14712832,14729216,14731264,14733312,14735360,604672,806144,861952
.long 88576,118016,43008,129024,3160064,3074048,1073741824,1073741824,1073741824,1073741824,10741760,10594304,10742784,10595328,755200,21504,188416,188928,119296,119552,172032,0,0,0,0,0,2609664,2695680,2781696,12288,59392,6144,3144,16840,1136,25032,189952,41872,40960,3125760,41216,10776576,1727744,48192,11872,28288,0,0,0,8,4294967295,0,0,7688,1065353216,2688,344320,459008,573696,401664,516352,631040,1433856,100608,125696,150784,175872,14639104,14647296,14655488,14643200,14651392,14659584,14716928,14737408,14739456,14741504,14743552,642304,856320,872704
.long 2560,3328,43008,129024,3244032,3330048,3270656,3356672,3268608,3354624,10888192,11035648,10887168,11034624,905728,21504,188928,188416,119040,118784,172032,0,0,0,0,0,2867712,2953728,3039744,24576,69632,12288,3152,16848,1136,25040,189448,41888,41472,3211776,41472,10924032,1734912,48256,11968,28416,0,0,0,8,4294967295,0,0,13832,1065353216,2688,688384,803072,917760,745728,860416,975104,1491200,200960,226048,251136,276224,14663680,14671872,14680064,14667776,14675968,14684160,14721024,14745600,14747648,14749696,14751744,604672,806144,883456
.long 88576,118016,43008,129024,3332096,3246080,1073741824,1073741824,1073741824,1073741824,11037696,10890240,11036672,10889216,1056256,21504,188928,188416,119552,119296,172032,0,0,0,0,0,3125760,3211776,3297792,36864,79872,18432,3160,16856,1136,25048,189960,41904,41472,3297792,41728,11071488,1742080,48320,12064,28544,0,0,0,8,4294967295,0,0,19976,1065353216,2688,1032448,1147136,1261824,1089792,1204480,1319168,1548544,301312,326400,351488,376576,14688256,14696448,14704640,14692352,14700544,14708736,14725120,14753792,14755840,14757888,14759936,642304,856320,894208
.long 512,640,57344,172032,614400,700416,6373376,6520832,6374400,6521856,6377472,6524928,6378496,6525952,512,28672,73728,73984,75776,76032,229376,0,0,0,0,0,2328064,2414080,2500096,0,49152,0,4672,12864,144,24608,131072,33920,33792,3016192,40960,10602496,115072,33792,4608,20992,0,0,0,8,0,4294967295,1,0,1049336022,3584,384,115072,229760,57728,172416,287104,1376640,384,25472,50560,75648,6356992,6365184,6373376,6361088,6369280,6377472,6455296,6471680,6473728,6475776,6477824,100864,100992,559360
.long 115200,115328,57344,172032,702464,616448,6522880,6375424,6523904,6376448,6526976,6379520,6528000,6380544,201216,28672,74240,74496,76288,76544,229376,0,0,0,0,0,2586112,2672128,2758144,12288,59392,6144,4680,12872,144,24616,131584,33936,33792,3102208,41216,10749952,122240,33856,4704,21120,0,0,0,8,0,4294967295,1,6144,1049336022,3584,344448,459136,573824,401792,516480,631168,1433984,100736,125824,150912,176000,6381568,6389760,6397952,6385664,6393856,6402048,6459392,6479872,6481920,6483968,6486016,151040,151168,570112
.long 512,640,57344,172032,786432,872448,6669312,6816768,6668288,6815744,6673408,6820864,6672384,6819840,401920,28672,73984,73728,76032,75776,229376,0,0,0,0,0,2844160,2930176,3016192,24576,69632,12288,4688,12880,144,24624,131080,33952,34304,3188224,41472,10897408,129408,33920,4800,21248,0,0,0,8,0,4294967295,1,12288,1049336022,3584,688512,803200,917888,745856,860544,975232,1491328,201088,226176,251264,276352,6406144,6414336,6422528,6410240,6418432,6426624,6463488,6488064,6490112,6492160,6494208,100864,100992,580864
.long 115200,115328,57344,172032,874496,788480,6818816,6671360,6817792,6670336,6822912,6675456,6821888,6674432,602624,28672,74496,74240,76544,76288,229376,0,0,0,0,0,3102208,3188224,3274240,36864,79872,18432,4696,12888,144,24632,131592,33968,34304,3274240,41728,11044864,136576,33984,4896,21376,0,0,0,8,0,4294967295,1,18432,1049336022,3584,1032576,1147264,1261952,1089920,1204608,1319296,1548672,301440,326528,351616,376704,6430720,6438912,6447104,6434816,6443008,6451200,6467584,6496256,6498304,6500352,6502400,151040,151168,591616
.long 512,640,57344,172032,3366912,3452928,11091968,11239424,11092992,11240448,11096064,11243520,11097088,11244544,803328,28672,73728,73984,75776,76032,229376,0,0,0,0,0,2331648,2417664,2503680,0,49152,0,8768,16960,1168,24672,132096,42112,41984,3019776,40960,10606592,344448,35840,5632,22016,0,0,0,8,0,4294967295,1,0,1049336022,3584,384,115072,229760,57728,172416,287104,1376640,384,25472,50560,75648,7536640,7544832,7553024,7540736,7548928,7557120,7634944,7651328,7653376,7655424,7657472,903680,903808,903424
.long 115200,115328,57344,172032,3454976,3368960,11241472,11094016,11242496,11095040,11245568,11098112,11246592,11099136,1004032,28672,74240,74496,76288,76544,229376,0,0,0,0,0,2589696,2675712,2761728,12288,59392,6144,8776,16968,1168,24680,132608,42128,41984,3105792,41216,10754048,351616,35904,5728,22144,0,0,0,8,0,4294967295,1,6144,1049336022,3584,344448,459136,573824,401792,516480,631168,1433984,100736,125824,150912,176000,7561216,7569408,7577600,7565312,7573504,7581696,7639040,7659520,7661568,7663616,7665664,953856,953984,914176
.long 512,640,57344,172032,3538944,3624960,11387904,11535360,11386880,11534336,11392000,11539456,11390976,11538432,1204736,28672,73984,73728,76032,75776,229376,0,0,0,0,0,2847744,2933760,3019776,24576,69632,12288,8784,16976,1168,24688,132104,42144,42496,3191808,41472,10901504,358784,35968,5824,22272,0,0,0,8,0,4294967295,1,12288,1049336022,3584,688512,803200,917888,745856,860544,975232,1491328,201088,226176,251264,276352,7585792,7593984,7602176,7589888,7598080,7606272,7643136,7667712,7669760,7671808,7673856,903680,903808,924928
.long 115200,115328,57344,172032,3627008,3540992,11537408,11389952,11536384,11388928,11541504,11394048,11540480,11393024,1405440,28672,74496,74240,76544,76288,229376,0,0,0,0,0,3105792,3191808,3277824,36864,79872,18432,8792,16984,1168,24696,132616,42160,42496,3277824,41728,11048960,365952,36032,5920,22400,0,0,0,8,0,4294967295,1,18432,1049336022,3584,1032576,1147264,1261952,1089920,1204608,1319296,1548672,301440,326528,351616,376704,7610368,7618560,7626752,7614464,7622656,7630848,7647232,7675904,7677952,7680000,7682048,953856,953984,935680
.long 1536,1664,57344,172032,630784,716800,6406144,6553600,6407168,6554624,6410240,6557696,6411264,6558720,1536,28672,90112,90368,92160,92416,229376,0,0,0,0,0,2335232,2421248,2507264,0,49152,0,4800,12992,176,24736,147456,34176,33792,3023360,40960,10610688,573824,37888,6656,23040,0,0,0,8,0,4294967295,1,0,1049336022,3584,384,115072,229760,57728,172416,287104,1376640,384,25472,50560,75648,8716288,8724480,8732672,8720384,8728576,8736768,8814592,8830976,8833024,8835072,8837120,101888,102016,559872
.long 116224,116352,57344,172032,718848,632832,6555648,6408192,6556672,6409216,6559744,6412288,6560768,6413312,202240,28672,90624,90880,92672,92928,229376,0,0,0,0,0,2593280,2679296,2765312,12288,59392,6144,4808,13000,176,24744,147968,34192,33792,3109376,41216,10758144,580992,37952,6752,23168,0,0,0,8,0,4294967295,1,6144,1049336022,3584,344448,459136,573824,401792,516480,631168,1433984,100736,125824,150912,176000,8740864,8749056,8757248,8744960,8753152,8761344,8818688,8839168,8841216,8843264,8845312,152064,152192,570624
.long 1536,1664,57344,172032,802816,888832,6702080,6849536,6701056,6848512,6706176,6853632,6705152,6852608,402944,28672,90368,90112,92416,92160,229376,0,0,0,0,0,2851328,2937344,3023360,24576,69632,12288,4816,13008,176,24752,147464,34208,34304,3195392,41472,10905600,588160,38016,6848,23296,0,0,0,8,0,4294967295,1,12288,1049336022,3584,688512,803200,917888,745856,860544,975232,1491328,201088,226176,251264,276352,8765440,8773632,8781824,8769536,8777728,8785920,8822784,8847360,8849408,8851456,8853504,101888,102016,581376
.long 116224,116352,57344,172032,890880,804864,6851584,6704128,6850560,6703104,6855680,6708224,6854656,6707200,603648,28672,90880,90624,92928,92672,229376,0,0,0,0,0,3109376,3195392,3281408,36864,79872,18432,4824,13016,176,24760,147976,34224,34304,3281408,41728,11053056,595328,38080,6944,23424,0,0,0,8,0,4294967295,1,18432,1049336022,3584,1032576,1147264,1261952,1089920,1204608,1319296,1548672,301440,326528,351616,376704,8790016,8798208,8806400,8794112,8802304,8810496,8826880,8855552,8857600,8859648,8861696,152064,152192,592128
.long 1536,1664,57344,172032,3383296,3469312,11124736,11272192,11125760,11273216,11128832,11276288,11129856,11277312,804352,28672,90112,90368,92160,92416,229376,0,0,0,0,0,2338816,2424832,2510848,0,49152,0,8896,17088,1200,24800,148480,42368,41984,3026944,40960,10614784,803200,39936,7680,24064,0,0,0,8,0,4294967295,1,0,1049336022,3584,384,115072,229760,57728,172416,287104,1376640,384,25472,50560,75648,9895936,9904128,9912320,9900032,9908224,9916416,9994240,10010624,10012672,10014720,10016768,904704,904832,903936
.long 116224,116352,57344,172032,3471360,3385344,11274240,11126784,11275264,11127808,11278336,11130880,11279360,11131904,1005056,28672,90624,90880,92672,92928,229376,0,0,0,0,0,2596864,2682880,2768896,12288,59392,6144,8904,17096,1200,24808,148992,42384,41984,3112960,41216,10762240,810368,40000,7776,24192,0,0,0,8,0,4294967295,1,6144,1049336022,3584,344448,459136,573824,401792,516480,631168,1433984,100736,125824,150912,176000,9920512,9928704,9936896,9924608,9932800,9940992,9998336,10018816,10020864,10022912,10024960,954880,955008,914688
.long 1536,1664,57344,172032,3555328,3641344,11420672,11568128,11419648,11567104,11424768,11572224,11423744,11571200,1205760,28672,90368,90112,92416,92160,229376,0,0,0,0,0,2854912,2940928,3026944,24576,69632,12288,8912,17104,1200,24816,148488,42400,42496,3198976,41472,10909696,817536,40064,7872,24320,0,0,0,8,0,4294967295,1,12288,1049336022,3584,688512,803200,917888,745856,860544,975232,1491328,201088,226176,251264,276352,9945088,9953280,9961472,9949184,9957376,9965568,10002432,10027008,10029056,10031104,10033152,904704,904832,925440
.long 116224,116352,57344,172032,3643392,3557376,11570176,11422720,11569152,11421696,11574272,11426816,11573248,11425792,1406464,28672,90880,90624,92928,92672,229376,0,0,0,0,0,3112960,3198976,3284992,36864,79872,18432,8920,17112,1200,24824,149000,42416,42496,3284992,41728,11057152,824704,40128,7968,24448,0,0,0,8,0,4294967295,1,18432,1049336022,3584,1032576,1147264,1261952,1089920,1204608,1319296,1548672,301440,326528,351616,376704,9969664,9977856,9986048,9973760,9981952,9990144,10006528,10035200,10037248,10039296,10041344,954880,955008,936192
.long 2560,2688,57344,172032,647168,733184,6438912,6586368,6439936,6587392,6443008,6590464,6444032,6591488,2560,28672,106496,106752,108544,108800,229376,0,0,0,0,0,2342400,2428416,2514432,0,49152,0,4928,13120,208,24864,163840,34432,33792,3030528,40960,10618880,1032576,41984,8704,25088,0,0,0,8,0,4294967295,1,0,1065353216,3584,384,115072,229760,57728,172416,287104,1376640,384,25472,50560,75648,11075584,11083776,11091968,11079680,11087872,11096064,11173888,11190272,11192320,11194368,11196416,102912,103040,560384
.long 117248,117376,57344,172032,735232,649216,6588416,6440960,6589440,6441984,6592512,6445056,6593536,6446080,203264,28672,107008,107264,109056,109312,229376,0,0,0,0,0,2600448,2686464,2772480,12288,59392,6144,4936,13128,208,24872,164352,34448,33792,3116544,41216,10766336,1039744,42048,8800,25216,0,0,0,8,0,4294967295,1,6144,1065353216,3584,344448,459136,573824,401792,516480,631168,1433984,100736,125824,150912,176000,11100160,11108352,11116544,11104256,11112448,11120640,11177984,11198464,11200512,11202560,11204608,153088,153216,571136
.long 2560,2688,57344,172032,819200,905216,6734848,6882304,6733824,6881280,6738944,6886400,6737920,6885376,403968,28672,106752,106496,108800,108544,229376,0,0,0,0,0,2858496,2944512,3030528,24576,69632,12288,4944,13136,208,24880,163848,34464,34304,3202560,41472,10913792,1046912,42112,8896,25344,0,0,0,8,0,4294967295,1,12288,1065353216,3584,688512,803200,917888,745856,860544,975232,1491328,201088,226176,251264,276352,11124736,11132928,11141120,11128832,11137024,11145216,11182080,11206656,11208704,11210752,11212800,102912,103040,581888
.long 117248,117376,57344,172032,907264,821248,6884352,6736896,6883328,6735872,6888448,6740992,6887424,6739968,604672,28672,107264,107008,109312,109056,229376,0,0,0,0,0,3116544,3202560,3288576,36864,79872,18432,4952,13144,208,24888,164360,34480,34304,3288576,41728,11061248,1054080,42176,8992,25472,0,0,0,8,0,4294967295,1,18432,1065353216,3584,1032576,1147264,1261952,1089920,1204608,1319296,1548672,301440,326528,351616,376704,11149312,11157504,11165696,11153408,11161600,11169792,11186176,11214848,11216896,11218944,11220992,153088,153216,592640
.long 2560,2688,57344,172032,3399680,3485696,11157504,11304960,11158528,11305984,11161600,11309056,11162624,11310080,805376,28672,106496,106752,108544,108800,229376,0,0,0,0,0,2345984,2432000,2518016,0,49152,0,9024,17216,1232,24928,164864,42624,41984,3034112,40960,10622976,1261952,44032,9728,26112,0,0,0,8,0,4294967295,1,0,1065353216,3584,384,115072,229760,57728,172416,287104,1376640,384,25472,50560,75648,12255232,12263424,12271616,12259328,12267520,12275712,12353536,12369920,12371968,12374016,12376064,905728,905856,904448
.long 117248,117376,57344,172032,3487744,3401728,11307008,11159552,11308032,11160576,11311104,11163648,11312128,11164672,1006080,28672,107008,107264,109056,109312,229376,0,0,0,0,0,2604032,2690048,2776064,12288,59392,6144,9032,17224,1232,24936,165376,42640,41984,3120128,41216,10770432,1269120,44096,9824,26240,0,0,0,8,0,4294967295,1,6144,1065353216,3584,344448,459136,573824,401792,516480,631168,1433984,100736,125824,150912,176000,12279808,12288000,12296192,12283904,12292096,12300288,12357632,12378112,12380160,12382208,12384256,955904,956032,915200
.long 2560,2688,57344,172032,3571712,3657728,11453440,11600896,11452416,11599872,11457536,11604992,11456512,11603968,1206784,28672,106752,106496,108800,108544,229376,0,0,0,0,0,2862080,2948096,3034112,24576,69632,12288,9040,17232,1232,24944,164872,42656,42496,3206144,41472,10917888,1276288,44160,9920,26368,0,0,0,8,0,4294967295,1,12288,1065353216,3584,688512,803200,917888,745856,860544,975232,1491328,201088,226176,251264,276352,12304384,12312576,12320768,12308480,12316672,12324864,12361728,12386304,12388352,12390400,12392448,905728,905856,925952
.long 117248,117376,57344,172032,3659776,3573760,11602944,11455488,11601920,11454464,11607040,11459584,11606016,11458560,1407488,28672,107264,107008,109312,109056,229376,0,0,0,0,0,3120128,3206144,3292160,36864,79872,18432,9048,17240,1232,24952,165384,42672,42496,3292160,41728,11065344,1283456,44224,10016,26496,0,0,0,8,0,4294967295,1,18432,1065353216,3584,1032576,1147264,1261952,1089920,1204608,1319296,1548672,301440,326528,351616,376704,12328960,12337152,12345344,12333056,12341248,12349440,12365824,12394496,12396544,12398592,12400640,955904,956032,936704
.long 2560,3328,43008,129024,663552,749568,688128,774144,690176,776192,6463488,6610944,6464512,6611968,2560,21504,188416,188928,118784,119040,172032,0,0,0,0,0,2349568,2435584,2521600,0,49152,0,2240,13248,240,24992,188416,34688,33792,3037696,40960,10627072,1491328,46080,10752,27136,0,0,0,8,0,4294967295,1,0,1065353216,2688,384,115072,229760,57728,172416,287104,1376640,384,25472,50560,75648,13434880,13443072,13451264,13438976,13447168,13455360,13533184,13549568,13551616,13553664,13555712,77824,103680,560896
.long 88576,118016,43008,129024,751616,665600,1073741824,1073741824,1073741824,1073741824,6612992,6465536,6614016,6466560,153088,21504,188416,188928,119296,119552,172032,0,0,0,0,0,2607616,2693632,2779648,12288,59392,6144,2248,13256,240,25000,188928,34704,33792,3123712,41216,10774528,1498496,46144,10848,27264,0,0,0,8,0,4294967295,1,6144,1065353216,2688,344448,459136,573824,401792,516480,631168,1433984,100736,125824,150912,176000,13459456,13467648,13475840,13463552,13471744,13479936,13537280,13557760,13559808,13561856,13563904,115456,153856,571648
.long 2560,3328,43008,129024,835584,921600,862208,948224,860160,946176,6759424,6906880,6758400,6905856,303616,21504,188928,188416,119040,118784,172032,0,0,0,0,0,2865664,2951680,3037696,24576,69632,12288,2256,13264,240,25008,188424,34720,34304,3209728,41472,10921984,1505664,46208,10944,27392,0,0,0,8,0,4294967295,1,12288,1065353216,2688,688512,803200,917888,745856,860544,975232,1491328,201088,226176,251264,276352,13484032,13492224,13500416,13488128,13496320,13504512,13541376,13565952,13568000,13570048,13572096,77824,103680,582400
.long 88576,118016,43008,129024,923648,837632,1073741824,1073741824,1073741824,1073741824,6908928,6761472,6907904,6760448,454144,21504,188928,188416,119552,119296,172032,0,0,0,0,0,3123712,3209728,3295744,36864,79872,18432,2264,13272,240,25016,188936,34736,34304,3295744,41728,11069440,1512832,46272,11040,27520,0,0,0,8,0,4294967295,1,18432,1065353216,2688,1032576,1147264,1261952,1089920,1204608,1319296,1548672,301440,326528,351616,376704,13508608,13516800,13524992,13512704,13520896,13529088,13545472,13574144,13576192,13578240,13580288,115456,153856,593152
.long 2560,3328,43008,129024,3416064,3502080,3440640,3526656,3442688,3528704,11182080,11329536,11183104,11330560,604672,21504,188416,188928,118784,119040,172032,0,0,0,0,0,2353152,2439168,2525184,0,49152,0,3264,17344,1264,25056,189440,42880,41984,3041280,40960,10631168,1720704,48128,11776,28160,0,0,0,8,0,4294967295,1,0,1065353216,2688,384,115072,229760,57728,172416,287104,1376640,384,25472,50560,75648,14614528,14622720,14630912,14618624,14626816,14635008,14712832,14729216,14731264,14733312,14735360,679936,906496,904960
.long 88576,118016,43008,129024,3504128,3418112,1073741824,1073741824,1073741824,1073741824,11331584,11184128,11332608,11185152,755200,21504,188416,188928,119296,119552,172032,0,0,0,0,0,2611200,2697216,2783232,12288,59392,6144,3272,17352,1264,25064,189952,42896,41984,3127296,41216,10778624,1727872,48192,11872,28288,0,0,0,8,0,4294967295,1,6144,1065353216,2688,344448,459136,573824,401792,516480,631168,1433984,100736,125824,150912,176000,14639104,14647296,14655488,14643200,14651392,14659584,14716928,14737408,14739456,14741504,14743552,717568,956672,915712
.long 2560,3328,43008,129024,3588096,3674112,3614720,3700736,3612672,3698688,11478016,11625472,11476992,11624448,905728,21504,188928,188416,119040,118784,172032,0,0,0,0,0,2869248,2955264,3041280,24576,69632,12288,3280,17360,1264,25072,189448,42912,42496,3213312,41472,10926080,1735040,48256,11968,28416,0,0,0,8,0,4294967295,1,12288,1065353216,2688,688512,803200,917888,745856,860544,975232,1491328,201088,226176,251264,276352,14663680,14671872,14680064,14667776,14675968,14684160,14721024,14745600,14747648,14749696,14751744,679936,906496,926464
.long 88576,118016,43008,129024,3676160,3590144,1073741824,1073741824,1073741824,1073741824,11627520,11480064,11626496,11479040,1056256,21504,188928,188416,119552,119296,172032,0,0,0,0,0,3127296,3213312,3299328,36864,79872,18432,3288,17368,1264,25080,189960,42928,42496,3299328,41728,11073536,1742208,48320,12064,28544,0,0,0,8,0,4294967295,1,18432,1065353216,2688,1032576,1147264,1261952,1089920,1204608,1319296,1548672,301440,326528,351616,376704,14688256,14696448,14704640,14692352,14700544,14708736,14725120,14753792,14755840,14757888,14759936,717568,956672,937216
.long 512,640,57344,172032,958464,1044480,6963200,7110656,6964224,7111680,6967296,7114752,6968320,7115776,640,28672,73728,73984,75776,76032,229376,0,0,0,0,0,2670592,2756608,2842624,0,49152,0,5184,13376,272,25088,75776,34944,34816,3358720,41984,11190272,115200,33792,4608,20992,0,0,0,9,4294967295,0,0,1544,1049336022,3584,512,115200,229888,57856,172544,287232,1376768,512,25600,50688,75776,6356992,6365184,6373376,6361088,6369280,6377472,6455296,6471680,6473728,6475776,6477824,201216,201344,602368
.long 115200,115328,57344,172032,1046528,960512,7112704,6965248,7113728,6966272,7116800,6969344,7117824,6970368,201344,28672,74240,74496,76288,76544,229376,0,0,0,0,0,2928640,3014656,3100672,12288,59392,6144,5192,13384,272,25096,76288,34960,34816,3444736,42240,11337728,122368,33856,4704,21120,0,0,0,9,4294967295,0,0,7688,1049336022,3584,344576,459264,573952,401920,516608,631296,1434112,100864,125952,151040,176128,6381568,6389760,6397952,6385664,6393856,6402048,6459392,6479872,6481920,6483968,6486016,251392,251520,613120
.long 512,640,57344,172032,1130496,1216512,7259136,7406592,7258112,7405568,7263232,7410688,7262208,7409664,402048,28672,73984,73728,76032,75776,229376,0,0,0,0,0,3186688,3272704,3358720,24576,69632,12288,5200,13392,272,25104,75784,34976,35328,3530752,42496,11485184,129536,33920,4800,21248,0,0,0,9,4294967295,0,0,13832,1049336022,3584,688640,803328,918016,745984,860672,975360,1491456,201216,226304,251392,276480,6406144,6414336,6422528,6410240,6418432,6426624,6463488,6488064,6490112,6492160,6494208,201216,201344,623872
.long 115200,115328,57344,172032,1218560,1132544,7408640,7261184,7407616,7260160,7412736,7265280,7411712,7264256,602752,28672,74496,74240,76544,76288,229376,0,0,0,0,0,3444736,3530752,3616768,36864,79872,18432,5208,13400,272,25112,76296,34992,35328,3616768,42752,11632640,136704,33984,4896,21376,0,0,0,9,4294967295,0,0,19976,1049336022,3584,1032704,1147392,1262080,1090048,1204736,1319424,1548800,301568,326656,351744,376832,6430720,6438912,6447104,6434816,6443008,6451200,6467584,6496256,6498304,6500352,6502400,251392,251520,634624
.long 512,640,57344,172032,3710976,3796992,11681792,11829248,11682816,11830272,11685888,11833344,11686912,11834368,803456,28672,73728,73984,75776,76032,229376,0,0,0,0,0,2674176,2760192,2846208,0,49152,0,9280,17472,1296,25152,76800,43136,43008,3362304,41984,11194368,344576,35840,5632,22016,0,0,0,9,4294967295,0,0,1544,1049336022,3584,512,115200,229888,57856,172544,287232,1376768,512,25600,50688,75776,7536640,7544832,7553024,7540736,7548928,7557120,7634944,7651328,7653376,7655424,7657472,1004032,1004160,946432
.long 115200,115328,57344,172032,3799040,3713024,11831296,11683840,11832320,11684864,11835392,11687936,11836416,11688960,1004160,28672,74240,74496,76288,76544,229376,0,0,0,0,0,2932224,3018240,3104256,12288,59392,6144,9288,17480,1296,25160,77312,43152,43008,3448320,42240,11341824,351744,35904,5728,22144,0,0,0,9,4294967295,0,0,7688,1049336022,3584,344576,459264,573952,401920,516608,631296,1434112,100864,125952,151040,176128,7561216,7569408,7577600,7565312,7573504,7581696,7639040,7659520,7661568,7663616,7665664,1054208,1054336,957184
.long 512,640,57344,172032,3883008,3969024,11977728,12125184,11976704,12124160,11981824,12129280,11980800,12128256,1204864,28672,73984,73728,76032,75776,229376,0,0,0,0,0,3190272,3276288,3362304,24576,69632,12288,9296,17488,1296,25168,76808,43168,43520,3534336,42496,11489280,358912,35968,5824,22272,0,0,0,9,4294967295,0,0,13832,1049336022,3584,688640,803328,918016,745984,860672,975360,1491456,201216,226304,251392,276480,7585792,7593984,7602176,7589888,7598080,7606272,7643136,7667712,7669760,7671808,7673856,1004032,1004160,967936
.long 115200,115328,57344,172032,3971072,3885056,12127232,11979776,12126208,11978752,12131328,11983872,12130304,11982848,1405568,28672,74496,74240,76544,76288,229376,0,0,0,0,0,3448320,3534336,3620352,36864,79872,18432,9304,17496,1296,25176,77320,43184,43520,3620352,42752,11636736,366080,36032,5920,22400,0,0,0,9,4294967295,0,0,19976,1049336022,3584,1032704,1147392,1262080,1090048,1204736,1319424,1548800,301568,326656,351744,376832,7610368,7618560,7626752,7614464,7622656,7630848,7647232,7675904,7677952,7680000,7682048,1054208,1054336,978688
.long 1536,1664,57344,172032,974848,1060864,6995968,7143424,6996992,7144448,7000064,7147520,7001088,7148544,1664,28672,90112,90368,92160,92416,229376,0,0,0,0,0,2677760,2763776,2849792,0,49152,0,5312,13504,304,25216,92160,35200,34816,3365888,41984,11198464,573952,37888,6656,23040,0,0,0,9,4294967295,0,0,1544,1049336022,3584,512,115200,229888,57856,172544,287232,1376768,512,25600,50688,75776,8716288,8724480,8732672,8720384,8728576,8736768,8814592,8830976,8833024,8835072,8837120,202240,202368,602880
.long 116224,116352,57344,172032,1062912,976896,7145472,6998016,7146496,6999040,7149568,7002112,7150592,7003136,202368,28672,90624,90880,92672,92928,229376,0,0,0,0,0,2935808,3021824,3107840,12288,59392,6144,5320,13512,304,25224,92672,35216,34816,3451904,42240,11345920,581120,37952,6752,23168,0,0,0,9,4294967295,0,0,7688,1049336022,3584,344576,459264,573952,401920,516608,631296,1434112,100864,125952,151040,176128,8740864,8749056,8757248,8744960,8753152,8761344,8818688,8839168,8841216,8843264,8845312,252416,252544,613632
.long 1536,1664,57344,172032,1146880,1232896,7291904,7439360,7290880,7438336,7296000,7443456,7294976,7442432,403072,28672,90368,90112,92416,92160,229376,0,0,0,0,0,3193856,3279872,3365888,24576,69632,12288,5328,13520,304,25232,92168,35232,35328,3537920,42496,11493376,588288,38016,6848,23296,0,0,0,9,4294967295,0,0,13832,1049336022,3584,688640,803328,918016,745984,860672,975360,1491456,201216,226304,251392,276480,8765440,8773632,8781824,8769536,8777728,8785920,8822784,8847360,8849408,8851456,8853504,202240,202368,624384
.long 116224,116352,57344,172032,1234944,1148928,7441408,7293952,7440384,7292928,7445504,7298048,7444480,7297024,603776,28672,90880,90624,92928,92672,229376,0,0,0,0,0,3451904,3537920,3623936,36864,79872,18432,5336,13528,304,25240,92680,35248,35328,3623936,42752,11640832,595456,38080,6944,23424,0,0,0,9,4294967295,0,0,19976,1049336022,3584,1032704,1147392,1262080,1090048,1204736,1319424,1548800,301568,326656,351744,376832,8790016,8798208,8806400,8794112,8802304,8810496,8826880,8855552,8857600,8859648,8861696,252416,252544,635136
.long 1536,1664,57344,172032,3727360,3813376,11714560,11862016,11715584,11863040,11718656,11866112,11719680,11867136,804480,28672,90112,90368,92160,92416,229376,0,0,0,0,0,2681344,2767360,2853376,0,49152,0,9408,17600,1328,25280,93184,43392,43008,3369472,41984,11202560,803328,39936,7680,24064,0,0,0,9,4294967295,0,0,1544,1049336022,3584,512,115200,229888,57856,172544,287232,1376768,512,25600,50688,75776,9895936,9904128,9912320,9900032,9908224,9916416,9994240,10010624,10012672,10014720,10016768,1005056,1005184,946944
.long 116224,116352,57344,172032,3815424,3729408,11864064,11716608,11865088,11717632,11868160,11720704,11869184,11721728,1005184,28672,90624,90880,92672,92928,229376,0,0,0,0,0,2939392,3025408,3111424,12288,59392,6144,9416,17608,1328,25288,93696,43408,43008,3455488,42240,11350016,810496,40000,7776,24192,0,0,0,9,4294967295,0,0,7688,1049336022,3584,344576,459264,573952,401920,516608,631296,1434112,100864,125952,151040,176128,9920512,9928704,9936896,9924608,9932800,9940992,9998336,10018816,10020864,10022912,10024960,1055232,1055360,957696
.long 1536,1664,57344,172032,3899392,3985408,12010496,12157952,12009472,12156928,12014592,12162048,12013568,12161024,1205888,28672,90368,90112,92416,92160,229376,0,0,0,0,0,3197440,3283456,3369472,24576,69632,12288,9424,17616,1328,25296,93192,43424,43520,3541504,42496,11497472,817664,40064,7872,24320,0,0,0,9,4294967295,0,0,13832,1049336022,3584,688640,803328,918016,745984,860672,975360,1491456,201216,226304,251392,276480,9945088,9953280,9961472,9949184,9957376,9965568,10002432,10027008,10029056,10031104,10033152,1005056,1005184,968448
.long 116224,116352,57344,172032,3987456,3901440,12160000,12012544,12158976,12011520,12164096,12016640,12163072,12015616,1406592,28672,90880,90624,92928,92672,229376,0,0,0,0,0,3455488,3541504,3627520,36864,79872,18432,9432,17624,1328,25304,93704,43440,43520,3627520,42752,11644928,824832,40128,7968,24448,0,0,0,9,4294967295,0,0,19976,1049336022,3584,1032704,1147392,1262080,1090048,1204736,1319424,1548800,301568,326656,351744,376832,9969664,9977856,9986048,9973760,9981952,9990144,10006528,10035200,10037248,10039296,10041344,1055232,1055360,979200
.long 2560,2688,57344,172032,991232,1077248,7028736,7176192,7029760,7177216,7032832,7180288,7033856,7181312,2688,28672,106496,106752,108544,108800,229376,0,0,0,0,0,2684928,2770944,2856960,0,49152,0,5440,13632,336,25344,108544,35456,34816,3373056,41984,11206656,1032704,41984,8704,25088,0,0,0,9,4294967295,0,0,1544,1065353216,3584,512,115200,229888,57856,172544,287232,1376768,512,25600,50688,75776,11075584,11083776,11091968,11079680,11087872,11096064,11173888,11190272,11192320,11194368,11196416,203264,203392,603392
.long 117248,117376,57344,172032,1079296,993280,7178240,7030784,7179264,7031808,7182336,7034880,7183360,7035904,203392,28672,107008,107264,109056,109312,229376,0,0,0,0,0,2942976,3028992,3115008,12288,59392,6144,5448,13640,336,25352,109056,35472,34816,3459072,42240,11354112,1039872,42048,8800,25216,0,0,0,9,4294967295,0,0,7688,1065353216,3584,344576,459264,573952,401920,516608,631296,1434112,100864,125952,151040,176128,11100160,11108352,11116544,11104256,11112448,11120640,11177984,11198464,11200512,11202560,11204608,253440,253568,614144
.long 2560,2688,57344,172032,1163264,1249280,7324672,7472128,7323648,7471104,7328768,7476224,7327744,7475200,404096,28672,106752,106496,108800,108544,229376,0,0,0,0,0,3201024,3287040,3373056,24576,69632,12288,5456,13648,336,25360,108552,35488,35328,3545088,42496,11501568,1047040,42112,8896,25344,0,0,0,9,4294967295,0,0,13832,1065353216,3584,688640,803328,918016,745984,860672,975360,1491456,201216,226304,251392,276480,11124736,11132928,11141120,11128832,11137024,11145216,11182080,11206656,11208704,11210752,11212800,203264,203392,624896
.long 117248,117376,57344,172032,1251328,1165312,7474176,7326720,7473152,7325696,7478272,7330816,7477248,7329792,604800,28672,107264,107008,109312,109056,229376,0,0,0,0,0,3459072,3545088,3631104,36864,79872,18432,5464,13656,336,25368,109064,35504,35328,3631104,42752,11649024,1054208,42176,8992,25472,0,0,0,9,4294967295,0,0,19976,1065353216,3584,1032704,1147392,1262080,1090048,1204736,1319424,1548800,301568,326656,351744,376832,11149312,11157504,11165696,11153408,11161600,11169792,11186176,11214848,11216896,11218944,11220992,253440,253568,635648
.long 2560,2688,57344,172032,3743744,3829760,11747328,11894784,11748352,11895808,11751424,11898880,11752448,11899904,805504,28672,106496,106752,108544,108800,229376,0,0,0,0,0,2688512,2774528,2860544,0,49152,0,9536,17728,1360,25408,109568,43648,43008,3376640,41984,11210752,1262080,44032,9728,26112,0,0,0,9,4294967295,0,0,1544,1065353216,3584,512,115200,229888,57856,172544,287232,1376768,512,25600,50688,75776,12255232,12263424,12271616,12259328,12267520,12275712,12353536,12369920,12371968,12374016,12376064,1006080,1006208,947456
.long 117248,117376,57344,172032,3831808,3745792,11896832,11749376,11897856,11750400,11900928,11753472,11901952,11754496,1006208,28672,107008,107264,109056,109312,229376,0,0,0,0,0,2946560,3032576,3118592,12288,59392,6144,9544,17736,1360,25416,110080,43664,43008,3462656,42240,11358208,1269248,44096,9824,26240,0,0,0,9,4294967295,0,0,7688,1065353216,3584,344576,459264,573952,401920,516608,631296,1434112,100864,125952,151040,176128,12279808,12288000,12296192,12283904,12292096,12300288,12357632,12378112,12380160,12382208,12384256,1056256,1056384,958208
.long 2560,2688,57344,172032,3915776,4001792,12043264,12190720,12042240,12189696,12047360,12194816,12046336,12193792,1206912,28672,106752,106496,108800,108544,229376,0,0,0,0,0,3204608,3290624,3376640,24576,69632,12288,9552,17744,1360,25424,109576,43680,43520,3548672,42496,11505664,1276416,44160,9920,26368,0,0,0,9,4294967295,0,0,13832,1065353216,3584,688640,803328,918016,745984,860672,975360,1491456,201216,226304,251392,276480,12304384,12312576,12320768,12308480,12316672,12324864,12361728,12386304,12388352,12390400,12392448,1006080,1006208,968960
.long 117248,117376,57344,172032,4003840,3917824,12192768,12045312,12191744,12044288,12196864,12049408,12195840,12048384,1407616,28672,107264,107008,109312,109056,229376,0,0,0,0,0,3462656,3548672,3634688,36864,79872,18432,9560,17752,1360,25432,110088,43696,43520,3634688,42752,11653120,1283584,44224,10016,26496,0,0,0,9,4294967295,0,0,19976,1065353216,3584,1032704,1147392,1262080,1090048,1204736,1319424,1548800,301568,326656,351744,376832,12328960,12337152,12345344,12333056,12341248,12349440,12365824,12394496,12396544,12398592,12400640,1056256,1056384,979712
.long 2560,3328,43008,129024,1007616,1093632,1032192,1118208,1034240,1120256,7053312,7200768,7054336,7201792,3328,28672,188416,188928,118784,119040,172032,0,0,0,0,0,2692096,2778112,2864128,0,49152,0,2368,13760,368,25472,118784,35712,34816,3380224,41984,11214848,1491456,46080,10752,27136,0,0,0,9,4294967295,0,0,1544,1065353216,2688,512,115200,229888,57856,172544,287232,1376768,512,25600,50688,75776,13434880,13443072,13451264,13438976,13447168,13455360,13533184,13549568,13551616,13553664,13555712,153088,204032,603904
.long 88576,118016,43008,129024,1095680,1009664,1073741824,1073741824,1073741824,1073741824,7202816,7055360,7203840,7056384,204032,28672,188416,188928,119296,119552,172032,0,0,0,0,0,2950144,3036160,3122176,12288,59392,6144,2376,13768,368,25480,119296,35728,34816,3466240,42240,11362304,1498624,46144,10848,27264,0,0,0,9,4294967295,0,0,7688,1065353216,2688,344576,459264,573952,401920,516608,631296,1434112,100864,125952,151040,176128,13459456,13467648,13475840,13463552,13471744,13479936,13537280,13557760,13559808,13561856,13563904,190720,254208,614656
.long 2560,3328,43008,129024,1179648,1265664,1206272,1292288,1204224,1290240,7349248,7496704,7348224,7495680,404736,28672,188928,188416,119040,118784,172032,0,0,0,0,0,3208192,3294208,3380224,24576,69632,12288,2384,13776,368,25488,118792,35744,35328,3552256,42496,11509760,1505792,46208,10944,27392,0,0,0,9,4294967295,0,0,13832,1065353216,2688,688640,803328,918016,745984,860672,975360,1491456,201216,226304,251392,276480,13484032,13492224,13500416,13488128,13496320,13504512,13541376,13565952,13568000,13570048,13572096,153088,204032,625408
.long 88576,118016,43008,129024,1267712,1181696,1073741824,1073741824,1073741824,1073741824,7498752,7351296,7497728,7350272,605440,28672,188928,188416,119552,119296,172032,0,0,0,0,0,3466240,3552256,3638272,36864,79872,18432,2392,13784,368,25496,119304,35760,35328,3638272,42752,11657216,1512960,46272,11040,27520,0,0,0,9,4294967295,0,0,19976,1065353216,2688,1032704,1147392,1262080,1090048,1204736,1319424,1548800,301568,326656,351744,376832,13508608,13516800,13524992,13512704,13520896,13529088,13545472,13574144,13576192,13578240,13580288,190720,254208,636160
.long 2560,3328,43008,129024,3760128,3846144,3784704,3870720,3786752,3872768,11771904,11919360,11772928,11920384,806144,28672,188416,188928,118784,119040,172032,0,0,0,0,0,2695680,2781696,2867712,0,49152,0,3392,17856,1392,25536,119808,43904,43008,3383808,41984,11218944,1720832,48128,11776,28160,0,0,0,9,4294967295,0,0,1544,1065353216,2688,512,115200,229888,57856,172544,287232,1376768,512,25600,50688,75776,14614528,14622720,14630912,14618624,14626816,14635008,14712832,14729216,14731264,14733312,14735360,755200,1006848,947968
.long 88576,118016,43008,129024,3848192,3762176,1073741824,1073741824,1073741824,1073741824,11921408,11773952,11922432,11774976,1006848,28672,188416,188928,119296,119552,172032,0,0,0,0,0,2953728,3039744,3125760,12288,59392,6144,3400,17864,1392,25544,120320,43920,43008,3469824,42240,11366400,1728000,48192,11872,28288,0,0,0,9,4294967295,0,0,7688,1065353216,2688,344576,459264,573952,401920,516608,631296,1434112,100864,125952,151040,176128,14639104,14647296,14655488,14643200,14651392,14659584,14716928,14737408,14739456,14741504,14743552,792832,1057024,958720
.long 2560,3328,43008,129024,3932160,4018176,3958784,4044800,3956736,4042752,12067840,12215296,12066816,12214272,1207552,28672,188928,188416,119040,118784,172032,0,0,0,0,0,3211776,3297792,3383808,24576,69632,12288,3408,17872,1392,25552,119816,43936,43520,3555840,42496,11513856,1735168,48256,11968,28416,0,0,0,9,4294967295,0,0,13832,1065353216,2688,688640,803328,918016,745984,860672,975360,1491456,201216,226304,251392,276480,14663680,14671872,14680064,14667776,14675968,14684160,14721024,14745600,14747648,14749696,14751744,755200,1006848,969472
.long 88576,118016,43008,129024,4020224,3934208,1073741824,1073741824,1073741824,1073741824,12217344,12069888,12216320,12068864,1408256,28672,188928,188416,119552,119296,172032,0,0,0,0,0,3469824,3555840,3641856,36864,79872,18432,3416,17880,1392,25560,120328,43952,43520,3641856,42752,11661312,1742336,48320,12064,28544,0,0,0,9,4294967295,0,0,19976,1065353216,2688,1032704,1147392,1262080,1090048,1204736,1319424,1548800,301568,326656,351744,376832,14688256,14696448,14704640,14692352,14700544,14708736,14725120,14753792,14755840,14757888,14759936,792832,1057024,980224
.long 512,640,57344,172032,1302528,1388544,7553024,7700480,7554048,7701504,7557120,7704576,7558144,7705600,640,28672,73728,73984,75776,76032,229376,0,0,0,0,0,2672128,2758144,2844160,0,49152,0,5696,13888,400,25120,133120,35968,35840,3360256,41984,11192320,115328,33792,4608,20992,0,0,0,9,0,4294967295,1,0,1049336022,3584,640,115328,230016,57984,172672,287360,1376896,640,25728,50816,75904,6356992,6365184,6373376,6361088,6369280,6377472,6455296,6471680,6473728,6475776,6477824,301568,301696,645376
.long 115200,115328,57344,172032,1390592,1304576,7702528,7555072,7703552,7556096,7706624,7559168,7707648,7560192,201344,28672,74240,74496,76288,76544,229376,0,0,0,0,0,2930176,3016192,3102208,12288,59392,6144,5704,13896,400,25128,133632,35984,35840,3446272,42240,11339776,122496,33856,4704,21120,0,0,0,9,0,4294967295,1,6144,1049336022,3584,344704,459392,574080,402048,516736,631424,1434240,100992,126080,151168,176256,6381568,6389760,6397952,6385664,6393856,6402048,6459392,6479872,6481920,6483968,6486016,351744,351872,656128
.long 512,640,57344,172032,1474560,1560576,7848960,7996416,7847936,7995392,7853056,8000512,7852032,7999488,402048,28672,73984,73728,76032,75776,229376,0,0,0,0,0,3188224,3274240,3360256,24576,69632,12288,5712,13904,400,25136,133128,36000,36352,3532288,42496,11487232,129664,33920,4800,21248,0,0,0,9,0,4294967295,1,12288,1049336022,3584,688768,803456,918144,746112,860800,975488,1491584,201344,226432,251520,276608,6406144,6414336,6422528,6410240,6418432,6426624,6463488,6488064,6490112,6492160,6494208,301568,301696,666880
.long 115200,115328,57344,172032,1562624,1476608,7998464,7851008,7997440,7849984,8002560,7855104,8001536,7854080,602752,28672,74496,74240,76544,76288,229376,0,0,0,0,0,3446272,3532288,3618304,36864,79872,18432,5720,13912,400,25144,133640,36016,36352,3618304,42752,11634688,136832,33984,4896,21376,0,0,0,9,0,4294967295,1,18432,1049336022,3584,1032832,1147520,1262208,1090176,1204864,1319552,1548928,301696,326784,351872,376960,6430720,6438912,6447104,6434816,6443008,6451200,6467584,6496256,6498304,6500352,6502400,351744,351872,677632
.long 512,640,57344,172032,4055040,4141056,12271616,12419072,12272640,12420096,12275712,12423168,12276736,12424192,803456,28672,73728,73984,75776,76032,229376,0,0,0,0,0,2675712,2761728,2847744,0,49152,0,9792,17984,1424,25184,134144,44160,44032,3363840,41984,11196416,344704,35840,5632,22016,0,0,0,9,0,4294967295,1,0,1049336022,3584,640,115328,230016,57984,172672,287360,1376896,640,25728,50816,75904,7536640,7544832,7553024,7540736,7548928,7557120,7634944,7651328,7653376,7655424,7657472,1104384,1104512,989440
.long 115200,115328,57344,172032,4143104,4057088,12421120,12273664,12422144,12274688,12425216,12277760,12426240,12278784,1004160,28672,74240,74496,76288,76544,229376,0,0,0,0,0,2933760,3019776,3105792,12288,59392,6144,9800,17992,1424,25192,134656,44176,44032,3449856,42240,11343872,351872,35904,5728,22144,0,0,0,9,0,4294967295,1,6144,1049336022,3584,344704,459392,574080,402048,516736,631424,1434240,100992,126080,151168,176256,7561216,7569408,7577600,7565312,7573504,7581696,7639040,7659520,7661568,7663616,7665664,1154560,1154688,1000192
.long 512,640,57344,172032,4227072,4313088,12567552,12715008,12566528,12713984,12571648,12719104,12570624,12718080,1204864,28672,73984,73728,76032,75776,229376,0,0,0,0,0,3191808,3277824,3363840,24576,69632,12288,9808,18000,1424,25200,134152,44192,44544,3535872,42496,11491328,359040,35968,5824,22272,0,0,0,9,0,4294967295,1,12288,1049336022,3584,688768,803456,918144,746112,860800,975488,1491584,201344,226432,251520,276608,7585792,7593984,7602176,7589888,7598080,7606272,7643136,7667712,7669760,7671808,7673856,1104384,1104512,1010944
.long 115200,115328,57344,172032,4315136,4229120,12717056,12569600,12716032,12568576,12721152,12573696,12720128,12572672,1405568,28672,74496,74240,76544,76288,229376,0,0,0,0,0,3449856,3535872,3621888,36864,79872,18432,9816,18008,1424,25208,134664,44208,44544,3621888,42752,11638784,366208,36032,5920,22400,0,0,0,9,0,4294967295,1,18432,1049336022,3584,1032832,1147520,1262208,1090176,1204864,1319552,1548928,301696,326784,351872,376960,7610368,7618560,7626752,7614464,7622656,7630848,7647232,7675904,7677952,7680000,7682048,1154560,1154688,1021696
.long 1536,1664,57344,172032,1318912,1404928,7585792,7733248,7586816,7734272,7589888,7737344,7590912,7738368,1664,28672,90112,90368,92160,92416,229376,0,0,0,0,0,2679296,2765312,2851328,0,49152,0,5824,14016,432,25248,149504,36224,35840,3367424,41984,11200512,574080,37888,6656,23040,0,0,0,9,0,4294967295,1,0,1049336022,3584,640,115328,230016,57984,172672,287360,1376896,640,25728,50816,75904,8716288,8724480,8732672,8720384,8728576,8736768,8814592,8830976,8833024,8835072,8837120,302592,302720,645888
.long 116224,116352,57344,172032,1406976,1320960,7735296,7587840,7736320,7588864,7739392,7591936,7740416,7592960,202368,28672,90624,90880,92672,92928,229376,0,0,0,0,0,2937344,3023360,3109376,12288,59392,6144,5832,14024,432,25256,150016,36240,35840,3453440,42240,11347968,581248,37952,6752,23168,0,0,0,9,0,4294967295,1,6144,1049336022,3584,344704,459392,574080,402048,516736,631424,1434240,100992,126080,151168,176256,8740864,8749056,8757248,8744960,8753152,8761344,8818688,8839168,8841216,8843264,8845312,352768,352896,656640
.long 1536,1664,57344,172032,1490944,1576960,7881728,8029184,7880704,8028160,7885824,8033280,7884800,8032256,403072,28672,90368,90112,92416,92160,229376,0,0,0,0,0,3195392,3281408,3367424,24576,69632,12288,5840,14032,432,25264,149512,36256,36352,3539456,42496,11495424,588416,38016,6848,23296,0,0,0,9,0,4294967295,1,12288,1049336022,3584,688768,803456,918144,746112,860800,975488,1491584,201344,226432,251520,276608,8765440,8773632,8781824,8769536,8777728,8785920,8822784,8847360,8849408,8851456,8853504,302592,302720,667392
.long 116224,116352,57344,172032,1579008,1492992,8031232,7883776,8030208,7882752,8035328,7887872,8034304,7886848,603776,28672,90880,90624,92928,92672,229376,0,0,0,0,0,3453440,3539456,3625472,36864,79872,18432,5848,14040,432,25272,150024,36272,36352,3625472,42752,11642880,595584,38080,6944,23424,0,0,0,9,0,4294967295,1,18432,1049336022,3584,1032832,1147520,1262208,1090176,1204864,1319552,1548928,301696,326784,351872,376960,8790016,8798208,8806400,8794112,8802304,8810496,8826880,8855552,8857600,8859648,8861696,352768,352896,678144
.long 1536,1664,57344,172032,4071424,4157440,12304384,12451840,12305408,12452864,12308480,12455936,12309504,12456960,804480,28672,90112,90368,92160,92416,229376,0,0,0,0,0,2682880,2768896,2854912,0,49152,0,9920,18112,1456,25312,150528,44416,44032,3371008,41984,11204608,803456,39936,7680,24064,0,0,0,9,0,4294967295,1,0,1049336022,3584,640,115328,230016,57984,172672,287360,1376896,640,25728,50816,75904,9895936,9904128,9912320,9900032,9908224,9916416,9994240,10010624,10012672,10014720,10016768,1105408,1105536,989952
.long 116224,116352,57344,172032,4159488,4073472,12453888,12306432,12454912,12307456,12457984,12310528,12459008,12311552,1005184,28672,90624,90880,92672,92928,229376,0,0,0,0,0,2940928,3026944,3112960,12288,59392,6144,9928,18120,1456,25320,151040,44432,44032,3457024,42240,11352064,810624,40000,7776,24192,0,0,0,9,0,4294967295,1,6144,1049336022,3584,344704,459392,574080,402048,516736,631424,1434240,100992,126080,151168,176256,9920512,9928704,9936896,9924608,9932800,9940992,9998336,10018816,10020864,10022912,10024960,1155584,1155712,1000704
.long 1536,1664,57344,172032,4243456,4329472,12600320,12747776,12599296,12746752,12604416,12751872,12603392,12750848,1205888,28672,90368,90112,92416,92160,229376,0,0,0,0,0,3198976,3284992,3371008,24576,69632,12288,9936,18128,1456,25328,150536,44448,44544,3543040,42496,11499520,817792,40064,7872,24320,0,0,0,9,0,4294967295,1,12288,1049336022,3584,688768,803456,918144,746112,860800,975488,1491584,201344,226432,251520,276608,9945088,9953280,9961472,9949184,9957376,9965568,10002432,10027008,10029056,10031104,10033152,1105408,1105536,1011456
.long 116224,116352,57344,172032,4331520,4245504,12749824,12602368,12748800,12601344,12753920,12606464,12752896,12605440,1406592,28672,90880,90624,92928,92672,229376,0,0,0,0,0,3457024,3543040,3629056,36864,79872,18432,9944,18136,1456,25336,151048,44464,44544,3629056,42752,11646976,824960,40128,7968,24448,0,0,0,9,0,4294967295,1,18432,1049336022,3584,1032832,1147520,1262208,1090176,1204864,1319552,1548928,301696,326784,351872,376960,9969664,9977856,9986048,9973760,9981952,9990144,10006528,10035200,10037248,10039296,10041344,1155584,1155712,1022208
.long 2560,2688,57344,172032,1335296,1421312,7618560,7766016,7619584,7767040,7622656,7770112,7623680,7771136,2688,28672,106496,106752,108544,108800,229376,0,0,0,0,0,2686464,2772480,2858496,0,49152,0,5952,14144,464,25376,165888,36480,35840,3374592,41984,11208704,1032832,41984,8704,25088,0,0,0,9,0,4294967295,1,0,1065353216,3584,640,115328,230016,57984,172672,287360,1376896,640,25728,50816,75904,11075584,11083776,11091968,11079680,11087872,11096064,11173888,11190272,11192320,11194368,11196416,303616,303744,646400
.long 117248,117376,57344,172032,1423360,1337344,7768064,7620608,7769088,7621632,7772160,7624704,7773184,7625728,203392,28672,107008,107264,109056,109312,229376,0,0,0,0,0,2944512,3030528,3116544,12288,59392,6144,5960,14152,464,25384,166400,36496,35840,3460608,42240,11356160,1040000,42048,8800,25216,0,0,0,9,0,4294967295,1,6144,1065353216,3584,344704,459392,574080,402048,516736,631424,1434240,100992,126080,151168,176256,11100160,11108352,11116544,11104256,11112448,11120640,11177984,11198464,11200512,11202560,11204608,353792,353920,657152
.long 2560,2688,57344,172032,1507328,1593344,7914496,8061952,7913472,8060928,7918592,8066048,7917568,8065024,404096,28672,106752,106496,108800,108544,229376,0,0,0,0,0,3202560,3288576,3374592,24576,69632,12288,5968,14160,464,25392,165896,36512,36352,3546624,42496,11503616,1047168,42112,8896,25344,0,0,0,9,0,4294967295,1,12288,1065353216,3584,688768,803456,918144,746112,860800,975488,1491584,201344,226432,251520,276608,11124736,11132928,11141120,11128832,11137024,11145216,11182080,11206656,11208704,11210752,11212800,303616,303744,667904
.long 117248,117376,57344,172032,1595392,1509376,8064000,7916544,8062976,7915520,8068096,7920640,8067072,7919616,604800,28672,107264,107008,109312,109056,229376,0,0,0,0,0,3460608,3546624,3632640,36864,79872,18432,5976,14168,464,25400,166408,36528,36352,3632640,42752,11651072,1054336,42176,8992,25472,0,0,0,9,0,4294967295,1,18432,1065353216,3584,1032832,1147520,1262208,1090176,1204864,1319552,1548928,301696,326784,351872,376960,11149312,11157504,11165696,11153408,11161600,11169792,11186176,11214848,11216896,11218944,11220992,353792,353920,678656
.long 2560,2688,57344,172032,4087808,4173824,12337152,12484608,12338176,12485632,12341248,12488704,12342272,12489728,805504,28672,106496,106752,108544,108800,229376,0,0,0,0,0,2690048,2776064,2862080,0,49152,0,10048,18240,1488,25440,166912,44672,44032,3378176,41984,11212800,1262208,44032,9728,26112,0,0,0,9,0,4294967295,1,0,1065353216,3584,640,115328,230016,57984,172672,287360,1376896,640,25728,50816,75904,12255232,12263424,12271616,12259328,12267520,12275712,12353536,12369920,12371968,12374016,12376064,1106432,1106560,990464
.long 117248,117376,57344,172032,4175872,4089856,12486656,12339200,12487680,12340224,12490752,12343296,12491776,12344320,1006208,28672,107008,107264,109056,109312,229376,0,0,0,0,0,2948096,3034112,3120128,12288,59392,6144,10056,18248,1488,25448,167424,44688,44032,3464192,42240,11360256,1269376,44096,9824,26240,0,0,0,9,0,4294967295,1,6144,1065353216,3584,344704,459392,574080,402048,516736,631424,1434240,100992,126080,151168,176256,12279808,12288000,12296192,12283904,12292096,12300288,12357632,12378112,12380160,12382208,12384256,1156608,1156736,1001216
.long 2560,2688,57344,172032,4259840,4345856,12633088,12780544,12632064,12779520,12637184,12784640,12636160,12783616,1206912,28672,106752,106496,108800,108544,229376,0,0,0,0,0,3206144,3292160,3378176,24576,69632,12288,10064,18256,1488,25456,166920,44704,44544,3550208,42496,11507712,1276544,44160,9920,26368,0,0,0,9,0,4294967295,1,12288,1065353216,3584,688768,803456,918144,746112,860800,975488,1491584,201344,226432,251520,276608,12304384,12312576,12320768,12308480,12316672,12324864,12361728,12386304,12388352,12390400,12392448,1106432,1106560,1011968
.long 117248,117376,57344,172032,4347904,4261888,12782592,12635136,12781568,12634112,12786688,12639232,12785664,12638208,1407616,28672,107264,107008,109312,109056,229376,0,0,0,0,0,3464192,3550208,3636224,36864,79872,18432,10072,18264,1488,25464,167432,44720,44544,3636224,42752,11655168,1283712,44224,10016,26496,0,0,0,9,0,4294967295,1,18432,1065353216,3584,1032832,1147520,1262208,1090176,1204864,1319552,1548928,301696,326784,351872,376960,12328960,12337152,12345344,12333056,12341248,12349440,12365824,12394496,12396544,12398592,12400640,1156608,1156736,1022720
.long 2560,3328,43008,129024,1351680,1437696,1376256,1462272,1378304,1464320,7643136,7790592,7644160,7791616,3328,28672,188416,188928,118784,119040,172032,0,0,0,0,0,2693632,2779648,2865664,0,49152,0,2496,14272,496,25504,176128,36736,35840,3381760,41984,11216896,1491584,46080,10752,27136,0,0,0,9,0,4294967295,1,0,1065353216,2688,640,115328,230016,57984,172672,287360,1376896,640,25728,50816,75904,13434880,13443072,13451264,13438976,13447168,13455360,13533184,13549568,13551616,13553664,13555712,228352,304384,646912
.long 88576,118016,43008,129024,1439744,1353728,1073741824,1073741824,1073741824,1073741824,7792640,7645184,7793664,7646208,204032,28672,188416,188928,119296,119552,172032,0,0,0,0,0,2951680,3037696,3123712,12288,59392,6144,2504,14280,496,25512,176640,36752,35840,3467776,42240,11364352,1498752,46144,10848,27264,0,0,0,9,0,4294967295,1,6144,1065353216,2688,344704,459392,574080,402048,516736,631424,1434240,100992,126080,151168,176256,13459456,13467648,13475840,13463552,13471744,13479936,13537280,13557760,13559808,13561856,13563904,265984,354560,657664
.long 2560,3328,43008,129024,1523712,1609728,1550336,1636352,1548288,1634304,7939072,8086528,7938048,8085504,404736,28672,188928,188416,119040,118784,172032,0,0,0,0,0,3209728,3295744,3381760,24576,69632,12288,2512,14288,496,25520,176136,36768,36352,3553792,42496,11511808,1505920,46208,10944,27392,0,0,0,9,0,4294967295,1,12288,1065353216,2688,688768,803456,918144,746112,860800,975488,1491584,201344,226432,251520,276608,13484032,13492224,13500416,13488128,13496320,13504512,13541376,13565952,13568000,13570048,13572096,228352,304384,668416
.long 88576,118016,43008,129024,1611776,1525760,1073741824,1073741824,1073741824,1073741824,8088576,7941120,8087552,7940096,605440,28672,188928,188416,119552,119296,172032,0,0,0,0,0,3467776,3553792,3639808,36864,79872,18432,2520,14296,496,25528,176648,36784,36352,3639808,42752,11659264,1513088,46272,11040,27520,0,0,0,9,0,4294967295,1,18432,1065353216,2688,1032832,1147520,1262208,1090176,1204864,1319552,1548928,301696,326784,351872,376960,13508608,13516800,13524992,13512704,13520896,13529088,13545472,13574144,13576192,13578240,13580288,265984,354560,679168
.long 2560,3328,43008,129024,4104192,4190208,4128768,4214784,4130816,4216832,12361728,12509184,12362752,12510208,806144,28672,188416,188928,118784,119040,172032,0,0,0,0,0,2697216,2783232,2869248,0,49152,0,3520,18368,1520,25568,177152,44928,44032,3385344,41984,11220992,1720960,48128,11776,28160,0,0,0,9,0,4294967295,1,0,1065353216,2688,640,115328,230016,57984,172672,287360,1376896,640,25728,50816,75904,14614528,14622720,14630912,14618624,14626816,14635008,14712832,14729216,14731264,14733312,14735360,830464,1107200,990976
.long 88576,118016,43008,129024,4192256,4106240,1073741824,1073741824,1073741824,1073741824,12511232,12363776,12512256,12364800,1006848,28672,188416,188928,119296,119552,172032,0,0,0,0,0,2955264,3041280,3127296,12288,59392,6144,3528,18376,1520,25576,177664,44944,44032,3471360,42240,11368448,1728128,48192,11872,28288,0,0,0,9,0,4294967295,1,6144,1065353216,2688,344704,459392,574080,402048,516736,631424,1434240,100992,126080,151168,176256,14639104,14647296,14655488,14643200,14651392,14659584,14716928,14737408,14739456,14741504,14743552,868096,1157376,1001728
.long 2560,3328,43008,129024,4276224,4362240,4302848,4388864,4300800,4386816,12657664,12805120,12656640,12804096,1207552,28672,188928,188416,119040,118784,172032,0,0,0,0,0,3213312,3299328,3385344,24576,69632,12288,3536,18384,1520,25584,177160,44960,44544,3557376,42496,11515904,1735296,48256,11968,28416,0,0,0,9,0,4294967295,1,12288,1065353216,2688,688768,803456,918144,746112,860800,975488,1491584,201344,226432,251520,276608,14663680,14671872,14680064,14667776,14675968,14684160,14721024,14745600,14747648,14749696,14751744,830464,1107200,1012480
.long 88576,118016,43008,129024,4364288,4278272,1073741824,1073741824,1073741824,1073741824,12807168,12659712,12806144,12658688,1408256,28672,188928,188416,119552,119296,172032,0,0,0,0,0,3471360,3557376,3643392,36864,79872,18432,3544,18392,1520,25592,177672,44976,44544,3643392,42752,11663360,1742464,48320,12064,28544,0,0,0,9,0,4294967295,1,18432,1065353216,2688,1032832,1147520,1262208,1090176,1204864,1319552,1548928,301696,326784,351872,376960,14688256,14696448,14704640,14692352,14700544,14708736,14725120,14753792,14755840,14757888,14759936,868096,1157376,1023232
.long 512,640,57344,172032,1646592,1732608,8142848,8290304,8143872,8291328,8146944,8294400,8147968,8295424,803328,28672,73728,73984,75776,76032,229376,0,0,0,0,0,3014656,3100672,3186688,0,49152,0,6208,14400,528,25600,74752,36992,36864,3702784,43008,11780096,115456,33792,4608,20992,0,0,0,10,4294967295,0,0,1544,1049336022,3584,768,115456,230144,58112,172800,287488,1377024,768,25856,50944,76032,6356992,6365184,6373376,6361088,6369280,6377472,6455296,6471680,6473728,6475776,6477824,401920,402048,688384
.long 115200,115328,57344,172032,1734656,1648640,8292352,8144896,8293376,8145920,8296448,8148992,8297472,8150016,1004032,28672,74240,74496,76288,76544,229376,0,0,0,0,0,3272704,3358720,3444736,12288,59392,6144,6216,14408,528,25608,75264,37008,36864,3788800,43264,11927552,122624,33856,4704,21120,0,0,0,10,4294967295,0,0,7688,1049336022,3584,344832,459520,574208,402176,516864,631552,1434368,101120,126208,151296,176384,6381568,6389760,6397952,6385664,6393856,6402048,6459392,6479872,6481920,6483968,6486016,452096,452224,699136
.long 512,640,57344,172032,1818624,1904640,8438784,8586240,8437760,8585216,8442880,8590336,8441856,8589312,1204736,28672,73984,73728,76032,75776,229376,0,0,0,0,0,3530752,3616768,3702784,24576,69632,12288,6224,14416,528,25616,74760,37024,37376,3874816,43520,12075008,129792,33920,4800,21248,0,0,0,10,4294967295,0,0,13832,1049336022,3584,688896,803584,918272,746240,860928,975616,1491712,201472,226560,251648,276736,6406144,6414336,6422528,6410240,6418432,6426624,6463488,6488064,6490112,6492160,6494208,401920,402048,709888
.long 115200,115328,57344,172032,1906688,1820672,8588288,8440832,8587264,8439808,8592384,8444928,8591360,8443904,1405440,28672,74496,74240,76544,76288,229376,0,0,0,0,0,3788800,3874816,3960832,36864,79872,18432,6232,14424,528,25624,75272,37040,37376,3960832,43776,12222464,136960,33984,4896,21376,0,0,0,10,4294967295,0,0,19976,1049336022,3584,1032960,1147648,1262336,1090304,1204992,1319680,1549056,301824,326912,352000,377088,6430720,6438912,6447104,6434816,6443008,6451200,6467584,6496256,6498304,6500352,6502400,452096,452224,720640
.long 512,640,57344,172032,4399104,4485120,12861440,13008896,12862464,13009920,12865536,13012992,12866560,13014016,512,28672,73728,73984,75776,76032,229376,0,0,0,0,0,3018240,3104256,3190272,0,49152,0,10304,18496,1552,25664,73728,45184,45056,3706368,43008,11784192,344832,35840,5632,22016,0,0,0,10,4294967295,0,0,1544,1049336022,3584,768,115456,230144,58112,172800,287488,1377024,768,25856,50944,76032,7536640,7544832,7553024,7540736,7548928,7557120,7634944,7651328,7653376,7655424,7657472,1204736,1204864,1032448
.long 115200,115328,57344,172032,4487168,4401152,13010944,12863488,13011968,12864512,13015040,12867584,13016064,12868608,201216,28672,74240,74496,76288,76544,229376,0,0,0,0,0,3276288,3362304,3448320,12288,59392,6144,10312,18504,1552,25672,74240,45200,45056,3792384,43264,11931648,352000,35904,5728,22144,0,0,0,10,4294967295,0,0,7688,1049336022,3584,344832,459520,574208,402176,516864,631552,1434368,101120,126208,151296,176384,7561216,7569408,7577600,7565312,7573504,7581696,7639040,7659520,7661568,7663616,7665664,1254912,1255040,1043200
.long 512,640,57344,172032,4571136,4657152,13157376,13304832,13156352,13303808,13161472,13308928,13160448,13307904,401920,28672,73984,73728,76032,75776,229376,0,0,0,0,0,3534336,3620352,3706368,24576,69632,12288,10320,18512,1552,25680,73736,45216,45568,3878400,43520,12079104,359168,35968,5824,22272,0,0,0,10,4294967295,0,0,13832,1049336022,3584,688896,803584,918272,746240,860928,975616,1491712,201472,226560,251648,276736,7585792,7593984,7602176,7589888,7598080,7606272,7643136,7667712,7669760,7671808,7673856,1204736,1204864,1053952
.long 115200,115328,57344,172032,4659200,4573184,13306880,13159424,13305856,13158400,13310976,13163520,13309952,13162496,602624,28672,74496,74240,76544,76288,229376,0,0,0,0,0,3792384,3878400,3964416,36864,79872,18432,10328,18520,1552,25688,74248,45232,45568,3964416,43776,12226560,366336,36032,5920,22400,0,0,0,10,4294967295,0,0,19976,1049336022,3584,1032960,1147648,1262336,1090304,1204992,1319680,1549056,301824,326912,352000,377088,7610368,7618560,7626752,7614464,7622656,7630848,7647232,7675904,7677952,7680000,7682048,1254912,1255040,1064704
.long 1536,1664,57344,172032,1662976,1748992,8175616,8323072,8176640,8324096,8179712,8327168,8180736,8328192,804352,28672,90112,90368,92160,92416,229376,0,0,0,0,0,3021824,3107840,3193856,0,49152,0,6336,14528,560,25728,91136,37248,36864,3709952,43008,11788288,574208,37888,6656,23040,0,0,0,10,4294967295,0,0,1544,1049336022,3584,768,115456,230144,58112,172800,287488,1377024,768,25856,50944,76032,8716288,8724480,8732672,8720384,8728576,8736768,8814592,8830976,8833024,8835072,8837120,402944,403072,688896
.long 116224,116352,57344,172032,1751040,1665024,8325120,8177664,8326144,8178688,8329216,8181760,8330240,8182784,1005056,28672,90624,90880,92672,92928,229376,0,0,0,0,0,3279872,3365888,3451904,12288,59392,6144,6344,14536,560,25736,91648,37264,36864,3795968,43264,11935744,581376,37952,6752,23168,0,0,0,10,4294967295,0,0,7688,1049336022,3584,344832,459520,574208,402176,516864,631552,1434368,101120,126208,151296,176384,8740864,8749056,8757248,8744960,8753152,8761344,8818688,8839168,8841216,8843264,8845312,453120,453248,699648
.long 1536,1664,57344,172032,1835008,1921024,8471552,8619008,8470528,8617984,8475648,8623104,8474624,8622080,1205760,28672,90368,90112,92416,92160,229376,0,0,0,0,0,3537920,3623936,3709952,24576,69632,12288,6352,14544,560,25744,91144,37280,37376,3881984,43520,12083200,588544,38016,6848,23296,0,0,0,10,4294967295,0,0,13832,1049336022,3584,688896,803584,918272,746240,860928,975616,1491712,201472,226560,251648,276736,8765440,8773632,8781824,8769536,8777728,8785920,8822784,8847360,8849408,8851456,8853504,402944,403072,710400
.long 116224,116352,57344,172032,1923072,1837056,8621056,8473600,8620032,8472576,8625152,8477696,8624128,8476672,1406464,28672,90880,90624,92928,92672,229376,0,0,0,0,0,3795968,3881984,3968000,36864,79872,18432,6360,14552,560,25752,91656,37296,37376,3968000,43776,12230656,595712,38080,6944,23424,0,0,0,10,4294967295,0,0,19976,1049336022,3584,1032960,1147648,1262336,1090304,1204992,1319680,1549056,301824,326912,352000,377088,8790016,8798208,8806400,8794112,8802304,8810496,8826880,8855552,8857600,8859648,8861696,453120,453248,721152
.long 1536,1664,57344,172032,4415488,4501504,12894208,13041664,12895232,13042688,12898304,13045760,12899328,13046784,1536,28672,90112,90368,92160,92416,229376,0,0,0,0,0,3025408,3111424,3197440,0,49152,0,10432,18624,1584,25792,90112,45440,45056,3713536,43008,11792384,803584,39936,7680,24064,0,0,0,10,4294967295,0,0,1544,1049336022,3584,768,115456,230144,58112,172800,287488,1377024,768,25856,50944,76032,9895936,9904128,9912320,9900032,9908224,9916416,9994240,10010624,10012672,10014720,10016768,1205760,1205888,1032960
.long 116224,116352,57344,172032,4503552,4417536,13043712,12896256,13044736,12897280,13047808,12900352,13048832,12901376,202240,28672,90624,90880,92672,92928,229376,0,0,0,0,0,3283456,3369472,3455488,12288,59392,6144,10440,18632,1584,25800,90624,45456,45056,3799552,43264,11939840,810752,40000,7776,24192,0,0,0,10,4294967295,0,0,7688,1049336022,3584,344832,459520,574208,402176,516864,631552,1434368,101120,126208,151296,176384,9920512,9928704,9936896,9924608,9932800,9940992,9998336,10018816,10020864,10022912,10024960,1255936,1256064,1043712
.long 1536,1664,57344,172032,4587520,4673536,13190144,13337600,13189120,13336576,13194240,13341696,13193216,13340672,402944,28672,90368,90112,92416,92160,229376,0,0,0,0,0,3541504,3627520,3713536,24576,69632,12288,10448,18640,1584,25808,90120,45472,45568,3885568,43520,12087296,817920,40064,7872,24320,0,0,0,10,4294967295,0,0,13832,1049336022,3584,688896,803584,918272,746240,860928,975616,1491712,201472,226560,251648,276736,9945088,9953280,9961472,9949184,9957376,9965568,10002432,10027008,10029056,10031104,10033152,1205760,1205888,1054464
.long 116224,116352,57344,172032,4675584,4589568,13339648,13192192,13338624,13191168,13343744,13196288,13342720,13195264,603648,28672,90880,90624,92928,92672,229376,0,0,0,0,0,3799552,3885568,3971584,36864,79872,18432,10456,18648,1584,25816,90632,45488,45568,3971584,43776,12234752,825088,40128,7968,24448,0,0,0,10,4294967295,0,0,19976,1049336022,3584,1032960,1147648,1262336,1090304,1204992,1319680,1549056,301824,326912,352000,377088,9969664,9977856,9986048,9973760,9981952,9990144,10006528,10035200,10037248,10039296,10041344,1255936,1256064,1065216
.long 2560,2688,57344,172032,1679360,1765376,8208384,8355840,8209408,8356864,8212480,8359936,8213504,8360960,805376,28672,106496,106752,108544,108800,229376,0,0,0,0,0,3028992,3115008,3201024,0,49152,0,6464,14656,592,25856,107520,37504,36864,3717120,43008,11796480,1032960,41984,8704,25088,0,0,0,10,4294967295,0,0,1544,1065353216,3584,768,115456,230144,58112,172800,287488,1377024,768,25856,50944,76032,11075584,11083776,11091968,11079680,11087872,11096064,11173888,11190272,11192320,11194368,11196416,403968,404096,689408
.long 117248,117376,57344,172032,1767424,1681408,8357888,8210432,8358912,8211456,8361984,8214528,8363008,8215552,1006080,28672,107008,107264,109056,109312,229376,0,0,0,0,0,3287040,3373056,3459072,12288,59392,6144,6472,14664,592,25864,108032,37520,36864,3803136,43264,11943936,1040128,42048,8800,25216,0,0,0,10,4294967295,0,0,7688,1065353216,3584,344832,459520,574208,402176,516864,631552,1434368,101120,126208,151296,176384,11100160,11108352,11116544,11104256,11112448,11120640,11177984,11198464,11200512,11202560,11204608,454144,454272,700160
.long 2560,2688,57344,172032,1851392,1937408,8504320,8651776,8503296,8650752,8508416,8655872,8507392,8654848,1206784,28672,106752,106496,108800,108544,229376,0,0,0,0,0,3545088,3631104,3717120,24576,69632,12288,6480,14672,592,25872,107528,37536,37376,3889152,43520,12091392,1047296,42112,8896,25344,0,0,0,10,4294967295,0,0,13832,1065353216,3584,688896,803584,918272,746240,860928,975616,1491712,201472,226560,251648,276736,11124736,11132928,11141120,11128832,11137024,11145216,11182080,11206656,11208704,11210752,11212800,403968,404096,710912
.long 117248,117376,57344,172032,1939456,1853440,8653824,8506368,8652800,8505344,8657920,8510464,8656896,8509440,1407488,28672,107264,107008,109312,109056,229376,0,0,0,0,0,3803136,3889152,3975168,36864,79872,18432,6488,14680,592,25880,108040,37552,37376,3975168,43776,12238848,1054464,42176,8992,25472,0,0,0,10,4294967295,0,0,19976,1065353216,3584,1032960,1147648,1262336,1090304,1204992,1319680,1549056,301824,326912,352000,377088,11149312,11157504,11165696,11153408,11161600,11169792,11186176,11214848,11216896,11218944,11220992,454144,454272,721664
.long 2560,2688,57344,172032,4431872,4517888,12926976,13074432,12928000,13075456,12931072,13078528,12932096,13079552,2560,28672,106496,106752,108544,108800,229376,0,0,0,0,0,3032576,3118592,3204608,0,49152,0,10560,18752,1616,25920,106496,45696,45056,3720704,43008,11800576,1262336,44032,9728,26112,0,0,0,10,4294967295,0,0,1544,1065353216,3584,768,115456,230144,58112,172800,287488,1377024,768,25856,50944,76032,12255232,12263424,12271616,12259328,12267520,12275712,12353536,12369920,12371968,12374016,12376064,1206784,1206912,1033472
.long 117248,117376,57344,172032,4519936,4433920,13076480,12929024,13077504,12930048,13080576,12933120,13081600,12934144,203264,28672,107008,107264,109056,109312,229376,0,0,0,0,0,3290624,3376640,3462656,12288,59392,6144,10568,18760,1616,25928,107008,45712,45056,3806720,43264,11948032,1269504,44096,9824,26240,0,0,0,10,4294967295,0,0,7688,1065353216,3584,344832,459520,574208,402176,516864,631552,1434368,101120,126208,151296,176384,12279808,12288000,12296192,12283904,12292096,12300288,12357632,12378112,12380160,12382208,12384256,1256960,1257088,1044224
.long 2560,2688,57344,172032,4603904,4689920,13222912,13370368,13221888,13369344,13227008,13374464,13225984,13373440,403968,28672,106752,106496,108800,108544,229376,0,0,0,0,0,3548672,3634688,3720704,24576,69632,12288,10576,18768,1616,25936,106504,45728,45568,3892736,43520,12095488,1276672,44160,9920,26368,0,0,0,10,4294967295,0,0,13832,1065353216,3584,688896,803584,918272,746240,860928,975616,1491712,201472,226560,251648,276736,12304384,12312576,12320768,12308480,12316672,12324864,12361728,12386304,12388352,12390400,12392448,1206784,1206912,1054976
.long 117248,117376,57344,172032,4691968,4605952,13372416,13224960,13371392,13223936,13376512,13229056,13375488,13228032,604672,28672,107264,107008,109312,109056,229376,0,0,0,0,0,3806720,3892736,3978752,36864,79872,18432,10584,18776,1616,25944,107016,45744,45568,3978752,43776,12242944,1283840,44224,10016,26496,0,0,0,10,4294967295,0,0,19976,1065353216,3584,1032960,1147648,1262336,1090304,1204992,1319680,1549056,301824,326912,352000,377088,12328960,12337152,12345344,12333056,12341248,12349440,12365824,12394496,12396544,12398592,12400640,1256960,1257088,1065728
.long 2560,3328,43008,129024,1695744,1781760,1720320,1806336,1722368,1808384,8232960,8380416,8233984,8381440,604672,21504,188416,188928,118784,119040,172032,0,0,0,0,0,3036160,3122176,3208192,0,49152,0,2624,14784,624,25984,189440,37760,36864,3724288,43008,11804672,1491712,46080,10752,27136,0,0,0,10,4294967295,0,0,1544,1065353216,2688,768,115456,230144,58112,172800,287488,1377024,768,25856,50944,76032,13434880,13443072,13451264,13438976,13447168,13455360,13533184,13549568,13551616,13553664,13555712,303616,404736,689920
.long 88576,118016,43008,129024,1783808,1697792,1073741824,1073741824,1073741824,1073741824,8382464,8235008,8383488,8236032,755200,21504,188416,188928,119296,119552,172032,0,0,0,0,0,3294208,3380224,3466240,12288,59392,6144,2632,14792,624,25992,189952,37776,36864,3810304,43264,11952128,1498880,46144,10848,27264,0,0,0,10,4294967295,0,0,7688,1065353216,2688,344832,459520,574208,402176,516864,631552,1434368,101120,126208,151296,176384,13459456,13467648,13475840,13463552,13471744,13479936,13537280,13557760,13559808,13561856,13563904,341248,454912,700672
.long 2560,3328,43008,129024,1867776,1953792,1894400,1980416,1892352,1978368,8528896,8676352,8527872,8675328,905728,21504,188928,188416,119040,118784,172032,0,0,0,0,0,3552256,3638272,3724288,24576,69632,12288,2640,14800,624,26000,189448,37792,37376,3896320,43520,12099584,1506048,46208,10944,27392,0,0,0,10,4294967295,0,0,13832,1065353216,2688,688896,803584,918272,746240,860928,975616,1491712,201472,226560,251648,276736,13484032,13492224,13500416,13488128,13496320,13504512,13541376,13565952,13568000,13570048,13572096,303616,404736,711424
.long 88576,118016,43008,129024,1955840,1869824,1073741824,1073741824,1073741824,1073741824,8678400,8530944,8677376,8529920,1056256,21504,188928,188416,119552,119296,172032,0,0,0,0,0,3810304,3896320,3982336,36864,79872,18432,2648,14808,624,26008,189960,37808,37376,3982336,43776,12247040,1513216,46272,11040,27520,0,0,0,10,4294967295,0,0,19976,1065353216,2688,1032960,1147648,1262336,1090304,1204992,1319680,1549056,301824,326912,352000,377088,13508608,13516800,13524992,13512704,13520896,13529088,13545472,13574144,13576192,13578240,13580288,341248,454912,722176
.long 2560,3328,43008,129024,4448256,4534272,4472832,4558848,4474880,4560896,12951552,13099008,12952576,13100032,2560,21504,188416,188928,118784,119040,172032,0,0,0,0,0,3039744,3125760,3211776,0,49152,0,3648,18880,1648,26048,188416,45952,45056,3727872,43008,11808768,1721088,48128,11776,28160,0,0,0,10,4294967295,0,0,1544,1065353216,2688,768,115456,230144,58112,172800,287488,1377024,768,25856,50944,76032,14614528,14622720,14630912,14618624,14626816,14635008,14712832,14729216,14731264,14733312,14735360,905728,1207552,1033984
.long 88576,118016,43008,129024,4536320,4450304,1073741824,1073741824,1073741824,1073741824,13101056,12953600,13102080,12954624,153088,21504,188416,188928,119296,119552,172032,0,0,0,0,0,3297792,3383808,3469824,12288,59392,6144,3656,18888,1648,26056,188928,45968,45056,3813888,43264,11956224,1728256,48192,11872,28288,0,0,0,10,4294967295,0,0,7688,1065353216,2688,344832,459520,574208,402176,516864,631552,1434368,101120,126208,151296,176384,14639104,14647296,14655488,14643200,14651392,14659584,14716928,14737408,14739456,14741504,14743552,943360,1257728,1044736
.long 2560,3328,43008,129024,4620288,4706304,4646912,4732928,4644864,4730880,13247488,13394944,13246464,13393920,303616,21504,188928,188416,119040,118784,172032,0,0,0,0,0,3555840,3641856,3727872,24576,69632,12288,3664,18896,1648,26064,188424,45984,45568,3899904,43520,12103680,1735424,48256,11968,28416,0,0,0,10,4294967295,0,0,13832,1065353216,2688,688896,803584,918272,746240,860928,975616,1491712,201472,226560,251648,276736,14663680,14671872,14680064,14667776,14675968,14684160,14721024,14745600,14747648,14749696,14751744,905728,1207552,1055488
.long 88576,118016,43008,129024,4708352,4622336,1073741824,1073741824,1073741824,1073741824,13396992,13249536,13395968,13248512,454144,21504,188928,188416,119552,119296,172032,0,0,0,0,0,3813888,3899904,3985920,36864,79872,18432,3672,18904,1648,26072,188936,46000,45568,3985920,43776,12251136,1742592,48320,12064,28544,0,0,0,10,4294967295,0,0,19976,1065353216,2688,1032960,1147648,1262336,1090304,1204992,1319680,1549056,301824,326912,352000,377088,14688256,14696448,14704640,14692352,14700544,14708736,14725120,14753792,14755840,14757888,14759936,943360,1257728,1066240
.long 512,640,57344,172032,1990656,2076672,8732672,8880128,8733696,8881152,8736768,8884224,8737792,8885248,803328,28672,73728,73984,75776,76032,229376,0,0,0,0,0,3016192,3102208,3188224,0,49152,0,6720,14912,656,25632,132096,38016,37888,3704320,43008,11782144,172032,34304,4624,21008,0,0,0,10,0,4294967295,1,0,1049336022,3584,0,114688,229376,57344,172032,286720,1376256,0,25088,50176,75264,6651904,6660096,6668288,6656000,6664192,6672384,6750208,6766592,6768640,6770688,6772736,502272,502400,731392
.long 115200,115328,57344,172032,2078720,1992704,8882176,8734720,8883200,8735744,8886272,8738816,8887296,8739840,1004032,28672,74240,74496,76288,76544,229376,0,0,0,0,0,3274240,3360256,3446272,12288,59392,6144,6728,14920,656,25640,132608,38032,37888,3790336,43264,11929600,179200,34368,4720,21136,0,0,0,10,0,4294967295,1,6144,1049336022,3584,344064,458752,573440,401408,516096,630784,1433600,100352,125440,150528,175616,6676480,6684672,6692864,6680576,6688768,6696960,6754304,6774784,6776832,6778880,6780928,552448,552576,742144
.long 512,640,57344,172032,2162688,2248704,9028608,9176064,9027584,9175040,9032704,9180160,9031680,9179136,1204736,28672,73984,73728,76032,75776,229376,0,0,0,0,0,3532288,3618304,3704320,24576,69632,12288,6736,14928,656,25648,132104,38048,38400,3876352,43520,12077056,186368,34432,4816,21264,0,0,0,10,0,4294967295,1,12288,1049336022,3584,688128,802816,917504,745472,860160,974848,1490944,200704,225792,250880,275968,6701056,6709248,6717440,6705152,6713344,6721536,6758400,6782976,6785024,6787072,6789120,502272,502400,752896
.long 115200,115328,57344,172032,2250752,2164736,9178112,9030656,9177088,9029632,9182208,9034752,9181184,9033728,1405440,28672,74496,74240,76544,76288,229376,0,0,0,0,0,3790336,3876352,3962368,36864,79872,18432,6744,14936,656,25656,132616,38064,38400,3962368,43776,12224512,193536,34496,4912,21392,0,0,0,10,0,4294967295,1,18432,1049336022,3584,1032192,1146880,1261568,1089536,1204224,1318912,1548288,301056,326144,351232,376320,6725632,6733824,6742016,6729728,6737920,6746112,6762496,6791168,6793216,6795264,6797312,552448,552576,763648
.long 512,640,57344,172032,4743168,4829184,13451264,13598720,13452288,13599744,13455360,13602816,13456384,13603840,512,28672,73728,73984,75776,76032,229376,0,0,0,0,0,3019776,3105792,3191808,0,49152,0,10816,19008,1680,25696,131072,46208,46080,3707904,43008,11786240,401408,36352,5648,22032,0,0,0,10,0,4294967295,1,0,1049336022,3584,0,114688,229376,57344,172032,286720,1376256,0,25088,50176,75264,7831552,7839744,7847936,7835648,7843840,7852032,7929856,7946240,7948288,7950336,7952384,1305088,1305216,1075456
.long 115200,115328,57344,172032,4831232,4745216,13600768,13453312,13601792,13454336,13604864,13457408,13605888,13458432,201216,28672,74240,74496,76288,76544,229376,0,0,0,0,0,3277824,3363840,3449856,12288,59392,6144,10824,19016,1680,25704,131584,46224,46080,3793920,43264,11933696,408576,36416,5744,22160,0,0,0,10,0,4294967295,1,6144,1049336022,3584,344064,458752,573440,401408,516096,630784,1433600,100352,125440,150528,175616,7856128,7864320,7872512,7860224,7868416,7876608,7933952,7954432,7956480,7958528,7960576,1355264,1355392,1086208
.long 512,640,57344,172032,4915200,5001216,13747200,13894656,13746176,13893632,13751296,13898752,13750272,13897728,401920,28672,73984,73728,76032,75776,229376,0,0,0,0,0,3535872,3621888,3707904,24576,69632,12288,10832,19024,1680,25712,131080,46240,46592,3879936,43520,12081152,415744,36480,5840,22288,0,0,0,10,0,4294967295,1,12288,1049336022,3584,688128,802816,917504,745472,860160,974848,1490944,200704,225792,250880,275968,7880704,7888896,7897088,7884800,7892992,7901184,7938048,7962624,7964672,7966720,7968768,1305088,1305216,1096960
.long 115200,115328,57344,172032,5003264,4917248,13896704,13749248,13895680,13748224,13900800,13753344,13899776,13752320,602624,28672,74496,74240,76544,76288,229376,0,0,0,0,0,3793920,3879936,3965952,36864,79872,18432,10840,19032,1680,25720,131592,46256,46592,3965952,43776,12228608,422912,36544,5936,22416,0,0,0,10,0,4294967295,1,18432,1049336022,3584,1032192,1146880,1261568,1089536,1204224,1318912,1548288,301056,326144,351232,376320,7905280,7913472,7921664,7909376,7917568,7925760,7942144,7970816,7972864,7974912,7976960,1355264,1355392,1107712
.long 1536,1664,57344,172032,2007040,2093056,8765440,8912896,8766464,8913920,8769536,8916992,8770560,8918016,804352,28672,90112,90368,92160,92416,229376,0,0,0,0,0,3023360,3109376,3195392,0,49152,0,6848,15040,688,25760,148480,38272,37888,3711488,43008,11790336,630784,38400,6672,23056,0,0,0,10,0,4294967295,1,0,1049336022,3584,0,114688,229376,57344,172032,286720,1376256,0,25088,50176,75264,9011200,9019392,9027584,9015296,9023488,9031680,9109504,9125888,9127936,9129984,9132032,503296,503424,731904
.long 116224,116352,57344,172032,2095104,2009088,8914944,8767488,8915968,8768512,8919040,8771584,8920064,8772608,1005056,28672,90624,90880,92672,92928,229376,0,0,0,0,0,3281408,3367424,3453440,12288,59392,6144,6856,15048,688,25768,148992,38288,37888,3797504,43264,11937792,637952,38464,6768,23184,0,0,0,10,0,4294967295,1,6144,1049336022,3584,344064,458752,573440,401408,516096,630784,1433600,100352,125440,150528,175616,9035776,9043968,9052160,9039872,9048064,9056256,9113600,9134080,9136128,9138176,9140224,553472,553600,742656
.long 1536,1664,57344,172032,2179072,2265088,9061376,9208832,9060352,9207808,9065472,9212928,9064448,9211904,1205760,28672,90368,90112,92416,92160,229376,0,0,0,0,0,3539456,3625472,3711488,24576,69632,12288,6864,15056,688,25776,148488,38304,38400,3883520,43520,12085248,645120,38528,6864,23312,0,0,0,10,0,4294967295,1,12288,1049336022,3584,688128,802816,917504,745472,860160,974848,1490944,200704,225792,250880,275968,9060352,9068544,9076736,9064448,9072640,9080832,9117696,9142272,9144320,9146368,9148416,503296,503424,753408
.long 116224,116352,57344,172032,2267136,2181120,9210880,9063424,9209856,9062400,9214976,9067520,9213952,9066496,1406464,28672,90880,90624,92928,92672,229376,0,0,0,0,0,3797504,3883520,3969536,36864,79872,18432,6872,15064,688,25784,149000,38320,38400,3969536,43776,12232704,652288,38592,6960,23440,0,0,0,10,0,4294967295,1,18432,1049336022,3584,1032192,1146880,1261568,1089536,1204224,1318912,1548288,301056,326144,351232,376320,9084928,9093120,9101312,9089024,9097216,9105408,9121792,9150464,9152512,9154560,9156608,553472,553600,764160
.long 1536,1664,57344,172032,4759552,4845568,13484032,13631488,13485056,13632512,13488128,13635584,13489152,13636608,1536,28672,90112,90368,92160,92416,229376,0,0,0,0,0,3026944,3112960,3198976,0,49152,0,10944,19136,1712,25824,147456,46464,46080,3715072,43008,11794432,860160,40448,7696,24080,0,0,0,10,0,4294967295,1,0,1049336022,3584,0,114688,229376,57344,172032,286720,1376256,0,25088,50176,75264,10190848,10199040,10207232,10194944,10203136,10211328,10289152,10305536,10307584,10309632,10311680,1306112,1306240,1075968
.long 116224,116352,57344,172032,4847616,4761600,13633536,13486080,13634560,13487104,13637632,13490176,13638656,13491200,202240,28672,90624,90880,92672,92928,229376,0,0,0,0,0,3284992,3371008,3457024,12288,59392,6144,10952,19144,1712,25832,147968,46480,46080,3801088,43264,11941888,867328,40512,7792,24208,0,0,0,10,0,4294967295,1,6144,1049336022,3584,344064,458752,573440,401408,516096,630784,1433600,100352,125440,150528,175616,10215424,10223616,10231808,10219520,10227712,10235904,10293248,10313728,10315776,10317824,10319872,1356288,1356416,1086720
.long 1536,1664,57344,172032,4931584,5017600,13779968,13927424,13778944,13926400,13784064,13931520,13783040,13930496,402944,28672,90368,90112,92416,92160,229376,0,0,0,0,0,3543040,3629056,3715072,24576,69632,12288,10960,19152,1712,25840,147464,46496,46592,3887104,43520,12089344,874496,40576,7888,24336,0,0,0,10,0,4294967295,1,12288,1049336022,3584,688128,802816,917504,745472,860160,974848,1490944,200704,225792,250880,275968,10240000,10248192,10256384,10244096,10252288,10260480,10297344,10321920,10323968,10326016,10328064,1306112,1306240,1097472
.long 116224,116352,57344,172032,5019648,4933632,13929472,13782016,13928448,13780992,13933568,13786112,13932544,13785088,603648,28672,90880,90624,92928,92672,229376,0,0,0,0,0,3801088,3887104,3973120,36864,79872,18432,10968,19160,1712,25848,147976,46512,46592,3973120,43776,12236800,881664,40640,7984,24464,0,0,0,10,0,4294967295,1,18432,1049336022,3584,1032192,1146880,1261568,1089536,1204224,1318912,1548288,301056,326144,351232,376320,10264576,10272768,10280960,10268672,10276864,10285056,10301440,10330112,10332160,10334208,10336256,1356288,1356416,1108224
.long 2560,2688,57344,172032,2023424,2109440,8798208,8945664,8799232,8946688,8802304,8949760,8803328,8950784,805376,28672,106496,106752,108544,108800,229376,0,0,0,0,0,3030528,3116544,3202560,0,49152,0,6976,15168,720,25888,164864,38528,37888,3718656,43008,11798528,1089536,42496,8720,25104,0,0,0,10,0,4294967295,1,0,1065353216,3584,0,114688,229376,57344,172032,286720,1376256,0,25088,50176,75264,11370496,11378688,11386880,11374592,11382784,11390976,11468800,11485184,11487232,11489280,11491328,504320,504448,732416
.long 117248,117376,57344,172032,2111488,2025472,8947712,8800256,8948736,8801280,8951808,8804352,8952832,8805376,1006080,28672,107008,107264,109056,109312,229376,0,0,0,0,0,3288576,3374592,3460608,12288,59392,6144,6984,15176,720,25896,165376,38544,37888,3804672,43264,11945984,1096704,42560,8816,25232,0,0,0,10,0,4294967295,1,6144,1065353216,3584,344064,458752,573440,401408,516096,630784,1433600,100352,125440,150528,175616,11395072,11403264,11411456,11399168,11407360,11415552,11472896,11493376,11495424,11497472,11499520,554496,554624,743168
.long 2560,2688,57344,172032,2195456,2281472,9094144,9241600,9093120,9240576,9098240,9245696,9097216,9244672,1206784,28672,106752,106496,108800,108544,229376,0,0,0,0,0,3546624,3632640,3718656,24576,69632,12288,6992,15184,720,25904,164872,38560,38400,3890688,43520,12093440,1103872,42624,8912,25360,0,0,0,10,0,4294967295,1,12288,1065353216,3584,688128,802816,917504,745472,860160,974848,1490944,200704,225792,250880,275968,11419648,11427840,11436032,11423744,11431936,11440128,11476992,11501568,11503616,11505664,11507712,504320,504448,753920
.long 117248,117376,57344,172032,2283520,2197504,9243648,9096192,9242624,9095168,9247744,9100288,9246720,9099264,1407488,28672,107264,107008,109312,109056,229376,0,0,0,0,0,3804672,3890688,3976704,36864,79872,18432,7000,15192,720,25912,165384,38576,38400,3976704,43776,12240896,1111040,42688,9008,25488,0,0,0,10,0,4294967295,1,18432,1065353216,3584,1032192,1146880,1261568,1089536,1204224,1318912,1548288,301056,326144,351232,376320,11444224,11452416,11460608,11448320,11456512,11464704,11481088,11509760,11511808,11513856,11515904,554496,554624,764672
.long 2560,2688,57344,172032,4775936,4861952,13516800,13664256,13517824,13665280,13520896,13668352,13521920,13669376,2560,28672,106496,106752,108544,108800,229376,0,0,0,0,0,3034112,3120128,3206144,0,49152,0,11072,19264,1744,25952,163840,46720,46080,3722240,43008,11802624,1318912,44544,9744,26128,0,0,0,10,0,4294967295,1,0,1065353216,3584,0,114688,229376,57344,172032,286720,1376256,0,25088,50176,75264,12550144,12558336,12566528,12554240,12562432,12570624,12648448,12664832,12666880,12668928,12670976,1307136,1307264,1076480
.long 117248,117376,57344,172032,4864000,4777984,13666304,13518848,13667328,13519872,13670400,13522944,13671424,13523968,203264,28672,107008,107264,109056,109312,229376,0,0,0,0,0,3292160,3378176,3464192,12288,59392,6144,11080,19272,1744,25960,164352,46736,46080,3808256,43264,11950080,1326080,44608,9840,26256,0,0,0,10,0,4294967295,1,6144,1065353216,3584,344064,458752,573440,401408,516096,630784,1433600,100352,125440,150528,175616,12574720,12582912,12591104,12578816,12587008,12595200,12652544,12673024,12675072,12677120,12679168,1357312,1357440,1087232
.long 2560,2688,57344,172032,4947968,5033984,13812736,13960192,13811712,13959168,13816832,13964288,13815808,13963264,403968,28672,106752,106496,108800,108544,229376,0,0,0,0,0,3550208,3636224,3722240,24576,69632,12288,11088,19280,1744,25968,163848,46752,46592,3894272,43520,12097536,1333248,44672,9936,26384,0,0,0,10,0,4294967295,1,12288,1065353216,3584,688128,802816,917504,745472,860160,974848,1490944,200704,225792,250880,275968,12599296,12607488,12615680,12603392,12611584,12619776,12656640,12681216,12683264,12685312,12687360,1307136,1307264,1097984
.long 117248,117376,57344,172032,5036032,4950016,13962240,13814784,13961216,13813760,13966336,13818880,13965312,13817856,604672,28672,107264,107008,109312,109056,229376,0,0,0,0,0,3808256,3894272,3980288,36864,79872,18432,11096,19288,1744,25976,164360,46768,46592,3980288,43776,12244992,1340416,44736,10032,26512,0,0,0,10,0,4294967295,1,18432,1065353216,3584,1032192,1146880,1261568,1089536,1204224,1318912,1548288,301056,326144,351232,376320,12623872,12632064,12640256,12627968,12636160,12644352,12660736,12689408,12691456,12693504,12695552,1357312,1357440,1108736
.long 2560,3328,43008,129024,2039808,2125824,2064384,2150400,2066432,2152448,8822784,8970240,8823808,8971264,604672,21504,188416,188928,118784,119040,172032,0,0,0,0,0,3037696,3123712,3209728,0,49152,0,2752,15296,752,26016,189440,38784,37888,3725824,43008,11806720,1548288,46592,10768,27152,0,0,0,10,0,4294967295,1,0,1065353216,2688,0,114688,229376,57344,172032,286720,1376256,0,25088,50176,75264,13729792,13737984,13746176,13733888,13742080,13750272,13828096,13844480,13846528,13848576,13850624,378880,505088,732928
.long 88576,118016,43008,129024,2127872,2041856,1073741824,1073741824,1073741824,1073741824,8972288,8824832,8973312,8825856,755200,21504,188416,188928,119296,119552,172032,0,0,0,0,0,3295744,3381760,3467776,12288,59392,6144,2760,15304,752,26024,189952,38800,37888,3811840,43264,11954176,1555456,46656,10864,27280,0,0,0,10,0,4294967295,1,6144,1065353216,2688,344064,458752,573440,401408,516096,630784,1433600,100352,125440,150528,175616,13754368,13762560,13770752,13758464,13766656,13774848,13832192,13852672,13854720,13856768,13858816,416512,555264,743680
.long 2560,3328,43008,129024,2211840,2297856,2238464,2324480,2236416,2322432,9118720,9266176,9117696,9265152,905728,21504,188928,188416,119040,118784,172032,0,0,0,0,0,3553792,3639808,3725824,24576,69632,12288,2768,15312,752,26032,189448,38816,38400,3897856,43520,12101632,1562624,46720,10960,27408,0,0,0,10,0,4294967295,1,12288,1065353216,2688,688128,802816,917504,745472,860160,974848,1490944,200704,225792,250880,275968,13778944,13787136,13795328,13783040,13791232,13799424,13836288,13860864,13862912,13864960,13867008,378880,505088,754432
.long 88576,118016,43008,129024,2299904,2213888,1073741824,1073741824,1073741824,1073741824,9268224,9120768,9267200,9119744,1056256,21504,188928,188416,119552,119296,172032,0,0,0,0,0,3811840,3897856,3983872,36864,79872,18432,2776,15320,752,26040,189960,38832,38400,3983872,43776,12249088,1569792,46784,11056,27536,0,0,0,10,0,4294967295,1,18432,1065353216,2688,1032192,1146880,1261568,1089536,1204224,1318912,1548288,301056,326144,351232,376320,13803520,13811712,13819904,13807616,13815808,13824000,13840384,13869056,13871104,13873152,13875200,416512,555264,765184
.long 2560,3328,43008,129024,4792320,4878336,4816896,4902912,4818944,4904960,13541376,13688832,13542400,13689856,2560,21504,188416,188928,118784,119040,172032,0,0,0,0,0,3041280,3127296,3213312,0,49152,0,3776,19392,1776,26080,188416,46976,46080,3729408,43008,11810816,1777664,48640,11792,28176,0,0,0,10,0,4294967295,1,0,1065353216,2688,0,114688,229376,57344,172032,286720,1376256,0,25088,50176,75264,14909440,14917632,14925824,14913536,14921728,14929920,15007744,15024128,15026176,15028224,15030272,980992,1307904,1076992
.long 88576,118016,43008,129024,4880384,4794368,1073741824,1073741824,1073741824,1073741824,13690880,13543424,13691904,13544448,153088,21504,188416,188928,119296,119552,172032,0,0,0,0,0,3299328,3385344,3471360,12288,59392,6144,3784,19400,1776,26088,188928,46992,46080,3815424,43264,11958272,1784832,48704,11888,28304,0,0,0,10,0,4294967295,1,6144,1065353216,2688,344064,458752,573440,401408,516096,630784,1433600,100352,125440,150528,175616,14934016,14942208,14950400,14938112,14946304,14954496,15011840,15032320,15034368,15036416,15038464,1018624,1358080,1087744
.long 2560,3328,43008,129024,4964352,5050368,4990976,5076992,4988928,5074944,13837312,13984768,13836288,13983744,303616,21504,188928,188416,119040,118784,172032,0,0,0,0,0,3557376,3643392,3729408,24576,69632,12288,3792,19408,1776,26096,188424,47008,46592,3901440,43520,12105728,1792000,48768,11984,28432,0,0,0,10,0,4294967295,1,12288,1065353216,2688,688128,802816,917504,745472,860160,974848,1490944,200704,225792,250880,275968,14958592,14966784,14974976,14962688,14970880,14979072,15015936,15040512,15042560,15044608,15046656,980992,1307904,1098496
.long 88576,118016,43008,129024,5052416,4966400,1073741824,1073741824,1073741824,1073741824,13986816,13839360,13985792,13838336,454144,21504,188928,188416,119552,119296,172032,0,0,0,0,0,3815424,3901440,3987456,36864,79872,18432,3800,19416,1776,26104,188936,47024,46592,3987456,43776,12253184,1799168,48832,12080,28560,0,0,0,10,0,4294967295,1,18432,1065353216,2688,1032192,1146880,1261568,1089536,1204224,1318912,1548288,301056,326144,351232,376320,14983168,14991360,14999552,14987264,14995456,15003648,15020032,15048704,15050752,15052800,15054848,1018624,1358080,1109248
.long 512,640,57344,172032,2334720,2420736,9322496,9469952,9323520,9470976,9326592,9474048,9327616,9475072,803456,28672,73728,73984,75776,76032,229376,0,0,0,0,0,3358720,3444736,3530752,0,49152,0,7232,15424,784,26112,76800,39040,38912,4046848,44032,12369920,172160,34304,4624,21008,0,0,0,11,4294967295,0,0,1544,1049336022,3584,128,114816,229504,57472,172160,286848,1376384,128,25216,50304,75392,6651904,6660096,6668288,6656000,6664192,6672384,6750208,6766592,6768640,6770688,6772736,602624,602752,774400
.long 115200,115328,57344,172032,2422784,2336768,9472000,9324544,9473024,9325568,9476096,9328640,9477120,9329664,1004160,28672,74240,74496,76288,76544,229376,0,0,0,0,0,3616768,3702784,3788800,12288,59392,6144,7240,15432,784,26120,77312,39056,38912,4132864,44288,12517376,179328,34368,4720,21136,0,0,0,11,4294967295,0,0,7688,1049336022,3584,344192,458880,573568,401536,516224,630912,1433728,100480,125568,150656,175744,6676480,6684672,6692864,6680576,6688768,6696960,6754304,6774784,6776832,6778880,6780928,652800,652928,785152
.long 512,640,57344,172032,2506752,2592768,9618432,9765888,9617408,9764864,9622528,9769984,9621504,9768960,1204864,28672,73984,73728,76032,75776,229376,0,0,0,0,0,3874816,3960832,4046848,24576,69632,12288,7248,15440,784,26128,76808,39072,39424,4218880,44544,12664832,186496,34432,4816,21264,0,0,0,11,4294967295,0,0,13832,1049336022,3584,688256,802944,917632,745600,860288,974976,1491072,200832,225920,251008,276096,6701056,6709248,6717440,6705152,6713344,6721536,6758400,6782976,6785024,6787072,6789120,602624,602752,795904
.long 115200,115328,57344,172032,2594816,2508800,9767936,9620480,9766912,9619456,9772032,9624576,9771008,9623552,1405568,28672,74496,74240,76544,76288,229376,0,0,0,0,0,4132864,4218880,4304896,36864,79872,18432,7256,15448,784,26136,77320,39088,39424,4304896,44800,12812288,193664,34496,4912,21392,0,0,0,11,4294967295,0,0,19976,1049336022,3584,1032320,1147008,1261696,1089664,1204352,1319040,1548416,301184,326272,351360,376448,6725632,6733824,6742016,6729728,6737920,6746112,6762496,6791168,6793216,6795264,6797312,652800,652928,806656
.long 512,640,57344,172032,5087232,5173248,14041088,14188544,14042112,14189568,14045184,14192640,14046208,14193664,640,28672,73728,73984,75776,76032,229376,0,0,0,0,0,3362304,3448320,3534336,0,49152,0,11328,19520,1808,26176,75776,47232,47104,4050432,44032,12374016,401536,36352,5648,22032,0,0,0,11,4294967295,0,0,1544,1049336022,3584,128,114816,229504,57472,172160,286848,1376384,128,25216,50304,75392,7831552,7839744,7847936,7835648,7843840,7852032,7929856,7946240,7948288,7950336,7952384,1405440,1405568,1118464
.long 115200,115328,57344,172032,5175296,5089280,14190592,14043136,14191616,14044160,14194688,14047232,14195712,14048256,201344,28672,74240,74496,76288,76544,229376,0,0,0,0,0,3620352,3706368,3792384,12288,59392,6144,11336,19528,1808,26184,76288,47248,47104,4136448,44288,12521472,408704,36416,5744,22160,0,0,0,11,4294967295,0,0,7688,1049336022,3584,344192,458880,573568,401536,516224,630912,1433728,100480,125568,150656,175744,7856128,7864320,7872512,7860224,7868416,7876608,7933952,7954432,7956480,7958528,7960576,1455616,1455744,1129216
.long 512,640,57344,172032,5259264,5345280,14337024,14484480,14336000,14483456,14341120,14488576,14340096,14487552,402048,28672,73984,73728,76032,75776,229376,0,0,0,0,0,3878400,3964416,4050432,24576,69632,12288,11344,19536,1808,26192,75784,47264,47616,4222464,44544,12668928,415872,36480,5840,22288,0,0,0,11,4294967295,0,0,13832,1049336022,3584,688256,802944,917632,745600,860288,974976,1491072,200832,225920,251008,276096,7880704,7888896,7897088,7884800,7892992,7901184,7938048,7962624,7964672,7966720,7968768,1405440,1405568,1139968
.long 115200,115328,57344,172032,5347328,5261312,14486528,14339072,14485504,14338048,14490624,14343168,14489600,14342144,602752,28672,74496,74240,76544,76288,229376,0,0,0,0,0,4136448,4222464,4308480,36864,79872,18432,11352,19544,1808,26200,76296,47280,47616,4308480,44800,12816384,423040,36544,5936,22416,0,0,0,11,4294967295,0,0,19976,1049336022,3584,1032320,1147008,1261696,1089664,1204352,1319040,1548416,301184,326272,351360,376448,7905280,7913472,7921664,7909376,7917568,7925760,7942144,7970816,7972864,7974912,7976960,1455616,1455744,1150720
.long 1536,1664,57344,172032,2351104,2437120,9355264,9502720,9356288,9503744,9359360,9506816,9360384,9507840,804480,28672,90112,90368,92160,92416,229376,0,0,0,0,0,3365888,3451904,3537920,0,49152,0,7360,15552,816,26240,93184,39296,38912,4054016,44032,12378112,630912,38400,6672,23056,0,0,0,11,4294967295,0,0,1544,1049336022,3584,128,114816,229504,57472,172160,286848,1376384,128,25216,50304,75392,9011200,9019392,9027584,9015296,9023488,9031680,9109504,9125888,9127936,9129984,9132032,603648,603776,774912
.long 116224,116352,57344,172032,2439168,2353152,9504768,9357312,9505792,9358336,9508864,9361408,9509888,9362432,1005184,28672,90624,90880,92672,92928,229376,0,0,0,0,0,3623936,3709952,3795968,12288,59392,6144,7368,15560,816,26248,93696,39312,38912,4140032,44288,12525568,638080,38464,6768,23184,0,0,0,11,4294967295,0,0,7688,1049336022,3584,344192,458880,573568,401536,516224,630912,1433728,100480,125568,150656,175744,9035776,9043968,9052160,9039872,9048064,9056256,9113600,9134080,9136128,9138176,9140224,653824,653952,785664
.long 1536,1664,57344,172032,2523136,2609152,9651200,9798656,9650176,9797632,9655296,9802752,9654272,9801728,1205888,28672,90368,90112,92416,92160,229376,0,0,0,0,0,3881984,3968000,4054016,24576,69632,12288,7376,15568,816,26256,93192,39328,39424,4226048,44544,12673024,645248,38528,6864,23312,0,0,0,11,4294967295,0,0,13832,1049336022,3584,688256,802944,917632,745600,860288,974976,1491072,200832,225920,251008,276096,9060352,9068544,9076736,9064448,9072640,9080832,9117696,9142272,9144320,9146368,9148416,603648,603776,796416
.long 116224,116352,57344,172032,2611200,2525184,9800704,9653248,9799680,9652224,9804800,9657344,9803776,9656320,1406592,28672,90880,90624,92928,92672,229376,0,0,0,0,0,4140032,4226048,4312064,36864,79872,18432,7384,15576,816,26264,93704,39344,39424,4312064,44800,12820480,652416,38592,6960,23440,0,0,0,11,4294967295,0,0,19976,1049336022,3584,1032320,1147008,1261696,1089664,1204352,1319040,1548416,301184,326272,351360,376448,9084928,9093120,9101312,9089024,9097216,9105408,9121792,9150464,9152512,9154560,9156608,653824,653952,807168
.long 1536,1664,57344,172032,5103616,5189632,14073856,14221312,14074880,14222336,14077952,14225408,14078976,14226432,1664,28672,90112,90368,92160,92416,229376,0,0,0,0,0,3369472,3455488,3541504,0,49152,0,11456,19648,1840,26304,92160,47488,47104,4057600,44032,12382208,860288,40448,7696,24080,0,0,0,11,4294967295,0,0,1544,1049336022,3584,128,114816,229504,57472,172160,286848,1376384,128,25216,50304,75392,10190848,10199040,10207232,10194944,10203136,10211328,10289152,10305536,10307584,10309632,10311680,1406464,1406592,1118976
.long 116224,116352,57344,172032,5191680,5105664,14223360,14075904,14224384,14076928,14227456,14080000,14228480,14081024,202368,28672,90624,90880,92672,92928,229376,0,0,0,0,0,3627520,3713536,3799552,12288,59392,6144,11464,19656,1840,26312,92672,47504,47104,4143616,44288,12529664,867456,40512,7792,24208,0,0,0,11,4294967295,0,0,7688,1049336022,3584,344192,458880,573568,401536,516224,630912,1433728,100480,125568,150656,175744,10215424,10223616,10231808,10219520,10227712,10235904,10293248,10313728,10315776,10317824,10319872,1456640,1456768,1129728
.long 1536,1664,57344,172032,5275648,5361664,14369792,14517248,14368768,14516224,14373888,14521344,14372864,14520320,403072,28672,90368,90112,92416,92160,229376,0,0,0,0,0,3885568,3971584,4057600,24576,69632,12288,11472,19664,1840,26320,92168,47520,47616,4229632,44544,12677120,874624,40576,7888,24336,0,0,0,11,4294967295,0,0,13832,1049336022,3584,688256,802944,917632,745600,860288,974976,1491072,200832,225920,251008,276096,10240000,10248192,10256384,10244096,10252288,10260480,10297344,10321920,10323968,10326016,10328064,1406464,1406592,1140480
.long 116224,116352,57344,172032,5363712,5277696,14519296,14371840,14518272,14370816,14523392,14375936,14522368,14374912,603776,28672,90880,90624,92928,92672,229376,0,0,0,0,0,4143616,4229632,4315648,36864,79872,18432,11480,19672,1840,26328,92680,47536,47616,4315648,44800,12824576,881792,40640,7984,24464,0,0,0,11,4294967295,0,0,19976,1049336022,3584,1032320,1147008,1261696,1089664,1204352,1319040,1548416,301184,326272,351360,376448,10264576,10272768,10280960,10268672,10276864,10285056,10301440,10330112,10332160,10334208,10336256,1456640,1456768,1151232
.long 2560,2688,57344,172032,2367488,2453504,9388032,9535488,9389056,9536512,9392128,9539584,9393152,9540608,805504,28672,106496,106752,108544,108800,229376,0,0,0,0,0,3373056,3459072,3545088,0,49152,0,7488,15680,848,26368,109568,39552,38912,4061184,44032,12386304,1089664,42496,8720,25104,0,0,0,11,4294967295,0,0,1544,1065353216,3584,128,114816,229504,57472,172160,286848,1376384,128,25216,50304,75392,11370496,11378688,11386880,11374592,11382784,11390976,11468800,11485184,11487232,11489280,11491328,604672,604800,775424
.long 117248,117376,57344,172032,2455552,2369536,9537536,9390080,9538560,9391104,9541632,9394176,9542656,9395200,1006208,28672,107008,107264,109056,109312,229376,0,0,0,0,0,3631104,3717120,3803136,12288,59392,6144,7496,15688,848,26376,110080,39568,38912,4147200,44288,12533760,1096832,42560,8816,25232,0,0,0,11,4294967295,0,0,7688,1065353216,3584,344192,458880,573568,401536,516224,630912,1433728,100480,125568,150656,175744,11395072,11403264,11411456,11399168,11407360,11415552,11472896,11493376,11495424,11497472,11499520,654848,654976,786176
.long 2560,2688,57344,172032,2539520,2625536,9683968,9831424,9682944,9830400,9688064,9835520,9687040,9834496,1206912,28672,106752,106496,108800,108544,229376,0,0,0,0,0,3889152,3975168,4061184,24576,69632,12288,7504,15696,848,26384,109576,39584,39424,4233216,44544,12681216,1104000,42624,8912,25360,0,0,0,11,4294967295,0,0,13832,1065353216,3584,688256,802944,917632,745600,860288,974976,1491072,200832,225920,251008,276096,11419648,11427840,11436032,11423744,11431936,11440128,11476992,11501568,11503616,11505664,11507712,604672,604800,796928
.long 117248,117376,57344,172032,2627584,2541568,9833472,9686016,9832448,9684992,9837568,9690112,9836544,9689088,1407616,28672,107264,107008,109312,109056,229376,0,0,0,0,0,4147200,4233216,4319232,36864,79872,18432,7512,15704,848,26392,110088,39600,39424,4319232,44800,12828672,1111168,42688,9008,25488,0,0,0,11,4294967295,0,0,19976,1065353216,3584,1032320,1147008,1261696,1089664,1204352,1319040,1548416,301184,326272,351360,376448,11444224,11452416,11460608,11448320,11456512,11464704,11481088,11509760,11511808,11513856,11515904,654848,654976,807680
.long 2560,2688,57344,172032,5120000,5206016,14106624,14254080,14107648,14255104,14110720,14258176,14111744,14259200,2688,28672,106496,106752,108544,108800,229376,0,0,0,0,0,3376640,3462656,3548672,0,49152,0,11584,19776,1872,26432,108544,47744,47104,4064768,44032,12390400,1319040,44544,9744,26128,0,0,0,11,4294967295,0,0,1544,1065353216,3584,128,114816,229504,57472,172160,286848,1376384,128,25216,50304,75392,12550144,12558336,12566528,12554240,12562432,12570624,12648448,12664832,12666880,12668928,12670976,1407488,1407616,1119488
.long 117248,117376,57344,172032,5208064,5122048,14256128,14108672,14257152,14109696,14260224,14112768,14261248,14113792,203392,28672,107008,107264,109056,109312,229376,0,0,0,0,0,3634688,3720704,3806720,12288,59392,6144,11592,19784,1872,26440,109056,47760,47104,4150784,44288,12537856,1326208,44608,9840,26256,0,0,0,11,4294967295,0,0,7688,1065353216,3584,344192,458880,573568,401536,516224,630912,1433728,100480,125568,150656,175744,12574720,12582912,12591104,12578816,12587008,12595200,12652544,12673024,12675072,12677120,12679168,1457664,1457792,1130240
.long 2560,2688,57344,172032,5292032,5378048,14402560,14550016,14401536,14548992,14406656,14554112,14405632,14553088,404096,28672,106752,106496,108800,108544,229376,0,0,0,0,0,3892736,3978752,4064768,24576,69632,12288,11600,19792,1872,26448,108552,47776,47616,4236800,44544,12685312,1333376,44672,9936,26384,0,0,0,11,4294967295,0,0,13832,1065353216,3584,688256,802944,917632,745600,860288,974976,1491072,200832,225920,251008,276096,12599296,12607488,12615680,12603392,12611584,12619776,12656640,12681216,12683264,12685312,12687360,1407488,1407616,1140992
.long 117248,117376,57344,172032,5380096,5294080,14552064,14404608,14551040,14403584,14556160,14408704,14555136,14407680,604800,28672,107264,107008,109312,109056,229376,0,0,0,0,0,4150784,4236800,4322816,36864,79872,18432,11608,19800,1872,26456,109064,47792,47616,4322816,44800,12832768,1340544,44736,10032,26512,0,0,0,11,4294967295,0,0,19976,1065353216,3584,1032320,1147008,1261696,1089664,1204352,1319040,1548416,301184,326272,351360,376448,12623872,12632064,12640256,12627968,12636160,12644352,12660736,12689408,12691456,12693504,12695552,1457664,1457792,1151744
.long 2560,3328,43008,129024,2383872,2469888,2408448,2494464,2410496,2496512,9412608,9560064,9413632,9561088,806144,28672,188416,188928,118784,119040,172032,0,0,0,0,0,3380224,3466240,3552256,0,49152,0,2880,15808,880,26496,119808,39808,38912,4068352,44032,12394496,1548416,46592,10768,27152,0,0,0,11,4294967295,0,0,1544,1065353216,2688,128,114816,229504,57472,172160,286848,1376384,128,25216,50304,75392,13729792,13737984,13746176,13733888,13742080,13750272,13828096,13844480,13846528,13848576,13850624,454144,605440,775936
.long 88576,118016,43008,129024,2471936,2385920,1073741824,1073741824,1073741824,1073741824,9562112,9414656,9563136,9415680,1006848,28672,188416,188928,119296,119552,172032,0,0,0,0,0,3638272,3724288,3810304,12288,59392,6144,2888,15816,880,26504,120320,39824,38912,4154368,44288,12541952,1555584,46656,10864,27280,0,0,0,11,4294967295,0,0,7688,1065353216,2688,344192,458880,573568,401536,516224,630912,1433728,100480,125568,150656,175744,13754368,13762560,13770752,13758464,13766656,13774848,13832192,13852672,13854720,13856768,13858816,491776,655616,786688
.long 2560,3328,43008,129024,2555904,2641920,2582528,2668544,2580480,2666496,9708544,9856000,9707520,9854976,1207552,28672,188928,188416,119040,118784,172032,0,0,0,0,0,3896320,3982336,4068352,24576,69632,12288,2896,15824,880,26512,119816,39840,39424,4240384,44544,12689408,1562752,46720,10960,27408,0,0,0,11,4294967295,0,0,13832,1065353216,2688,688256,802944,917632,745600,860288,974976,1491072,200832,225920,251008,276096,13778944,13787136,13795328,13783040,13791232,13799424,13836288,13860864,13862912,13864960,13867008,454144,605440,797440
.long 88576,118016,43008,129024,2643968,2557952,1073741824,1073741824,1073741824,1073741824,9858048,9710592,9857024,9709568,1408256,28672,188928,188416,119552,119296,172032,0,0,0,0,0,4154368,4240384,4326400,36864,79872,18432,2904,15832,880,26520,120328,39856,39424,4326400,44800,12836864,1569920,46784,11056,27536,0,0,0,11,4294967295,0,0,19976,1065353216,2688,1032320,1147008,1261696,1089664,1204352,1319040,1548416,301184,326272,351360,376448,13803520,13811712,13819904,13807616,13815808,13824000,13840384,13869056,13871104,13873152,13875200,491776,655616,808192
.long 2560,3328,43008,129024,5136384,5222400,5160960,5246976,5163008,5249024,14131200,14278656,14132224,14279680,3328,28672,188416,188928,118784,119040,172032,0,0,0,0,0,3383808,3469824,3555840,0,49152,0,3904,19904,1904,26560,118784,48000,47104,4071936,44032,12398592,1777792,48640,11792,28176,0,0,0,11,4294967295,0,0,1544,1065353216,2688,128,114816,229504,57472,172160,286848,1376384,128,25216,50304,75392,14909440,14917632,14925824,14913536,14921728,14929920,15007744,15024128,15026176,15028224,15030272,1056256,1408256,1120000
.long 88576,118016,43008,129024,5224448,5138432,1073741824,1073741824,1073741824,1073741824,14280704,14133248,14281728,14134272,204032,28672,188416,188928,119296,119552,172032,0,0,0,0,0,3641856,3727872,3813888,12288,59392,6144,3912,19912,1904,26568,119296,48016,47104,4157952,44288,12546048,1784960,48704,11888,28304,0,0,0,11,4294967295,0,0,7688,1065353216,2688,344192,458880,573568,401536,516224,630912,1433728,100480,125568,150656,175744,14934016,14942208,14950400,14938112,14946304,14954496,15011840,15032320,15034368,15036416,15038464,1093888,1458432,1130752
.long 2560,3328,43008,129024,5308416,5394432,5335040,5421056,5332992,5419008,14427136,14574592,14426112,14573568,404736,28672,188928,188416,119040,118784,172032,0,0,0,0,0,3899904,3985920,4071936,24576,69632,12288,3920,19920,1904,26576,118792,48032,47616,4243968,44544,12693504,1792128,48768,11984,28432,0,0,0,11,4294967295,0,0,13832,1065353216,2688,688256,802944,917632,745600,860288,974976,1491072,200832,225920,251008,276096,14958592,14966784,14974976,14962688,14970880,14979072,15015936,15040512,15042560,15044608,15046656,1056256,1408256,1141504
.long 88576,118016,43008,129024,5396480,5310464,1073741824,1073741824,1073741824,1073741824,14576640,14429184,14575616,14428160,605440,28672,188928,188416,119552,119296,172032,0,0,0,0,0,4157952,4243968,4329984,36864,79872,18432,3928,19928,1904,26584,119304,48048,47616,4329984,44800,12840960,1799296,48832,12080,28560,0,0,0,11,4294967295,0,0,19976,1065353216,2688,1032320,1147008,1261696,1089664,1204352,1319040,1548416,301184,326272,351360,376448,14983168,14991360,14999552,14987264,14995456,15003648,15020032,15048704,15050752,15052800,15054848,1093888,1458432,1152256
.long 512,640,57344,172032,2678784,2764800,9912320,10059776,9913344,10060800,9916416,10063872,9917440,10064896,803456,28672,73728,73984,75776,76032,229376,0,0,0,0,0,3360256,3446272,3532288,0,49152,0,7744,15936,912,26144,134144,40064,39936,4048384,44032,12371968,172288,34304,4624,21008,0,0,0,11,0,4294967295,1,0,1049336022,3584,256,114944,229632,57600,172288,286976,1376512,256,25344,50432,75520,6651904,6660096,6668288,6656000,6664192,6672384,6750208,6766592,6768640,6770688,6772736,702976,703104,817408
.long 115200,115328,57344,172032,2766848,2680832,10061824,9914368,10062848,9915392,10065920,9918464,10066944,9919488,1004160,28672,74240,74496,76288,76544,229376,0,0,0,0,0,3618304,3704320,3790336,12288,59392,6144,7752,15944,912,26152,134656,40080,39936,4134400,44288,12519424,179456,34368,4720,21136,0,0,0,11,0,4294967295,1,6144,1049336022,3584,344320,459008,573696,401664,516352,631040,1433856,100608,125696,150784,175872,6676480,6684672,6692864,6680576,6688768,6696960,6754304,6774784,6776832,6778880,6780928,753152,753280,828160
.long 512,640,57344,172032,2850816,2936832,10208256,10355712,10207232,10354688,10212352,10359808,10211328,10358784,1204864,28672,73984,73728,76032,75776,229376,0,0,0,0,0,3876352,3962368,4048384,24576,69632,12288,7760,15952,912,26160,134152,40096,40448,4220416,44544,12666880,186624,34432,4816,21264,0,0,0,11,0,4294967295,1,12288,1049336022,3584,688384,803072,917760,745728,860416,975104,1491200,200960,226048,251136,276224,6701056,6709248,6717440,6705152,6713344,6721536,6758400,6782976,6785024,6787072,6789120,702976,703104,838912
.long 115200,115328,57344,172032,2938880,2852864,10357760,10210304,10356736,10209280,10361856,10214400,10360832,10213376,1405568,28672,74496,74240,76544,76288,229376,0,0,0,0,0,4134400,4220416,4306432,36864,79872,18432,7768,15960,912,26168,134664,40112,40448,4306432,44800,12814336,193792,34496,4912,21392,0,0,0,11,0,4294967295,1,18432,1049336022,3584,1032448,1147136,1261824,1089792,1204480,1319168,1548544,301312,326400,351488,376576,6725632,6733824,6742016,6729728,6737920,6746112,6762496,6791168,6793216,6795264,6797312,753152,753280,849664
.long 512,640,57344,172032,5431296,5517312,14630912,14778368,14631936,14779392,14635008,14782464,14636032,14783488,640,28672,73728,73984,75776,76032,229376,0,0,0,0,0,3363840,3449856,3535872,0,49152,0,11840,20032,1936,26208,133120,48256,48128,4051968,44032,12376064,401664,36352,5648,22032,0,0,0,11,0,4294967295,1,0,1049336022,3584,256,114944,229632,57600,172288,286976,1376512,256,25344,50432,75520,7831552,7839744,7847936,7835648,7843840,7852032,7929856,7946240,7948288,7950336,7952384,1505792,1505920,1161472
.long 115200,115328,57344,172032,5519360,5433344,14780416,14632960,14781440,14633984,14784512,14637056,14785536,14638080,201344,28672,74240,74496,76288,76544,229376,0,0,0,0,0,3621888,3707904,3793920,12288,59392,6144,11848,20040,1936,26216,133632,48272,48128,4137984,44288,12523520,408832,36416,5744,22160,0,0,0,11,0,4294967295,1,6144,1049336022,3584,344320,459008,573696,401664,516352,631040,1433856,100608,125696,150784,175872,7856128,7864320,7872512,7860224,7868416,7876608,7933952,7954432,7956480,7958528,7960576,1555968,1556096,1172224
.long 512,640,57344,172032,5603328,5689344,14926848,15074304,14925824,15073280,14930944,15078400,14929920,15077376,402048,28672,73984,73728,76032,75776,229376,0,0,0,0,0,3879936,3965952,4051968,24576,69632,12288,11856,20048,1936,26224,133128,48288,48640,4224000,44544,12670976,416000,36480,5840,22288,0,0,0,11,0,4294967295,1,12288,1049336022,3584,688384,803072,917760,745728,860416,975104,1491200,200960,226048,251136,276224,7880704,7888896,7897088,7884800,7892992,7901184,7938048,7962624,7964672,7966720,7968768,1505792,1505920,1182976
.long 115200,115328,57344,172032,5691392,5605376,15076352,14928896,15075328,14927872,15080448,14932992,15079424,14931968,602752,28672,74496,74240,76544,76288,229376,0,0,0,0,0,4137984,4224000,4310016,36864,79872,18432,11864,20056,1936,26232,133640,48304,48640,4310016,44800,12818432,423168,36544,5936,22416,0,0,0,11,0,4294967295,1,18432,1049336022,3584,1032448,1147136,1261824,1089792,1204480,1319168,1548544,301312,326400,351488,376576,7905280,7913472,7921664,7909376,7917568,7925760,7942144,7970816,7972864,7974912,7976960,1555968,1556096,1193728
.long 1536,1664,57344,172032,2695168,2781184,9945088,10092544,9946112,10093568,9949184,10096640,9950208,10097664,804480,28672,90112,90368,92160,92416,229376,0,0,0,0,0,3367424,3453440,3539456,0,49152,0,7872,16064,944,26272,150528,40320,39936,4055552,44032,12380160,631040,38400,6672,23056,0,0,0,11,0,4294967295,1,0,1049336022,3584,256,114944,229632,57600,172288,286976,1376512,256,25344,50432,75520,9011200,9019392,9027584,9015296,9023488,9031680,9109504,9125888,9127936,9129984,9132032,704000,704128,817920
.long 116224,116352,57344,172032,2783232,2697216,10094592,9947136,10095616,9948160,10098688,9951232,10099712,9952256,1005184,28672,90624,90880,92672,92928,229376,0,0,0,0,0,3625472,3711488,3797504,12288,59392,6144,7880,16072,944,26280,151040,40336,39936,4141568,44288,12527616,638208,38464,6768,23184,0,0,0,11,0,4294967295,1,6144,1049336022,3584,344320,459008,573696,401664,516352,631040,1433856,100608,125696,150784,175872,9035776,9043968,9052160,9039872,9048064,9056256,9113600,9134080,9136128,9138176,9140224,754176,754304,828672
.long 1536,1664,57344,172032,2867200,2953216,10241024,10388480,10240000,10387456,10245120,10392576,10244096,10391552,1205888,28672,90368,90112,92416,92160,229376,0,0,0,0,0,3883520,3969536,4055552,24576,69632,12288,7888,16080,944,26288,150536,40352,40448,4227584,44544,12675072,645376,38528,6864,23312,0,0,0,11,0,4294967295,1,12288,1049336022,3584,688384,803072,917760,745728,860416,975104,1491200,200960,226048,251136,276224,9060352,9068544,9076736,9064448,9072640,9080832,9117696,9142272,9144320,9146368,9148416,704000,704128,839424
.long 116224,116352,57344,172032,2955264,2869248,10390528,10243072,10389504,10242048,10394624,10247168,10393600,10246144,1406592,28672,90880,90624,92928,92672,229376,0,0,0,0,0,4141568,4227584,4313600,36864,79872,18432,7896,16088,944,26296,151048,40368,40448,4313600,44800,12822528,652544,38592,6960,23440,0,0,0,11,0,4294967295,1,18432,1049336022,3584,1032448,1147136,1261824,1089792,1204480,1319168,1548544,301312,326400,351488,376576,9084928,9093120,9101312,9089024,9097216,9105408,9121792,9150464,9152512,9154560,9156608,754176,754304,850176
.long 1536,1664,57344,172032,5447680,5533696,14663680,14811136,14664704,14812160,14667776,14815232,14668800,14816256,1664,28672,90112,90368,92160,92416,229376,0,0,0,0,0,3371008,3457024,3543040,0,49152,0,11968,20160,1968,26336,149504,48512,48128,4059136,44032,12384256,860416,40448,7696,24080,0,0,0,11,0,4294967295,1,0,1049336022,3584,256,114944,229632,57600,172288,286976,1376512,256,25344,50432,75520,10190848,10199040,10207232,10194944,10203136,10211328,10289152,10305536,10307584,10309632,10311680,1506816,1506944,1161984
.long 116224,116352,57344,172032,5535744,5449728,14813184,14665728,14814208,14666752,14817280,14669824,14818304,14670848,202368,28672,90624,90880,92672,92928,229376,0,0,0,0,0,3629056,3715072,3801088,12288,59392,6144,11976,20168,1968,26344,150016,48528,48128,4145152,44288,12531712,867584,40512,7792,24208,0,0,0,11,0,4294967295,1,6144,1049336022,3584,344320,459008,573696,401664,516352,631040,1433856,100608,125696,150784,175872,10215424,10223616,10231808,10219520,10227712,10235904,10293248,10313728,10315776,10317824,10319872,1556992,1557120,1172736
.long 1536,1664,57344,172032,5619712,5705728,14959616,15107072,14958592,15106048,14963712,15111168,14962688,15110144,403072,28672,90368,90112,92416,92160,229376,0,0,0,0,0,3887104,3973120,4059136,24576,69632,12288,11984,20176,1968,26352,149512,48544,48640,4231168,44544,12679168,874752,40576,7888,24336,0,0,0,11,0,4294967295,1,12288,1049336022,3584,688384,803072,917760,745728,860416,975104,1491200,200960,226048,251136,276224,10240000,10248192,10256384,10244096,10252288,10260480,10297344,10321920,10323968,10326016,10328064,1506816,1506944,1183488
.long 116224,116352,57344,172032,5707776,5621760,15109120,14961664,15108096,14960640,15113216,14965760,15112192,14964736,603776,28672,90880,90624,92928,92672,229376,0,0,0,0,0,4145152,4231168,4317184,36864,79872,18432,11992,20184,1968,26360,150024,48560,48640,4317184,44800,12826624,881920,40640,7984,24464,0,0,0,11,0,4294967295,1,18432,1049336022,3584,1032448,1147136,1261824,1089792,1204480,1319168,1548544,301312,326400,351488,376576,10264576,10272768,10280960,10268672,10276864,10285056,10301440,10330112,10332160,10334208,10336256,1556992,1557120,1194240
.long 2560,2688,57344,172032,2711552,2797568,9977856,10125312,9978880,10126336,9981952,10129408,9982976,10130432,805504,28672,106496,106752,108544,108800,229376,0,0,0,0,0,3374592,3460608,3546624,0,49152,0,8000,16192,976,26400,166912,40576,39936,4062720,44032,12388352,1089792,42496,8720,25104,0,0,0,11,0,4294967295,1,0,1065353216,3584,256,114944,229632,57600,172288,286976,1376512,256,25344,50432,75520,11370496,11378688,11386880,11374592,11382784,11390976,11468800,11485184,11487232,11489280,11491328,705024,705152,818432
.long 117248,117376,57344,172032,2799616,2713600,10127360,9979904,10128384,9980928,10131456,9984000,10132480,9985024,1006208,28672,107008,107264,109056,109312,229376,0,0,0,0,0,3632640,3718656,3804672,12288,59392,6144,8008,16200,976,26408,167424,40592,39936,4148736,44288,12535808,1096960,42560,8816,25232,0,0,0,11,0,4294967295,1,6144,1065353216,3584,344320,459008,573696,401664,516352,631040,1433856,100608,125696,150784,175872,11395072,11403264,11411456,11399168,11407360,11415552,11472896,11493376,11495424,11497472,11499520,755200,755328,829184
.long 2560,2688,57344,172032,2883584,2969600,10273792,10421248,10272768,10420224,10277888,10425344,10276864,10424320,1206912,28672,106752,106496,108800,108544,229376,0,0,0,0,0,3890688,3976704,4062720,24576,69632,12288,8016,16208,976,26416,166920,40608,40448,4234752,44544,12683264,1104128,42624,8912,25360,0,0,0,11,0,4294967295,1,12288,1065353216,3584,688384,803072,917760,745728,860416,975104,1491200,200960,226048,251136,276224,11419648,11427840,11436032,11423744,11431936,11440128,11476992,11501568,11503616,11505664,11507712,705024,705152,839936
.long 117248,117376,57344,172032,2971648,2885632,10423296,10275840,10422272,10274816,10427392,10279936,10426368,10278912,1407616,28672,107264,107008,109312,109056,229376,0,0,0,0,0,4148736,4234752,4320768,36864,79872,18432,8024,16216,976,26424,167432,40624,40448,4320768,44800,12830720,1111296,42688,9008,25488,0,0,0,11,0,4294967295,1,18432,1065353216,3584,1032448,1147136,1261824,1089792,1204480,1319168,1548544,301312,326400,351488,376576,11444224,11452416,11460608,11448320,11456512,11464704,11481088,11509760,11511808,11513856,11515904,755200,755328,850688
.long 2560,2688,57344,172032,5464064,5550080,14696448,14843904,14697472,14844928,14700544,14848000,14701568,14849024,2688,28672,106496,106752,108544,108800,229376,0,0,0,0,0,3378176,3464192,3550208,0,49152,0,12096,20288,2000,26464,165888,48768,48128,4066304,44032,12392448,1319168,44544,9744,26128,0,0,0,11,0,4294967295,1,0,1065353216,3584,256,114944,229632,57600,172288,286976,1376512,256,25344,50432,75520,12550144,12558336,12566528,12554240,12562432,12570624,12648448,12664832,12666880,12668928,12670976,1507840,1507968,1162496
.long 117248,117376,57344,172032,5552128,5466112,14845952,14698496,14846976,14699520,14850048,14702592,14851072,14703616,203392,28672,107008,107264,109056,109312,229376,0,0,0,0,0,3636224,3722240,3808256,12288,59392,6144,12104,20296,2000,26472,166400,48784,48128,4152320,44288,12539904,1326336,44608,9840,26256,0,0,0,11,0,4294967295,1,6144,1065353216,3584,344320,459008,573696,401664,516352,631040,1433856,100608,125696,150784,175872,12574720,12582912,12591104,12578816,12587008,12595200,12652544,12673024,12675072,12677120,12679168,1558016,1558144,1173248
.long 2560,2688,57344,172032,5636096,5722112,14992384,15139840,14991360,15138816,14996480,15143936,14995456,15142912,404096,28672,106752,106496,108800,108544,229376,0,0,0,0,0,3894272,3980288,4066304,24576,69632,12288,12112,20304,2000,26480,165896,48800,48640,4238336,44544,12687360,1333504,44672,9936,26384,0,0,0,11,0,4294967295,1,12288,1065353216,3584,688384,803072,917760,745728,860416,975104,1491200,200960,226048,251136,276224,12599296,12607488,12615680,12603392,12611584,12619776,12656640,12681216,12683264,12685312,12687360,1507840,1507968,1184000
.long 117248,117376,57344,172032,5724160,5638144,15141888,14994432,15140864,14993408,15145984,14998528,15144960,14997504,604800,28672,107264,107008,109312,109056,229376,0,0,0,0,0,4152320,4238336,4324352,36864,79872,18432,12120,20312,2000,26488,166408,48816,48640,4324352,44800,12834816,1340672,44736,10032,26512,0,0,0,11,0,4294967295,1,18432,1065353216,3584,1032448,1147136,1261824,1089792,1204480,1319168,1548544,301312,326400,351488,376576,12623872,12632064,12640256,12627968,12636160,12644352,12660736,12689408,12691456,12693504,12695552,1558016,1558144,1194752
.long 2560,3328,43008,129024,2727936,2813952,2752512,2838528,2754560,2840576,10002432,10149888,10003456,10150912,806144,28672,188416,188928,118784,119040,172032,0,0,0,0,0,3381760,3467776,3553792,0,49152,0,3008,16320,1008,26528,177152,40832,39936,4069888,44032,12396544,1548544,46592,10768,27152,0,0,0,11,0,4294967295,1,0,1065353216,2688,256,114944,229632,57600,172288,286976,1376512,256,25344,50432,75520,13729792,13737984,13746176,13733888,13742080,13750272,13828096,13844480,13846528,13848576,13850624,529408,705792,818944
.long 88576,118016,43008,129024,2816000,2729984,1073741824,1073741824,1073741824,1073741824,10151936,10004480,10152960,10005504,1006848,28672,188416,188928,119296,119552,172032,0,0,0,0,0,3639808,3725824,3811840,12288,59392,6144,3016,16328,1008,26536,177664,40848,39936,4155904,44288,12544000,1555712,46656,10864,27280,0,0,0,11,0,4294967295,1,6144,1065353216,2688,344320,459008,573696,401664,516352,631040,1433856,100608,125696,150784,175872,13754368,13762560,13770752,13758464,13766656,13774848,13832192,13852672,13854720,13856768,13858816,567040,755968,829696
.long 2560,3328,43008,129024,2899968,2985984,2926592,3012608,2924544,3010560,10298368,10445824,10297344,10444800,1207552,28672,188928,188416,119040,118784,172032,0,0,0,0,0,3897856,3983872,4069888,24576,69632,12288,3024,16336,1008,26544,177160,40864,40448,4241920,44544,12691456,1562880,46720,10960,27408,0,0,0,11,0,4294967295,1,12288,1065353216,2688,688384,803072,917760,745728,860416,975104,1491200,200960,226048,251136,276224,13778944,13787136,13795328,13783040,13791232,13799424,13836288,13860864,13862912,13864960,13867008,529408,705792,840448
.long 88576,118016,43008,129024,2988032,2902016,1073741824,1073741824,1073741824,1073741824,10447872,10300416,10446848,10299392,1408256,28672,188928,188416,119552,119296,172032,0,0,0,0,0,4155904,4241920,4327936,36864,79872,18432,3032,16344,1008,26552,177672,40880,40448,4327936,44800,12838912,1570048,46784,11056,27536,0,0,0,11,0,4294967295,1,18432,1065353216,2688,1032448,1147136,1261824,1089792,1204480,1319168,1548544,301312,326400,351488,376576,13803520,13811712,13819904,13807616,13815808,13824000,13840384,13869056,13871104,13873152,13875200,567040,755968,851200
.long 2560,3328,43008,129024,5480448,5566464,5505024,5591040,5507072,5593088,14721024,14868480,14722048,14869504,3328,28672,188416,188928,118784,119040,172032,0,0,0,0,0,3385344,3471360,3557376,0,49152,0,4032,20416,2032,26592,176128,49024,48128,4073472,44032,12400640,1777920,48640,11792,28176,0,0,0,11,0,4294967295,1,0,1065353216,2688,256,114944,229632,57600,172288,286976,1376512,256,25344,50432,75520,14909440,14917632,14925824,14913536,14921728,14929920,15007744,15024128,15026176,15028224,15030272,1131520,1508608,1163008
.long 88576,118016,43008,129024,5568512,5482496,1073741824,1073741824,1073741824,1073741824,14870528,14723072,14871552,14724096,204032,28672,188416,188928,119296,119552,172032,0,0,0,0,0,3643392,3729408,3815424,12288,59392,6144,4040,20424,2032,26600,176640,49040,48128,4159488,44288,12548096,1785088,48704,11888,28304,0,0,0,11,0,4294967295,1,6144,1065353216,2688,344320,459008,573696,401664,516352,631040,1433856,100608,125696,150784,175872,14934016,14942208,14950400,14938112,14946304,14954496,15011840,15032320,15034368,15036416,15038464,1169152,1558784,1173760
.long 2560,3328,43008,129024,5652480,5738496,5679104,5765120,5677056,5763072,15016960,15164416,15015936,15163392,404736,28672,188928,188416,119040,118784,172032,0,0,0,0,0,3901440,3987456,4073472,24576,69632,12288,4048,20432,2032,26608,176136,49056,48640,4245504,44544,12695552,1792256,48768,11984,28432,0,0,0,11,0,4294967295,1,12288,1065353216,2688,688384,803072,917760,745728,860416,975104,1491200,200960,226048,251136,276224,14958592,14966784,14974976,14962688,14970880,14979072,15015936,15040512,15042560,15044608,15046656,1131520,1508608,1184512
.long 88576,118016,43008,129024,5740544,5654528,1073741824,1073741824,1073741824,1073741824,15166464,15019008,15165440,15017984,605440,28672,188928,188416,119552,119296,172032,0,0,0,0,0,4159488,4245504,4331520,36864,79872,18432,4056,20440,2032,26616,176648,49072,48640,4331520,44800,12843008,1799424,48832,12080,28560,0,0,0,11,0,4294967295,1,18432,1065353216,2688,1032448,1147136,1261824,1089792,1204480,1319168,1548544,301312,326400,351488,376576,14983168,14991360,14999552,14987264,14995456,15003648,15020032,15048704,15050752,15052800,15054848,1169152,1558784,1195264
.long 768,896,57344,172032,274432,360448,5791744,5939200,5792768,5940224,5795840,5943296,5796864,5944320,768,28672,77824,78080,79872,80128,229376,0,0,0,0,0,3702784,3788800,3874816,0,49152,0,4192,12384,24,26624,77824,32960,32768,4390912,45056,12959744,172416,34304,4624,21008,0,0,0,12,4294967295,0,0,1544,1049336022,3584,384,115072,229760,57728,172416,287104,1376640,384,25472,50560,75648,6651904,6660096,6668288,6656000,6664192,6672384,6750208,6766592,6768640,6770688,6772736,768,896,516480
.long 115456,115584,57344,172032,362496,276480,5941248,5793792,5942272,5794816,5945344,5797888,5946368,5798912,201472,28672,78336,78592,80384,80640,229376,0,0,0,0,0,3960832,4046848,4132864,12288,59392,6144,4200,12392,24,26632,78336,32976,32768,4476928,45312,13107200,179584,34368,4720,21136,0,0,0,12,4294967295,0,0,7688,1049336022,3584,344448,459136,573824,401792,516480,631168,1433984,100736,125824,150912,176000,6676480,6684672,6692864,6680576,6688768,6696960,6754304,6774784,6776832,6778880,6780928,50944,51072,527232
.long 768,896,57344,172032,446464,532480,6087680,6235136,6086656,6234112,6091776,6239232,6090752,6238208,402176,28672,78080,77824,80128,79872,229376,0,0,0,0,0,4218880,4304896,4390912,24576,69632,12288,4208,12400,24,26640,77832,32992,33280,4562944,45568,13254656,186752,34432,4816,21264,0,0,0,12,4294967295,0,0,13832,1049336022,3584,688512,803200,917888,745856,860544,975232,1491328,201088,226176,251264,276352,6701056,6709248,6717440,6705152,6713344,6721536,6758400,6782976,6785024,6787072,6789120,768,896,537984
.long 115456,115584,57344,172032,534528,448512,6237184,6089728,6236160,6088704,6241280,6093824,6240256,6092800,602880,28672,78592,78336,80640,80384,229376,0,0,0,0,0,4476928,4562944,4648960,36864,79872,18432,4216,12408,24,26648,78344,33008,33280,4648960,45824,13402112,193920,34496,4912,21392,0,0,0,12,4294967295,0,0,19976,1049336022,3584,1032576,1147264,1261952,1089920,1204608,1319296,1548672,301440,326528,351616,376704,6725632,6733824,6742016,6729728,6737920,6746112,6762496,6791168,6793216,6795264,6797312,50944,51072,548736
.long 768,896,57344,172032,3026944,3112960,10510336,10657792,10511360,10658816,10514432,10661888,10515456,10662912,803584,28672,77824,78080,79872,80128,229376,0,0,0,0,0,3706368,3792384,3878400,0,49152,0,8288,16480,1048,26688,78848,41152,40960,4394496,45056,12963840,401792,36352,5648,22032,0,0,0,12,4294967295,0,0,1544,1049336022,3584,384,115072,229760,57728,172416,287104,1376640,384,25472,50560,75648,7831552,7839744,7847936,7835648,7843840,7852032,7929856,7946240,7948288,7950336,7952384,803584,803712,860544
.long 115456,115584,57344,172032,3115008,3028992,10659840,10512384,10660864,10513408,10663936,10516480,10664960,10517504,1004288,28672,78336,78592,80384,80640,229376,0,0,0,0,0,3964416,4050432,4136448,12288,59392,6144,8296,16488,1048,26696,79360,41168,40960,4480512,45312,13111296,408960,36416,5744,22160,0,0,0,12,4294967295,0,0,7688,1049336022,3584,344448,459136,573824,401792,516480,631168,1433984,100736,125824,150912,176000,7856128,7864320,7872512,7860224,7868416,7876608,7933952,7954432,7956480,7958528,7960576,853760,853888,871296
.long 768,896,57344,172032,3198976,3284992,10806272,10953728,10805248,10952704,10810368,10957824,10809344,10956800,1204992,28672,78080,77824,80128,79872,229376,0,0,0,0,0,4222464,4308480,4394496,24576,69632,12288,8304,16496,1048,26704,78856,41184,41472,4566528,45568,13258752,416128,36480,5840,22288,0,0,0,12,4294967295,0,0,13832,1049336022,3584,688512,803200,917888,745856,860544,975232,1491328,201088,226176,251264,276352,7880704,7888896,7897088,7884800,7892992,7901184,7938048,7962624,7964672,7966720,7968768,803584,803712,882048
.long 115456,115584,57344,172032,3287040,3201024,10955776,10808320,10954752,10807296,10959872,10812416,10958848,10811392,1405696,28672,78592,78336,80640,80384,229376,0,0,0,0,0,4480512,4566528,4652544,36864,79872,18432,8312,16504,1048,26712,79368,41200,41472,4652544,45824,13406208,423296,36544,5936,22416,0,0,0,12,4294967295,0,0,19976,1049336022,3584,1032576,1147264,1261952,1089920,1204608,1319296,1548672,301440,326528,351616,376704,7905280,7913472,7921664,7909376,7917568,7925760,7942144,7970816,7972864,7974912,7976960,853760,853888,892800
.long 1792,1920,57344,172032,290816,376832,5824512,5971968,5825536,5972992,5828608,5976064,5829632,5977088,1792,28672,94208,94464,96256,96512,229376,0,0,0,0,0,3709952,3795968,3881984,0,49152,0,4320,12512,56,26752,94208,33216,32768,4398080,45056,12967936,631168,38400,6672,23056,0,0,0,12,4294967295,0,0,1544,1065353216,3584,384,115072,229760,57728,172416,287104,1376640,384,25472,50560,75648,9011200,9019392,9027584,9015296,9023488,9031680,9109504,9125888,9127936,9129984,9132032,1792,1920,516992
.long 116480,116608,57344,172032,378880,292864,5974016,5826560,5975040,5827584,5978112,5830656,5979136,5831680,202496,28672,94720,94976,96768,97024,229376,0,0,0,0,0,3968000,4054016,4140032,12288,59392,6144,4328,12520,56,26760,94720,33232,32768,4484096,45312,13115392,638336,38464,6768,23184,0,0,0,12,4294967295,0,0,7688,1065353216,3584,344448,459136,573824,401792,516480,631168,1433984,100736,125824,150912,176000,9035776,9043968,9052160,9039872,9048064,9056256,9113600,9134080,9136128,9138176,9140224,51968,52096,527744
.long 1792,1920,57344,172032,462848,548864,6120448,6267904,6119424,6266880,6124544,6272000,6123520,6270976,403200,28672,94464,94208,96512,96256,229376,0,0,0,0,0,4226048,4312064,4398080,24576,69632,12288,4336,12528,56,26768,94216,33248,33280,4570112,45568,13262848,645504,38528,6864,23312,0,0,0,12,4294967295,0,0,13832,1065353216,3584,688512,803200,917888,745856,860544,975232,1491328,201088,226176,251264,276352,9060352,9068544,9076736,9064448,9072640,9080832,9117696,9142272,9144320,9146368,9148416,1792,1920,538496
.long 116480,116608,57344,172032,550912,464896,6269952,6122496,6268928,6121472,6274048,6126592,6273024,6125568,603904,28672,94976,94720,97024,96768,229376,0,0,0,0,0,4484096,4570112,4656128,36864,79872,18432,4344,12536,56,26776,94728,33264,33280,4656128,45824,13410304,652672,38592,6960,23440,0,0,0,12,4294967295,0,0,19976,1065353216,3584,1032576,1147264,1261952,1089920,1204608,1319296,1548672,301440,326528,351616,376704,9084928,9093120,9101312,9089024,9097216,9105408,9121792,9150464,9152512,9154560,9156608,51968,52096,549248
.long 1792,1920,57344,172032,3043328,3129344,10543104,10690560,10544128,10691584,10547200,10694656,10548224,10695680,804608,28672,94208,94464,96256,96512,229376,0,0,0,0,0,3713536,3799552,3885568,0,49152,0,8416,16608,1080,26816,95232,41408,40960,4401664,45056,12972032,860544,40448,7696,24080,0,0,0,12,4294967295,0,0,1544,1065353216,3584,384,115072,229760,57728,172416,287104,1376640,384,25472,50560,75648,10190848,10199040,10207232,10194944,10203136,10211328,10289152,10305536,10307584,10309632,10311680,804608,804736,861056
.long 116480,116608,57344,172032,3131392,3045376,10692608,10545152,10693632,10546176,10696704,10549248,10697728,10550272,1005312,28672,94720,94976,96768,97024,229376,0,0,0,0,0,3971584,4057600,4143616,12288,59392,6144,8424,16616,1080,26824,95744,41424,40960,4487680,45312,13119488,867712,40512,7792,24208,0,0,0,12,4294967295,0,0,7688,1065353216,3584,344448,459136,573824,401792,516480,631168,1433984,100736,125824,150912,176000,10215424,10223616,10231808,10219520,10227712,10235904,10293248,10313728,10315776,10317824,10319872,854784,854912,871808
.long 1792,1920,57344,172032,3215360,3301376,10839040,10986496,10838016,10985472,10843136,10990592,10842112,10989568,1206016,28672,94464,94208,96512,96256,229376,0,0,0,0,0,4229632,4315648,4401664,24576,69632,12288,8432,16624,1080,26832,95240,41440,41472,4573696,45568,13266944,874880,40576,7888,24336,0,0,0,12,4294967295,0,0,13832,1065353216,3584,688512,803200,917888,745856,860544,975232,1491328,201088,226176,251264,276352,10240000,10248192,10256384,10244096,10252288,10260480,10297344,10321920,10323968,10326016,10328064,804608,804736,882560
.long 116480,116608,57344,172032,3303424,3217408,10988544,10841088,10987520,10840064,10992640,10845184,10991616,10844160,1406720,28672,94976,94720,97024,96768,229376,0,0,0,0,0,4487680,4573696,4659712,36864,79872,18432,8440,16632,1080,26840,95752,41456,41472,4659712,45824,13414400,882048,40640,7984,24464,0,0,0,12,4294967295,0,0,19976,1065353216,3584,1032576,1147264,1261952,1089920,1204608,1319296,1548672,301440,326528,351616,376704,10264576,10272768,10280960,10268672,10276864,10285056,10301440,10330112,10332160,10334208,10336256,854784,854912,893312
.long 2816,2944,57344,172032,307200,393216,5857280,6004736,5858304,6005760,5861376,6008832,5862400,6009856,2816,28672,110592,110848,112640,112896,229376,0,0,0,0,0,3717120,3803136,3889152,0,49152,0,4448,12640,88,26880,110592,33472,32768,4405248,45056,12976128,1089920,42496,8720,25104,0,0,0,12,4294967295,0,0,1544,1065353216,3584,384,115072,229760,57728,172416,287104,1376640,384,25472,50560,75648,11370496,11378688,11386880,11374592,11382784,11390976,11468800,11485184,11487232,11489280,11491328,2816,2944,517504
.long 117504,117632,57344,172032,395264,309248,6006784,5859328,6007808,5860352,6010880,5863424,6011904,5864448,203520,28672,111104,111360,113152,113408,229376,0,0,0,0,0,3975168,4061184,4147200,12288,59392,6144,4456,12648,88,26888,111104,33488,32768,4491264,45312,13123584,1097088,42560,8816,25232,0,0,0,12,4294967295,0,0,7688,1065353216,3584,344448,459136,573824,401792,516480,631168,1433984,100736,125824,150912,176000,11395072,11403264,11411456,11399168,11407360,11415552,11472896,11493376,11495424,11497472,11499520,52992,53120,528256
.long 2816,2944,57344,172032,479232,565248,6153216,6300672,6152192,6299648,6157312,6304768,6156288,6303744,404224,28672,110848,110592,112896,112640,229376,0,0,0,0,0,4233216,4319232,4405248,24576,69632,12288,4464,12656,88,26896,110600,33504,33280,4577280,45568,13271040,1104256,42624,8912,25360,0,0,0,12,4294967295,0,0,13832,1065353216,3584,688512,803200,917888,745856,860544,975232,1491328,201088,226176,251264,276352,11419648,11427840,11436032,11423744,11431936,11440128,11476992,11501568,11503616,11505664,11507712,2816,2944,539008
.long 117504,117632,57344,172032,567296,481280,6302720,6155264,6301696,6154240,6306816,6159360,6305792,6158336,604928,28672,111360,111104,113408,113152,229376,0,0,0,0,0,4491264,4577280,4663296,36864,79872,18432,4472,12664,88,26904,111112,33520,33280,4663296,45824,13418496,1111424,42688,9008,25488,0,0,0,12,4294967295,0,0,19976,1065353216,3584,1032576,1147264,1261952,1089920,1204608,1319296,1548672,301440,326528,351616,376704,11444224,11452416,11460608,11448320,11456512,11464704,11481088,11509760,11511808,11513856,11515904,52992,53120,549760
.long 2816,2944,57344,172032,3059712,3145728,10575872,10723328,10576896,10724352,10579968,10727424,10580992,10728448,805632,28672,110592,110848,112640,112896,229376,0,0,0,0,0,3720704,3806720,3892736,0,49152,0,8544,16736,1112,26944,111616,41664,40960,4408832,45056,12980224,1319296,44544,9744,26128,0,0,0,12,4294967295,0,0,1544,1065353216,3584,384,115072,229760,57728,172416,287104,1376640,384,25472,50560,75648,12550144,12558336,12566528,12554240,12562432,12570624,12648448,12664832,12666880,12668928,12670976,805632,805760,861568
.long 117504,117632,57344,172032,3147776,3061760,10725376,10577920,10726400,10578944,10729472,10582016,10730496,10583040,1006336,28672,111104,111360,113152,113408,229376,0,0,0,0,0,3978752,4064768,4150784,12288,59392,6144,8552,16744,1112,26952,112128,41680,40960,4494848,45312,13127680,1326464,44608,9840,26256,0,0,0,12,4294967295,0,0,7688,1065353216,3584,344448,459136,573824,401792,516480,631168,1433984,100736,125824,150912,176000,12574720,12582912,12591104,12578816,12587008,12595200,12652544,12673024,12675072,12677120,12679168,855808,855936,872320
.long 2816,2944,57344,172032,3231744,3317760,10871808,11019264,10870784,11018240,10875904,11023360,10874880,11022336,1207040,28672,110848,110592,112896,112640,229376,0,0,0,0,0,4236800,4322816,4408832,24576,69632,12288,8560,16752,1112,26960,111624,41696,41472,4580864,45568,13275136,1333632,44672,9936,26384,0,0,0,12,4294967295,0,0,13832,1065353216,3584,688512,803200,917888,745856,860544,975232,1491328,201088,226176,251264,276352,12599296,12607488,12615680,12603392,12611584,12619776,12656640,12681216,12683264,12685312,12687360,805632,805760,883072
.long 117504,117632,57344,172032,3319808,3233792,11021312,10873856,11020288,10872832,11025408,10877952,11024384,10876928,1407744,28672,111360,111104,113408,113152,229376,0,0,0,0,0,4494848,4580864,4666880,36864,79872,18432,8568,16760,1112,26968,112136,41712,41472,4666880,45824,13422592,1340800,44736,10032,26512,0,0,0,12,4294967295,0,0,19976,1065353216,3584,1032576,1147264,1261952,1089920,1204608,1319296,1548672,301440,326528,351616,376704,12623872,12632064,12640256,12627968,12636160,12644352,12660736,12689408,12691456,12693504,12695552,855808,855936,893824
.long 3456,3456,57344,172032,323584,409600,1073741824,1073741824,1073741824,1073741824,5877760,6025216,5878784,6026240,3456,28672,120832,121088,120832,121088,229376,0,0,0,0,0,3724288,3810304,3896320,0,49152,0,4576,12768,120,27008,120832,33728,32768,4412416,45056,12984320,1548672,46592,10768,27152,0,0,0,12,4294967295,0,0,1544,1065353216,3584,384,115072,229760,57728,172416,287104,1376640,384,25472,50560,75648,13729792,13737984,13746176,13733888,13742080,13750272,13828096,13844480,13846528,13848576,13850624,3456,3456,518016
.long 118144,118144,57344,172032,411648,325632,1073741824,1073741824,1073741824,1073741824,6027264,5879808,6028288,5880832,204160,28672,121344,121600,121344,121600,229376,0,0,0,0,0,3982336,4068352,4154368,12288,59392,6144,4584,12776,120,27016,121344,33744,32768,4498432,45312,13131776,1555840,46656,10864,27280,0,0,0,12,4294967295,0,0,7688,1065353216,3584,344448,459136,573824,401792,516480,631168,1433984,100736,125824,150912,176000,13754368,13762560,13770752,13758464,13766656,13774848,13832192,13852672,13854720,13856768,13858816,53632,53632,528768
.long 3456,3456,57344,172032,495616,581632,1073741824,1073741824,1073741824,1073741824,6173696,6321152,6172672,6320128,404864,28672,121088,120832,121088,120832,229376,0,0,0,0,0,4240384,4326400,4412416,24576,69632,12288,4592,12784,120,27024,120840,33760,33280,4584448,45568,13279232,1563008,46720,10960,27408,0,0,0,12,4294967295,0,0,13832,1065353216,3584,688512,803200,917888,745856,860544,975232,1491328,201088,226176,251264,276352,13778944,13787136,13795328,13783040,13791232,13799424,13836288,13860864,13862912,13864960,13867008,3456,3456,539520
.long 118144,118144,57344,172032,583680,497664,1073741824,1073741824,1073741824,1073741824,6323200,6175744,6322176,6174720,605568,28672,121600,121344,121600,121344,229376,0,0,0,0,0,4498432,4584448,4670464,36864,79872,18432,4600,12792,120,27032,121352,33776,33280,4670464,45824,13426688,1570176,46784,11056,27536,0,0,0,12,4294967295,0,0,19976,1065353216,3584,1032576,1147264,1261952,1089920,1204608,1319296,1548672,301440,326528,351616,376704,13803520,13811712,13819904,13807616,13815808,13824000,13840384,13869056,13871104,13873152,13875200,53632,53632,550272
.long 3456,3456,57344,172032,3076096,3162112,1073741824,1073741824,1073741824,1073741824,10596352,10743808,10597376,10744832,806272,28672,120832,121088,120832,121088,229376,0,0,0,0,0,3727872,3813888,3899904,0,49152,0,8672,16864,1144,27072,121856,41920,40960,4416000,45056,12988416,1778048,48640,11792,28176,0,0,0,12,4294967295,0,0,1544,1065353216,3584,384,115072,229760,57728,172416,287104,1376640,384,25472,50560,75648,14909440,14917632,14925824,14913536,14921728,14929920,15007744,15024128,15026176,15028224,15030272,806272,806272,862080
.long 118144,118144,57344,172032,3164160,3078144,1073741824,1073741824,1073741824,1073741824,10745856,10598400,10746880,10599424,1006976,28672,121344,121600,121344,121600,229376,0,0,0,0,0,3985920,4071936,4157952,12288,59392,6144,8680,16872,1144,27080,122368,41936,40960,4502016,45312,13135872,1785216,48704,11888,28304,0,0,0,12,4294967295,0,0,7688,1065353216,3584,344448,459136,573824,401792,516480,631168,1433984,100736,125824,150912,176000,14934016,14942208,14950400,14938112,14946304,14954496,15011840,15032320,15034368,15036416,15038464,856448,856448,872832
.long 3456,3456,57344,172032,3248128,3334144,1073741824,1073741824,1073741824,1073741824,10892288,11039744,10891264,11038720,1207680,28672,121088,120832,121088,120832,229376,0,0,0,0,0,4243968,4329984,4416000,24576,69632,12288,8688,16880,1144,27088,121864,41952,41472,4588032,45568,13283328,1792384,48768,11984,28432,0,0,0,12,4294967295,0,0,13832,1065353216,3584,688512,803200,917888,745856,860544,975232,1491328,201088,226176,251264,276352,14958592,14966784,14974976,14962688,14970880,14979072,15015936,15040512,15042560,15044608,15046656,806272,806272,883584
.long 118144,118144,57344,172032,3336192,3250176,1073741824,1073741824,1073741824,1073741824,11041792,10894336,11040768,10893312,1408384,28672,121600,121344,121600,121344,229376,0,0,0,0,0,4502016,4588032,4674048,36864,79872,18432,8696,16888,1144,27096,122376,41968,41472,4674048,45824,13430784,1799552,48832,12080,28560,0,0,0,12,4294967295,0,0,19976,1065353216,3584,1032576,1147264,1261952,1089920,1204608,1319296,1548672,301440,326528,351616,376704,14983168,14991360,14999552,14987264,14995456,15003648,15020032,15048704,15050752,15052800,15054848,856448,856448,894336
.long 768,896,57344,172032,618496,704512,6381568,6529024,6382592,6530048,6385664,6533120,6386688,6534144,768,28672,77824,78080,79872,80128,229376,0,0,0,0,0,3704320,3790336,3876352,0,49152,0,4704,12896,152,26656,135168,33984,33792,4392448,45056,12961792,172544,34304,4624,21008,0,0,0,12,0,4294967295,1,0,1049336022,3584,512,115200,229888,57856,172544,287232,1376768,512,25600,50688,75776,6651904,6660096,6668288,6656000,6664192,6672384,6750208,6766592,6768640,6770688,6772736,101120,101248,559488
.long 115456,115584,57344,172032,706560,620544,6531072,6383616,6532096,6384640,6535168,6387712,6536192,6388736,201472,28672,78336,78592,80384,80640,229376,0,0,0,0,0,3962368,4048384,4134400,12288,59392,6144,4712,12904,152,26664,135680,34000,33792,4478464,45312,13109248,179712,34368,4720,21136,0,0,0,12,0,4294967295,1,6144,1049336022,3584,344576,459264,573952,401920,516608,631296,1434112,100864,125952,151040,176128,6676480,6684672,6692864,6680576,6688768,6696960,6754304,6774784,6776832,6778880,6780928,151296,151424,570240
.long 768,896,57344,172032,790528,876544,6677504,6824960,6676480,6823936,6681600,6829056,6680576,6828032,402176,28672,78080,77824,80128,79872,229376,0,0,0,0,0,4220416,4306432,4392448,24576,69632,12288,4720,12912,152,26672,135176,34016,34304,4564480,45568,13256704,186880,34432,4816,21264,0,0,0,12,0,4294967295,1,12288,1049336022,3584,688640,803328,918016,745984,860672,975360,1491456,201216,226304,251392,276480,6701056,6709248,6717440,6705152,6713344,6721536,6758400,6782976,6785024,6787072,6789120,101120,101248,580992
.long 115456,115584,57344,172032,878592,792576,6827008,6679552,6825984,6678528,6831104,6683648,6830080,6682624,602880,28672,78592,78336,80640,80384,229376,0,0,0,0,0,4478464,4564480,4650496,36864,79872,18432,4728,12920,152,26680,135688,34032,34304,4650496,45824,13404160,194048,34496,4912,21392,0,0,0,12,0,4294967295,1,18432,1049336022,3584,1032704,1147392,1262080,1090048,1204736,1319424,1548800,301568,326656,351744,376832,6725632,6733824,6742016,6729728,6737920,6746112,6762496,6791168,6793216,6795264,6797312,151296,151424,591744
.long 768,896,57344,172032,3371008,3457024,11100160,11247616,11101184,11248640,11104256,11251712,11105280,11252736,803584,28672,77824,78080,79872,80128,229376,0,0,0,0,0,3707904,3793920,3879936,0,49152,0,8800,16992,1176,26720,136192,42176,41984,4396032,45056,12965888,401920,36352,5648,22032,0,0,0,12,0,4294967295,1,0,1049336022,3584,512,115200,229888,57856,172544,287232,1376768,512,25600,50688,75776,7831552,7839744,7847936,7835648,7843840,7852032,7929856,7946240,7948288,7950336,7952384,903936,904064,903552
.long 115456,115584,57344,172032,3459072,3373056,11249664,11102208,11250688,11103232,11253760,11106304,11254784,11107328,1004288,28672,78336,78592,80384,80640,229376,0,0,0,0,0,3965952,4051968,4137984,12288,59392,6144,8808,17000,1176,26728,136704,42192,41984,4482048,45312,13113344,409088,36416,5744,22160,0,0,0,12,0,4294967295,1,6144,1049336022,3584,344576,459264,573952,401920,516608,631296,1434112,100864,125952,151040,176128,7856128,7864320,7872512,7860224,7868416,7876608,7933952,7954432,7956480,7958528,7960576,954112,954240,914304
.long 768,896,57344,172032,3543040,3629056,11396096,11543552,11395072,11542528,11400192,11547648,11399168,11546624,1204992,28672,78080,77824,80128,79872,229376,0,0,0,0,0,4224000,4310016,4396032,24576,69632,12288,8816,17008,1176,26736,136200,42208,42496,4568064,45568,13260800,416256,36480,5840,22288,0,0,0,12,0,4294967295,1,12288,1049336022,3584,688640,803328,918016,745984,860672,975360,1491456,201216,226304,251392,276480,7880704,7888896,7897088,7884800,7892992,7901184,7938048,7962624,7964672,7966720,7968768,903936,904064,925056
.long 115456,115584,57344,172032,3631104,3545088,11545600,11398144,11544576,11397120,11549696,11402240,11548672,11401216,1405696,28672,78592,78336,80640,80384,229376,0,0,0,0,0,4482048,4568064,4654080,36864,79872,18432,8824,17016,1176,26744,136712,42224,42496,4654080,45824,13408256,423424,36544,5936,22416,0,0,0,12,0,4294967295,1,18432,1049336022,3584,1032704,1147392,1262080,1090048,1204736,1319424,1548800,301568,326656,351744,376832,7905280,7913472,7921664,7909376,7917568,7925760,7942144,7970816,7972864,7974912,7976960,954112,954240,935808
.long 1792,1920,57344,172032,634880,720896,6414336,6561792,6415360,6562816,6418432,6565888,6419456,6566912,1792,28672,94208,94464,96256,96512,229376,0,0,0,0,0,3711488,3797504,3883520,0,49152,0,4832,13024,184,26784,151552,34240,33792,4399616,45056,12969984,631296,38400,6672,23056,0,0,0,12,0,4294967295,1,0,1065353216,3584,512,115200,229888,57856,172544,287232,1376768,512,25600,50688,75776,9011200,9019392,9027584,9015296,9023488,9031680,9109504,9125888,9127936,9129984,9132032,102144,102272,560000
.long 116480,116608,57344,172032,722944,636928,6563840,6416384,6564864,6417408,6567936,6420480,6568960,6421504,202496,28672,94720,94976,96768,97024,229376,0,0,0,0,0,3969536,4055552,4141568,12288,59392,6144,4840,13032,184,26792,152064,34256,33792,4485632,45312,13117440,638464,38464,6768,23184,0,0,0,12,0,4294967295,1,6144,1065353216,3584,344576,459264,573952,401920,516608,631296,1434112,100864,125952,151040,176128,9035776,9043968,9052160,9039872,9048064,9056256,9113600,9134080,9136128,9138176,9140224,152320,152448,570752
.long 1792,1920,57344,172032,806912,892928,6710272,6857728,6709248,6856704,6714368,6861824,6713344,6860800,403200,28672,94464,94208,96512,96256,229376,0,0,0,0,0,4227584,4313600,4399616,24576,69632,12288,4848,13040,184,26800,151560,34272,34304,4571648,45568,13264896,645632,38528,6864,23312,0,0,0,12,0,4294967295,1,12288,1065353216,3584,688640,803328,918016,745984,860672,975360,1491456,201216,226304,251392,276480,9060352,9068544,9076736,9064448,9072640,9080832,9117696,9142272,9144320,9146368,9148416,102144,102272,581504
.long 116480,116608,57344,172032,894976,808960,6859776,6712320,6858752,6711296,6863872,6716416,6862848,6715392,603904,28672,94976,94720,97024,96768,229376,0,0,0,0,0,4485632,4571648,4657664,36864,79872,18432,4856,13048,184,26808,152072,34288,34304,4657664,45824,13412352,652800,38592,6960,23440,0,0,0,12,0,4294967295,1,18432,1065353216,3584,1032704,1147392,1262080,1090048,1204736,1319424,1548800,301568,326656,351744,376832,9084928,9093120,9101312,9089024,9097216,9105408,9121792,9150464,9152512,9154560,9156608,152320,152448,592256
.long 1792,1920,57344,172032,3387392,3473408,11132928,11280384,11133952,11281408,11137024,11284480,11138048,11285504,804608,28672,94208,94464,96256,96512,229376,0,0,0,0,0,3715072,3801088,3887104,0,49152,0,8928,17120,1208,26848,152576,42432,41984,4403200,45056,12974080,860672,40448,7696,24080,0,0,0,12,0,4294967295,1,0,1065353216,3584,512,115200,229888,57856,172544,287232,1376768,512,25600,50688,75776,10190848,10199040,10207232,10194944,10203136,10211328,10289152,10305536,10307584,10309632,10311680,904960,905088,904064
.long 116480,116608,57344,172032,3475456,3389440,11282432,11134976,11283456,11136000,11286528,11139072,11287552,11140096,1005312,28672,94720,94976,96768,97024,229376,0,0,0,0,0,3973120,4059136,4145152,12288,59392,6144,8936,17128,1208,26856,153088,42448,41984,4489216,45312,13121536,867840,40512,7792,24208,0,0,0,12,0,4294967295,1,6144,1065353216,3584,344576,459264,573952,401920,516608,631296,1434112,100864,125952,151040,176128,10215424,10223616,10231808,10219520,10227712,10235904,10293248,10313728,10315776,10317824,10319872,955136,955264,914816
.long 1792,1920,57344,172032,3559424,3645440,11428864,11576320,11427840,11575296,11432960,11580416,11431936,11579392,1206016,28672,94464,94208,96512,96256,229376,0,0,0,0,0,4231168,4317184,4403200,24576,69632,12288,8944,17136,1208,26864,152584,42464,42496,4575232,45568,13268992,875008,40576,7888,24336,0,0,0,12,0,4294967295,1,12288,1065353216,3584,688640,803328,918016,745984,860672,975360,1491456,201216,226304,251392,276480,10240000,10248192,10256384,10244096,10252288,10260480,10297344,10321920,10323968,10326016,10328064,904960,905088,925568
.long 116480,116608,57344,172032,3647488,3561472,11578368,11430912,11577344,11429888,11582464,11435008,11581440,11433984,1406720,28672,94976,94720,97024,96768,229376,0,0,0,0,0,4489216,4575232,4661248,36864,79872,18432,8952,17144,1208,26872,153096,42480,42496,4661248,45824,13416448,882176,40640,7984,24464,0,0,0,12,0,4294967295,1,18432,1065353216,3584,1032704,1147392,1262080,1090048,1204736,1319424,1548800,301568,326656,351744,376832,10264576,10272768,10280960,10268672,10276864,10285056,10301440,10330112,10332160,10334208,10336256,955136,955264,936320
.long 2816,2944,57344,172032,651264,737280,6447104,6594560,6448128,6595584,6451200,6598656,6452224,6599680,2816,28672,110592,110848,112640,112896,229376,0,0,0,0,0,3718656,3804672,3890688,0,49152,0,4960,13152,216,26912,167936,34496,33792,4406784,45056,12978176,1090048,42496,8720,25104,0,0,0,12,0,4294967295,1,0,1065353216,3584,512,115200,229888,57856,172544,287232,1376768,512,25600,50688,75776,11370496,11378688,11386880,11374592,11382784,11390976,11468800,11485184,11487232,11489280,11491328,103168,103296,560512
.long 117504,117632,57344,172032,739328,653312,6596608,6449152,6597632,6450176,6600704,6453248,6601728,6454272,203520,28672,111104,111360,113152,113408,229376,0,0,0,0,0,3976704,4062720,4148736,12288,59392,6144,4968,13160,216,26920,168448,34512,33792,4492800,45312,13125632,1097216,42560,8816,25232,0,0,0,12,0,4294967295,1,6144,1065353216,3584,344576,459264,573952,401920,516608,631296,1434112,100864,125952,151040,176128,11395072,11403264,11411456,11399168,11407360,11415552,11472896,11493376,11495424,11497472,11499520,153344,153472,571264
.long 2816,2944,57344,172032,823296,909312,6743040,6890496,6742016,6889472,6747136,6894592,6746112,6893568,404224,28672,110848,110592,112896,112640,229376,0,0,0,0,0,4234752,4320768,4406784,24576,69632,12288,4976,13168,216,26928,167944,34528,34304,4578816,45568,13273088,1104384,42624,8912,25360,0,0,0,12,0,4294967295,1,12288,1065353216,3584,688640,803328,918016,745984,860672,975360,1491456,201216,226304,251392,276480,11419648,11427840,11436032,11423744,11431936,11440128,11476992,11501568,11503616,11505664,11507712,103168,103296,582016
.long 117504,117632,57344,172032,911360,825344,6892544,6745088,6891520,6744064,6896640,6749184,6895616,6748160,604928,28672,111360,111104,113408,113152,229376,0,0,0,0,0,4492800,4578816,4664832,36864,79872,18432,4984,13176,216,26936,168456,34544,34304,4664832,45824,13420544,1111552,42688,9008,25488,0,0,0,12,0,4294967295,1,18432,1065353216,3584,1032704,1147392,1262080,1090048,1204736,1319424,1548800,301568,326656,351744,376832,11444224,11452416,11460608,11448320,11456512,11464704,11481088,11509760,11511808,11513856,11515904,153344,153472,592768
.long 2816,2944,57344,172032,3403776,3489792,11165696,11313152,11166720,11314176,11169792,11317248,11170816,11318272,805632,28672,110592,110848,112640,112896,229376,0,0,0,0,0,3722240,3808256,3894272,0,49152,0,9056,17248,1240,26976,168960,42688,41984,4410368,45056,12982272,1319424,44544,9744,26128,0,0,0,12,0,4294967295,1,0,1065353216,3584,512,115200,229888,57856,172544,287232,1376768,512,25600,50688,75776,12550144,12558336,12566528,12554240,12562432,12570624,12648448,12664832,12666880,12668928,12670976,905984,906112,904576
.long 117504,117632,57344,172032,3491840,3405824,11315200,11167744,11316224,11168768,11319296,11171840,11320320,11172864,1006336,28672,111104,111360,113152,113408,229376,0,0,0,0,0,3980288,4066304,4152320,12288,59392,6144,9064,17256,1240,26984,169472,42704,41984,4496384,45312,13129728,1326592,44608,9840,26256,0,0,0,12,0,4294967295,1,6144,1065353216,3584,344576,459264,573952,401920,516608,631296,1434112,100864,125952,151040,176128,12574720,12582912,12591104,12578816,12587008,12595200,12652544,12673024,12675072,12677120,12679168,956160,956288,915328
.long 2816,2944,57344,172032,3575808,3661824,11461632,11609088,11460608,11608064,11465728,11613184,11464704,11612160,1207040,28672,110848,110592,112896,112640,229376,0,0,0,0,0,4238336,4324352,4410368,24576,69632,12288,9072,17264,1240,26992,168968,42720,42496,4582400,45568,13277184,1333760,44672,9936,26384,0,0,0,12,0,4294967295,1,12288,1065353216,3584,688640,803328,918016,745984,860672,975360,1491456,201216,226304,251392,276480,12599296,12607488,12615680,12603392,12611584,12619776,12656640,12681216,12683264,12685312,12687360,905984,906112,926080
.long 117504,117632,57344,172032,3663872,3577856,11611136,11463680,11610112,11462656,11615232,11467776,11614208,11466752,1407744,28672,111360,111104,113408,113152,229376,0,0,0,0,0,4496384,4582400,4668416,36864,79872,18432,9080,17272,1240,27000,169480,42736,42496,4668416,45824,13424640,1340928,44736,10032,26512,0,0,0,12,0,4294967295,1,18432,1065353216,3584,1032704,1147392,1262080,1090048,1204736,1319424,1548800,301568,326656,351744,376832,12623872,12632064,12640256,12627968,12636160,12644352,12660736,12689408,12691456,12693504,12695552,956160,956288,936832
.long 3456,3456,57344,172032,667648,753664,1073741824,1073741824,1073741824,1073741824,6467584,6615040,6468608,6616064,3456,28672,120832,121088,120832,121088,229376,0,0,0,0,0,3725824,3811840,3897856,0,49152,0,5088,13280,248,27040,178176,34752,33792,4413952,45056,12986368,1548800,46592,10768,27152,0,0,0,12,0,4294967295,1,0,1065353216,3584,512,115200,229888,57856,172544,287232,1376768,512,25600,50688,75776,13729792,13737984,13746176,13733888,13742080,13750272,13828096,13844480,13846528,13848576,13850624,103808,103808,561024
.long 118144,118144,57344,172032,755712,669696,1073741824,1073741824,1073741824,1073741824,6617088,6469632,6618112,6470656,204160,28672,121344,121600,121344,121600,229376,0,0,0,0,0,3983872,4069888,4155904,12288,59392,6144,5096,13288,248,27048,178688,34768,33792,4499968,45312,13133824,1555968,46656,10864,27280,0,0,0,12,0,4294967295,1,6144,1065353216,3584,344576,459264,573952,401920,516608,631296,1434112,100864,125952,151040,176128,13754368,13762560,13770752,13758464,13766656,13774848,13832192,13852672,13854720,13856768,13858816,153984,153984,571776
.long 3456,3456,57344,172032,839680,925696,1073741824,1073741824,1073741824,1073741824,6763520,6910976,6762496,6909952,404864,28672,121088,120832,121088,120832,229376,0,0,0,0,0,4241920,4327936,4413952,24576,69632,12288,5104,13296,248,27056,178184,34784,34304,4585984,45568,13281280,1563136,46720,10960,27408,0,0,0,12,0,4294967295,1,12288,1065353216,3584,688640,803328,918016,745984,860672,975360,1491456,201216,226304,251392,276480,13778944,13787136,13795328,13783040,13791232,13799424,13836288,13860864,13862912,13864960,13867008,103808,103808,582528
.long 118144,118144,57344,172032,927744,841728,1073741824,1073741824,1073741824,1073741824,6913024,6765568,6912000,6764544,605568,28672,121600,121344,121600,121344,229376,0,0,0,0,0,4499968,4585984,4672000,36864,79872,18432,5112,13304,248,27064,178696,34800,34304,4672000,45824,13428736,1570304,46784,11056,27536,0,0,0,12,0,4294967295,1,18432,1065353216,3584,1032704,1147392,1262080,1090048,1204736,1319424,1548800,301568,326656,351744,376832,13803520,13811712,13819904,13807616,13815808,13824000,13840384,13869056,13871104,13873152,13875200,153984,153984,593280
.long 3456,3456,57344,172032,3420160,3506176,1073741824,1073741824,1073741824,1073741824,11186176,11333632,11187200,11334656,806272,28672,120832,121088,120832,121088,229376,0,0,0,0,0,3729408,3815424,3901440,0,49152,0,9184,17376,1272,27104,179200,42944,41984,4417536,45056,12990464,1778176,48640,11792,28176,0,0,0,12,0,4294967295,1,0,1065353216,3584,512,115200,229888,57856,172544,287232,1376768,512,25600,50688,75776,14909440,14917632,14925824,14913536,14921728,14929920,15007744,15024128,15026176,15028224,15030272,906624,906624,905088
.long 118144,118144,57344,172032,3508224,3422208,1073741824,1073741824,1073741824,1073741824,11335680,11188224,11336704,11189248,1006976,28672,121344,121600,121344,121600,229376,0,0,0,0,0,3987456,4073472,4159488,12288,59392,6144,9192,17384,1272,27112,179712,42960,41984,4503552,45312,13137920,1785344,48704,11888,28304,0,0,0,12,0,4294967295,1,6144,1065353216,3584,344576,459264,573952,401920,516608,631296,1434112,100864,125952,151040,176128,14934016,14942208,14950400,14938112,14946304,14954496,15011840,15032320,15034368,15036416,15038464,956800,956800,915840
.long 3456,3456,57344,172032,3592192,3678208,1073741824,1073741824,1073741824,1073741824,11482112,11629568,11481088,11628544,1207680,28672,121088,120832,121088,120832,229376,0,0,0,0,0,4245504,4331520,4417536,24576,69632,12288,9200,17392,1272,27120,179208,42976,42496,4589568,45568,13285376,1792512,48768,11984,28432,0,0,0,12,0,4294967295,1,12288,1065353216,3584,688640,803328,918016,745984,860672,975360,1491456,201216,226304,251392,276480,14958592,14966784,14974976,14962688,14970880,14979072,15015936,15040512,15042560,15044608,15046656,906624,906624,926592
.long 118144,118144,57344,172032,3680256,3594240,1073741824,1073741824,1073741824,1073741824,11631616,11484160,11630592,11483136,1408384,28672,121600,121344,121600,121344,229376,0,0,0,0,0,4503552,4589568,4675584,36864,79872,18432,9208,17400,1272,27128,179720,42992,42496,4675584,45824,13432832,1799680,48832,12080,28560,0,0,0,12,0,4294967295,1,18432,1065353216,3584,1032704,1147392,1262080,1090048,1204736,1319424,1548800,301568,326656,351744,376832,14983168,14991360,14999552,14987264,14995456,15003648,15020032,15048704,15050752,15052800,15054848,956800,956800,937344
.long 768,896,57344,172032,962560,1048576,6971392,7118848,6972416,7119872,6975488,7122944,6976512,7123968,896,28672,77824,78080,79872,80128,229376,0,0,0,0,0,4046848,4132864,4218880,0,49152,0,5216,13408,280,27136,79872,35008,34816,4734976,46080,13549568,172672,34304,4624,21008,0,0,0,13,4294967295,0,0,1544,1049336022,3584,640,115328,230016,57984,172672,287360,1376896,640,25728,50816,75904,6651904,6660096,6668288,6656000,6664192,6672384,6750208,6766592,6768640,6770688,6772736,201472,201600,602496
.long 115456,115584,57344,172032,1050624,964608,7120896,6973440,7121920,6974464,7124992,6977536,7126016,6978560,201600,28672,78336,78592,80384,80640,229376,0,0,0,0,0,4304896,4390912,4476928,12288,59392,6144,5224,13416,280,27144,80384,35024,34816,4820992,46336,13697024,179840,34368,4720,21136,0,0,0,13,4294967295,0,0,7688,1049336022,3584,344704,459392,574080,402048,516736,631424,1434240,100992,126080,151168,176256,6676480,6684672,6692864,6680576,6688768,6696960,6754304,6774784,6776832,6778880,6780928,251648,251776,613248
.long 768,896,57344,172032,1134592,1220608,7267328,7414784,7266304,7413760,7271424,7418880,7270400,7417856,402304,28672,78080,77824,80128,79872,229376,0,0,0,0,0,4562944,4648960,4734976,24576,69632,12288,5232,13424,280,27152,79880,35040,35328,4907008,46592,13844480,187008,34432,4816,21264,0,0,0,13,4294967295,0,0,13832,1049336022,3584,688768,803456,918144,746112,860800,975488,1491584,201344,226432,251520,276608,6701056,6709248,6717440,6705152,6713344,6721536,6758400,6782976,6785024,6787072,6789120,201472,201600,624000
.long 115456,115584,57344,172032,1222656,1136640,7416832,7269376,7415808,7268352,7420928,7273472,7419904,7272448,603008,28672,78592,78336,80640,80384,229376,0,0,0,0,0,4820992,4907008,4993024,36864,79872,18432,5240,13432,280,27160,80392,35056,35328,4993024,46848,13991936,194176,34496,4912,21392,0,0,0,13,4294967295,0,0,19976,1049336022,3584,1032832,1147520,1262208,1090176,1204864,1319552,1548928,301696,326784,351872,376960,6725632,6733824,6742016,6729728,6737920,6746112,6762496,6791168,6793216,6795264,6797312,251648,251776,634752
.long 768,896,57344,172032,3715072,3801088,11689984,11837440,11691008,11838464,11694080,11841536,11695104,11842560,803712,28672,77824,78080,79872,80128,229376,0,0,0,0,0,4050432,4136448,4222464,0,49152,0,9312,17504,1304,27200,80896,43200,43008,4738560,46080,13553664,402048,36352,5648,22032,0,0,0,13,4294967295,0,0,1544,1049336022,3584,640,115328,230016,57984,172672,287360,1376896,640,25728,50816,75904,7831552,7839744,7847936,7835648,7843840,7852032,7929856,7946240,7948288,7950336,7952384,1004288,1004416,946560
.long 115456,115584,57344,172032,3803136,3717120,11839488,11692032,11840512,11693056,11843584,11696128,11844608,11697152,1004416,28672,78336,78592,80384,80640,229376,0,0,0,0,0,4308480,4394496,4480512,12288,59392,6144,9320,17512,1304,27208,81408,43216,43008,4824576,46336,13701120,409216,36416,5744,22160,0,0,0,13,4294967295,0,0,7688,1049336022,3584,344704,459392,574080,402048,516736,631424,1434240,100992,126080,151168,176256,7856128,7864320,7872512,7860224,7868416,7876608,7933952,7954432,7956480,7958528,7960576,1054464,1054592,957312
.long 768,896,57344,172032,3887104,3973120,11985920,12133376,11984896,12132352,11990016,12137472,11988992,12136448,1205120,28672,78080,77824,80128,79872,229376,0,0,0,0,0,4566528,4652544,4738560,24576,69632,12288,9328,17520,1304,27216,80904,43232,43520,4910592,46592,13848576,416384,36480,5840,22288,0,0,0,13,4294967295,0,0,13832,1049336022,3584,688768,803456,918144,746112,860800,975488,1491584,201344,226432,251520,276608,7880704,7888896,7897088,7884800,7892992,7901184,7938048,7962624,7964672,7966720,7968768,1004288,1004416,968064
.long 115456,115584,57344,172032,3975168,3889152,12135424,11987968,12134400,11986944,12139520,11992064,12138496,11991040,1405824,28672,78592,78336,80640,80384,229376,0,0,0,0,0,4824576,4910592,4996608,36864,79872,18432,9336,17528,1304,27224,81416,43248,43520,4996608,46848,13996032,423552,36544,5936,22416,0,0,0,13,4294967295,0,0,19976,1049336022,3584,1032832,1147520,1262208,1090176,1204864,1319552,1548928,301696,326784,351872,376960,7905280,7913472,7921664,7909376,7917568,7925760,7942144,7970816,7972864,7974912,7976960,1054464,1054592,978816
.long 1792,1920,57344,172032,978944,1064960,7004160,7151616,7005184,7152640,7008256,7155712,7009280,7156736,1920,28672,94208,94464,96256,96512,229376,0,0,0,0,0,4054016,4140032,4226048,0,49152,0,5344,13536,312,27264,96256,35264,34816,4742144,46080,13557760,631424,38400,6672,23056,0,0,0,13,4294967295,0,0,1544,1065353216,3584,640,115328,230016,57984,172672,287360,1376896,640,25728,50816,75904,9011200,9019392,9027584,9015296,9023488,9031680,9109504,9125888,9127936,9129984,9132032,202496,202624,603008
.long 116480,116608,57344,172032,1067008,980992,7153664,7006208,7154688,7007232,7157760,7010304,7158784,7011328,202624,28672,94720,94976,96768,97024,229376,0,0,0,0,0,4312064,4398080,4484096,12288,59392,6144,5352,13544,312,27272,96768,35280,34816,4828160,46336,13705216,638592,38464,6768,23184,0,0,0,13,4294967295,0,0,7688,1065353216,3584,344704,459392,574080,402048,516736,631424,1434240,100992,126080,151168,176256,9035776,9043968,9052160,9039872,9048064,9056256,9113600,9134080,9136128,9138176,9140224,252672,252800,613760
.long 1792,1920,57344,172032,1150976,1236992,7300096,7447552,7299072,7446528,7304192,7451648,7303168,7450624,403328,28672,94464,94208,96512,96256,229376,0,0,0,0,0,4570112,4656128,4742144,24576,69632,12288,5360,13552,312,27280,96264,35296,35328,4914176,46592,13852672,645760,38528,6864,23312,0,0,0,13,4294967295,0,0,13832,1065353216,3584,688768,803456,918144,746112,860800,975488,1491584,201344,226432,251520,276608,9060352,9068544,9076736,9064448,9072640,9080832,9117696,9142272,9144320,9146368,9148416,202496,202624,624512
.long 116480,116608,57344,172032,1239040,1153024,7449600,7302144,7448576,7301120,7453696,7306240,7452672,7305216,604032,28672,94976,94720,97024,96768,229376,0,0,0,0,0,4828160,4914176,5000192,36864,79872,18432,5368,13560,312,27288,96776,35312,35328,5000192,46848,14000128,652928,38592,6960,23440,0,0,0,13,4294967295,0,0,19976,1065353216,3584,1032832,1147520,1262208,1090176,1204864,1319552,1548928,301696,326784,351872,376960,9084928,9093120,9101312,9089024,9097216,9105408,9121792,9150464,9152512,9154560,9156608,252672,252800,635264
.long 1792,1920,57344,172032,3731456,3817472,11722752,11870208,11723776,11871232,11726848,11874304,11727872,11875328,804736,28672,94208,94464,96256,96512,229376,0,0,0,0,0,4057600,4143616,4229632,0,49152,0,9440,17632,1336,27328,97280,43456,43008,4745728,46080,13561856,860800,40448,7696,24080,0,0,0,13,4294967295,0,0,1544,1065353216,3584,640,115328,230016,57984,172672,287360,1376896,640,25728,50816,75904,10190848,10199040,10207232,10194944,10203136,10211328,10289152,10305536,10307584,10309632,10311680,1005312,1005440,947072
.long 116480,116608,57344,172032,3819520,3733504,11872256,11724800,11873280,11725824,11876352,11728896,11877376,11729920,1005440,28672,94720,94976,96768,97024,229376,0,0,0,0,0,4315648,4401664,4487680,12288,59392,6144,9448,17640,1336,27336,97792,43472,43008,4831744,46336,13709312,867968,40512,7792,24208,0,0,0,13,4294967295,0,0,7688,1065353216,3584,344704,459392,574080,402048,516736,631424,1434240,100992,126080,151168,176256,10215424,10223616,10231808,10219520,10227712,10235904,10293248,10313728,10315776,10317824,10319872,1055488,1055616,957824
.long 1792,1920,57344,172032,3903488,3989504,12018688,12166144,12017664,12165120,12022784,12170240,12021760,12169216,1206144,28672,94464,94208,96512,96256,229376,0,0,0,0,0,4573696,4659712,4745728,24576,69632,12288,9456,17648,1336,27344,97288,43488,43520,4917760,46592,13856768,875136,40576,7888,24336,0,0,0,13,4294967295,0,0,13832,1065353216,3584,688768,803456,918144,746112,860800,975488,1491584,201344,226432,251520,276608,10240000,10248192,10256384,10244096,10252288,10260480,10297344,10321920,10323968,10326016,10328064,1005312,1005440,968576
.long 116480,116608,57344,172032,3991552,3905536,12168192,12020736,12167168,12019712,12172288,12024832,12171264,12023808,1406848,28672,94976,94720,97024,96768,229376,0,0,0,0,0,4831744,4917760,5003776,36864,79872,18432,9464,17656,1336,27352,97800,43504,43520,5003776,46848,14004224,882304,40640,7984,24464,0,0,0,13,4294967295,0,0,19976,1065353216,3584,1032832,1147520,1262208,1090176,1204864,1319552,1548928,301696,326784,351872,376960,10264576,10272768,10280960,10268672,10276864,10285056,10301440,10330112,10332160,10334208,10336256,1055488,1055616,979328
.long 2816,2944,57344,172032,995328,1081344,7036928,7184384,7037952,7185408,7041024,7188480,7042048,7189504,2944,28672,110592,110848,112640,112896,229376,0,0,0,0,0,4061184,4147200,4233216,0,49152,0,5472,13664,344,27392,112640,35520,34816,4749312,46080,13565952,1090176,42496,8720,25104,0,0,0,13,4294967295,0,0,1544,1065353216,3584,640,115328,230016,57984,172672,287360,1376896,640,25728,50816,75904,11370496,11378688,11386880,11374592,11382784,11390976,11468800,11485184,11487232,11489280,11491328,203520,203648,603520
.long 117504,117632,57344,172032,1083392,997376,7186432,7038976,7187456,7040000,7190528,7043072,7191552,7044096,203648,28672,111104,111360,113152,113408,229376,0,0,0,0,0,4319232,4405248,4491264,12288,59392,6144,5480,13672,344,27400,113152,35536,34816,4835328,46336,13713408,1097344,42560,8816,25232,0,0,0,13,4294967295,0,0,7688,1065353216,3584,344704,459392,574080,402048,516736,631424,1434240,100992,126080,151168,176256,11395072,11403264,11411456,11399168,11407360,11415552,11472896,11493376,11495424,11497472,11499520,253696,253824,614272
.long 2816,2944,57344,172032,1167360,1253376,7332864,7480320,7331840,7479296,7336960,7484416,7335936,7483392,404352,28672,110848,110592,112896,112640,229376,0,0,0,0,0,4577280,4663296,4749312,24576,69632,12288,5488,13680,344,27408,112648,35552,35328,4921344,46592,13860864,1104512,42624,8912,25360,0,0,0,13,4294967295,0,0,13832,1065353216,3584,688768,803456,918144,746112,860800,975488,1491584,201344,226432,251520,276608,11419648,11427840,11436032,11423744,11431936,11440128,11476992,11501568,11503616,11505664,11507712,203520,203648,625024
.long 117504,117632,57344,172032,1255424,1169408,7482368,7334912,7481344,7333888,7486464,7339008,7485440,7337984,605056,28672,111360,111104,113408,113152,229376,0,0,0,0,0,4835328,4921344,5007360,36864,79872,18432,5496,13688,344,27416,113160,35568,35328,5007360,46848,14008320,1111680,42688,9008,25488,0,0,0,13,4294967295,0,0,19976,1065353216,3584,1032832,1147520,1262208,1090176,1204864,1319552,1548928,301696,326784,351872,376960,11444224,11452416,11460608,11448320,11456512,11464704,11481088,11509760,11511808,11513856,11515904,253696,253824,635776
.long 2816,2944,57344,172032,3747840,3833856,11755520,11902976,11756544,11904000,11759616,11907072,11760640,11908096,805760,28672,110592,110848,112640,112896,229376,0,0,0,0,0,4064768,4150784,4236800,0,49152,0,9568,17760,1368,27456,113664,43712,43008,4752896,46080,13570048,1319552,44544,9744,26128,0,0,0,13,4294967295,0,0,1544,1065353216,3584,640,115328,230016,57984,172672,287360,1376896,640,25728,50816,75904,12550144,12558336,12566528,12554240,12562432,12570624,12648448,12664832,12666880,12668928,12670976,1006336,1006464,947584
.long 117504,117632,57344,172032,3835904,3749888,11905024,11757568,11906048,11758592,11909120,11761664,11910144,11762688,1006464,28672,111104,111360,113152,113408,229376,0,0,0,0,0,4322816,4408832,4494848,12288,59392,6144,9576,17768,1368,27464,114176,43728,43008,4838912,46336,13717504,1326720,44608,9840,26256,0,0,0,13,4294967295,0,0,7688,1065353216,3584,344704,459392,574080,402048,516736,631424,1434240,100992,126080,151168,176256,12574720,12582912,12591104,12578816,12587008,12595200,12652544,12673024,12675072,12677120,12679168,1056512,1056640,958336
.long 2816,2944,57344,172032,3919872,4005888,12051456,12198912,12050432,12197888,12055552,12203008,12054528,12201984,1207168,28672,110848,110592,112896,112640,229376,0,0,0,0,0,4580864,4666880,4752896,24576,69632,12288,9584,17776,1368,27472,113672,43744,43520,4924928,46592,13864960,1333888,44672,9936,26384,0,0,0,13,4294967295,0,0,13832,1065353216,3584,688768,803456,918144,746112,860800,975488,1491584,201344,226432,251520,276608,12599296,12607488,12615680,12603392,12611584,12619776,12656640,12681216,12683264,12685312,12687360,1006336,1006464,969088
.long 117504,117632,57344,172032,4007936,3921920,12200960,12053504,12199936,12052480,12205056,12057600,12204032,12056576,1407872,28672,111360,111104,113408,113152,229376,0,0,0,0,0,4838912,4924928,5010944,36864,79872,18432,9592,17784,1368,27480,114184,43760,43520,5010944,46848,14012416,1341056,44736,10032,26512,0,0,0,13,4294967295,0,0,19976,1065353216,3584,1032832,1147520,1262208,1090176,1204864,1319552,1548928,301696,326784,351872,376960,12623872,12632064,12640256,12627968,12636160,12644352,12660736,12689408,12691456,12693504,12695552,1056512,1056640,979840
.long 3456,3456,57344,172032,1011712,1097728,1073741824,1073741824,1073741824,1073741824,7057408,7204864,7058432,7205888,3456,28672,120832,121088,120832,121088,229376,0,0,0,0,0,4068352,4154368,4240384,0,49152,0,5600,13792,376,27520,120832,35776,34816,4756480,46080,13574144,1548928,46592,10768,27152,0,0,0,13,4294967295,0,0,1544,1065353216,3584,640,115328,230016,57984,172672,287360,1376896,640,25728,50816,75904,13729792,13737984,13746176,13733888,13742080,13750272,13828096,13844480,13846528,13848576,13850624,204160,204160,604032
.long 118144,118144,57344,172032,1099776,1013760,1073741824,1073741824,1073741824,1073741824,7206912,7059456,7207936,7060480,204160,28672,121344,121600,121344,121600,229376,0,0,0,0,0,4326400,4412416,4498432,12288,59392,6144,5608,13800,376,27528,121344,35792,34816,4842496,46336,13721600,1556096,46656,10864,27280,0,0,0,13,4294967295,0,0,7688,1065353216,3584,344704,459392,574080,402048,516736,631424,1434240,100992,126080,151168,176256,13754368,13762560,13770752,13758464,13766656,13774848,13832192,13852672,13854720,13856768,13858816,254336,254336,614784
.long 3456,3456,57344,172032,1183744,1269760,1073741824,1073741824,1073741824,1073741824,7353344,7500800,7352320,7499776,404864,28672,121088,120832,121088,120832,229376,0,0,0,0,0,4584448,4670464,4756480,24576,69632,12288,5616,13808,376,27536,120840,35808,35328,4928512,46592,13869056,1563264,46720,10960,27408,0,0,0,13,4294967295,0,0,13832,1065353216,3584,688768,803456,918144,746112,860800,975488,1491584,201344,226432,251520,276608,13778944,13787136,13795328,13783040,13791232,13799424,13836288,13860864,13862912,13864960,13867008,204160,204160,625536
.long 118144,118144,57344,172032,1271808,1185792,1073741824,1073741824,1073741824,1073741824,7502848,7355392,7501824,7354368,605568,28672,121600,121344,121600,121344,229376,0,0,0,0,0,4842496,4928512,5014528,36864,79872,18432,5624,13816,376,27544,121352,35824,35328,5014528,46848,14016512,1570432,46784,11056,27536,0,0,0,13,4294967295,0,0,19976,1065353216,3584,1032832,1147520,1262208,1090176,1204864,1319552,1548928,301696,326784,351872,376960,13803520,13811712,13819904,13807616,13815808,13824000,13840384,13869056,13871104,13873152,13875200,254336,254336,636288
.long 3456,3456,57344,172032,3764224,3850240,1073741824,1073741824,1073741824,1073741824,11776000,11923456,11777024,11924480,806272,28672,120832,121088,120832,121088,229376,0,0,0,0,0,4071936,4157952,4243968,0,49152,0,9696,17888,1400,27584,121856,43968,43008,4760064,46080,13578240,1778304,48640,11792,28176,0,0,0,13,4294967295,0,0,1544,1065353216,3584,640,115328,230016,57984,172672,287360,1376896,640,25728,50816,75904,14909440,14917632,14925824,14913536,14921728,14929920,15007744,15024128,15026176,15028224,15030272,1006976,1006976,948096
.long 118144,118144,57344,172032,3852288,3766272,1073741824,1073741824,1073741824,1073741824,11925504,11778048,11926528,11779072,1006976,28672,121344,121600,121344,121600,229376,0,0,0,0,0,4329984,4416000,4502016,12288,59392,6144,9704,17896,1400,27592,122368,43984,43008,4846080,46336,13725696,1785472,48704,11888,28304,0,0,0,13,4294967295,0,0,7688,1065353216,3584,344704,459392,574080,402048,516736,631424,1434240,100992,126080,151168,176256,14934016,14942208,14950400,14938112,14946304,14954496,15011840,15032320,15034368,15036416,15038464,1057152,1057152,958848
.long 3456,3456,57344,172032,3936256,4022272,1073741824,1073741824,1073741824,1073741824,12071936,12219392,12070912,12218368,1207680,28672,121088,120832,121088,120832,229376,0,0,0,0,0,4588032,4674048,4760064,24576,69632,12288,9712,17904,1400,27600,121864,44000,43520,4932096,46592,13873152,1792640,48768,11984,28432,0,0,0,13,4294967295,0,0,13832,1065353216,3584,688768,803456,918144,746112,860800,975488,1491584,201344,226432,251520,276608,14958592,14966784,14974976,14962688,14970880,14979072,15015936,15040512,15042560,15044608,15046656,1006976,1006976,969600
.long 118144,118144,57344,172032,4024320,3938304,1073741824,1073741824,1073741824,1073741824,12221440,12073984,12220416,12072960,1408384,28672,121600,121344,121600,121344,229376,0,0,0,0,0,4846080,4932096,5018112,36864,79872,18432,9720,17912,1400,27608,122376,44016,43520,5018112,46848,14020608,1799808,48832,12080,28560,0,0,0,13,4294967295,0,0,19976,1065353216,3584,1032832,1147520,1262208,1090176,1204864,1319552,1548928,301696,326784,351872,376960,14983168,14991360,14999552,14987264,14995456,15003648,15020032,15048704,15050752,15052800,15054848,1057152,1057152,980352
.long 768,896,57344,172032,1306624,1392640,7561216,7708672,7562240,7709696,7565312,7712768,7566336,7713792,896,28672,77824,78080,79872,80128,229376,0,0,0,0,0,4048384,4134400,4220416,0,49152,0,5728,13920,408,27168,137216,36032,35840,4736512,46080,13551616,172800,34304,4624,21008,0,0,0,13,0,4294967295,1,0,1049336022,3584,768,115456,230144,58112,172800,287488,1377024,768,25856,50944,76032,6651904,6660096,6668288,6656000,6664192,6672384,6750208,6766592,6768640,6770688,6772736,301824,301952,645504
.long 115456,115584,57344,172032,1394688,1308672,7710720,7563264,7711744,7564288,7714816,7567360,7715840,7568384,201600,28672,78336,78592,80384,80640,229376,0,0,0,0,0,4306432,4392448,4478464,12288,59392,6144,5736,13928,408,27176,137728,36048,35840,4822528,46336,13699072,179968,34368,4720,21136,0,0,0,13,0,4294967295,1,6144,1049336022,3584,344832,459520,574208,402176,516864,631552,1434368,101120,126208,151296,176384,6676480,6684672,6692864,6680576,6688768,6696960,6754304,6774784,6776832,6778880,6780928,352000,352128,656256
.long 768,896,57344,172032,1478656,1564672,7857152,8004608,7856128,8003584,7861248,8008704,7860224,8007680,402304,28672,78080,77824,80128,79872,229376,0,0,0,0,0,4564480,4650496,4736512,24576,69632,12288,5744,13936,408,27184,137224,36064,36352,4908544,46592,13846528,187136,34432,4816,21264,0,0,0,13,0,4294967295,1,12288,1049336022,3584,688896,803584,918272,746240,860928,975616,1491712,201472,226560,251648,276736,6701056,6709248,6717440,6705152,6713344,6721536,6758400,6782976,6785024,6787072,6789120,301824,301952,667008
.long 115456,115584,57344,172032,1566720,1480704,8006656,7859200,8005632,7858176,8010752,7863296,8009728,7862272,603008,28672,78592,78336,80640,80384,229376,0,0,0,0,0,4822528,4908544,4994560,36864,79872,18432,5752,13944,408,27192,137736,36080,36352,4994560,46848,13993984,194304,34496,4912,21392,0,0,0,13,0,4294967295,1,18432,1049336022,3584,1032960,1147648,1262336,1090304,1204992,1319680,1549056,301824,326912,352000,377088,6725632,6733824,6742016,6729728,6737920,6746112,6762496,6791168,6793216,6795264,6797312,352000,352128,677760
.long 768,896,57344,172032,4059136,4145152,12279808,12427264,12280832,12428288,12283904,12431360,12284928,12432384,803712,28672,77824,78080,79872,80128,229376,0,0,0,0,0,4051968,4137984,4224000,0,49152,0,9824,18016,1432,27232,138240,44224,44032,4740096,46080,13555712,402176,36352,5648,22032,0,0,0,13,0,4294967295,1,0,1049336022,3584,768,115456,230144,58112,172800,287488,1377024,768,25856,50944,76032,7831552,7839744,7847936,7835648,7843840,7852032,7929856,7946240,7948288,7950336,7952384,1104640,1104768,989568
.long 115456,115584,57344,172032,4147200,4061184,12429312,12281856,12430336,12282880,12433408,12285952,12434432,12286976,1004416,28672,78336,78592,80384,80640,229376,0,0,0,0,0,4310016,4396032,4482048,12288,59392,6144,9832,18024,1432,27240,138752,44240,44032,4826112,46336,13703168,409344,36416,5744,22160,0,0,0,13,0,4294967295,1,6144,1049336022,3584,344832,459520,574208,402176,516864,631552,1434368,101120,126208,151296,176384,7856128,7864320,7872512,7860224,7868416,7876608,7933952,7954432,7956480,7958528,7960576,1154816,1154944,1000320
.long 768,896,57344,172032,4231168,4317184,12575744,12723200,12574720,12722176,12579840,12727296,12578816,12726272,1205120,28672,78080,77824,80128,79872,229376,0,0,0,0,0,4568064,4654080,4740096,24576,69632,12288,9840,18032,1432,27248,138248,44256,44544,4912128,46592,13850624,416512,36480,5840,22288,0,0,0,13,0,4294967295,1,12288,1049336022,3584,688896,803584,918272,746240,860928,975616,1491712,201472,226560,251648,276736,7880704,7888896,7897088,7884800,7892992,7901184,7938048,7962624,7964672,7966720,7968768,1104640,1104768,1011072
.long 115456,115584,57344,172032,4319232,4233216,12725248,12577792,12724224,12576768,12729344,12581888,12728320,12580864,1405824,28672,78592,78336,80640,80384,229376,0,0,0,0,0,4826112,4912128,4998144,36864,79872,18432,9848,18040,1432,27256,138760,44272,44544,4998144,46848,13998080,423680,36544,5936,22416,0,0,0,13,0,4294967295,1,18432,1049336022,3584,1032960,1147648,1262336,1090304,1204992,1319680,1549056,301824,326912,352000,377088,7905280,7913472,7921664,7909376,7917568,7925760,7942144,7970816,7972864,7974912,7976960,1154816,1154944,1021824
.long 1792,1920,57344,172032,1323008,1409024,7593984,7741440,7595008,7742464,7598080,7745536,7599104,7746560,1920,28672,94208,94464,96256,96512,229376,0,0,0,0,0,4055552,4141568,4227584,0,49152,0,5856,14048,440,27296,153600,36288,35840,4743680,46080,13559808,631552,38400,6672,23056,0,0,0,13,0,4294967295,1,0,1065353216,3584,768,115456,230144,58112,172800,287488,1377024,768,25856,50944,76032,9011200,9019392,9027584,9015296,9023488,9031680,9109504,9125888,9127936,9129984,9132032,302848,302976,646016
.long 116480,116608,57344,172032,1411072,1325056,7743488,7596032,7744512,7597056,7747584,7600128,7748608,7601152,202624,28672,94720,94976,96768,97024,229376,0,0,0,0,0,4313600,4399616,4485632,12288,59392,6144,5864,14056,440,27304,154112,36304,35840,4829696,46336,13707264,638720,38464,6768,23184,0,0,0,13,0,4294967295,1,6144,1065353216,3584,344832,459520,574208,402176,516864,631552,1434368,101120,126208,151296,176384,9035776,9043968,9052160,9039872,9048064,9056256,9113600,9134080,9136128,9138176,9140224,353024,353152,656768
.long 1792,1920,57344,172032,1495040,1581056,7889920,8037376,7888896,8036352,7894016,8041472,7892992,8040448,403328,28672,94464,94208,96512,96256,229376,0,0,0,0,0,4571648,4657664,4743680,24576,69632,12288,5872,14064,440,27312,153608,36320,36352,4915712,46592,13854720,645888,38528,6864,23312,0,0,0,13,0,4294967295,1,12288,1065353216,3584,688896,803584,918272,746240,860928,975616,1491712,201472,226560,251648,276736,9060352,9068544,9076736,9064448,9072640,9080832,9117696,9142272,9144320,9146368,9148416,302848,302976,667520
.long 116480,116608,57344,172032,1583104,1497088,8039424,7891968,8038400,7890944,8043520,7896064,8042496,7895040,604032,28672,94976,94720,97024,96768,229376,0,0,0,0,0,4829696,4915712,5001728,36864,79872,18432,5880,14072,440,27320,154120,36336,36352,5001728,46848,14002176,653056,38592,6960,23440,0,0,0,13,0,4294967295,1,18432,1065353216,3584,1032960,1147648,1262336,1090304,1204992,1319680,1549056,301824,326912,352000,377088,9084928,9093120,9101312,9089024,9097216,9105408,9121792,9150464,9152512,9154560,9156608,353024,353152,678272
.long 1792,1920,57344,172032,4075520,4161536,12312576,12460032,12313600,12461056,12316672,12464128,12317696,12465152,804736,28672,94208,94464,96256,96512,229376,0,0,0,0,0,4059136,4145152,4231168,0,49152,0,9952,18144,1464,27360,154624,44480,44032,4747264,46080,13563904,860928,40448,7696,24080,0,0,0,13,0,4294967295,1,0,1065353216,3584,768,115456,230144,58112,172800,287488,1377024,768,25856,50944,76032,10190848,10199040,10207232,10194944,10203136,10211328,10289152,10305536,10307584,10309632,10311680,1105664,1105792,990080
.long 116480,116608,57344,172032,4163584,4077568,12462080,12314624,12463104,12315648,12466176,12318720,12467200,12319744,1005440,28672,94720,94976,96768,97024,229376,0,0,0,0,0,4317184,4403200,4489216,12288,59392,6144,9960,18152,1464,27368,155136,44496,44032,4833280,46336,13711360,868096,40512,7792,24208,0,0,0,13,0,4294967295,1,6144,1065353216,3584,344832,459520,574208,402176,516864,631552,1434368,101120,126208,151296,176384,10215424,10223616,10231808,10219520,10227712,10235904,10293248,10313728,10315776,10317824,10319872,1155840,1155968,1000832
.long 1792,1920,57344,172032,4247552,4333568,12608512,12755968,12607488,12754944,12612608,12760064,12611584,12759040,1206144,28672,94464,94208,96512,96256,229376,0,0,0,0,0,4575232,4661248,4747264,24576,69632,12288,9968,18160,1464,27376,154632,44512,44544,4919296,46592,13858816,875264,40576,7888,24336,0,0,0,13,0,4294967295,1,12288,1065353216,3584,688896,803584,918272,746240,860928,975616,1491712,201472,226560,251648,276736,10240000,10248192,10256384,10244096,10252288,10260480,10297344,10321920,10323968,10326016,10328064,1105664,1105792,1011584
.long 116480,116608,57344,172032,4335616,4249600,12758016,12610560,12756992,12609536,12762112,12614656,12761088,12613632,1406848,28672,94976,94720,97024,96768,229376,0,0,0,0,0,4833280,4919296,5005312,36864,79872,18432,9976,18168,1464,27384,155144,44528,44544,5005312,46848,14006272,882432,40640,7984,24464,0,0,0,13,0,4294967295,1,18432,1065353216,3584,1032960,1147648,1262336,1090304,1204992,1319680,1549056,301824,326912,352000,377088,10264576,10272768,10280960,10268672,10276864,10285056,10301440,10330112,10332160,10334208,10336256,1155840,1155968,1022336
.long 2816,2944,57344,172032,1339392,1425408,7626752,7774208,7627776,7775232,7630848,7778304,7631872,7779328,2944,28672,110592,110848,112640,112896,229376,0,0,0,0,0,4062720,4148736,4234752,0,49152,0,5984,14176,472,27424,169984,36544,35840,4750848,46080,13568000,1090304,42496,8720,25104,0,0,0,13,0,4294967295,1,0,1065353216,3584,768,115456,230144,58112,172800,287488,1377024,768,25856,50944,76032,11370496,11378688,11386880,11374592,11382784,11390976,11468800,11485184,11487232,11489280,11491328,303872,304000,646528
.long 117504,117632,57344,172032,1427456,1341440,7776256,7628800,7777280,7629824,7780352,7632896,7781376,7633920,203648,28672,111104,111360,113152,113408,229376,0,0,0,0,0,4320768,4406784,4492800,12288,59392,6144,5992,14184,472,27432,170496,36560,35840,4836864,46336,13715456,1097472,42560,8816,25232,0,0,0,13,0,4294967295,1,6144,1065353216,3584,344832,459520,574208,402176,516864,631552,1434368,101120,126208,151296,176384,11395072,11403264,11411456,11399168,11407360,11415552,11472896,11493376,11495424,11497472,11499520,354048,354176,657280
.long 2816,2944,57344,172032,1511424,1597440,7922688,8070144,7921664,8069120,7926784,8074240,7925760,8073216,404352,28672,110848,110592,112896,112640,229376,0,0,0,0,0,4578816,4664832,4750848,24576,69632,12288,6000,14192,472,27440,169992,36576,36352,4922880,46592,13862912,1104640,42624,8912,25360,0,0,0,13,0,4294967295,1,12288,1065353216,3584,688896,803584,918272,746240,860928,975616,1491712,201472,226560,251648,276736,11419648,11427840,11436032,11423744,11431936,11440128,11476992,11501568,11503616,11505664,11507712,303872,304000,668032
.long 117504,117632,57344,172032,1599488,1513472,8072192,7924736,8071168,7923712,8076288,7928832,8075264,7927808,605056,28672,111360,111104,113408,113152,229376,0,0,0,0,0,4836864,4922880,5008896,36864,79872,18432,6008,14200,472,27448,170504,36592,36352,5008896,46848,14010368,1111808,42688,9008,25488,0,0,0,13,0,4294967295,1,18432,1065353216,3584,1032960,1147648,1262336,1090304,1204992,1319680,1549056,301824,326912,352000,377088,11444224,11452416,11460608,11448320,11456512,11464704,11481088,11509760,11511808,11513856,11515904,354048,354176,678784
.long 2816,2944,57344,172032,4091904,4177920,12345344,12492800,12346368,12493824,12349440,12496896,12350464,12497920,805760,28672,110592,110848,112640,112896,229376,0,0,0,0,0,4066304,4152320,4238336,0,49152,0,10080,18272,1496,27488,171008,44736,44032,4754432,46080,13572096,1319680,44544,9744,26128,0,0,0,13,0,4294967295,1,0,1065353216,3584,768,115456,230144,58112,172800,287488,1377024,768,25856,50944,76032,12550144,12558336,12566528,12554240,12562432,12570624,12648448,12664832,12666880,12668928,12670976,1106688,1106816,990592
.long 117504,117632,57344,172032,4179968,4093952,12494848,12347392,12495872,12348416,12498944,12351488,12499968,12352512,1006464,28672,111104,111360,113152,113408,229376,0,0,0,0,0,4324352,4410368,4496384,12288,59392,6144,10088,18280,1496,27496,171520,44752,44032,4840448,46336,13719552,1326848,44608,9840,26256,0,0,0,13,0,4294967295,1,6144,1065353216,3584,344832,459520,574208,402176,516864,631552,1434368,101120,126208,151296,176384,12574720,12582912,12591104,12578816,12587008,12595200,12652544,12673024,12675072,12677120,12679168,1156864,1156992,1001344
.long 2816,2944,57344,172032,4263936,4349952,12641280,12788736,12640256,12787712,12645376,12792832,12644352,12791808,1207168,28672,110848,110592,112896,112640,229376,0,0,0,0,0,4582400,4668416,4754432,24576,69632,12288,10096,18288,1496,27504,171016,44768,44544,4926464,46592,13867008,1334016,44672,9936,26384,0,0,0,13,0,4294967295,1,12288,1065353216,3584,688896,803584,918272,746240,860928,975616,1491712,201472,226560,251648,276736,12599296,12607488,12615680,12603392,12611584,12619776,12656640,12681216,12683264,12685312,12687360,1106688,1106816,1012096
.long 117504,117632,57344,172032,4352000,4265984,12790784,12643328,12789760,12642304,12794880,12647424,12793856,12646400,1407872,28672,111360,111104,113408,113152,229376,0,0,0,0,0,4840448,4926464,5012480,36864,79872,18432,10104,18296,1496,27512,171528,44784,44544,5012480,46848,14014464,1341184,44736,10032,26512,0,0,0,13,0,4294967295,1,18432,1065353216,3584,1032960,1147648,1262336,1090304,1204992,1319680,1549056,301824,326912,352000,377088,12623872,12632064,12640256,12627968,12636160,12644352,12660736,12689408,12691456,12693504,12695552,1156864,1156992,1022848
.long 3456,3456,57344,172032,1355776,1441792,1073741824,1073741824,1073741824,1073741824,7647232,7794688,7648256,7795712,3456,28672,120832,121088,120832,121088,229376,0,0,0,0,0,4069888,4155904,4241920,0,49152,0,6112,14304,504,27552,178176,36800,35840,4758016,46080,13576192,1549056,46592,10768,27152,0,0,0,13,0,4294967295,1,0,1065353216,3584,768,115456,230144,58112,172800,287488,1377024,768,25856,50944,76032,13729792,13737984,13746176,13733888,13742080,13750272,13828096,13844480,13846528,13848576,13850624,304512,304512,647040
.long 118144,118144,57344,172032,1443840,1357824,1073741824,1073741824,1073741824,1073741824,7796736,7649280,7797760,7650304,204160,28672,121344,121600,121344,121600,229376,0,0,0,0,0,4327936,4413952,4499968,12288,59392,6144,6120,14312,504,27560,178688,36816,35840,4844032,46336,13723648,1556224,46656,10864,27280,0,0,0,13,0,4294967295,1,6144,1065353216,3584,344832,459520,574208,402176,516864,631552,1434368,101120,126208,151296,176384,13754368,13762560,13770752,13758464,13766656,13774848,13832192,13852672,13854720,13856768,13858816,354688,354688,657792
.long 3456,3456,57344,172032,1527808,1613824,1073741824,1073741824,1073741824,1073741824,7943168,8090624,7942144,8089600,404864,28672,121088,120832,121088,120832,229376,0,0,0,0,0,4585984,4672000,4758016,24576,69632,12288,6128,14320,504,27568,178184,36832,36352,4930048,46592,13871104,1563392,46720,10960,27408,0,0,0,13,0,4294967295,1,12288,1065353216,3584,688896,803584,918272,746240,860928,975616,1491712,201472,226560,251648,276736,13778944,13787136,13795328,13783040,13791232,13799424,13836288,13860864,13862912,13864960,13867008,304512,304512,668544
.long 118144,118144,57344,172032,1615872,1529856,1073741824,1073741824,1073741824,1073741824,8092672,7945216,8091648,7944192,605568,28672,121600,121344,121600,121344,229376,0,0,0,0,0,4844032,4930048,5016064,36864,79872,18432,6136,14328,504,27576,178696,36848,36352,5016064,46848,14018560,1570560,46784,11056,27536,0,0,0,13,0,4294967295,1,18432,1065353216,3584,1032960,1147648,1262336,1090304,1204992,1319680,1549056,301824,326912,352000,377088,13803520,13811712,13819904,13807616,13815808,13824000,13840384,13869056,13871104,13873152,13875200,354688,354688,679296
.long 3456,3456,57344,172032,4108288,4194304,1073741824,1073741824,1073741824,1073741824,12365824,12513280,12366848,12514304,806272,28672,120832,121088,120832,121088,229376,0,0,0,0,0,4073472,4159488,4245504,0,49152,0,10208,18400,1528,27616,179200,44992,44032,4761600,46080,13580288,1778432,48640,11792,28176,0,0,0,13,0,4294967295,1,0,1065353216,3584,768,115456,230144,58112,172800,287488,1377024,768,25856,50944,76032,14909440,14917632,14925824,14913536,14921728,14929920,15007744,15024128,15026176,15028224,15030272,1107328,1107328,991104
.long 118144,118144,57344,172032,4196352,4110336,1073741824,1073741824,1073741824,1073741824,12515328,12367872,12516352,12368896,1006976,28672,121344,121600,121344,121600,229376,0,0,0,0,0,4331520,4417536,4503552,12288,59392,6144,10216,18408,1528,27624,179712,45008,44032,4847616,46336,13727744,1785600,48704,11888,28304,0,0,0,13,0,4294967295,1,6144,1065353216,3584,344832,459520,574208,402176,516864,631552,1434368,101120,126208,151296,176384,14934016,14942208,14950400,14938112,14946304,14954496,15011840,15032320,15034368,15036416,15038464,1157504,1157504,1001856
.long 3456,3456,57344,172032,4280320,4366336,1073741824,1073741824,1073741824,1073741824,12661760,12809216,12660736,12808192,1207680,28672,121088,120832,121088,120832,229376,0,0,0,0,0,4589568,4675584,4761600,24576,69632,12288,10224,18416,1528,27632,179208,45024,44544,4933632,46592,13875200,1792768,48768,11984,28432,0,0,0,13,0,4294967295,1,12288,1065353216,3584,688896,803584,918272,746240,860928,975616,1491712,201472,226560,251648,276736,14958592,14966784,14974976,14962688,14970880,14979072,15015936,15040512,15042560,15044608,15046656,1107328,1107328,1012608
.long 118144,118144,57344,172032,4368384,4282368,1073741824,1073741824,1073741824,1073741824,12811264,12663808,12810240,12662784,1408384,28672,121600,121344,121600,121344,229376,0,0,0,0,0,4847616,4933632,5019648,36864,79872,18432,10232,18424,1528,27640,179720,45040,44544,5019648,46848,14022656,1799936,48832,12080,28560,0,0,0,13,0,4294967295,1,18432,1065353216,3584,1032960,1147648,1262336,1090304,1204992,1319680,1549056,301824,326912,352000,377088,14983168,14991360,14999552,14987264,14995456,15003648,15020032,15048704,15050752,15052800,15054848,1157504,1157504,1023360
.long 768,896,57344,172032,1650688,1736704,8151040,8298496,8152064,8299520,8155136,8302592,8156160,8303616,803584,28672,77824,78080,79872,80128,229376,0,0,0,0,0,4390912,4476928,4562944,0,49152,0,6240,14432,536,27648,78848,37056,36864,5079040,47104,14139392,172800,34304,4624,21008,0,0,0,14,4294967295,0,0,1544,1049336022,3584,768,115456,230144,58112,172800,287488,1377024,768,25856,50944,76032,6651904,6660096,6668288,6656000,6664192,6672384,6750208,6766592,6768640,6770688,6772736,402176,402304,688512
.long 115456,115584,57344,172032,1738752,1652736,8300544,8153088,8301568,8154112,8304640,8157184,8305664,8158208,1004288,28672,78336,78592,80384,80640,229376,0,0,0,0,0,4648960,4734976,4820992,12288,59392,6144,6248,14440,536,27656,79360,37072,36864,5165056,47360,14286848,179968,34368,4720,21136,0,0,0,14,4294967295,0,0,7688,1049336022,3584,344832,459520,574208,402176,516864,631552,1434368,101120,126208,151296,176384,6676480,6684672,6692864,6680576,6688768,6696960,6754304,6774784,6776832,6778880,6780928,452352,452480,699264
.long 768,896,57344,172032,1822720,1908736,8446976,8594432,8445952,8593408,8451072,8598528,8450048,8597504,1204992,28672,78080,77824,80128,79872,229376,0,0,0,0,0,4907008,4993024,5079040,24576,69632,12288,6256,14448,536,27664,78856,37088,37376,5251072,47616,14434304,187136,34432,4816,21264,0,0,0,14,4294967295,0,0,13832,1049336022,3584,688896,803584,918272,746240,860928,975616,1491712,201472,226560,251648,276736,6701056,6709248,6717440,6705152,6713344,6721536,6758400,6782976,6785024,6787072,6789120,402176,402304,710016
.long 115456,115584,57344,172032,1910784,1824768,8596480,8449024,8595456,8448000,8600576,8453120,8599552,8452096,1405696,28672,78592,78336,80640,80384,229376,0,0,0,0,0,5165056,5251072,5337088,36864,79872,18432,6264,14456,536,27672,79368,37104,37376,5337088,47872,14581760,194304,34496,4912,21392,0,0,0,14,4294967295,0,0,19976,1049336022,3584,1032960,1147648,1262336,1090304,1204992,1319680,1549056,301824,326912,352000,377088,6725632,6733824,6742016,6729728,6737920,6746112,6762496,6791168,6793216,6795264,6797312,452352,452480,720768
.long 768,896,57344,172032,4403200,4489216,12869632,13017088,12870656,13018112,12873728,13021184,12874752,13022208,768,28672,77824,78080,79872,80128,229376,0,0,0,0,0,4394496,4480512,4566528,0,49152,0,10336,18528,1560,27712,77824,45248,45056,5082624,47104,14143488,402176,36352,5648,22032,0,0,0,14,4294967295,0,0,1544,1049336022,3584,768,115456,230144,58112,172800,287488,1377024,768,25856,50944,76032,7831552,7839744,7847936,7835648,7843840,7852032,7929856,7946240,7948288,7950336,7952384,1204992,1205120,1032576
.long 115456,115584,57344,172032,4491264,4405248,13019136,12871680,13020160,12872704,13023232,12875776,13024256,12876800,201472,28672,78336,78592,80384,80640,229376,0,0,0,0,0,4652544,4738560,4824576,12288,59392,6144,10344,18536,1560,27720,78336,45264,45056,5168640,47360,14290944,409344,36416,5744,22160,0,0,0,14,4294967295,0,0,7688,1049336022,3584,344832,459520,574208,402176,516864,631552,1434368,101120,126208,151296,176384,7856128,7864320,7872512,7860224,7868416,7876608,7933952,7954432,7956480,7958528,7960576,1255168,1255296,1043328
.long 768,896,57344,172032,4575232,4661248,13165568,13313024,13164544,13312000,13169664,13317120,13168640,13316096,402176,28672,78080,77824,80128,79872,229376,0,0,0,0,0,4910592,4996608,5082624,24576,69632,12288,10352,18544,1560,27728,77832,45280,45568,5254656,47616,14438400,416512,36480,5840,22288,0,0,0,14,4294967295,0,0,13832,1049336022,3584,688896,803584,918272,746240,860928,975616,1491712,201472,226560,251648,276736,7880704,7888896,7897088,7884800,7892992,7901184,7938048,7962624,7964672,7966720,7968768,1204992,1205120,1054080
.long 115456,115584,57344,172032,4663296,4577280,13315072,13167616,13314048,13166592,13319168,13171712,13318144,13170688,602880,28672,78592,78336,80640,80384,229376,0,0,0,0,0,5168640,5254656,5340672,36864,79872,18432,10360,18552,1560,27736,78344,45296,45568,5340672,47872,14585856,423680,36544,5936,22416,0,0,0,14,4294967295,0,0,19976,1049336022,3584,1032960,1147648,1262336,1090304,1204992,1319680,1549056,301824,326912,352000,377088,7905280,7913472,7921664,7909376,7917568,7925760,7942144,7970816,7972864,7974912,7976960,1255168,1255296,1064832
.long 1792,1920,57344,172032,1667072,1753088,8183808,8331264,8184832,8332288,8187904,8335360,8188928,8336384,804608,28672,94208,94464,96256,96512,229376,0,0,0,0,0,4398080,4484096,4570112,0,49152,0,6368,14560,568,27776,95232,37312,36864,5086208,47104,14147584,631552,38400,6672,23056,0,0,0,14,4294967295,0,0,1544,1065353216,3584,768,115456,230144,58112,172800,287488,1377024,768,25856,50944,76032,9011200,9019392,9027584,9015296,9023488,9031680,9109504,9125888,9127936,9129984,9132032,403200,403328,689024
.long 116480,116608,57344,172032,1755136,1669120,8333312,8185856,8334336,8186880,8337408,8189952,8338432,8190976,1005312,28672,94720,94976,96768,97024,229376,0,0,0,0,0,4656128,4742144,4828160,12288,59392,6144,6376,14568,568,27784,95744,37328,36864,5172224,47360,14295040,638720,38464,6768,23184,0,0,0,14,4294967295,0,0,7688,1065353216,3584,344832,459520,574208,402176,516864,631552,1434368,101120,126208,151296,176384,9035776,9043968,9052160,9039872,9048064,9056256,9113600,9134080,9136128,9138176,9140224,453376,453504,699776
.long 1792,1920,57344,172032,1839104,1925120,8479744,8627200,8478720,8626176,8483840,8631296,8482816,8630272,1206016,28672,94464,94208,96512,96256,229376,0,0,0,0,0,4914176,5000192,5086208,24576,69632,12288,6384,14576,568,27792,95240,37344,37376,5258240,47616,14442496,645888,38528,6864,23312,0,0,0,14,4294967295,0,0,13832,1065353216,3584,688896,803584,918272,746240,860928,975616,1491712,201472,226560,251648,276736,9060352,9068544,9076736,9064448,9072640,9080832,9117696,9142272,9144320,9146368,9148416,403200,403328,710528
.long 116480,116608,57344,172032,1927168,1841152,8629248,8481792,8628224,8480768,8633344,8485888,8632320,8484864,1406720,28672,94976,94720,97024,96768,229376,0,0,0,0,0,5172224,5258240,5344256,36864,79872,18432,6392,14584,568,27800,95752,37360,37376,5344256,47872,14589952,653056,38592,6960,23440,0,0,0,14,4294967295,0,0,19976,1065353216,3584,1032960,1147648,1262336,1090304,1204992,1319680,1549056,301824,326912,352000,377088,9084928,9093120,9101312,9089024,9097216,9105408,9121792,9150464,9152512,9154560,9156608,453376,453504,721280
.long 1792,1920,57344,172032,4419584,4505600,12902400,13049856,12903424,13050880,12906496,13053952,12907520,13054976,1792,28672,94208,94464,96256,96512,229376,0,0,0,0,0,4401664,4487680,4573696,0,49152,0,10464,18656,1592,27840,94208,45504,45056,5089792,47104,14151680,860928,40448,7696,24080,0,0,0,14,4294967295,0,0,1544,1065353216,3584,768,115456,230144,58112,172800,287488,1377024,768,25856,50944,76032,10190848,10199040,10207232,10194944,10203136,10211328,10289152,10305536,10307584,10309632,10311680,1206016,1206144,1033088
.long 116480,116608,57344,172032,4507648,4421632,13051904,12904448,13052928,12905472,13056000,12908544,13057024,12909568,202496,28672,94720,94976,96768,97024,229376,0,0,0,0,0,4659712,4745728,4831744,12288,59392,6144,10472,18664,1592,27848,94720,45520,45056,5175808,47360,14299136,868096,40512,7792,24208,0,0,0,14,4294967295,0,0,7688,1065353216,3584,344832,459520,574208,402176,516864,631552,1434368,101120,126208,151296,176384,10215424,10223616,10231808,10219520,10227712,10235904,10293248,10313728,10315776,10317824,10319872,1256192,1256320,1043840
.long 1792,1920,57344,172032,4591616,4677632,13198336,13345792,13197312,13344768,13202432,13349888,13201408,13348864,403200,28672,94464,94208,96512,96256,229376,0,0,0,0,0,4917760,5003776,5089792,24576,69632,12288,10480,18672,1592,27856,94216,45536,45568,5261824,47616,14446592,875264,40576,7888,24336,0,0,0,14,4294967295,0,0,13832,1065353216,3584,688896,803584,918272,746240,860928,975616,1491712,201472,226560,251648,276736,10240000,10248192,10256384,10244096,10252288,10260480,10297344,10321920,10323968,10326016,10328064,1206016,1206144,1054592
.long 116480,116608,57344,172032,4679680,4593664,13347840,13200384,13346816,13199360,13351936,13204480,13350912,13203456,603904,28672,94976,94720,97024,96768,229376,0,0,0,0,0,5175808,5261824,5347840,36864,79872,18432,10488,18680,1592,27864,94728,45552,45568,5347840,47872,14594048,882432,40640,7984,24464,0,0,0,14,4294967295,0,0,19976,1065353216,3584,1032960,1147648,1262336,1090304,1204992,1319680,1549056,301824,326912,352000,377088,10264576,10272768,10280960,10268672,10276864,10285056,10301440,10330112,10332160,10334208,10336256,1256192,1256320,1065344
.long 2816,2944,57344,172032,1683456,1769472,8216576,8364032,8217600,8365056,8220672,8368128,8221696,8369152,805632,28672,110592,110848,112640,112896,229376,0,0,0,0,0,4405248,4491264,4577280,0,49152,0,6496,14688,600,27904,111616,37568,36864,5093376,47104,14155776,1090304,42496,8720,25104,0,0,0,14,4294967295,0,0,1544,1065353216,3584,768,115456,230144,58112,172800,287488,1377024,768,25856,50944,76032,11370496,11378688,11386880,11374592,11382784,11390976,11468800,11485184,11487232,11489280,11491328,404224,404352,689536
.long 117504,117632,57344,172032,1771520,1685504,8366080,8218624,8367104,8219648,8370176,8222720,8371200,8223744,1006336,28672,111104,111360,113152,113408,229376,0,0,0,0,0,4663296,4749312,4835328,12288,59392,6144,6504,14696,600,27912,112128,37584,36864,5179392,47360,14303232,1097472,42560,8816,25232,0,0,0,14,4294967295,0,0,7688,1065353216,3584,344832,459520,574208,402176,516864,631552,1434368,101120,126208,151296,176384,11395072,11403264,11411456,11399168,11407360,11415552,11472896,11493376,11495424,11497472,11499520,454400,454528,700288
.long 2816,2944,57344,172032,1855488,1941504,8512512,8659968,8511488,8658944,8516608,8664064,8515584,8663040,1207040,28672,110848,110592,112896,112640,229376,0,0,0,0,0,4921344,5007360,5093376,24576,69632,12288,6512,14704,600,27920,111624,37600,37376,5265408,47616,14450688,1104640,42624,8912,25360,0,0,0,14,4294967295,0,0,13832,1065353216,3584,688896,803584,918272,746240,860928,975616,1491712,201472,226560,251648,276736,11419648,11427840,11436032,11423744,11431936,11440128,11476992,11501568,11503616,11505664,11507712,404224,404352,711040
.long 117504,117632,57344,172032,1943552,1857536,8662016,8514560,8660992,8513536,8666112,8518656,8665088,8517632,1407744,28672,111360,111104,113408,113152,229376,0,0,0,0,0,5179392,5265408,5351424,36864,79872,18432,6520,14712,600,27928,112136,37616,37376,5351424,47872,14598144,1111808,42688,9008,25488,0,0,0,14,4294967295,0,0,19976,1065353216,3584,1032960,1147648,1262336,1090304,1204992,1319680,1549056,301824,326912,352000,377088,11444224,11452416,11460608,11448320,11456512,11464704,11481088,11509760,11511808,11513856,11515904,454400,454528,721792
.long 2816,2944,57344,172032,4435968,4521984,12935168,13082624,12936192,13083648,12939264,13086720,12940288,13087744,2816,28672,110592,110848,112640,112896,229376,0,0,0,0,0,4408832,4494848,4580864,0,49152,0,10592,18784,1624,27968,110592,45760,45056,5096960,47104,14159872,1319680,44544,9744,26128,0,0,0,14,4294967295,0,0,1544,1065353216,3584,768,115456,230144,58112,172800,287488,1377024,768,25856,50944,76032,12550144,12558336,12566528,12554240,12562432,12570624,12648448,12664832,12666880,12668928,12670976,1207040,1207168,1033600
.long 117504,117632,57344,172032,4524032,4438016,13084672,12937216,13085696,12938240,13088768,12941312,13089792,12942336,203520,28672,111104,111360,113152,113408,229376,0,0,0,0,0,4666880,4752896,4838912,12288,59392,6144,10600,18792,1624,27976,111104,45776,45056,5182976,47360,14307328,1326848,44608,9840,26256,0,0,0,14,4294967295,0,0,7688,1065353216,3584,344832,459520,574208,402176,516864,631552,1434368,101120,126208,151296,176384,12574720,12582912,12591104,12578816,12587008,12595200,12652544,12673024,12675072,12677120,12679168,1257216,1257344,1044352
.long 2816,2944,57344,172032,4608000,4694016,13231104,13378560,13230080,13377536,13235200,13382656,13234176,13381632,404224,28672,110848,110592,112896,112640,229376,0,0,0,0,0,4924928,5010944,5096960,24576,69632,12288,10608,18800,1624,27984,110600,45792,45568,5268992,47616,14454784,1334016,44672,9936,26384,0,0,0,14,4294967295,0,0,13832,1065353216,3584,688896,803584,918272,746240,860928,975616,1491712,201472,226560,251648,276736,12599296,12607488,12615680,12603392,12611584,12619776,12656640,12681216,12683264,12685312,12687360,1207040,1207168,1055104
.long 117504,117632,57344,172032,4696064,4610048,13380608,13233152,13379584,13232128,13384704,13237248,13383680,13236224,604928,28672,111360,111104,113408,113152,229376,0,0,0,0,0,5182976,5268992,5355008,36864,79872,18432,10616,18808,1624,27992,111112,45808,45568,5355008,47872,14602240,1341184,44736,10032,26512,0,0,0,14,4294967295,0,0,19976,1065353216,3584,1032960,1147648,1262336,1090304,1204992,1319680,1549056,301824,326912,352000,377088,12623872,12632064,12640256,12627968,12636160,12644352,12660736,12689408,12691456,12693504,12695552,1257216,1257344,1065856
.long 3456,3456,57344,172032,1699840,1785856,1073741824,1073741824,1073741824,1073741824,8237056,8384512,8238080,8385536,806272,28672,120832,121088,120832,121088,229376,0,0,0,0,0,4412416,4498432,4584448,0,49152,0,6624,14816,632,28032,121856,37824,36864,5100544,47104,14163968,1549056,46592,10768,27152,0,0,0,14,4294967295,0,0,1544,1065353216,3584,768,115456,230144,58112,172800,287488,1377024,768,25856,50944,76032,13729792,13737984,13746176,13733888,13742080,13750272,13828096,13844480,13846528,13848576,13850624,404864,404864,690048
.long 118144,118144,57344,172032,1787904,1701888,1073741824,1073741824,1073741824,1073741824,8386560,8239104,8387584,8240128,1006976,28672,121344,121600,121344,121600,229376,0,0,0,0,0,4670464,4756480,4842496,12288,59392,6144,6632,14824,632,28040,122368,37840,36864,5186560,47360,14311424,1556224,46656,10864,27280,0,0,0,14,4294967295,0,0,7688,1065353216,3584,344832,459520,574208,402176,516864,631552,1434368,101120,126208,151296,176384,13754368,13762560,13770752,13758464,13766656,13774848,13832192,13852672,13854720,13856768,13858816,455040,455040,700800
.long 3456,3456,57344,172032,1871872,1957888,1073741824,1073741824,1073741824,1073741824,8532992,8680448,8531968,8679424,1207680,28672,121088,120832,121088,120832,229376,0,0,0,0,0,4928512,5014528,5100544,24576,69632,12288,6640,14832,632,28048,121864,37856,37376,5272576,47616,14458880,1563392,46720,10960,27408,0,0,0,14,4294967295,0,0,13832,1065353216,3584,688896,803584,918272,746240,860928,975616,1491712,201472,226560,251648,276736,13778944,13787136,13795328,13783040,13791232,13799424,13836288,13860864,13862912,13864960,13867008,404864,404864,711552
.long 118144,118144,57344,172032,1959936,1873920,1073741824,1073741824,1073741824,1073741824,8682496,8535040,8681472,8534016,1408384,28672,121600,121344,121600,121344,229376,0,0,0,0,0,5186560,5272576,5358592,36864,79872,18432,6648,14840,632,28056,122376,37872,37376,5358592,47872,14606336,1570560,46784,11056,27536,0,0,0,14,4294967295,0,0,19976,1065353216,3584,1032960,1147648,1262336,1090304,1204992,1319680,1549056,301824,326912,352000,377088,13803520,13811712,13819904,13807616,13815808,13824000,13840384,13869056,13871104,13873152,13875200,455040,455040,722304
.long 3456,3456,57344,172032,4452352,4538368,1073741824,1073741824,1073741824,1073741824,12955648,13103104,12956672,13104128,3456,28672,120832,121088,120832,121088,229376,0,0,0,0,0,4416000,4502016,4588032,0,49152,0,10720,18912,1656,28096,120832,46016,45056,5104128,47104,14168064,1778432,48640,11792,28176,0,0,0,14,4294967295,0,0,1544,1065353216,3584,768,115456,230144,58112,172800,287488,1377024,768,25856,50944,76032,14909440,14917632,14925824,14913536,14921728,14929920,15007744,15024128,15026176,15028224,15030272,1207680,1207680,1034112
.long 118144,118144,57344,172032,4540416,4454400,1073741824,1073741824,1073741824,1073741824,13105152,12957696,13106176,12958720,204160,28672,121344,121600,121344,121600,229376,0,0,0,0,0,4674048,4760064,4846080,12288,59392,6144,10728,18920,1656,28104,121344,46032,45056,5190144,47360,14315520,1785600,48704,11888,28304,0,0,0,14,4294967295,0,0,7688,1065353216,3584,344832,459520,574208,402176,516864,631552,1434368,101120,126208,151296,176384,14934016,14942208,14950400,14938112,14946304,14954496,15011840,15032320,15034368,15036416,15038464,1257856,1257856,1044864
.long 3456,3456,57344,172032,4624384,4710400,1073741824,1073741824,1073741824,1073741824,13251584,13399040,13250560,13398016,404864,28672,121088,120832,121088,120832,229376,0,0,0,0,0,4932096,5018112,5104128,24576,69632,12288,10736,18928,1656,28112,120840,46048,45568,5276160,47616,14462976,1792768,48768,11984,28432,0,0,0,14,4294967295,0,0,13832,1065353216,3584,688896,803584,918272,746240,860928,975616,1491712,201472,226560,251648,276736,14958592,14966784,14974976,14962688,14970880,14979072,15015936,15040512,15042560,15044608,15046656,1207680,1207680,1055616
.long 118144,118144,57344,172032,4712448,4626432,1073741824,1073741824,1073741824,1073741824,13401088,13253632,13400064,13252608,605568,28672,121600,121344,121600,121344,229376,0,0,0,0,0,5190144,5276160,5362176,36864,79872,18432,10744,18936,1656,28120,121352,46064,45568,5362176,47872,14610432,1799936,48832,12080,28560,0,0,0,14,4294967295,0,0,19976,1065353216,3584,1032960,1147648,1262336,1090304,1204992,1319680,1549056,301824,326912,352000,377088,14983168,14991360,14999552,14987264,14995456,15003648,15020032,15048704,15050752,15052800,15054848,1257856,1257856,1066368
.long 768,896,57344,172032,1994752,2080768,8740864,8888320,8741888,8889344,8744960,8892416,8745984,8893440,803584,28672,77824,78080,79872,80128,229376,0,0,0,0,0,4392448,4478464,4564480,0,49152,0,6752,14944,664,27680,136192,38080,37888,5080576,47104,14141440,172800,34304,4624,21008,0,0,0,14,0,4294967295,1,0,1049336022,3584,768,115456,230144,58112,172800,287488,1377024,768,25856,50944,76032,6651904,6660096,6668288,6656000,6664192,6672384,6750208,6766592,6768640,6770688,6772736,502528,502656,731520
.long 115456,115584,57344,172032,2082816,1996800,8890368,8742912,8891392,8743936,8894464,8747008,8895488,8748032,1004288,28672,78336,78592,80384,80640,229376,0,0,0,0,0,4650496,4736512,4822528,12288,59392,6144,6760,14952,664,27688,136704,38096,37888,5166592,47360,14288896,179968,34368,4720,21136,0,0,0,14,0,4294967295,1,6144,1049336022,3584,344832,459520,574208,402176,516864,631552,1434368,101120,126208,151296,176384,6676480,6684672,6692864,6680576,6688768,6696960,6754304,6774784,6776832,6778880,6780928,552704,552832,742272
.long 768,896,57344,172032,2166784,2252800,9036800,9184256,9035776,9183232,9040896,9188352,9039872,9187328,1204992,28672,78080,77824,80128,79872,229376,0,0,0,0,0,4908544,4994560,5080576,24576,69632,12288,6768,14960,664,27696,136200,38112,38400,5252608,47616,14436352,187136,34432,4816,21264,0,0,0,14,0,4294967295,1,12288,1049336022,3584,688896,803584,918272,746240,860928,975616,1491712,201472,226560,251648,276736,6701056,6709248,6717440,6705152,6713344,6721536,6758400,6782976,6785024,6787072,6789120,502528,502656,753024
.long 115456,115584,57344,172032,2254848,2168832,9186304,9038848,9185280,9037824,9190400,9042944,9189376,9041920,1405696,28672,78592,78336,80640,80384,229376,0,0,0,0,0,5166592,5252608,5338624,36864,79872,18432,6776,14968,664,27704,136712,38128,38400,5338624,47872,14583808,194304,34496,4912,21392,0,0,0,14,0,4294967295,1,18432,1049336022,3584,1032960,1147648,1262336,1090304,1204992,1319680,1549056,301824,326912,352000,377088,6725632,6733824,6742016,6729728,6737920,6746112,6762496,6791168,6793216,6795264,6797312,552704,552832,763776
.long 768,896,57344,172032,4747264,4833280,13459456,13606912,13460480,13607936,13463552,13611008,13464576,13612032,768,28672,77824,78080,79872,80128,229376,0,0,0,0,0,4396032,4482048,4568064,0,49152,0,10848,19040,1688,27744,135168,46272,46080,5084160,47104,14145536,402176,36352,5648,22032,0,0,0,14,0,4294967295,1,0,1049336022,3584,768,115456,230144,58112,172800,287488,1377024,768,25856,50944,76032,7831552,7839744,7847936,7835648,7843840,7852032,7929856,7946240,7948288,7950336,7952384,1305344,1305472,1075584
.long 115456,115584,57344,172032,4835328,4749312,13608960,13461504,13609984,13462528,13613056,13465600,13614080,13466624,201472,28672,78336,78592,80384,80640,229376,0,0,0,0,0,4654080,4740096,4826112,12288,59392,6144,10856,19048,1688,27752,135680,46288,46080,5170176,47360,14292992,409344,36416,5744,22160,0,0,0,14,0,4294967295,1,6144,1049336022,3584,344832,459520,574208,402176,516864,631552,1434368,101120,126208,151296,176384,7856128,7864320,7872512,7860224,7868416,7876608,7933952,7954432,7956480,7958528,7960576,1355520,1355648,1086336
.long 768,896,57344,172032,4919296,5005312,13755392,13902848,13754368,13901824,13759488,13906944,13758464,13905920,402176,28672,78080,77824,80128,79872,229376,0,0,0,0,0,4912128,4998144,5084160,24576,69632,12288,10864,19056,1688,27760,135176,46304,46592,5256192,47616,14440448,416512,36480,5840,22288,0,0,0,14,0,4294967295,1,12288,1049336022,3584,688896,803584,918272,746240,860928,975616,1491712,201472,226560,251648,276736,7880704,7888896,7897088,7884800,7892992,7901184,7938048,7962624,7964672,7966720,7968768,1305344,1305472,1097088
.long 115456,115584,57344,172032,5007360,4921344,13904896,13757440,13903872,13756416,13908992,13761536,13907968,13760512,602880,28672,78592,78336,80640,80384,229376,0,0,0,0,0,5170176,5256192,5342208,36864,79872,18432,10872,19064,1688,27768,135688,46320,46592,5342208,47872,14587904,423680,36544,5936,22416,0,0,0,14,0,4294967295,1,18432,1049336022,3584,1032960,1147648,1262336,1090304,1204992,1319680,1549056,301824,326912,352000,377088,7905280,7913472,7921664,7909376,7917568,7925760,7942144,7970816,7972864,7974912,7976960,1355520,1355648,1107840
.long 1792,1920,57344,172032,2011136,2097152,8773632,8921088,8774656,8922112,8777728,8925184,8778752,8926208,804608,28672,94208,94464,96256,96512,229376,0,0,0,0,0,4399616,4485632,4571648,0,49152,0,6880,15072,696,27808,152576,38336,37888,5087744,47104,14149632,631552,38400,6672,23056,0,0,0,14,0,4294967295,1,0,1065353216,3584,768,115456,230144,58112,172800,287488,1377024,768,25856,50944,76032,9011200,9019392,9027584,9015296,9023488,9031680,9109504,9125888,9127936,9129984,9132032,503552,503680,732032
.long 116480,116608,57344,172032,2099200,2013184,8923136,8775680,8924160,8776704,8927232,8779776,8928256,8780800,1005312,28672,94720,94976,96768,97024,229376,0,0,0,0,0,4657664,4743680,4829696,12288,59392,6144,6888,15080,696,27816,153088,38352,37888,5173760,47360,14297088,638720,38464,6768,23184,0,0,0,14,0,4294967295,1,6144,1065353216,3584,344832,459520,574208,402176,516864,631552,1434368,101120,126208,151296,176384,9035776,9043968,9052160,9039872,9048064,9056256,9113600,9134080,9136128,9138176,9140224,553728,553856,742784
.long 1792,1920,57344,172032,2183168,2269184,9069568,9217024,9068544,9216000,9073664,9221120,9072640,9220096,1206016,28672,94464,94208,96512,96256,229376,0,0,0,0,0,4915712,5001728,5087744,24576,69632,12288,6896,15088,696,27824,152584,38368,38400,5259776,47616,14444544,645888,38528,6864,23312,0,0,0,14,0,4294967295,1,12288,1065353216,3584,688896,803584,918272,746240,860928,975616,1491712,201472,226560,251648,276736,9060352,9068544,9076736,9064448,9072640,9080832,9117696,9142272,9144320,9146368,9148416,503552,503680,753536
.long 116480,116608,57344,172032,2271232,2185216,9219072,9071616,9218048,9070592,9223168,9075712,9222144,9074688,1406720,28672,94976,94720,97024,96768,229376,0,0,0,0,0,5173760,5259776,5345792,36864,79872,18432,6904,15096,696,27832,153096,38384,38400,5345792,47872,14592000,653056,38592,6960,23440,0,0,0,14,0,4294967295,1,18432,1065353216,3584,1032960,1147648,1262336,1090304,1204992,1319680,1549056,301824,326912,352000,377088,9084928,9093120,9101312,9089024,9097216,9105408,9121792,9150464,9152512,9154560,9156608,553728,553856,764288
.long 1792,1920,57344,172032,4763648,4849664,13492224,13639680,13493248,13640704,13496320,13643776,13497344,13644800,1792,28672,94208,94464,96256,96512,229376,0,0,0,0,0,4403200,4489216,4575232,0,49152,0,10976,19168,1720,27872,151552,46528,46080,5091328,47104,14153728,860928,40448,7696,24080,0,0,0,14,0,4294967295,1,0,1065353216,3584,768,115456,230144,58112,172800,287488,1377024,768,25856,50944,76032,10190848,10199040,10207232,10194944,10203136,10211328,10289152,10305536,10307584,10309632,10311680,1306368,1306496,1076096
.long 116480,116608,57344,172032,4851712,4765696,13641728,13494272,13642752,13495296,13645824,13498368,13646848,13499392,202496,28672,94720,94976,96768,97024,229376,0,0,0,0,0,4661248,4747264,4833280,12288,59392,6144,10984,19176,1720,27880,152064,46544,46080,5177344,47360,14301184,868096,40512,7792,24208,0,0,0,14,0,4294967295,1,6144,1065353216,3584,344832,459520,574208,402176,516864,631552,1434368,101120,126208,151296,176384,10215424,10223616,10231808,10219520,10227712,10235904,10293248,10313728,10315776,10317824,10319872,1356544,1356672,1086848
.long 1792,1920,57344,172032,4935680,5021696,13788160,13935616,13787136,13934592,13792256,13939712,13791232,13938688,403200,28672,94464,94208,96512,96256,229376,0,0,0,0,0,4919296,5005312,5091328,24576,69632,12288,10992,19184,1720,27888,151560,46560,46592,5263360,47616,14448640,875264,40576,7888,24336,0,0,0,14,0,4294967295,1,12288,1065353216,3584,688896,803584,918272,746240,860928,975616,1491712,201472,226560,251648,276736,10240000,10248192,10256384,10244096,10252288,10260480,10297344,10321920,10323968,10326016,10328064,1306368,1306496,1097600
.long 116480,116608,57344,172032,5023744,4937728,13937664,13790208,13936640,13789184,13941760,13794304,13940736,13793280,603904,28672,94976,94720,97024,96768,229376,0,0,0,0,0,5177344,5263360,5349376,36864,79872,18432,11000,19192,1720,27896,152072,46576,46592,5349376,47872,14596096,882432,40640,7984,24464,0,0,0,14,0,4294967295,1,18432,1065353216,3584,1032960,1147648,1262336,1090304,1204992,1319680,1549056,301824,326912,352000,377088,10264576,10272768,10280960,10268672,10276864,10285056,10301440,10330112,10332160,10334208,10336256,1356544,1356672,1108352
.long 2816,2944,57344,172032,2027520,2113536,8806400,8953856,8807424,8954880,8810496,8957952,8811520,8958976,805632,28672,110592,110848,112640,112896,229376,0,0,0,0,0,4406784,4492800,4578816,0,49152,0,7008,15200,728,27936,168960,38592,37888,5094912,47104,14157824,1090304,42496,8720,25104,0,0,0,14,0,4294967295,1,0,1065353216,3584,768,115456,230144,58112,172800,287488,1377024,768,25856,50944,76032,11370496,11378688,11386880,11374592,11382784,11390976,11468800,11485184,11487232,11489280,11491328,504576,504704,732544
.long 117504,117632,57344,172032,2115584,2029568,8955904,8808448,8956928,8809472,8960000,8812544,8961024,8813568,1006336,28672,111104,111360,113152,113408,229376,0,0,0,0,0,4664832,4750848,4836864,12288,59392,6144,7016,15208,728,27944,169472,38608,37888,5180928,47360,14305280,1097472,42560,8816,25232,0,0,0,14,0,4294967295,1,6144,1065353216,3584,344832,459520,574208,402176,516864,631552,1434368,101120,126208,151296,176384,11395072,11403264,11411456,11399168,11407360,11415552,11472896,11493376,11495424,11497472,11499520,554752,554880,743296
.long 2816,2944,57344,172032,2199552,2285568,9102336,9249792,9101312,9248768,9106432,9253888,9105408,9252864,1207040,28672,110848,110592,112896,112640,229376,0,0,0,0,0,4922880,5008896,5094912,24576,69632,12288,7024,15216,728,27952,168968,38624,38400,5266944,47616,14452736,1104640,42624,8912,25360,0,0,0,14,0,4294967295,1,12288,1065353216,3584,688896,803584,918272,746240,860928,975616,1491712,201472,226560,251648,276736,11419648,11427840,11436032,11423744,11431936,11440128,11476992,11501568,11503616,11505664,11507712,504576,504704,754048
.long 117504,117632,57344,172032,2287616,2201600,9251840,9104384,9250816,9103360,9255936,9108480,9254912,9107456,1407744,28672,111360,111104,113408,113152,229376,0,0,0,0,0,5180928,5266944,5352960,36864,79872,18432,7032,15224,728,27960,169480,38640,38400,5352960,47872,14600192,1111808,42688,9008,25488,0,0,0,14,0,4294967295,1,18432,1065353216,3584,1032960,1147648,1262336,1090304,1204992,1319680,1549056,301824,326912,352000,377088,11444224,11452416,11460608,11448320,11456512,11464704,11481088,11509760,11511808,11513856,11515904,554752,554880,764800
.long 2816,2944,57344,172032,4780032,4866048,13524992,13672448,13526016,13673472,13529088,13676544,13530112,13677568,2816,28672,110592,110848,112640,112896,229376,0,0,0,0,0,4410368,4496384,4582400,0,49152,0,11104,19296,1752,28000,167936,46784,46080,5098496,47104,14161920,1319680,44544,9744,26128,0,0,0,14,0,4294967295,1,0,1065353216,3584,768,115456,230144,58112,172800,287488,1377024,768,25856,50944,76032,12550144,12558336,12566528,12554240,12562432,12570624,12648448,12664832,12666880,12668928,12670976,1307392,1307520,1076608
.long 117504,117632,57344,172032,4868096,4782080,13674496,13527040,13675520,13528064,13678592,13531136,13679616,13532160,203520,28672,111104,111360,113152,113408,229376,0,0,0,0,0,4668416,4754432,4840448,12288,59392,6144,11112,19304,1752,28008,168448,46800,46080,5184512,47360,14309376,1326848,44608,9840,26256,0,0,0,14,0,4294967295,1,6144,1065353216,3584,344832,459520,574208,402176,516864,631552,1434368,101120,126208,151296,176384,12574720,12582912,12591104,12578816,12587008,12595200,12652544,12673024,12675072,12677120,12679168,1357568,1357696,1087360
.long 2816,2944,57344,172032,4952064,5038080,13820928,13968384,13819904,13967360,13825024,13972480,13824000,13971456,404224,28672,110848,110592,112896,112640,229376,0,0,0,0,0,4926464,5012480,5098496,24576,69632,12288,11120,19312,1752,28016,167944,46816,46592,5270528,47616,14456832,1334016,44672,9936,26384,0,0,0,14,0,4294967295,1,12288,1065353216,3584,688896,803584,918272,746240,860928,975616,1491712,201472,226560,251648,276736,12599296,12607488,12615680,12603392,12611584,12619776,12656640,12681216,12683264,12685312,12687360,1307392,1307520,1098112
.long 117504,117632,57344,172032,5040128,4954112,13970432,13822976,13969408,13821952,13974528,13827072,13973504,13826048,604928,28672,111360,111104,113408,113152,229376,0,0,0,0,0,5184512,5270528,5356544,36864,79872,18432,11128,19320,1752,28024,168456,46832,46592,5356544,47872,14604288,1341184,44736,10032,26512,0,0,0,14,0,4294967295,1,18432,1065353216,3584,1032960,1147648,1262336,1090304,1204992,1319680,1549056,301824,326912,352000,377088,12623872,12632064,12640256,12627968,12636160,12644352,12660736,12689408,12691456,12693504,12695552,1357568,1357696,1108864
.long 3456,3456,57344,172032,2043904,2129920,1073741824,1073741824,1073741824,1073741824,8826880,8974336,8827904,8975360,806272,28672,120832,121088,120832,121088,229376,0,0,0,0,0,4413952,4499968,4585984,0,49152,0,7136,15328,760,28064,179200,38848,37888,5102080,47104,14166016,1549056,46592,10768,27152,0,0,0,14,0,4294967295,1,0,1065353216,3584,768,115456,230144,58112,172800,287488,1377024,768,25856,50944,76032,13729792,13737984,13746176,13733888,13742080,13750272,13828096,13844480,13846528,13848576,13850624,505216,505216,733056
.long 118144,118144,57344,172032,2131968,2045952,1073741824,1073741824,1073741824,1073741824,8976384,8828928,8977408,8829952,1006976,28672,121344,121600,121344,121600,229376,0,0,0,0,0,4672000,4758016,4844032,12288,59392,6144,7144,15336,760,28072,179712,38864,37888,5188096,47360,14313472,1556224,46656,10864,27280,0,0,0,14,0,4294967295,1,6144,1065353216,3584,344832,459520,574208,402176,516864,631552,1434368,101120,126208,151296,176384,13754368,13762560,13770752,13758464,13766656,13774848,13832192,13852672,13854720,13856768,13858816,555392,555392,743808
.long 3456,3456,57344,172032,2215936,2301952,1073741824,1073741824,1073741824,1073741824,9122816,9270272,9121792,9269248,1207680,28672,121088,120832,121088,120832,229376,0,0,0,0,0,4930048,5016064,5102080,24576,69632,12288,7152,15344,760,28080,179208,38880,38400,5274112,47616,14460928,1563392,46720,10960,27408,0,0,0,14,0,4294967295,1,12288,1065353216,3584,688896,803584,918272,746240,860928,975616,1491712,201472,226560,251648,276736,13778944,13787136,13795328,13783040,13791232,13799424,13836288,13860864,13862912,13864960,13867008,505216,505216,754560
.long 118144,118144,57344,172032,2304000,2217984,1073741824,1073741824,1073741824,1073741824,9272320,9124864,9271296,9123840,1408384,28672,121600,121344,121600,121344,229376,0,0,0,0,0,5188096,5274112,5360128,36864,79872,18432,7160,15352,760,28088,179720,38896,38400,5360128,47872,14608384,1570560,46784,11056,27536,0,0,0,14,0,4294967295,1,18432,1065353216,3584,1032960,1147648,1262336,1090304,1204992,1319680,1549056,301824,326912,352000,377088,13803520,13811712,13819904,13807616,13815808,13824000,13840384,13869056,13871104,13873152,13875200,555392,555392,765312
.long 3456,3456,57344,172032,4796416,4882432,1073741824,1073741824,1073741824,1073741824,13545472,13692928,13546496,13693952,3456,28672,120832,121088,120832,121088,229376,0,0,0,0,0,4417536,4503552,4589568,0,49152,0,11232,19424,1784,28128,178176,47040,46080,5105664,47104,14170112,1778432,48640,11792,28176,0,0,0,14,0,4294967295,1,0,1065353216,3584,768,115456,230144,58112,172800,287488,1377024,768,25856,50944,76032,14909440,14917632,14925824,14913536,14921728,14929920,15007744,15024128,15026176,15028224,15030272,1308032,1308032,1077120
.long 118144,118144,57344,172032,4884480,4798464,1073741824,1073741824,1073741824,1073741824,13694976,13547520,13696000,13548544,204160,28672,121344,121600,121344,121600,229376,0,0,0,0,0,4675584,4761600,4847616,12288,59392,6144,11240,19432,1784,28136,178688,47056,46080,5191680,47360,14317568,1785600,48704,11888,28304,0,0,0,14,0,4294967295,1,6144,1065353216,3584,344832,459520,574208,402176,516864,631552,1434368,101120,126208,151296,176384,14934016,14942208,14950400,14938112,14946304,14954496,15011840,15032320,15034368,15036416,15038464,1358208,1358208,1087872
.long 3456,3456,57344,172032,4968448,5054464,1073741824,1073741824,1073741824,1073741824,13841408,13988864,13840384,13987840,404864,28672,121088,120832,121088,120832,229376,0,0,0,0,0,4933632,5019648,5105664,24576,69632,12288,11248,19440,1784,28144,178184,47072,46592,5277696,47616,14465024,1792768,48768,11984,28432,0,0,0,14,0,4294967295,1,12288,1065353216,3584,688896,803584,918272,746240,860928,975616,1491712,201472,226560,251648,276736,14958592,14966784,14974976,14962688,14970880,14979072,15015936,15040512,15042560,15044608,15046656,1308032,1308032,1098624
.long 118144,118144,57344,172032,5056512,4970496,1073741824,1073741824,1073741824,1073741824,13990912,13843456,13989888,13842432,605568,28672,121600,121344,121600,121344,229376,0,0,0,0,0,5191680,5277696,5363712,36864,79872,18432,11256,19448,1784,28152,178696,47088,46592,5363712,47872,14612480,1799936,48832,12080,28560,0,0,0,14,0,4294967295,1,18432,1065353216,3584,1032960,1147648,1262336,1090304,1204992,1319680,1549056,301824,326912,352000,377088,14983168,14991360,14999552,14987264,14995456,15003648,15020032,15048704,15050752,15052800,15054848,1358208,1358208,1109376
.long 768,896,57344,172032,2338816,2424832,9330688,9478144,9331712,9479168,9334784,9482240,9335808,9483264,803712,28672,77824,78080,79872,80128,229376,0,0,0,0,0,4734976,4820992,4907008,0,49152,0,7264,15456,792,28160,80896,39104,38912,5423104,48128,14729216,172800,34304,4624,21008,0,0,0,15,4294967295,0,0,1544,1049336022,3584,768,115456,230144,58112,172800,287488,1377024,768,25856,50944,76032,6651904,6660096,6668288,6656000,6664192,6672384,6750208,6766592,6768640,6770688,6772736,602880,603008,774528
.long 115456,115584,57344,172032,2426880,2340864,9480192,9332736,9481216,9333760,9484288,9336832,9485312,9337856,1004416,28672,78336,78592,80384,80640,229376,0,0,0,0,0,4993024,5079040,5165056,12288,59392,6144,7272,15464,792,28168,81408,39120,38912,5509120,48384,14876672,179968,34368,4720,21136,0,0,0,15,4294967295,0,0,7688,1049336022,3584,344832,459520,574208,402176,516864,631552,1434368,101120,126208,151296,176384,6676480,6684672,6692864,6680576,6688768,6696960,6754304,6774784,6776832,6778880,6780928,653056,653184,785280
.long 768,896,57344,172032,2510848,2596864,9626624,9774080,9625600,9773056,9630720,9778176,9629696,9777152,1205120,28672,78080,77824,80128,79872,229376,0,0,0,0,0,5251072,5337088,5423104,24576,69632,12288,7280,15472,792,28176,80904,39136,39424,5595136,48640,15024128,187136,34432,4816,21264,0,0,0,15,4294967295,0,0,13832,1049336022,3584,688896,803584,918272,746240,860928,975616,1491712,201472,226560,251648,276736,6701056,6709248,6717440,6705152,6713344,6721536,6758400,6782976,6785024,6787072,6789120,602880,603008,796032
.long 115456,115584,57344,172032,2598912,2512896,9776128,9628672,9775104,9627648,9780224,9632768,9779200,9631744,1405824,28672,78592,78336,80640,80384,229376,0,0,0,0,0,5509120,5595136,5681152,36864,79872,18432,7288,15480,792,28184,81416,39152,39424,5681152,48896,15171584,194304,34496,4912,21392,0,0,0,15,4294967295,0,0,19976,1049336022,3584,1032960,1147648,1262336,1090304,1204992,1319680,1549056,301824,326912,352000,377088,6725632,6733824,6742016,6729728,6737920,6746112,6762496,6791168,6793216,6795264,6797312,653056,653184,806784
.long 768,896,57344,172032,5091328,5177344,14049280,14196736,14050304,14197760,14053376,14200832,14054400,14201856,896,28672,77824,78080,79872,80128,229376,0,0,0,0,0,4738560,4824576,4910592,0,49152,0,11360,19552,1816,28224,79872,47296,47104,5426688,48128,14733312,402176,36352,5648,22032,0,0,0,15,4294967295,0,0,1544,1049336022,3584,768,115456,230144,58112,172800,287488,1377024,768,25856,50944,76032,7831552,7839744,7847936,7835648,7843840,7852032,7929856,7946240,7948288,7950336,7952384,1405696,1405824,1118592
.long 115456,115584,57344,172032,5179392,5093376,14198784,14051328,14199808,14052352,14202880,14055424,14203904,14056448,201600,28672,78336,78592,80384,80640,229376,0,0,0,0,0,4996608,5082624,5168640,12288,59392,6144,11368,19560,1816,28232,80384,47312,47104,5512704,48384,14880768,409344,36416,5744,22160,0,0,0,15,4294967295,0,0,7688,1049336022,3584,344832,459520,574208,402176,516864,631552,1434368,101120,126208,151296,176384,7856128,7864320,7872512,7860224,7868416,7876608,7933952,7954432,7956480,7958528,7960576,1455872,1456000,1129344
.long 768,896,57344,172032,5263360,5349376,14345216,14492672,14344192,14491648,14349312,14496768,14348288,14495744,402304,28672,78080,77824,80128,79872,229376,0,0,0,0,0,5254656,5340672,5426688,24576,69632,12288,11376,19568,1816,28240,79880,47328,47616,5598720,48640,15028224,416512,36480,5840,22288,0,0,0,15,4294967295,0,0,13832,1049336022,3584,688896,803584,918272,746240,860928,975616,1491712,201472,226560,251648,276736,7880704,7888896,7897088,7884800,7892992,7901184,7938048,7962624,7964672,7966720,7968768,1405696,1405824,1140096
.long 115456,115584,57344,172032,5351424,5265408,14494720,14347264,14493696,14346240,14498816,14351360,14497792,14350336,603008,28672,78592,78336,80640,80384,229376,0,0,0,0,0,5512704,5598720,5684736,36864,79872,18432,11384,19576,1816,28248,80392,47344,47616,5684736,48896,15175680,423680,36544,5936,22416,0,0,0,15,4294967295,0,0,19976,1049336022,3584,1032960,1147648,1262336,1090304,1204992,1319680,1549056,301824,326912,352000,377088,7905280,7913472,7921664,7909376,7917568,7925760,7942144,7970816,7972864,7974912,7976960,1455872,1456000,1150848
.long 1792,1920,57344,172032,2355200,2441216,9363456,9510912,9364480,9511936,9367552,9515008,9368576,9516032,804736,28672,94208,94464,96256,96512,229376,0,0,0,0,0,4742144,4828160,4914176,0,49152,0,7392,15584,824,28288,97280,39360,38912,5430272,48128,14737408,631552,38400,6672,23056,0,0,0,15,4294967295,0,0,1544,1065353216,3584,768,115456,230144,58112,172800,287488,1377024,768,25856,50944,76032,9011200,9019392,9027584,9015296,9023488,9031680,9109504,9125888,9127936,9129984,9132032,603904,604032,775040
.long 116480,116608,57344,172032,2443264,2357248,9512960,9365504,9513984,9366528,9517056,9369600,9518080,9370624,1005440,28672,94720,94976,96768,97024,229376,0,0,0,0,0,5000192,5086208,5172224,12288,59392,6144,7400,15592,824,28296,97792,39376,38912,5516288,48384,14884864,638720,38464,6768,23184,0,0,0,15,4294967295,0,0,7688,1065353216,3584,344832,459520,574208,402176,516864,631552,1434368,101120,126208,151296,176384,9035776,9043968,9052160,9039872,9048064,9056256,9113600,9134080,9136128,9138176,9140224,654080,654208,785792
.long 1792,1920,57344,172032,2527232,2613248,9659392,9806848,9658368,9805824,9663488,9810944,9662464,9809920,1206144,28672,94464,94208,96512,96256,229376,0,0,0,0,0,5258240,5344256,5430272,24576,69632,12288,7408,15600,824,28304,97288,39392,39424,5602304,48640,15032320,645888,38528,6864,23312,0,0,0,15,4294967295,0,0,13832,1065353216,3584,688896,803584,918272,746240,860928,975616,1491712,201472,226560,251648,276736,9060352,9068544,9076736,9064448,9072640,9080832,9117696,9142272,9144320,9146368,9148416,603904,604032,796544
.long 116480,116608,57344,172032,2615296,2529280,9808896,9661440,9807872,9660416,9812992,9665536,9811968,9664512,1406848,28672,94976,94720,97024,96768,229376,0,0,0,0,0,5516288,5602304,5688320,36864,79872,18432,7416,15608,824,28312,97800,39408,39424,5688320,48896,15179776,653056,38592,6960,23440,0,0,0,15,4294967295,0,0,19976,1065353216,3584,1032960,1147648,1262336,1090304,1204992,1319680,1549056,301824,326912,352000,377088,9084928,9093120,9101312,9089024,9097216,9105408,9121792,9150464,9152512,9154560,9156608,654080,654208,807296
.long 1792,1920,57344,172032,5107712,5193728,14082048,14229504,14083072,14230528,14086144,14233600,14087168,14234624,1920,28672,94208,94464,96256,96512,229376,0,0,0,0,0,4745728,4831744,4917760,0,49152,0,11488,19680,1848,28352,96256,47552,47104,5433856,48128,14741504,860928,40448,7696,24080,0,0,0,15,4294967295,0,0,1544,1065353216,3584,768,115456,230144,58112,172800,287488,1377024,768,25856,50944,76032,10190848,10199040,10207232,10194944,10203136,10211328,10289152,10305536,10307584,10309632,10311680,1406720,1406848,1119104
.long 116480,116608,57344,172032,5195776,5109760,14231552,14084096,14232576,14085120,14235648,14088192,14236672,14089216,202624,28672,94720,94976,96768,97024,229376,0,0,0,0,0,5003776,5089792,5175808,12288,59392,6144,11496,19688,1848,28360,96768,47568,47104,5519872,48384,14888960,868096,40512,7792,24208,0,0,0,15,4294967295,0,0,7688,1065353216,3584,344832,459520,574208,402176,516864,631552,1434368,101120,126208,151296,176384,10215424,10223616,10231808,10219520,10227712,10235904,10293248,10313728,10315776,10317824,10319872,1456896,1457024,1129856
.long 1792,1920,57344,172032,5279744,5365760,14377984,14525440,14376960,14524416,14382080,14529536,14381056,14528512,403328,28672,94464,94208,96512,96256,229376,0,0,0,0,0,5261824,5347840,5433856,24576,69632,12288,11504,19696,1848,28368,96264,47584,47616,5605888,48640,15036416,875264,40576,7888,24336,0,0,0,15,4294967295,0,0,13832,1065353216,3584,688896,803584,918272,746240,860928,975616,1491712,201472,226560,251648,276736,10240000,10248192,10256384,10244096,10252288,10260480,10297344,10321920,10323968,10326016,10328064,1406720,1406848,1140608
.long 116480,116608,57344,172032,5367808,5281792,14527488,14380032,14526464,14379008,14531584,14384128,14530560,14383104,604032,28672,94976,94720,97024,96768,229376,0,0,0,0,0,5519872,5605888,5691904,36864,79872,18432,11512,19704,1848,28376,96776,47600,47616,5691904,48896,15183872,882432,40640,7984,24464,0,0,0,15,4294967295,0,0,19976,1065353216,3584,1032960,1147648,1262336,1090304,1204992,1319680,1549056,301824,326912,352000,377088,10264576,10272768,10280960,10268672,10276864,10285056,10301440,10330112,10332160,10334208,10336256,1456896,1457024,1151360
.long 2816,2944,57344,172032,2371584,2457600,9396224,9543680,9397248,9544704,9400320,9547776,9401344,9548800,805760,28672,110592,110848,112640,112896,229376,0,0,0,0,0,4749312,4835328,4921344,0,49152,0,7520,15712,856,28416,113664,39616,38912,5437440,48128,14745600,1090304,42496,8720,25104,0,0,0,15,4294967295,0,0,1544,1065353216,3584,768,115456,230144,58112,172800,287488,1377024,768,25856,50944,76032,11370496,11378688,11386880,11374592,11382784,11390976,11468800,11485184,11487232,11489280,11491328,604928,605056,775552
.long 117504,117632,57344,172032,2459648,2373632,9545728,9398272,9546752,9399296,9549824,9402368,9550848,9403392,1006464,28672,111104,111360,113152,113408,229376,0,0,0,0,0,5007360,5093376,5179392,12288,59392,6144,7528,15720,856,28424,114176,39632,38912,5523456,48384,14893056,1097472,42560,8816,25232,0,0,0,15,4294967295,0,0,7688,1065353216,3584,344832,459520,574208,402176,516864,631552,1434368,101120,126208,151296,176384,11395072,11403264,11411456,11399168,11407360,11415552,11472896,11493376,11495424,11497472,11499520,655104,655232,786304
.long 2816,2944,57344,172032,2543616,2629632,9692160,9839616,9691136,9838592,9696256,9843712,9695232,9842688,1207168,28672,110848,110592,112896,112640,229376,0,0,0,0,0,5265408,5351424,5437440,24576,69632,12288,7536,15728,856,28432,113672,39648,39424,5609472,48640,15040512,1104640,42624,8912,25360,0,0,0,15,4294967295,0,0,13832,1065353216,3584,688896,803584,918272,746240,860928,975616,1491712,201472,226560,251648,276736,11419648,11427840,11436032,11423744,11431936,11440128,11476992,11501568,11503616,11505664,11507712,604928,605056,797056
.long 117504,117632,57344,172032,2631680,2545664,9841664,9694208,9840640,9693184,9845760,9698304,9844736,9697280,1407872,28672,111360,111104,113408,113152,229376,0,0,0,0,0,5523456,5609472,5695488,36864,79872,18432,7544,15736,856,28440,114184,39664,39424,5695488,48896,15187968,1111808,42688,9008,25488,0,0,0,15,4294967295,0,0,19976,1065353216,3584,1032960,1147648,1262336,1090304,1204992,1319680,1549056,301824,326912,352000,377088,11444224,11452416,11460608,11448320,11456512,11464704,11481088,11509760,11511808,11513856,11515904,655104,655232,807808
.long 2816,2944,57344,172032,5124096,5210112,14114816,14262272,14115840,14263296,14118912,14266368,14119936,14267392,2944,28672,110592,110848,112640,112896,229376,0,0,0,0,0,4752896,4838912,4924928,0,49152,0,11616,19808,1880,28480,112640,47808,47104,5441024,48128,14749696,1319680,44544,9744,26128,0,0,0,15,4294967295,0,0,1544,1065353216,3584,768,115456,230144,58112,172800,287488,1377024,768,25856,50944,76032,12550144,12558336,12566528,12554240,12562432,12570624,12648448,12664832,12666880,12668928,12670976,1407744,1407872,1119616
.long 117504,117632,57344,172032,5212160,5126144,14264320,14116864,14265344,14117888,14268416,14120960,14269440,14121984,203648,28672,111104,111360,113152,113408,229376,0,0,0,0,0,5010944,5096960,5182976,12288,59392,6144,11624,19816,1880,28488,113152,47824,47104,5527040,48384,14897152,1326848,44608,9840,26256,0,0,0,15,4294967295,0,0,7688,1065353216,3584,344832,459520,574208,402176,516864,631552,1434368,101120,126208,151296,176384,12574720,12582912,12591104,12578816,12587008,12595200,12652544,12673024,12675072,12677120,12679168,1457920,1458048,1130368
.long 2816,2944,57344,172032,5296128,5382144,14410752,14558208,14409728,14557184,14414848,14562304,14413824,14561280,404352,28672,110848,110592,112896,112640,229376,0,0,0,0,0,5268992,5355008,5441024,24576,69632,12288,11632,19824,1880,28496,112648,47840,47616,5613056,48640,15044608,1334016,44672,9936,26384,0,0,0,15,4294967295,0,0,13832,1065353216,3584,688896,803584,918272,746240,860928,975616,1491712,201472,226560,251648,276736,12599296,12607488,12615680,12603392,12611584,12619776,12656640,12681216,12683264,12685312,12687360,1407744,1407872,1141120
.long 117504,117632,57344,172032,5384192,5298176,14560256,14412800,14559232,14411776,14564352,14416896,14563328,14415872,605056,28672,111360,111104,113408,113152,229376,0,0,0,0,0,5527040,5613056,5699072,36864,79872,18432,11640,19832,1880,28504,113160,47856,47616,5699072,48896,15192064,1341184,44736,10032,26512,0,0,0,15,4294967295,0,0,19976,1065353216,3584,1032960,1147648,1262336,1090304,1204992,1319680,1549056,301824,326912,352000,377088,12623872,12632064,12640256,12627968,12636160,12644352,12660736,12689408,12691456,12693504,12695552,1457920,1458048,1151872
.long 3456,3456,57344,172032,2387968,2473984,1073741824,1073741824,1073741824,1073741824,9416704,9564160,9417728,9565184,806272,28672,120832,121088,120832,121088,229376,0,0,0,0,0,4756480,4842496,4928512,0,49152,0,7648,15840,888,28544,121856,39872,38912,5444608,48128,14753792,1549056,46592,10768,27152,0,0,0,15,4294967295,0,0,1544,1065353216,3584,768,115456,230144,58112,172800,287488,1377024,768,25856,50944,76032,13729792,13737984,13746176,13733888,13742080,13750272,13828096,13844480,13846528,13848576,13850624,605568,605568,776064
.long 118144,118144,57344,172032,2476032,2390016,1073741824,1073741824,1073741824,1073741824,9566208,9418752,9567232,9419776,1006976,28672,121344,121600,121344,121600,229376,0,0,0,0,0,5014528,5100544,5186560,12288,59392,6144,7656,15848,888,28552,122368,39888,38912,5530624,48384,14901248,1556224,46656,10864,27280,0,0,0,15,4294967295,0,0,7688,1065353216,3584,344832,459520,574208,402176,516864,631552,1434368,101120,126208,151296,176384,13754368,13762560,13770752,13758464,13766656,13774848,13832192,13852672,13854720,13856768,13858816,655744,655744,786816
.long 3456,3456,57344,172032,2560000,2646016,1073741824,1073741824,1073741824,1073741824,9712640,9860096,9711616,9859072,1207680,28672,121088,120832,121088,120832,229376,0,0,0,0,0,5272576,5358592,5444608,24576,69632,12288,7664,15856,888,28560,121864,39904,39424,5616640,48640,15048704,1563392,46720,10960,27408,0,0,0,15,4294967295,0,0,13832,1065353216,3584,688896,803584,918272,746240,860928,975616,1491712,201472,226560,251648,276736,13778944,13787136,13795328,13783040,13791232,13799424,13836288,13860864,13862912,13864960,13867008,605568,605568,797568
.long 118144,118144,57344,172032,2648064,2562048,1073741824,1073741824,1073741824,1073741824,9862144,9714688,9861120,9713664,1408384,28672,121600,121344,121600,121344,229376,0,0,0,0,0,5530624,5616640,5702656,36864,79872,18432,7672,15864,888,28568,122376,39920,39424,5702656,48896,15196160,1570560,46784,11056,27536,0,0,0,15,4294967295,0,0,19976,1065353216,3584,1032960,1147648,1262336,1090304,1204992,1319680,1549056,301824,326912,352000,377088,13803520,13811712,13819904,13807616,13815808,13824000,13840384,13869056,13871104,13873152,13875200,655744,655744,808320
.long 3456,3456,57344,172032,5140480,5226496,1073741824,1073741824,1073741824,1073741824,14135296,14282752,14136320,14283776,3456,28672,120832,121088,120832,121088,229376,0,0,0,0,0,4760064,4846080,4932096,0,49152,0,11744,19936,1912,28608,120832,48064,47104,5448192,48128,14757888,1778432,48640,11792,28176,0,0,0,15,4294967295,0,0,1544,1065353216,3584,768,115456,230144,58112,172800,287488,1377024,768,25856,50944,76032,14909440,14917632,14925824,14913536,14921728,14929920,15007744,15024128,15026176,15028224,15030272,1408384,1408384,1120128
.long 118144,118144,57344,172032,5228544,5142528,1073741824,1073741824,1073741824,1073741824,14284800,14137344,14285824,14138368,204160,28672,121344,121600,121344,121600,229376,0,0,0,0,0,5018112,5104128,5190144,12288,59392,6144,11752,19944,1912,28616,121344,48080,47104,5534208,48384,14905344,1785600,48704,11888,28304,0,0,0,15,4294967295,0,0,7688,1065353216,3584,344832,459520,574208,402176,516864,631552,1434368,101120,126208,151296,176384,14934016,14942208,14950400,14938112,14946304,14954496,15011840,15032320,15034368,15036416,15038464,1458560,1458560,1130880
.long 3456,3456,57344,172032,5312512,5398528,1073741824,1073741824,1073741824,1073741824,14431232,14578688,14430208,14577664,404864,28672,121088,120832,121088,120832,229376,0,0,0,0,0,5276160,5362176,5448192,24576,69632,12288,11760,19952,1912,28624,120840,48096,47616,5620224,48640,15052800,1792768,48768,11984,28432,0,0,0,15,4294967295,0,0,13832,1065353216,3584,688896,803584,918272,746240,860928,975616,1491712,201472,226560,251648,276736,14958592,14966784,14974976,14962688,14970880,14979072,15015936,15040512,15042560,15044608,15046656,1408384,1408384,1141632
.long 118144,118144,57344,172032,5400576,5314560,1073741824,1073741824,1073741824,1073741824,14580736,14433280,14579712,14432256,605568,28672,121600,121344,121600,121344,229376,0,0,0,0,0,5534208,5620224,5706240,36864,79872,18432,11768,19960,1912,28632,121352,48112,47616,5706240,48896,15200256,1799936,48832,12080,28560,0,0,0,15,4294967295,0,0,19976,1065353216,3584,1032960,1147648,1262336,1090304,1204992,1319680,1549056,301824,326912,352000,377088,14983168,14991360,14999552,14987264,14995456,15003648,15020032,15048704,15050752,15052800,15054848,1458560,1458560,1152384
.long 768,896,57344,172032,2682880,2768896,9920512,10067968,9921536,10068992,9924608,10072064,9925632,10073088,803712,28672,77824,78080,79872,80128,229376,0,0,0,0,0,4736512,4822528,4908544,0,49152,0,7776,15968,920,28192,138240,40128,39936,5424640,48128,14731264,172800,34304,4624,21008,0,0,0,15,0,4294967295,1,0,1049336022,3584,768,115456,230144,58112,172800,287488,1377024,768,25856,50944,76032,6651904,6660096,6668288,6656000,6664192,6672384,6750208,6766592,6768640,6770688,6772736,703232,703360,817536
.long 115456,115584,57344,172032,2770944,2684928,10070016,9922560,10071040,9923584,10074112,9926656,10075136,9927680,1004416,28672,78336,78592,80384,80640,229376,0,0,0,0,0,4994560,5080576,5166592,12288,59392,6144,7784,15976,920,28200,138752,40144,39936,5510656,48384,14878720,179968,34368,4720,21136,0,0,0,15,0,4294967295,1,6144,1049336022,3584,344832,459520,574208,402176,516864,631552,1434368,101120,126208,151296,176384,6676480,6684672,6692864,6680576,6688768,6696960,6754304,6774784,6776832,6778880,6780928,753408,753536,828288
.long 768,896,57344,172032,2854912,2940928,10216448,10363904,10215424,10362880,10220544,10368000,10219520,10366976,1205120,28672,78080,77824,80128,79872,229376,0,0,0,0,0,5252608,5338624,5424640,24576,69632,12288,7792,15984,920,28208,138248,40160,40448,5596672,48640,15026176,187136,34432,4816,21264,0,0,0,15,0,4294967295,1,12288,1049336022,3584,688896,803584,918272,746240,860928,975616,1491712,201472,226560,251648,276736,6701056,6709248,6717440,6705152,6713344,6721536,6758400,6782976,6785024,6787072,6789120,703232,703360,839040
.long 115456,115584,57344,172032,2942976,2856960,10365952,10218496,10364928,10217472,10370048,10222592,10369024,10221568,1405824,28672,78592,78336,80640,80384,229376,0,0,0,0,0,5510656,5596672,5682688,36864,79872,18432,7800,15992,920,28216,138760,40176,40448,5682688,48896,15173632,194304,34496,4912,21392,0,0,0,15,0,4294967295,1,18432,1049336022,3584,1032960,1147648,1262336,1090304,1204992,1319680,1549056,301824,326912,352000,377088,6725632,6733824,6742016,6729728,6737920,6746112,6762496,6791168,6793216,6795264,6797312,753408,753536,849792
.long 768,896,57344,172032,5435392,5521408,14639104,14786560,14640128,14787584,14643200,14790656,14644224,14791680,896,28672,77824,78080,79872,80128,229376,0,0,0,0,0,4740096,4826112,4912128,0,49152,0,11872,20064,1944,28256,137216,48320,48128,5428224,48128,14735360,402176,36352,5648,22032,0,0,0,15,0,4294967295,1,0,1049336022,3584,768,115456,230144,58112,172800,287488,1377024,768,25856,50944,76032,7831552,7839744,7847936,7835648,7843840,7852032,7929856,7946240,7948288,7950336,7952384,1506048,1506176,1161600
.long 115456,115584,57344,172032,5523456,5437440,14788608,14641152,14789632,14642176,14792704,14645248,14793728,14646272,201600,28672,78336,78592,80384,80640,229376,0,0,0,0,0,4998144,5084160,5170176,12288,59392,6144,11880,20072,1944,28264,137728,48336,48128,5514240,48384,14882816,409344,36416,5744,22160,0,0,0,15,0,4294967295,1,6144,1049336022,3584,344832,459520,574208,402176,516864,631552,1434368,101120,126208,151296,176384,7856128,7864320,7872512,7860224,7868416,7876608,7933952,7954432,7956480,7958528,7960576,1556224,1556352,1172352
.long 768,896,57344,172032,5607424,5693440,14935040,15082496,14934016,15081472,14939136,15086592,14938112,15085568,402304,28672,78080,77824,80128,79872,229376,0,0,0,0,0,5256192,5342208,5428224,24576,69632,12288,11888,20080,1944,28272,137224,48352,48640,5600256,48640,15030272,416512,36480,5840,22288,0,0,0,15,0,4294967295,1,12288,1049336022,3584,688896,803584,918272,746240,860928,975616,1491712,201472,226560,251648,276736,7880704,7888896,7897088,7884800,7892992,7901184,7938048,7962624,7964672,7966720,7968768,1506048,1506176,1183104
.long 115456,115584,57344,172032,5695488,5609472,15084544,14937088,15083520,14936064,15088640,14941184,15087616,14940160,603008,28672,78592,78336,80640,80384,229376,0,0,0,0,0,5514240,5600256,5686272,36864,79872,18432,11896,20088,1944,28280,137736,48368,48640,5686272,48896,15177728,423680,36544,5936,22416,0,0,0,15,0,4294967295,1,18432,1049336022,3584,1032960,1147648,1262336,1090304,1204992,1319680,1549056,301824,326912,352000,377088,7905280,7913472,7921664,7909376,7917568,7925760,7942144,7970816,7972864,7974912,7976960,1556224,1556352,1193856
.long 1792,1920,57344,172032,2699264,2785280,9953280,10100736,9954304,10101760,9957376,10104832,9958400,10105856,804736,28672,94208,94464,96256,96512,229376,0,0,0,0,0,4743680,4829696,4915712,0,49152,0,7904,16096,952,28320,154624,40384,39936,5431808,48128,14739456,631552,38400,6672,23056,0,0,0,15,0,4294967295,1,0,1065353216,3584,768,115456,230144,58112,172800,287488,1377024,768,25856,50944,76032,9011200,9019392,9027584,9015296,9023488,9031680,9109504,9125888,9127936,9129984,9132032,704256,704384,818048
.long 116480,116608,57344,172032,2787328,2701312,10102784,9955328,10103808,9956352,10106880,9959424,10107904,9960448,1005440,28672,94720,94976,96768,97024,229376,0,0,0,0,0,5001728,5087744,5173760,12288,59392,6144,7912,16104,952,28328,155136,40400,39936,5517824,48384,14886912,638720,38464,6768,23184,0,0,0,15,0,4294967295,1,6144,1065353216,3584,344832,459520,574208,402176,516864,631552,1434368,101120,126208,151296,176384,9035776,9043968,9052160,9039872,9048064,9056256,9113600,9134080,9136128,9138176,9140224,754432,754560,828800
.long 1792,1920,57344,172032,2871296,2957312,10249216,10396672,10248192,10395648,10253312,10400768,10252288,10399744,1206144,28672,94464,94208,96512,96256,229376,0,0,0,0,0,5259776,5345792,5431808,24576,69632,12288,7920,16112,952,28336,154632,40416,40448,5603840,48640,15034368,645888,38528,6864,23312,0,0,0,15,0,4294967295,1,12288,1065353216,3584,688896,803584,918272,746240,860928,975616,1491712,201472,226560,251648,276736,9060352,9068544,9076736,9064448,9072640,9080832,9117696,9142272,9144320,9146368,9148416,704256,704384,839552
.long 116480,116608,57344,172032,2959360,2873344,10398720,10251264,10397696,10250240,10402816,10255360,10401792,10254336,1406848,28672,94976,94720,97024,96768,229376,0,0,0,0,0,5517824,5603840,5689856,36864,79872,18432,7928,16120,952,28344,155144,40432,40448,5689856,48896,15181824,653056,38592,6960,23440,0,0,0,15,0,4294967295,1,18432,1065353216,3584,1032960,1147648,1262336,1090304,1204992,1319680,1549056,301824,326912,352000,377088,9084928,9093120,9101312,9089024,9097216,9105408,9121792,9150464,9152512,9154560,9156608,754432,754560,850304
.long 1792,1920,57344,172032,5451776,5537792,14671872,14819328,14672896,14820352,14675968,14823424,14676992,14824448,1920,28672,94208,94464,96256,96512,229376,0,0,0,0,0,4747264,4833280,4919296,0,49152,0,12000,20192,1976,28384,153600,48576,48128,5435392,48128,14743552,860928,40448,7696,24080,0,0,0,15,0,4294967295,1,0,1065353216,3584,768,115456,230144,58112,172800,287488,1377024,768,25856,50944,76032,10190848,10199040,10207232,10194944,10203136,10211328,10289152,10305536,10307584,10309632,10311680,1507072,1507200,1162112
.long 116480,116608,57344,172032,5539840,5453824,14821376,14673920,14822400,14674944,14825472,14678016,14826496,14679040,202624,28672,94720,94976,96768,97024,229376,0,0,0,0,0,5005312,5091328,5177344,12288,59392,6144,12008,20200,1976,28392,154112,48592,48128,5521408,48384,14891008,868096,40512,7792,24208,0,0,0,15,0,4294967295,1,6144,1065353216,3584,344832,459520,574208,402176,516864,631552,1434368,101120,126208,151296,176384,10215424,10223616,10231808,10219520,10227712,10235904,10293248,10313728,10315776,10317824,10319872,1557248,1557376,1172864
.long 1792,1920,57344,172032,5623808,5709824,14967808,15115264,14966784,15114240,14971904,15119360,14970880,15118336,403328,28672,94464,94208,96512,96256,229376,0,0,0,0,0,5263360,5349376,5435392,24576,69632,12288,12016,20208,1976,28400,153608,48608,48640,5607424,48640,15038464,875264,40576,7888,24336,0,0,0,15,0,4294967295,1,12288,1065353216,3584,688896,803584,918272,746240,860928,975616,1491712,201472,226560,251648,276736,10240000,10248192,10256384,10244096,10252288,10260480,10297344,10321920,10323968,10326016,10328064,1507072,1507200,1183616
.long 116480,116608,57344,172032,5711872,5625856,15117312,14969856,15116288,14968832,15121408,14973952,15120384,14972928,604032,28672,94976,94720,97024,96768,229376,0,0,0,0,0,5521408,5607424,5693440,36864,79872,18432,12024,20216,1976,28408,154120,48624,48640,5693440,48896,15185920,882432,40640,7984,24464,0,0,0,15,0,4294967295,1,18432,1065353216,3584,1032960,1147648,1262336,1090304,1204992,1319680,1549056,301824,326912,352000,377088,10264576,10272768,10280960,10268672,10276864,10285056,10301440,10330112,10332160,10334208,10336256,1557248,1557376,1194368
.long 2816,2944,57344,172032,2715648,2801664,9986048,10133504,9987072,10134528,9990144,10137600,9991168,10138624,805760,28672,110592,110848,112640,112896,229376,0,0,0,0,0,4750848,4836864,4922880,0,49152,0,8032,16224,984,28448,171008,40640,39936,5438976,48128,14747648,1090304,42496,8720,25104,0,0,0,15,0,4294967295,1,0,1065353216,3584,768,115456,230144,58112,172800,287488,1377024,768,25856,50944,76032,11370496,11378688,11386880,11374592,11382784,11390976,11468800,11485184,11487232,11489280,11491328,705280,705408,818560
.long 117504,117632,57344,172032,2803712,2717696,10135552,9988096,10136576,9989120,10139648,9992192,10140672,9993216,1006464,28672,111104,111360,113152,113408,229376,0,0,0,0,0,5008896,5094912,5180928,12288,59392,6144,8040,16232,984,28456,171520,40656,39936,5524992,48384,14895104,1097472,42560,8816,25232,0,0,0,15,0,4294967295,1,6144,1065353216,3584,344832,459520,574208,402176,516864,631552,1434368,101120,126208,151296,176384,11395072,11403264,11411456,11399168,11407360,11415552,11472896,11493376,11495424,11497472,11499520,755456,755584,829312
.long 2816,2944,57344,172032,2887680,2973696,10281984,10429440,10280960,10428416,10286080,10433536,10285056,10432512,1207168,28672,110848,110592,112896,112640,229376,0,0,0,0,0,5266944,5352960,5438976,24576,69632,12288,8048,16240,984,28464,171016,40672,40448,5611008,48640,15042560,1104640,42624,8912,25360,0,0,0,15,0,4294967295,1,12288,1065353216,3584,688896,803584,918272,746240,860928,975616,1491712,201472,226560,251648,276736,11419648,11427840,11436032,11423744,11431936,11440128,11476992,11501568,11503616,11505664,11507712,705280,705408,840064
.long 117504,117632,57344,172032,2975744,2889728,10431488,10284032,10430464,10283008,10435584,10288128,10434560,10287104,1407872,28672,111360,111104,113408,113152,229376,0,0,0,0,0,5524992,5611008,5697024,36864,79872,18432,8056,16248,984,28472,171528,40688,40448,5697024,48896,15190016,1111808,42688,9008,25488,0,0,0,15,0,4294967295,1,18432,1065353216,3584,1032960,1147648,1262336,1090304,1204992,1319680,1549056,301824,326912,352000,377088,11444224,11452416,11460608,11448320,11456512,11464704,11481088,11509760,11511808,11513856,11515904,755456,755584,850816
.long 2816,2944,57344,172032,5468160,5554176,14704640,14852096,14705664,14853120,14708736,14856192,14709760,14857216,2944,28672,110592,110848,112640,112896,229376,0,0,0,0,0,4754432,4840448,4926464,0,49152,0,12128,20320,2008,28512,169984,48832,48128,5442560,48128,14751744,1319680,44544,9744,26128,0,0,0,15,0,4294967295,1,0,1065353216,3584,768,115456,230144,58112,172800,287488,1377024,768,25856,50944,76032,12550144,12558336,12566528,12554240,12562432,12570624,12648448,12664832,12666880,12668928,12670976,1508096,1508224,1162624
.long 117504,117632,57344,172032,5556224,5470208,14854144,14706688,14855168,14707712,14858240,14710784,14859264,14711808,203648,28672,111104,111360,113152,113408,229376,0,0,0,0,0,5012480,5098496,5184512,12288,59392,6144,12136,20328,2008,28520,170496,48848,48128,5528576,48384,14899200,1326848,44608,9840,26256,0,0,0,15,0,4294967295,1,6144,1065353216,3584,344832,459520,574208,402176,516864,631552,1434368,101120,126208,151296,176384,12574720,12582912,12591104,12578816,12587008,12595200,12652544,12673024,12675072,12677120,12679168,1558272,1558400,1173376
.long 2816,2944,57344,172032,5640192,5726208,15000576,15148032,14999552,15147008,15004672,15152128,15003648,15151104,404352,28672,110848,110592,112896,112640,229376,0,0,0,0,0,5270528,5356544,5442560,24576,69632,12288,12144,20336,2008,28528,169992,48864,48640,5614592,48640,15046656,1334016,44672,9936,26384,0,0,0,15,0,4294967295,1,12288,1065353216,3584,688896,803584,918272,746240,860928,975616,1491712,201472,226560,251648,276736,12599296,12607488,12615680,12603392,12611584,12619776,12656640,12681216,12683264,12685312,12687360,1508096,1508224,1184128
.long 117504,117632,57344,172032,5728256,5642240,15150080,15002624,15149056,15001600,15154176,15006720,15153152,15005696,605056,28672,111360,111104,113408,113152,229376,0,0,0,0,0,5528576,5614592,5700608,36864,79872,18432,12152,20344,2008,28536,170504,48880,48640,5700608,48896,15194112,1341184,44736,10032,26512,0,0,0,15,0,4294967295,1,18432,1065353216,3584,1032960,1147648,1262336,1090304,1204992,1319680,1549056,301824,326912,352000,377088,12623872,12632064,12640256,12627968,12636160,12644352,12660736,12689408,12691456,12693504,12695552,1558272,1558400,1194880
.long 3456,3456,57344,172032,2732032,2818048,1073741824,1073741824,1073741824,1073741824,10006528,10153984,10007552,10155008,806272,28672,120832,121088,120832,121088,229376,0,0,0,0,0,4758016,4844032,4930048,0,49152,0,8160,16352,1016,28576,179200,40896,39936,5446144,48128,14755840,1549056,46592,10768,27152,0,0,0,15,0,4294967295,1,0,1065353216,3584,768,115456,230144,58112,172800,287488,1377024,768,25856,50944,76032,13729792,13737984,13746176,13733888,13742080,13750272,13828096,13844480,13846528,13848576,13850624,705920,705920,819072
.long 118144,118144,57344,172032,2820096,2734080,1073741824,1073741824,1073741824,1073741824,10156032,10008576,10157056,10009600,1006976,28672,121344,121600,121344,121600,229376,0,0,0,0,0,5016064,5102080,5188096,12288,59392,6144,8168,16360,1016,28584,179712,40912,39936,5532160,48384,14903296,1556224,46656,10864,27280,0,0,0,15,0,4294967295,1,6144,1065353216,3584,344832,459520,574208,402176,516864,631552,1434368,101120,126208,151296,176384,13754368,13762560,13770752,13758464,13766656,13774848,13832192,13852672,13854720,13856768,13858816,756096,756096,829824
.long 3456,3456,57344,172032,2904064,2990080,1073741824,1073741824,1073741824,1073741824,10302464,10449920,10301440,10448896,1207680,28672,121088,120832,121088,120832,229376,0,0,0,0,0,5274112,5360128,5446144,24576,69632,12288,8176,16368,1016,28592,179208,40928,40448,5618176,48640,15050752,1563392,46720,10960,27408,0,0,0,15,0,4294967295,1,12288,1065353216,3584,688896,803584,918272,746240,860928,975616,1491712,201472,226560,251648,276736,13778944,13787136,13795328,13783040,13791232,13799424,13836288,13860864,13862912,13864960,13867008,705920,705920,840576
.long 118144,118144,57344,172032,2992128,2906112,1073741824,1073741824,1073741824,1073741824,10451968,10304512,10450944,10303488,1408384,28672,121600,121344,121600,121344,229376,0,0,0,0,0,5532160,5618176,5704192,36864,79872,18432,8184,16376,1016,28600,179720,40944,40448,5704192,48896,15198208,1570560,46784,11056,27536,0,0,0,15,0,4294967295,1,18432,1065353216,3584,1032960,1147648,1262336,1090304,1204992,1319680,1549056,301824,326912,352000,377088,13803520,13811712,13819904,13807616,13815808,13824000,13840384,13869056,13871104,13873152,13875200,756096,756096,851328
.long 3456,3456,57344,172032,5484544,5570560,1073741824,1073741824,1073741824,1073741824,14725120,14872576,14726144,14873600,3456,28672,120832,121088,120832,121088,229376,0,0,0,0,0,4761600,4847616,4933632,0,49152,0,12256,20448,2040,28640,178176,49088,48128,5449728,48128,14759936,1778432,48640,11792,28176,0,0,0,15,0,4294967295,1,0,1065353216,3584,768,115456,230144,58112,172800,287488,1377024,768,25856,50944,76032,14909440,14917632,14925824,14913536,14921728,14929920,15007744,15024128,15026176,15028224,15030272,1508736,1508736,1163136
.long 118144,118144,57344,172032,5572608,5486592,1073741824,1073741824,1073741824,1073741824,14874624,14727168,14875648,14728192,204160,28672,121344,121600,121344,121600,229376,0,0,0,0,0,5019648,5105664,5191680,12288,59392,6144,12264,20456,2040,28648,178688,49104,48128,5535744,48384,14907392,1785600,48704,11888,28304,0,0,0,15,0,4294967295,1,6144,1065353216,3584,344832,459520,574208,402176,516864,631552,1434368,101120,126208,151296,176384,14934016,14942208,14950400,14938112,14946304,14954496,15011840,15032320,15034368,15036416,15038464,1558912,1558912,1173888
.long 3456,3456,57344,172032,5656576,5742592,1073741824,1073741824,1073741824,1073741824,15021056,15168512,15020032,15167488,404864,28672,121088,120832,121088,120832,229376,0,0,0,0,0,5277696,5363712,5449728,24576,69632,12288,12272,20464,2040,28656,178184,49120,48640,5621760,48640,15054848,1792768,48768,11984,28432,0,0,0,15,0,4294967295,1,12288,1065353216,3584,688896,803584,918272,746240,860928,975616,1491712,201472,226560,251648,276736,14958592,14966784,14974976,14962688,14970880,14979072,15015936,15040512,15042560,15044608,15046656,1508736,1508736,1184640
.long 118144,118144,57344,172032,5744640,5658624,1073741824,1073741824,1073741824,1073741824,15170560,15023104,15169536,15022080,605568,28672,121600,121344,121600,121344,229376,0,0,0,0,0,5535744,5621760,5707776,36864,79872,18432,12280,20472,2040,28664,178696,49136,48640,5707776,48896,15202304,1799936,48832,12080,28560,0,0,0,15,0,4294967295,1,18432,1065353216,3584,1032960,1147648,1262336,1090304,1204992,1319680,1549056,301824,326912,352000,377088,14983168,14991360,14999552,14987264,14995456,15003648,15020032,15048704,15050752,15052800,15054848,1558912,1558912,1195392
.section .rodata,"a"
.p2align 6
.amdhsa_kernel parallel_sum__sliding_block__glu_gated_bilinear__prompt_kernel
  .amdhsa_next_free_vgpr 512
  .amdhsa_next_free_sgpr 102
  .amdhsa_accum_offset 256
  .amdhsa_group_segment_fixed_size 0
  .amdhsa_kernarg_size 80
  .amdhsa_user_sgpr_count 2
  .amdhsa_user_sgpr_kernarg_segment_ptr 1
  .amdhsa_system_sgpr_workgroup_id_x 1
.end_amdhsa_kernel
```
